```python
import torch

def _softmax(x, axis=-1):
    return torch.softmax(x, dim=axis)
def _gelu(x):
    return torch.nn.functional.gelu(x, approximate="tanh")
def _silu(x):
    return torch.nn.functional.silu(x)
def _sigmoid(x):
    return torch.sigmoid(x)
def _layernorm(x, axis=-1, eps=1e-5):
    m = x.mean(dim=axis, keepdim=True)
    v = x.var(dim=axis, keepdim=True, unbiased=False)
    return (x - m) / torch.sqrt(v + eps)
def _scatter_add(tgt, idx, src, axis=0):
    return tgt.clone().index_add_(axis, idx, src)
def _segment_sum(src, seg, n):
    out = torch.zeros((n,) + src.shape[1:], dtype=src.dtype)
    return out.index_add_(0, seg, src)
def _pad(x, pw):
    flat = tuple(v for pair in reversed(pw) for v in pair)
    return torch.nn.functional.pad(x, flat)

kernel_name = 'parallel_sum__linear_kernel_hedgehog__mixer_s_mlp__prompt'

def setup_inputs():

    _w = (lambda a: (lambda t: t.to(torch.bfloat16) if t.is_floating_point() else t)(torch.as_tensor(a)))
    def _A_setup():
        B, S, D, H = 1, 2048, 576, 32
        Dh = D // H
        return {
            "x": _w((lambda *s: torch.randn(*s, dtype=torch.bfloat16) * 0.05)(B, S, D)),
            "wqkv": _w((lambda *s: torch.randn(*s, dtype=torch.bfloat16) * 0.8)(D, 3 * D)),
            "w_phi": _w((lambda *s: torch.randn(*s, dtype=torch.bfloat16) * 0.8)(H, Dh, Dh) * (Dh ** -0.5)),
            "wo": _w((lambda *s: torch.randn(*s, dtype=torch.bfloat16) * 0.1)(D, D)),
        }
    _A_in = _A_setup()

    def _B_setup():
        B, S, D, F = 1, 2048, 576, 4608
        return {
            "x":  _w((lambda *s: torch.randn(*s, dtype=torch.bfloat16) * 0.05)(B, S, D)),
            "w1": _w((lambda *s: torch.randn(*s, dtype=torch.bfloat16) * 3.2)(D, D) * (D ** -0.5)),
            "w2": _w((lambda *s: torch.randn(*s, dtype=torch.bfloat16) * 3.2)(D, D) * (D ** -0.5)),
            "w3": _w((lambda *s: torch.randn(*s, dtype=torch.bfloat16) * 3.2)(D, F) * (D ** -0.5)),
            "w4": _w((lambda *s: torch.randn(*s, dtype=torch.bfloat16) * 3.2)(F, D) * (F ** -0.5)),
        }
    _B_in = _B_setup()

    return {
        "A_x": _A_in["x"],
        "A_wqkv": _A_in["wqkv"],
        "A_w_phi": _A_in["w_phi"],
        "A_wo": _A_in["wo"],
        "B_x": _B_in["x"],
        "B_w1": _B_in["w1"],
        "B_w2": _B_in["w2"],
        "B_w3": _B_in["w3"],
        "B_w4": _B_in["w4"],
    }

def reference(A_x, A_wqkv, A_w_phi, A_wo, B_x, B_w1, B_w2, B_w3, B_w4):
    def _A_ref(x, wqkv, w_phi, wo):
        B, S, D = x.shape
        H = 32; Dh = D // H
        qkv = (lambda x, *d: x.permute(*d))((x @ wqkv).reshape(B, S, 3, H, Dh), 2, 0, 3, 1, 4)
        q, k, v = qkv[0], qkv[1], qkv[2]
        pq = torch.einsum("bhsd,hdf->bhsf", q, w_phi)
        pk = torch.einsum("bhsd,hdf->bhsf", k, w_phi)
        phi_q = torch.concatenate([_softmax(pq, axis=-1), _softmax(-pq, axis=-1)], axis=-1)
        phi_k = torch.concatenate([_softmax(pk, axis=-1), _softmax(-pk, axis=-1)], axis=-1)
        kv = torch.einsum("bhsf,bhsd->bhfd", phi_k, v)
        z  = torch.einsum("bhsf->bhf", phi_k)
        num = torch.einsum("bhqf,bhfd->bhqd", phi_q, kv)
        den = torch.einsum("bhqf,bhf->bhq", phi_q, z)[..., None] + 1e-6
        o = num / den
        return (lambda x, *d: x.permute(*d))(o, 0, 2, 1, 3).reshape(B, S, D) @ wo

    def _B_ref(x, w1, w2, w3, w4):
        B, S, D = x.shape
        h = _gelu(_layernorm(x, axis=-1) @ w1)
        c = D // 4
        g0 = _pad(h[:, :, 0*c:1*c], ((0, 0), (1, 0), (0, 0)))[:, :S, :]
        g1 = _pad(h[:, :, 1*c:2*c], ((0, 0), (0, 1), (0, 0)))[:, 1:, :]
        g2 = _pad(h[:, :, 2*c:3*c], ((0, 0), (2, 0), (0, 0)))[:, :S, :]
        g3 = _pad(h[:, :, 3*c:   ], ((0, 0), (0, 2), (0, 0)))[:, 2:, :]
        hs = torch.concatenate([g0, g1, g2, g3], axis=-1) @ w2
        x1 = x + hs
        h2 = _gelu(_layernorm(x1, axis=-1) @ w3) @ w4
        return x1 + h2

    x = A_x
    xn = _layernorm(x, axis=-1)
    return x + _A_ref(xn, A_wqkv, A_w_phi, A_wo) + _B_ref(xn, B_w1, B_w2, B_w3, B_w4)
```

```asm
; @launch grid=(256,1,1) block=(512,1,1) lds=163840
.amdgcn_target "amdgcn-amd-amdhsa--gfx950"
.set CODE_SLICE, 3072
.text
.globl parallel_sum__linear_kernel_hedgehog__mixer_s_mlp__prompt_kernel
.p2align 8
.type parallel_sum__linear_kernel_hedgehog__mixer_s_mlp__prompt_kernel,@function
parallel_sum__linear_kernel_hedgehog__mixer_s_mlp__prompt_kernel:
    s_cmp_ge_u32 s2, 256
    s_cbranch_scc0 L_go
    s_endpgm
L_go:
    s_load_dwordx2 s[4:5], s[0:1], 0
    s_load_dwordx2 s[44:45], s[0:1], 88
    s_load_dwordx2 s[8:9], s[0:1], 8
    s_load_dwordx2 s[20:21], s[0:1], 40
    v_lshrrev_b32 v1, 6, v0
    v_and_b32 v255, 63, v0
    v_readfirstlane_b32 s48, v1
    v_lshlrev_b32 v254, 4, v255
    s_nop 0
    s_cmp_lg_u32 s48, 1
    s_cbranch_scc1 L_nocp
    s_getpc_b64 s[70:71]
L_pc1:
    s_lshr_b32 s64, s2, 3
    s_mul_i32 s64, s64, CODE_SLICE
    v_lshlrev_b32 v1, 7, v255
    v_min_u32 v1, CODE_SLICE-128, v1
    v_add_u32 v1, s64, v1
    v_min_u32 v1, L_code_end-L_pc1-4, v1
    global_load_dword v225, v1, s[70:71]
L_nocp:
    s_mov_b32 s6, 2359296
    s_mov_b32 s7, 0x20000
    s_mov_b32 s10, 1990656
    s_mov_b32 s11, 0x20000
    s_mov_b32 s14, 20736
    s_mov_b32 s15, 0x20000
    s_mov_b32 s18, 663552
    s_mov_b32 s19, 0x20000
    s_mov_b32 s22, 663552
    s_mov_b32 s23, 0x20000
    s_mov_b32 s26, 663552
    s_mov_b32 s27, 0x20000
    s_mov_b32 s30, 5308416
    s_mov_b32 s31, 0x20000
    s_mov_b32 s34, 5308416
    s_mov_b32 s35, 0x20000
    s_mov_b32 s38, 2359296
    s_mov_b32 s39, 0x20000
    s_mov_b32 s42, 256
    s_mov_b32 s43, 0x20000
    s_mov_b32 s46, 268435456
    s_mov_b32 s47, 0x20000
    s_and_b32 s49, s48, 3
    s_and_b32 s50, s2, 7
    s_lshr_b32 s51, s2, 3
    s_and_b32 s64, s50, 1
    s_lshl_b32 s64, s64, 2
    s_lshr_b32 s65, s51, 3
    s_add_u32 s52, s64, s65
    s_and_b32 s64, s50, 6
    s_bfe_u32 s65, s51, 0x10002
    s_add_u32 s53, s64, s65
    s_and_b32 s54, s51, 3
    s_lshl_b32 s64, s52, 1
    s_lshr_b32 s65, s52, 2
    s_add_u32 s64, s64, s65
    s_add_u32 s3, s64, s51
    s_lshr_b32 s64, s51, 4
    s_and_b32 s65, s48, 4
    s_add_u32 s64, s64, s65
    s_cmp_eq_u32 s64, 4
    s_cbranch_scc1 L_BY
    s_cmp_eq_u32 s64, 1
    s_cbranch_scc1 L_A
    s_cmp_eq_u32 s64, 0
    s_cbranch_scc1 L_BO
L_AY:
    s_lshr_b32 s64, s50, 1
    s_lshl_b32 s64, s64, 2
    s_bfe_u32 s65, s51, 0x20002
    s_add_u32 s56, s64, s65
    s_and_b32 s64, s50, 1
    s_lshl_b32 s64, s64, 2
    s_and_b32 s65, s51, 3
    s_add_u32 s57, s64, s65
    s_setprio 1
    s_and_b32 s94, s56, 1
    s_lshl_b32 s94, s94, 2
    s_lshr_b32 s64, s50, 1
    s_add_u32 s94, s94, s64
    v_lshrrev_b32 v230, 2, v255
    v_mul_u32_u24 v230, 1152, v230
    v_lshrrev_b32 v231, 4, v255
    v_and_b32 v231, 2, v231
    v_xor_b32 v231, v231, v255
    v_and_b32 v231, 3, v231
    v_lshl_add_u32 v224, v231, 4, v230
    s_lshl_b32 s64, s56, 3
    s_add_u32 s64, s64, s49
    s_mul_i32 s64, s64, 18432
    v_add_u32 v224, s64, v224
    s_lshl_b32 s58, s49, 10
    s_mul_i32 s59, s49, 2304
    s_lshr_b32 s64, s49, 1
    s_lshl_b32 s64, s64, 5
    s_and_b32 s65, s49, 1
    s_lshl_b32 s65, s65, 2
    s_add_u32 s64, s64, s65
    s_mul_i32 s64, s64, 3456
    s_mul_i32 s65, s57, 144
    s_add_u32 s64, s64, s65
    v_add_u32 v230, 0, v255
    v_mul_u32_u24 v231, 7282, v230
    v_lshrrev_b32 v231, 16, v231
    v_mul_u32_u24 v232, 9, v231
    v_sub_u32 v230, v230, v232
    v_and_b32 v225, 9, v231
    v_and_b32 v232, 2, v231
    v_lshl_add_u32 v225, v232, 3, v225
    v_bfe_u32 v232, v231, 2, 1
    v_lshl_add_u32 v225, v232, 1, v225
    v_mul_u32_u24 v225, 3456, v225
    v_lshl_add_u32 v225, v230, 4, v225
    v_add_u32 v225, s64, v225
    v_add_u32 v230, 48, v255
    v_mul_u32_u24 v231, 7282, v230
    v_lshrrev_b32 v231, 16, v231
    v_mul_u32_u24 v232, 9, v231
    v_sub_u32 v230, v230, v232
    v_and_b32 v226, 9, v231
    v_and_b32 v232, 2, v231
    v_lshl_add_u32 v226, v232, 3, v226
    v_bfe_u32 v232, v231, 2, 1
    v_lshl_add_u32 v226, v232, 1, v226
    v_mul_u32_u24 v226, 3456, v226
    v_lshl_add_u32 v226, v230, 4, v226
    v_add_u32 v226, s64, v226
    v_add_u32 v230, 96, v255
    v_mul_u32_u24 v231, 7282, v230
    v_lshrrev_b32 v231, 16, v231
    v_mul_u32_u24 v232, 9, v231
    v_sub_u32 v230, v230, v232
    v_and_b32 v227, 9, v231
    v_and_b32 v232, 2, v231
    v_lshl_add_u32 v227, v232, 3, v227
    v_bfe_u32 v232, v231, 2, 1
    v_lshl_add_u32 v227, v232, 1, v227
    v_mul_u32_u24 v227, 3456, v227
    v_lshl_add_u32 v227, v230, 4, v227
    v_add_u32 v227, s64, v227
    s_waitcnt lgkmcnt(0)
    s_add_u32 s67, s94, 0
    s_cmp_ge_u32 s67, 9
    s_cselect_b32 s95, 9, 0
    s_sub_u32 s67, s67, s95
    s_mul_i32 s67, s67, 128
    s_add_u32 m0, s58, 0x0000d000
    s_nop 0
    buffer_load_dwordx4 v224, s[4:7], s67 offen lds
    s_add_u32 m0, s58, 0x0000efc0
    s_nop 0
    buffer_load_dwordx4 v224, s[4:7], s67 offen offset:64 lds
    s_add_u32 s66, s67, 73728
    s_add_u32 m0, s58, 0x0000e000
    s_nop 0
    buffer_load_dwordx4 v224, s[4:7], s66 offen lds
    s_add_u32 m0, s58, 0x0000ffc0
    s_nop 0
    buffer_load_dwordx4 v224, s[4:7], s66 offen offset:64 lds
    s_mul_i32 s66, s67, 1728
    s_add_u32 s66, s66, 1152
    s_add_u32 m0, s59, 0x00008800
    s_mov_b32 exec_hi, 0x0000ffff
    buffer_load_dwordx4 v225, s[8:11], s66 offen lds
    s_mov_b64 exec, -1
    s_add_u32 m0, s59, 0x00008b00
    s_mov_b32 exec_hi, 0x0000ffff
    buffer_load_dwordx4 v226, s[8:11], s66 offen lds
    s_mov_b64 exec, -1
    s_add_u32 m0, s59, 0x00008e00
    s_mov_b32 exec_hi, 0x0000ffff
    buffer_load_dwordx4 v227, s[8:11], s66 offen lds
    s_mov_b64 exec, -1
    s_add_u32 m0, s59, 0x0000a780
    s_mov_b32 exec_hi, 0x0000ffff
    buffer_load_dwordx4 v225, s[8:11], s66 offen offset:1152 lds
    s_mov_b64 exec, -1
    s_add_u32 m0, s59, 0x0000aa80
    s_mov_b32 exec_hi, 0x0000ffff
    buffer_load_dwordx4 v226, s[8:11], s66 offen offset:1152 lds
    s_mov_b64 exec, -1
    s_add_u32 m0, s59, 0x0000ad80
    s_mov_b32 exec_hi, 0x0000ffff
    buffer_load_dwordx4 v227, s[8:11], s66 offen offset:1152 lds
    s_mov_b64 exec, -1
    s_branch L_AY2
L_BY:
    s_setprio 1
    s_and_b32 s57, s51, 3
    s_bfe_u32 s64, s51, 0x20002
    s_lshl_b32 s56, s50, 2
    s_add_u32 s56, s56, s64
    s_mov_b32 s94, s50
    v_lshrrev_b32 v204, 2, v255
    v_mul_u32_u24 v204, 1152, v204
    v_lshrrev_b32 v205, 4, v255
    v_and_b32 v205, 2, v205
    v_xor_b32 v205, v205, v255
    v_and_b32 v205, 3, v205
    v_lshl_add_u32 v202, v205, 4, v204
    s_lshl_b32 s64, s56, 2
    s_add_u32 s64, s64, s49
    s_mul_i32 s64, s64, 18432
    v_add_u32 v202, s64, v202
    s_add_u32 s61, s64, 4194304
    s_lshl_b32 s59, s49, 10
    s_mul_i32 s58, s49, 4608
    v_lshrrev_b32 v204, 2, v255
    v_and_b32 v205, 12, v204
    v_add_u32 v204, v204, v205
    v_mul_u32_u24 v204, 1152, v204
    v_lshrrev_b32 v205, 3, v255
    v_and_b32 v205, 2, v205
    v_xor_b32 v205, v205, v255
    v_and_b32 v205, 3, v205
    v_lshl_add_u32 v200, v205, 4, v204
    v_bfe_u32 v204, v255, 1, 4
    v_and_b32 v205, 12, v204
    v_add_u32 v204, v204, v205
    v_mul_u32_u24 v204, 1152, v204
    v_and_b32 v205, 1, v255
    v_lshl_add_u32 v201, v205, 4, v204
    s_lshr_b32 s64, s49, 1
    s_lshl_b32 s64, s64, 5
    s_and_b32 s65, s49, 1
    s_lshl_b32 s65, s65, 2
    s_add_u32 s64, s64, s65
    s_mul_i32 s64, s64, 1152
    s_mul_i32 s65, s57, 288
    s_add_u32 s64, s64, s65
    s_bitcmp1_b32 s57, 0
    s_cselect_b32 s65, 32, 0
    s_cselect_b32 s67, 0, 256
    s_add_u32 s65, s65, s64
    s_add_u32 s67, s67, s64
    v_add_u32 v200, s65, v200
    v_add_u32 v201, s67, v201
    s_waitcnt lgkmcnt(0)
    s_add_u32 s67, s94, 0
    s_cmp_ge_u32 s67, 9
    s_cselect_b32 s95, 9, 0
    s_sub_u32 s67, s67, s95
    s_mul_i32 s67, s67, 128
    s_add_u32 m0, s59, 0x0001b000
    s_nop 0
    buffer_load_dwordx4 v202, s[4:7], s67 offen lds
    s_add_u32 m0, s59, 0x0001bfc0
    s_nop 0
    buffer_load_dwordx4 v202, s[4:7], s67 offen offset:64 lds
    s_mul_i32 s66, s67, 576
    s_add_u32 m0, s58, 0x00000000
    s_nop 0
    buffer_load_dwordx4 v200, s[20:23], s66 offen lds
    s_add_u32 m0, s58, 0x000003c0
    s_nop 0
    buffer_load_dwordx4 v200, s[20:23], s66 offen offset:64 lds
    s_add_u32 m0, s58, 0x00000780
    s_nop 0
    buffer_load_dwordx4 v200, s[20:23], s66 offen offset:128 lds
    s_add_u32 m0, s58, 0x00000b40
    s_nop 0
    buffer_load_dwordx4 v200, s[20:23], s66 offen offset:192 lds
    s_add_u32 m0, s58, 0x00001000
    s_mov_b32 exec_hi, 0x00000000
    buffer_load_dwordx4 v201, s[20:23], s66 offen lds
    s_mov_b64 exec, -1
    s_branch L_BY2
L_BO:
    s_and_b32 s57, s51, 3
    s_bfe_u32 s64, s51, 0x20002
    s_lshl_b32 s56, s50, 2
    s_add_u32 s56, s56, s64
    s_mov_b32 s94, s50
    s_waitcnt lgkmcnt(0)
    s_lshr_b32 s64, s50, 1
    s_lshl_b32 s64, s64, 5
    s_lshl_b32 s65, s50, 4
    s_add_u32 s65, s65, s51
    s_and_b32 s65, s65, 31
    s_add_u32 s64, s64, s65
    s_lshl_b32 s64, s64, 2
    s_add_u32 s64, s64, s49
    s_mul_i32 s64, s64, 4608
    v_lshlrev_b32 v222, 7, v255
    s_mov_b32 exec_hi, 0x0000000f
    buffer_load_dword v224, v222, s[4:7], s64 offen
    s_mov_b64 exec, -1
    s_lshl_b32 s64, s2, 2
    s_add_u32 s64, s64, s49
    s_mul_i32 s64, s64, 640
    s_add_u32 s64, s64, 4220
    v_lshlrev_b32 v222, 7, v255
    v_mov_b32 v223, 0
    s_mov_b64 exec, 0x0000001f
    buffer_atomic_add v223, v222, s[44:47], s64 offen
    s_mov_b64 exec, -1
    s_load_dwordx2 s[12:13], s[0:1], 16
    s_load_dwordx2 s[16:17], s[0:1], 24
    s_load_dwordx2 s[24:25], s[0:1], 48
    s_load_dwordx2 s[28:29], s[0:1], 56
    s_load_dwordx2 s[32:33], s[0:1], 64
    s_load_dwordx2 s[36:37], s[0:1], 72
    s_load_dwordx2 s[40:41], s[0:1], 80
    s_waitcnt lgkmcnt(0)
    s_lshl_b32 s64, s2, 2
    s_add_u32 s64, s64, s49
    s_mul_i32 s65, s64, 2304
    s_lshl_b32 s101, s64, 4
    s_add_u32 s101, s101, 905216
    s_cmp_ge_u32 s64, 288
    s_cselect_b32 s101, 0x40000000, s101
    v_lshrrev_b32 v218, 5, v255
    v_mul_u32_u24 v218, 1152, v218
    v_and_b32 v219, 31, v255
    v_lshl_add_u32 v220, v219, 2, v218
    v_lshl_add_u32 v218, v219, 4, v218
    buffer_load_dwordx4 v[136:139], v218, s[24:27], s65 offen
    buffer_load_dwordx4 v[140:143], v218, s[24:27], s65 offen offset:512
    buffer_load_dword v144, v220, s[24:27], s65 offen offset:1024
    s_or_b32 s64, s2, s49
    s_cmp_lg_u32 s64, 0
    s_cbranch_scc1 L_nononce_1
    s_buffer_load_dword s64, s[44:47], 0 glc
    v_mov_b32 v218, 0
    s_waitcnt lgkmcnt(0)
    s_mul_i32 s64, s64, 1664525
    s_add_u32 s64, s64, 1013904223
    s_cmp_eq_u32 s64, 0
    s_cselect_b32 s64, 1013904223, s64
    v_mov_b32 v219, s64
    s_mov_b64 exec, 0x00000001
    buffer_store_dword v219, v218, s[40:43], 0 offen sc1
    buffer_store_dword v219, v218, s[44:47], 0 offen sc1
    s_mov_b64 exec, -1
L_nononce_1:
    s_nop 1
    s_xor_b32 s96, s49, 0
    s_lshl_b32 s96, s96, 10
    s_xor_b32 s97, s49, 1
    s_lshl_b32 s97, s97, 10
    s_xor_b32 s98, s49, 2
    s_lshl_b32 s98, s98, 10
    s_xor_b32 s99, s49, 3
    s_lshl_b32 s99, s99, 10
    v_lshrrev_b32 v218, 2, v255
    v_lshlrev_b32 v200, 6, v218
    v_and_b32 v218, 3, v255
    v_lshl_add_u32 v200, v218, 3, v200
    v_and_b32 v218, 16, v255
    v_lshl_add_u32 v200, v218, 1, v200
    v_xor_b32 v201, 32, v200
    v_add_u32 v200, s96, v200
    v_add_u32 v201, s96, v201
    v_lshlrev_b32 v202, 3, v255
    v_and_b32 v218, 15, v255
    v_lshlrev_b32 v220, 6, v218
    v_lshrrev_b32 v218, 2, v255
    v_and_b32 v218, 2, v218
    v_lshrrev_b32 v219, 4, v255
    v_xor_b32 v218, v218, v219
    v_lshl_add_u32 v220, v218, 4, v220
    v_add_u32 v203, s96, v220
    v_add_u32 v204, s97, v220
    v_add_u32 v205, s98, v220
    v_add_u32 v206, s99, v220
    v_mov_b32 v132, 0x3f803f80
    v_mov_b32 v133, 0x3f803f80
    v_mov_b32 v134, 0x3f803f80
    v_mov_b32 v135, 0x3f803f80
    v_and_b32 v218, 15, v255
    v_lshlrev_b32 v220, 6, v218
    v_and_b32 v218, 8, v255
    v_lshl_add_u32 v220, v218, 2, v220
    v_lshrrev_b32 v218, 4, v255
    v_lshl_add_u32 v220, v218, 3, v220
    s_lshl_b32 s58, s57, 1
    s_lshr_b32 s64, s49, 1
    s_add_u32 s58, s58, s64
    s_add_u32 s58, s58, 9
    s_sub_u32 s58, s58, s94
    s_cmp_ge_u32 s58, 9
    s_cselect_b32 s64, 9, 0
    s_sub_u32 s58, s58, s64
    s_cmp_ge_u32 s58, 6
    s_cselect_b32 s64, 6, 0
    s_sub_u32 s64, s58, s64
    s_lshl_b32 s64, s64, 13
    s_add_u32 s64, s64, 110592
    s_and_b32 s65, s49, 1
    s_lshl_b32 s65, s65, 12
    s_add_u32 s64, s64, s65
    v_add_u32 v216, s64, v220
    s_sub_u32 s59, 8, s94
    s_cmp_ge_u32 s59, 6
    s_cselect_b32 s64, 6, 0
    s_sub_u32 s64, s59, s64
    s_lshl_b32 s64, s64, 13
    s_add_u32 s64, s64, 110592
    s_lshr_b32 s65, s57, 1
    s_lshl_b32 s65, s65, 12
    s_add_u32 s64, s64, s65
    s_add_u32 s64, s64, s96
    s_and_b32 s65, s57, 1
    s_lshl_b32 s65, s65, 5
    v_xor_b32 v220, s65, v220
    v_add_u32 v217, s64, v220
    s_lshr_b32 s64, s57, 1
    s_add_u32 s64, s64, 1
    s_sub_u32 s65, 0, s64
    s_bitcmp1_b32 s57, 0
    s_cselect_b32 s64, s65, s64
    s_lshl_b32 s65, s56, 6
    s_add_u32 s64, s64, s65
    s_lshr_b32 s65, s96, 6
    s_add_u32 s65, s65, s64
    v_and_b32 v218, 15, v255
    v_add_u32 v218, s65, v218
    v_bfe_u32 v219, v218, 4, 7
    v_mul_u32_u24 v211, 18432, v219
    v_and_b32 v218, 15, v218
    v_and_or_b32 v218, v255, 48, v218
    v_lshl_add_u32 v211, v218, 4, v211
    s_lshr_b32 s65, s97, 6
    s_add_u32 s65, s65, s64
    v_and_b32 v218, 15, v255
    v_add_u32 v218, s65, v218
    v_bfe_u32 v219, v218, 4, 7
    v_mul_u32_u24 v212, 18432, v219
    v_and_b32 v218, 15, v218
    v_and_or_b32 v218, v255, 48, v218
    v_lshl_add_u32 v212, v218, 4, v212
    s_lshr_b32 s65, s98, 6
    s_add_u32 s65, s65, s64
    v_and_b32 v218, 15, v255
    v_add_u32 v218, s65, v218
    v_bfe_u32 v219, v218, 4, 7
    v_mul_u32_u24 v213, 18432, v219
    v_and_b32 v218, 15, v218
    v_and_or_b32 v218, v255, 48, v218
    v_lshl_add_u32 v213, v218, 4, v213
    s_lshr_b32 s65, s99, 6
    s_add_u32 s65, s65, s64
    v_and_b32 v218, 15, v255
    v_add_u32 v218, s65, v218
    v_bfe_u32 v219, v218, 4, 7
    v_mul_u32_u24 v214, 18432, v219
    v_and_b32 v218, 15, v218
    v_and_or_b32 v218, v255, 48, v218
    v_lshl_add_u32 v214, v218, 4, v214
    s_mul_i32 s64, s57, 9
    s_add_u32 s64, s64, 1
    s_lshr_b32 s64, s64, 1
    s_add_u32 s64, s64, s49
    s_lshl_b32 s64, s64, 10
    s_add_u32 s60, s64, 4194304
    s_cmp_lt_u32 s57, 2
    s_cselect_b32 s64, 0, 9216
    s_add_u32 s64, s64, 4198400
    s_and_b32 s65, s57, 1
    s_lshl_b32 s65, s65, 3
    s_add_u32 s61, s64, s65
    v_and_b32 v220, 15, v255
    v_lshlrev_b32 v220, 5, v220
    v_add_u32 v220, 159744, v220
    v_mov_b32 v228, 0
    s_waitcnt vmcnt(2)
    v_dot2c_f32_bf16 v228, v132, v136
    v_dot2c_f32_bf16 v228, v132, v137
    v_dot2c_f32_bf16 v228, v132, v138
    v_dot2c_f32_bf16 v228, v132, v139
    s_waitcnt vmcnt(1)
    v_dot2c_f32_bf16 v228, v132, v140
    v_dot2c_f32_bf16 v228, v132, v141
    v_dot2c_f32_bf16 v228, v132, v142
    v_dot2c_f32_bf16 v228, v132, v143
    s_waitcnt vmcnt(0)
    v_dot2c_f32_bf16 v228, v132, v144
    s_nop 2
    v_add_f32_dpp v228, v228, v228 row_ror:8 row_mask:0xf bank_mask:0xf
    s_nop 1
    v_add_f32_dpp v228, v228, v228 row_ror:4 row_mask:0xf bank_mask:0xf
    s_nop 1
    v_add_f32_dpp v228, v228, v228 row_ror:2 row_mask:0xf bank_mask:0xf
    s_nop 1
    v_add_f32_dpp v228, v228, v228 row_ror:1 row_mask:0xf bank_mask:0xf
    v_mov_b32 v229, v228
    s_nop 1
    v_permlane16_swap_b32 v228, v229
    v_add_f32 v228, v228, v229
    v_mul_f32 v228, 0x3ae38e39, v228
    s_waitcnt lgkmcnt(0)
    s_barrier
    s_cmp_eq_u32 s58, 0
    s_cbranch_scc1 L_res_4
L_resb_5:
    ds_read_b64_tr_b16 v[16:17], v200 offset:0
    ds_read_b64_tr_b16 v[18:19], v200 offset:4608
    v_add_u32 v203, 0x00019000, v203
    ds_read_b128 v[0:3], v203 offset:8192
    ds_read_b64_tr_b16 v[20:21], v201 offset:0
    ds_read_b64_tr_b16 v[22:23], v201 offset:4608
    v_add_u32 v204, 0x00019000, v204
    ds_read_b128 v[4:7], v204 offset:8192
    v_add_u32 v205, 0x00019000, v205
    ds_read_b128 v[8:11], v205 offset:8192
    v_add_u32 v206, 0x00019000, v206
    ds_read_b128 v[12:15], v206 offset:8192
    ds_read_b64_tr_b16 v[24:25], v202 offset:4096
    ds_read_b64_tr_b16 v[26:27], v202 offset:8704
    s_waitcnt lgkmcnt(7)
    v_mfma_f32_16x16x32_bf16 v[84:87], v[16:19], v[0:3], 0
    ds_read_b64_tr_b16 v[44:45], v200 offset:9216
    ds_read_b64_tr_b16 v[46:47], v200 offset:13824
    s_waitcnt lgkmcnt(7)
    v_mfma_f32_16x16x32_bf16 v[88:91], v[20:23], v[0:3], 0
    ds_read_b128 v[28:31], v203 offset:12288
    ds_read_b64_tr_b16 v[48:49], v201 offset:9216
    s_waitcnt lgkmcnt(8)
    v_mfma_f32_16x16x32_bf16 v[92:95], v[16:19], v[4:7], 0
    ds_read_b64_tr_b16 v[50:51], v201 offset:13824
    ds_read_b128 v[32:35], v204 offset:12288
    v_mfma_f32_16x16x32_bf16 v[96:99], v[20:23], v[4:7], 0
    ds_read_b128 v[36:39], v205 offset:12288
    ds_read_b128 v[40:43], v206 offset:12288
    s_waitcnt lgkmcnt(11)
    v_mfma_f32_16x16x32_bf16 v[100:103], v[16:19], v[8:11], 0
    ds_read_b64_tr_b16 v[52:53], v202 offset:13312
    ds_read_b64_tr_b16 v[54:55], v202 offset:17920
    v_mfma_f32_16x16x32_bf16 v[104:107], v[20:23], v[8:11], 0
    s_waitcnt lgkmcnt(12)
    v_mfma_f32_16x16x32_bf16 v[108:111], v[16:19], v[12:15], 0
    v_mfma_f32_16x16x32_bf16 v[112:115], v[20:23], v[12:15], 0
    s_waitcnt lgkmcnt(10)
    v_mfma_f32_16x16x32_bf16 v[116:119], v[24:27], v[0:3], 0
    v_mfma_f32_16x16x32_bf16 v[120:123], v[16:19], v[132:135], 0
    v_mfma_f32_16x16x32_bf16 v[124:127], v[20:23], v[132:135], 0
    v_mfma_f32_16x16x32_bf16 v[128:131], v[24:27], v[132:135], 0
    s_barrier
    s_cmp_eq_u32 s58, 1
    s_cbranch_scc1 L_res_6
L_resb_7:
    s_cmp_eq_u32 s59, 1
    s_cbranch_scc1 L_res_8
L_resb_9:
    s_waitcnt lgkmcnt(7)
    v_mfma_f32_16x16x32_bf16 v[84:87], v[44:47], v[28:31], v[84:87]
    ds_read_b64_tr_b16 v[16:17], v200 offset:18432
    ds_read_b64_tr_b16 v[18:19], v200 offset:23040
    s_waitcnt lgkmcnt(7)
    v_mfma_f32_16x16x32_bf16 v[88:91], v[48:51], v[28:31], v[88:91]
    ds_read_b128 v[0:3], v203 offset:16384
    ds_read_b64_tr_b16 v[20:21], v201 offset:18432
    s_waitcnt lgkmcnt(8)
    v_mfma_f32_16x16x32_bf16 v[92:95], v[44:47], v[32:35], v[92:95]
    ds_read_b64_tr_b16 v[22:23], v201 offset:23040
    ds_read_b128 v[4:7], v204 offset:16384
    v_mfma_f32_16x16x32_bf16 v[96:99], v[48:51], v[32:35], v[96:99]
    ds_read_b128 v[8:11], v205 offset:16384
    ds_read_b128 v[12:15], v206 offset:16384
    s_waitcnt lgkmcnt(11)
    v_mfma_f32_16x16x32_bf16 v[100:103], v[44:47], v[36:39], v[100:103]
    ds_read_b64_tr_b16 v[24:25], v202 offset:22528
    ds_read_b64_tr_b16 v[26:27], v202 offset:27136
    v_mfma_f32_16x16x32_bf16 v[104:107], v[48:51], v[36:39], v[104:107]
    s_waitcnt lgkmcnt(12)
    v_mfma_f32_16x16x32_bf16 v[108:111], v[44:47], v[40:43], v[108:111]
    v_mfma_f32_16x16x32_bf16 v[112:115], v[48:51], v[40:43], v[112:115]
    s_waitcnt lgkmcnt(10)
    v_mfma_f32_16x16x32_bf16 v[116:119], v[52:55], v[28:31], v[116:119]
    v_mfma_f32_16x16x32_bf16 v[120:123], v[44:47], v[132:135], v[120:123]
    v_mfma_f32_16x16x32_bf16 v[124:127], v[48:51], v[132:135], v[124:127]
    v_mfma_f32_16x16x32_bf16 v[128:131], v[52:55], v[132:135], v[128:131]
    s_waitcnt lgkmcnt(7)
    v_mfma_f32_16x16x32_bf16 v[84:87], v[16:19], v[0:3], v[84:87]
    ds_read_b64_tr_b16 v[44:45], v200 offset:27648
    ds_read_b64_tr_b16 v[46:47], v200 offset:32256
    s_waitcnt lgkmcnt(7)
    v_mfma_f32_16x16x32_bf16 v[88:91], v[20:23], v[0:3], v[88:91]
    ds_read_b128 v[28:31], v203 offset:20480
    ds_read_b64_tr_b16 v[48:49], v201 offset:27648
    s_waitcnt lgkmcnt(8)
    v_mfma_f32_16x16x32_bf16 v[92:95], v[16:19], v[4:7], v[92:95]
    ds_read_b64_tr_b16 v[50:51], v201 offset:32256
    ds_read_b128 v[32:35], v204 offset:20480
    v_mfma_f32_16x16x32_bf16 v[96:99], v[20:23], v[4:7], v[96:99]
    ds_read_b128 v[36:39], v205 offset:20480
    ds_read_b128 v[40:43], v206 offset:20480
    s_waitcnt lgkmcnt(11)
    v_mfma_f32_16x16x32_bf16 v[100:103], v[16:19], v[8:11], v[100:103]
    ds_read_b64_tr_b16 v[52:53], v202 offset:31744
    ds_read_b64_tr_b16 v[54:55], v202 offset:36352
    v_mfma_f32_16x16x32_bf16 v[104:107], v[20:23], v[8:11], v[104:107]
    s_waitcnt lgkmcnt(12)
    v_mfma_f32_16x16x32_bf16 v[108:111], v[16:19], v[12:15], v[108:111]
    v_mfma_f32_16x16x32_bf16 v[112:115], v[20:23], v[12:15], v[112:115]
    s_waitcnt lgkmcnt(10)
    v_mfma_f32_16x16x32_bf16 v[116:119], v[24:27], v[0:3], v[116:119]
    v_mfma_f32_16x16x32_bf16 v[120:123], v[16:19], v[132:135], v[120:123]
    v_mfma_f32_16x16x32_bf16 v[124:127], v[20:23], v[132:135], v[124:127]
    v_mfma_f32_16x16x32_bf16 v[128:131], v[24:27], v[132:135], v[128:131]
    s_barrier
    s_cmp_eq_u32 s58, 2
    s_cbranch_scc1 L_res_10
L_resb_11:
    s_cmp_eq_u32 s59, 2
    s_cbranch_scc1 L_res_12
L_resb_13:
    s_waitcnt lgkmcnt(7)
    v_mfma_f32_16x16x32_bf16 v[84:87], v[44:47], v[28:31], v[84:87]
    ds_read_b64_tr_b16 v[16:17], v200 offset:36864
    ds_read_b64_tr_b16 v[18:19], v200 offset:41472
    s_waitcnt lgkmcnt(7)
    v_mfma_f32_16x16x32_bf16 v[88:91], v[48:51], v[28:31], v[88:91]
    ds_read_b128 v[0:3], v203 offset:24576
    ds_read_b64_tr_b16 v[20:21], v201 offset:36864
    s_waitcnt lgkmcnt(8)
    v_mfma_f32_16x16x32_bf16 v[92:95], v[44:47], v[32:35], v[92:95]
    ds_read_b64_tr_b16 v[22:23], v201 offset:41472
    ds_read_b128 v[4:7], v204 offset:24576
    v_mfma_f32_16x16x32_bf16 v[96:99], v[48:51], v[32:35], v[96:99]
    ds_read_b128 v[8:11], v205 offset:24576
    ds_read_b128 v[12:15], v206 offset:24576
    s_waitcnt lgkmcnt(11)
    v_mfma_f32_16x16x32_bf16 v[100:103], v[44:47], v[36:39], v[100:103]
    ds_read_b64_tr_b16 v[24:25], v202 offset:40960
    ds_read_b64_tr_b16 v[26:27], v202 offset:45568
    v_mfma_f32_16x16x32_bf16 v[104:107], v[48:51], v[36:39], v[104:107]
    s_waitcnt lgkmcnt(12)
    v_mfma_f32_16x16x32_bf16 v[108:111], v[44:47], v[40:43], v[108:111]
    v_mfma_f32_16x16x32_bf16 v[112:115], v[48:51], v[40:43], v[112:115]
    s_waitcnt lgkmcnt(10)
    v_mfma_f32_16x16x32_bf16 v[116:119], v[52:55], v[28:31], v[116:119]
    v_mfma_f32_16x16x32_bf16 v[120:123], v[44:47], v[132:135], v[120:123]
    v_mfma_f32_16x16x32_bf16 v[124:127], v[48:51], v[132:135], v[124:127]
    v_mfma_f32_16x16x32_bf16 v[128:131], v[52:55], v[132:135], v[128:131]
    s_waitcnt lgkmcnt(7)
    v_mfma_f32_16x16x32_bf16 v[84:87], v[16:19], v[0:3], v[84:87]
    ds_read_b64_tr_b16 v[44:45], v200 offset:46080
    ds_read_b64_tr_b16 v[46:47], v200 offset:50688
    s_waitcnt lgkmcnt(7)
    v_mfma_f32_16x16x32_bf16 v[88:91], v[20:23], v[0:3], v[88:91]
    ds_read_b128 v[28:31], v203 offset:28672
    ds_read_b64_tr_b16 v[48:49], v201 offset:46080
    s_waitcnt lgkmcnt(8)
    v_mfma_f32_16x16x32_bf16 v[92:95], v[16:19], v[4:7], v[92:95]
    ds_read_b64_tr_b16 v[50:51], v201 offset:50688
    ds_read_b128 v[32:35], v204 offset:28672
    v_mfma_f32_16x16x32_bf16 v[96:99], v[20:23], v[4:7], v[96:99]
    ds_read_b128 v[36:39], v205 offset:28672
    ds_read_b128 v[40:43], v206 offset:28672
    s_waitcnt lgkmcnt(11)
    v_mfma_f32_16x16x32_bf16 v[100:103], v[16:19], v[8:11], v[100:103]
    ds_read_b64_tr_b16 v[52:53], v202 offset:50176
    ds_read_b64_tr_b16 v[54:55], v202 offset:54784
    v_mfma_f32_16x16x32_bf16 v[104:107], v[20:23], v[8:11], v[104:107]
    s_waitcnt lgkmcnt(12)
    v_mfma_f32_16x16x32_bf16 v[108:111], v[16:19], v[12:15], v[108:111]
    v_mfma_f32_16x16x32_bf16 v[112:115], v[20:23], v[12:15], v[112:115]
    s_waitcnt lgkmcnt(10)
    v_mfma_f32_16x16x32_bf16 v[116:119], v[24:27], v[0:3], v[116:119]
    v_mfma_f32_16x16x32_bf16 v[120:123], v[16:19], v[132:135], v[120:123]
    v_mfma_f32_16x16x32_bf16 v[124:127], v[20:23], v[132:135], v[124:127]
    v_mfma_f32_16x16x32_bf16 v[128:131], v[24:27], v[132:135], v[128:131]
    s_barrier
    s_cmp_eq_u32 s58, 3
    s_cbranch_scc1 L_res_14
L_resb_15:
    s_cmp_eq_u32 s59, 3
    s_cbranch_scc1 L_res_16
L_resb_17:
    s_waitcnt lgkmcnt(7)
    v_mfma_f32_16x16x32_bf16 v[84:87], v[44:47], v[28:31], v[84:87]
    ds_read_b64_tr_b16 v[16:17], v200 offset:55296
    ds_read_b64_tr_b16 v[18:19], v200 offset:59904
    s_waitcnt lgkmcnt(7)
    v_mfma_f32_16x16x32_bf16 v[88:91], v[48:51], v[28:31], v[88:91]
    ds_read_b128 v[0:3], v203 offset:32768
    ds_read_b64_tr_b16 v[20:21], v201 offset:55296
    s_waitcnt lgkmcnt(8)
    v_mfma_f32_16x16x32_bf16 v[92:95], v[44:47], v[32:35], v[92:95]
    ds_read_b64_tr_b16 v[22:23], v201 offset:59904
    ds_read_b128 v[4:7], v204 offset:32768
    v_mfma_f32_16x16x32_bf16 v[96:99], v[48:51], v[32:35], v[96:99]
    ds_read_b128 v[8:11], v205 offset:32768
    ds_read_b128 v[12:15], v206 offset:32768
    s_waitcnt lgkmcnt(11)
    v_mfma_f32_16x16x32_bf16 v[100:103], v[44:47], v[36:39], v[100:103]
    ds_read_b64_tr_b16 v[24:25], v202 offset:59392
    ds_read_b64_tr_b16 v[26:27], v202 offset:64000
    v_mfma_f32_16x16x32_bf16 v[104:107], v[48:51], v[36:39], v[104:107]
    s_waitcnt lgkmcnt(12)
    v_mfma_f32_16x16x32_bf16 v[108:111], v[44:47], v[40:43], v[108:111]
    v_mfma_f32_16x16x32_bf16 v[112:115], v[48:51], v[40:43], v[112:115]
    s_waitcnt lgkmcnt(10)
    v_mfma_f32_16x16x32_bf16 v[116:119], v[52:55], v[28:31], v[116:119]
    v_mfma_f32_16x16x32_bf16 v[120:123], v[44:47], v[132:135], v[120:123]
    v_mfma_f32_16x16x32_bf16 v[124:127], v[48:51], v[132:135], v[124:127]
    v_mfma_f32_16x16x32_bf16 v[128:131], v[52:55], v[132:135], v[128:131]
    s_waitcnt lgkmcnt(7)
    v_mfma_f32_16x16x32_bf16 v[84:87], v[16:19], v[0:3], v[84:87]
    ds_read_b64_tr_b16 v[44:45], v200 offset:64512
    v_add_u32 v200, 0x0000ec00, v200
    ds_read_b64_tr_b16 v[46:47], v200 offset:8704
    s_waitcnt lgkmcnt(7)
    v_mfma_f32_16x16x32_bf16 v[88:91], v[20:23], v[0:3], v[88:91]
    ds_read_b128 v[28:31], v203 offset:36864
    ds_read_b64_tr_b16 v[48:49], v201 offset:64512
    s_waitcnt lgkmcnt(8)
    v_mfma_f32_16x16x32_bf16 v[92:95], v[16:19], v[4:7], v[92:95]
    v_add_u32 v201, 0x0000ec00, v201
    ds_read_b64_tr_b16 v[50:51], v201 offset:8704
    ds_read_b128 v[32:35], v204 offset:36864
    v_mfma_f32_16x16x32_bf16 v[96:99], v[20:23], v[4:7], v[96:99]
    ds_read_b128 v[36:39], v205 offset:36864
    ds_read_b128 v[40:43], v206 offset:36864
    s_waitcnt lgkmcnt(11)
    v_mfma_f32_16x16x32_bf16 v[100:103], v[16:19], v[8:11], v[100:103]
    v_add_u32 v202, 0x0000ec00, v202
    ds_read_b64_tr_b16 v[52:53], v202 offset:8192
    ds_read_b64_tr_b16 v[54:55], v202 offset:12800
    v_mfma_f32_16x16x32_bf16 v[104:107], v[20:23], v[8:11], v[104:107]
    s_waitcnt lgkmcnt(12)
    v_mfma_f32_16x16x32_bf16 v[108:111], v[16:19], v[12:15], v[108:111]
    v_mfma_f32_16x16x32_bf16 v[112:115], v[20:23], v[12:15], v[112:115]
    s_waitcnt lgkmcnt(10)
    v_mfma_f32_16x16x32_bf16 v[116:119], v[24:27], v[0:3], v[116:119]
    v_mfma_f32_16x16x32_bf16 v[120:123], v[16:19], v[132:135], v[120:123]
    v_mfma_f32_16x16x32_bf16 v[124:127], v[20:23], v[132:135], v[124:127]
    v_mfma_f32_16x16x32_bf16 v[128:131], v[24:27], v[132:135], v[128:131]
    s_barrier
    s_cmp_eq_u32 s58, 4
    s_cbranch_scc1 L_res_18
L_resb_19:
    s_cmp_eq_u32 s59, 4
    s_cbranch_scc1 L_res_20
L_resb_21:
    s_waitcnt lgkmcnt(7)
    v_mfma_f32_16x16x32_bf16 v[84:87], v[44:47], v[28:31], v[84:87]
    ds_read_b64_tr_b16 v[16:17], v200 offset:13312
    ds_read_b64_tr_b16 v[18:19], v200 offset:17920
    s_waitcnt lgkmcnt(7)
    v_mfma_f32_16x16x32_bf16 v[88:91], v[48:51], v[28:31], v[88:91]
    ds_read_b128 v[0:3], v203 offset:40960
    ds_read_b64_tr_b16 v[20:21], v201 offset:13312
    s_waitcnt lgkmcnt(8)
    v_mfma_f32_16x16x32_bf16 v[92:95], v[44:47], v[32:35], v[92:95]
    ds_read_b64_tr_b16 v[22:23], v201 offset:17920
    ds_read_b128 v[4:7], v204 offset:40960
    v_mfma_f32_16x16x32_bf16 v[96:99], v[48:51], v[32:35], v[96:99]
    ds_read_b128 v[8:11], v205 offset:40960
    ds_read_b128 v[12:15], v206 offset:40960
    s_waitcnt lgkmcnt(11)
    v_mfma_f32_16x16x32_bf16 v[100:103], v[44:47], v[36:39], v[100:103]
    ds_read_b64_tr_b16 v[24:25], v202 offset:17408
    ds_read_b64_tr_b16 v[26:27], v202 offset:22016
    v_mfma_f32_16x16x32_bf16 v[104:107], v[48:51], v[36:39], v[104:107]
    s_waitcnt lgkmcnt(12)
    v_mfma_f32_16x16x32_bf16 v[108:111], v[44:47], v[40:43], v[108:111]
    v_mfma_f32_16x16x32_bf16 v[112:115], v[48:51], v[40:43], v[112:115]
    s_waitcnt lgkmcnt(10)
    v_mfma_f32_16x16x32_bf16 v[116:119], v[52:55], v[28:31], v[116:119]
    v_mfma_f32_16x16x32_bf16 v[120:123], v[44:47], v[132:135], v[120:123]
    v_mfma_f32_16x16x32_bf16 v[124:127], v[48:51], v[132:135], v[124:127]
    v_mfma_f32_16x16x32_bf16 v[128:131], v[52:55], v[132:135], v[128:131]
    s_waitcnt lgkmcnt(7)
    v_mfma_f32_16x16x32_bf16 v[84:87], v[16:19], v[0:3], v[84:87]
    ds_read_b64_tr_b16 v[44:45], v200 offset:22528
    ds_read_b64_tr_b16 v[46:47], v200 offset:27136
    s_waitcnt lgkmcnt(7)
    v_mfma_f32_16x16x32_bf16 v[88:91], v[20:23], v[0:3], v[88:91]
    ds_read_b128 v[28:31], v203 offset:45056
    ds_read_b64_tr_b16 v[48:49], v201 offset:22528
    s_waitcnt lgkmcnt(8)
    v_mfma_f32_16x16x32_bf16 v[92:95], v[16:19], v[4:7], v[92:95]
    ds_read_b64_tr_b16 v[50:51], v201 offset:27136
    ds_read_b128 v[32:35], v204 offset:45056
    v_mfma_f32_16x16x32_bf16 v[96:99], v[20:23], v[4:7], v[96:99]
    ds_read_b128 v[36:39], v205 offset:45056
    ds_read_b128 v[40:43], v206 offset:45056
    s_waitcnt lgkmcnt(11)
    v_mfma_f32_16x16x32_bf16 v[100:103], v[16:19], v[8:11], v[100:103]
    ds_read_b64_tr_b16 v[52:53], v202 offset:26624
    ds_read_b64_tr_b16 v[54:55], v202 offset:31232
    v_mfma_f32_16x16x32_bf16 v[104:107], v[20:23], v[8:11], v[104:107]
    s_waitcnt lgkmcnt(12)
    v_mfma_f32_16x16x32_bf16 v[108:111], v[16:19], v[12:15], v[108:111]
    v_mfma_f32_16x16x32_bf16 v[112:115], v[20:23], v[12:15], v[112:115]
    s_waitcnt lgkmcnt(10)
    v_mfma_f32_16x16x32_bf16 v[116:119], v[24:27], v[0:3], v[116:119]
    v_mfma_f32_16x16x32_bf16 v[120:123], v[16:19], v[132:135], v[120:123]
    v_mfma_f32_16x16x32_bf16 v[124:127], v[20:23], v[132:135], v[124:127]
    v_mfma_f32_16x16x32_bf16 v[128:131], v[24:27], v[132:135], v[128:131]
    s_barrier
    s_cmp_eq_u32 s58, 5
    s_cbranch_scc1 L_res_22
L_resb_23:
    s_cmp_eq_u32 s59, 5
    s_cbranch_scc1 L_res_24
L_resb_25:
    s_waitcnt lgkmcnt(7)
    v_mfma_f32_16x16x32_bf16 v[84:87], v[44:47], v[28:31], v[84:87]
    ds_read_b64_tr_b16 v[16:17], v200 offset:31744
    ds_read_b64_tr_b16 v[18:19], v200 offset:36352
    s_waitcnt lgkmcnt(7)
    v_mfma_f32_16x16x32_bf16 v[88:91], v[48:51], v[28:31], v[88:91]
    ds_read_b128 v[0:3], v203 offset:49152
    ds_read_b64_tr_b16 v[20:21], v201 offset:31744
    s_waitcnt lgkmcnt(8)
    v_mfma_f32_16x16x32_bf16 v[92:95], v[44:47], v[32:35], v[92:95]
    ds_read_b64_tr_b16 v[22:23], v201 offset:36352
    ds_read_b128 v[4:7], v204 offset:49152
    v_mfma_f32_16x16x32_bf16 v[96:99], v[48:51], v[32:35], v[96:99]
    ds_read_b128 v[8:11], v205 offset:49152
    ds_read_b128 v[12:15], v206 offset:49152
    s_waitcnt lgkmcnt(11)
    v_mfma_f32_16x16x32_bf16 v[100:103], v[44:47], v[36:39], v[100:103]
    ds_read_b64_tr_b16 v[24:25], v202 offset:35840
    ds_read_b64_tr_b16 v[26:27], v202 offset:40448
    v_mfma_f32_16x16x32_bf16 v[104:107], v[48:51], v[36:39], v[104:107]
    s_waitcnt lgkmcnt(12)
    v_mfma_f32_16x16x32_bf16 v[108:111], v[44:47], v[40:43], v[108:111]
    v_mfma_f32_16x16x32_bf16 v[112:115], v[48:51], v[40:43], v[112:115]
    s_waitcnt lgkmcnt(10)
    v_mfma_f32_16x16x32_bf16 v[116:119], v[52:55], v[28:31], v[116:119]
    v_mfma_f32_16x16x32_bf16 v[120:123], v[44:47], v[132:135], v[120:123]
    v_mfma_f32_16x16x32_bf16 v[124:127], v[48:51], v[132:135], v[124:127]
    v_mfma_f32_16x16x32_bf16 v[128:131], v[52:55], v[132:135], v[128:131]
    s_waitcnt lgkmcnt(7)
    v_mfma_f32_16x16x32_bf16 v[84:87], v[16:19], v[0:3], v[84:87]
    ds_read_b64_tr_b16 v[44:45], v200 offset:40960
    ds_read_b64_tr_b16 v[46:47], v200 offset:45568
    s_waitcnt lgkmcnt(7)
    v_mfma_f32_16x16x32_bf16 v[88:91], v[20:23], v[0:3], v[88:91]
    ds_read_b128 v[28:31], v203 offset:53248
    ds_read_b64_tr_b16 v[48:49], v201 offset:40960
    s_waitcnt lgkmcnt(8)
    v_mfma_f32_16x16x32_bf16 v[92:95], v[16:19], v[4:7], v[92:95]
    ds_read_b64_tr_b16 v[50:51], v201 offset:45568
    ds_read_b128 v[32:35], v204 offset:53248
    v_mfma_f32_16x16x32_bf16 v[96:99], v[20:23], v[4:7], v[96:99]
    ds_read_b128 v[36:39], v205 offset:53248
    ds_read_b128 v[40:43], v206 offset:53248
    s_waitcnt lgkmcnt(11)
    v_mfma_f32_16x16x32_bf16 v[100:103], v[16:19], v[8:11], v[100:103]
    ds_read_b64_tr_b16 v[52:53], v202 offset:45056
    ds_read_b64_tr_b16 v[54:55], v202 offset:49664
    v_mfma_f32_16x16x32_bf16 v[104:107], v[20:23], v[8:11], v[104:107]
    s_waitcnt lgkmcnt(12)
    v_mfma_f32_16x16x32_bf16 v[108:111], v[16:19], v[12:15], v[108:111]
    v_mfma_f32_16x16x32_bf16 v[112:115], v[20:23], v[12:15], v[112:115]
    s_waitcnt lgkmcnt(10)
    v_mfma_f32_16x16x32_bf16 v[116:119], v[24:27], v[0:3], v[116:119]
    v_mfma_f32_16x16x32_bf16 v[120:123], v[16:19], v[132:135], v[120:123]
    v_mfma_f32_16x16x32_bf16 v[124:127], v[20:23], v[132:135], v[124:127]
    v_mfma_f32_16x16x32_bf16 v[128:131], v[24:27], v[132:135], v[128:131]
    s_barrier
    s_cmp_eq_u32 s58, 6
    s_cbranch_scc1 L_res_26
L_resb_27:
    s_cmp_eq_u32 s59, 6
    s_cbranch_scc1 L_res_28
L_resb_29:
    v_mov_b32 v221, 0
    buffer_load_dword v221, v221, s[40:43], 0 offen sc1
    s_waitcnt lgkmcnt(7)
    v_mfma_f32_16x16x32_bf16 v[84:87], v[44:47], v[28:31], v[84:87]
    v_add_u32 v200, 0xffff1400, v200
    ds_read_b64_tr_b16 v[16:17], v200 offset:0
    ds_read_b64_tr_b16 v[18:19], v200 offset:4608
    s_waitcnt lgkmcnt(7)
    v_mfma_f32_16x16x32_bf16 v[88:91], v[48:51], v[28:31], v[88:91]
    ds_read_b128 v[0:3], v203 offset:8192
    v_add_u32 v201, 0xffff1400, v201
    ds_read_b64_tr_b16 v[20:21], v201 offset:0
    s_waitcnt lgkmcnt(8)
    v_mfma_f32_16x16x32_bf16 v[92:95], v[44:47], v[32:35], v[92:95]
    ds_read_b64_tr_b16 v[22:23], v201 offset:4608
    ds_read_b128 v[4:7], v204 offset:8192
    v_mfma_f32_16x16x32_bf16 v[96:99], v[48:51], v[32:35], v[96:99]
    ds_read_b128 v[8:11], v205 offset:8192
    ds_read_b128 v[12:15], v206 offset:8192
    s_waitcnt lgkmcnt(11)
    v_mfma_f32_16x16x32_bf16 v[100:103], v[44:47], v[36:39], v[100:103]
    v_add_u32 v202, 0xffff1400, v202
    ds_read_b64_tr_b16 v[24:25], v202 offset:4096
    ds_read_b64_tr_b16 v[26:27], v202 offset:8704
    v_mfma_f32_16x16x32_bf16 v[104:107], v[48:51], v[36:39], v[104:107]
    s_waitcnt lgkmcnt(12)
    v_mfma_f32_16x16x32_bf16 v[108:111], v[44:47], v[40:43], v[108:111]
    v_mfma_f32_16x16x32_bf16 v[112:115], v[48:51], v[40:43], v[112:115]
    s_waitcnt lgkmcnt(10)
    v_mfma_f32_16x16x32_bf16 v[116:119], v[52:55], v[28:31], v[116:119]
    v_mfma_f32_16x16x32_bf16 v[120:123], v[44:47], v[132:135], v[120:123]
    v_mfma_f32_16x16x32_bf16 v[124:127], v[48:51], v[132:135], v[124:127]
    v_mfma_f32_16x16x32_bf16 v[128:131], v[52:55], v[132:135], v[128:131]
    s_waitcnt lgkmcnt(7)
    v_mfma_f32_16x16x32_bf16 v[84:87], v[16:19], v[0:3], v[84:87]
    ds_read_b64_tr_b16 v[44:45], v200 offset:9216
    ds_read_b64_tr_b16 v[46:47], v200 offset:13824
    s_waitcnt lgkmcnt(7)
    v_mfma_f32_16x16x32_bf16 v[88:91], v[20:23], v[0:3], v[88:91]
    ds_read_b128 v[28:31], v203 offset:12288
    ds_read_b64_tr_b16 v[48:49], v201 offset:9216
    s_waitcnt lgkmcnt(8)
    v_mfma_f32_16x16x32_bf16 v[92:95], v[16:19], v[4:7], v[92:95]
    ds_read_b64_tr_b16 v[50:51], v201 offset:13824
    ds_read_b128 v[32:35], v204 offset:12288
    v_mfma_f32_16x16x32_bf16 v[96:99], v[20:23], v[4:7], v[96:99]
    ds_read_b128 v[36:39], v205 offset:12288
    ds_read_b128 v[40:43], v206 offset:12288
    s_waitcnt lgkmcnt(11)
    v_mfma_f32_16x16x32_bf16 v[100:103], v[16:19], v[8:11], v[100:103]
    ds_read_b64_tr_b16 v[52:53], v202 offset:13312
    ds_read_b64_tr_b16 v[54:55], v202 offset:17920
    v_mfma_f32_16x16x32_bf16 v[104:107], v[20:23], v[8:11], v[104:107]
    s_waitcnt lgkmcnt(12)
    v_mfma_f32_16x16x32_bf16 v[108:111], v[16:19], v[12:15], v[108:111]
    v_mfma_f32_16x16x32_bf16 v[112:115], v[20:23], v[12:15], v[112:115]
    s_waitcnt lgkmcnt(10)
    v_mfma_f32_16x16x32_bf16 v[116:119], v[24:27], v[0:3], v[116:119]
    v_mfma_f32_16x16x32_bf16 v[120:123], v[16:19], v[132:135], v[120:123]
    v_mfma_f32_16x16x32_bf16 v[124:127], v[20:23], v[132:135], v[124:127]
    v_mfma_f32_16x16x32_bf16 v[128:131], v[24:27], v[132:135], v[128:131]
    s_barrier
    s_cmp_eq_u32 s58, 7
    s_cbranch_scc1 L_res_30
L_resb_31:
    s_cmp_eq_u32 s59, 7
    s_cbranch_scc1 L_res_32
L_resb_33:
    s_waitcnt lgkmcnt(7)
    v_mfma_f32_16x16x32_bf16 v[84:87], v[44:47], v[28:31], v[84:87]
    ds_read_b64_tr_b16 v[16:17], v200 offset:18432
    ds_read_b64_tr_b16 v[18:19], v200 offset:23040
    s_waitcnt lgkmcnt(7)
    v_mfma_f32_16x16x32_bf16 v[88:91], v[48:51], v[28:31], v[88:91]
    ds_read_b128 v[0:3], v203 offset:16384
    ds_read_b64_tr_b16 v[20:21], v201 offset:18432
    s_waitcnt lgkmcnt(8)
    v_mfma_f32_16x16x32_bf16 v[92:95], v[44:47], v[32:35], v[92:95]
    ds_read_b64_tr_b16 v[22:23], v201 offset:23040
    ds_read_b128 v[4:7], v204 offset:16384
    v_mfma_f32_16x16x32_bf16 v[96:99], v[48:51], v[32:35], v[96:99]
    ds_read_b128 v[8:11], v205 offset:16384
    ds_read_b128 v[12:15], v206 offset:16384
    s_waitcnt lgkmcnt(11)
    v_mfma_f32_16x16x32_bf16 v[100:103], v[44:47], v[36:39], v[100:103]
    ds_read_b64_tr_b16 v[24:25], v202 offset:22528
    ds_read_b64_tr_b16 v[26:27], v202 offset:27136
    v_mfma_f32_16x16x32_bf16 v[104:107], v[48:51], v[36:39], v[104:107]
    s_waitcnt lgkmcnt(12)
    v_mfma_f32_16x16x32_bf16 v[108:111], v[44:47], v[40:43], v[108:111]
    v_mfma_f32_16x16x32_bf16 v[112:115], v[48:51], v[40:43], v[112:115]
    s_waitcnt lgkmcnt(10)
    v_mfma_f32_16x16x32_bf16 v[116:119], v[52:55], v[28:31], v[116:119]
    v_mfma_f32_16x16x32_bf16 v[120:123], v[44:47], v[132:135], v[120:123]
    v_mfma_f32_16x16x32_bf16 v[124:127], v[48:51], v[132:135], v[124:127]
    v_mfma_f32_16x16x32_bf16 v[128:131], v[52:55], v[132:135], v[128:131]
    s_waitcnt lgkmcnt(7)
    v_mfma_f32_16x16x32_bf16 v[84:87], v[16:19], v[0:3], v[84:87]
    ds_read_b64_tr_b16 v[44:45], v200 offset:27648
    ds_read_b64_tr_b16 v[46:47], v200 offset:32256
    s_waitcnt lgkmcnt(7)
    v_mfma_f32_16x16x32_bf16 v[88:91], v[20:23], v[0:3], v[88:91]
    ds_read_b128 v[28:31], v203 offset:20480
    ds_read_b64_tr_b16 v[48:49], v201 offset:27648
    s_waitcnt lgkmcnt(8)
    v_mfma_f32_16x16x32_bf16 v[92:95], v[16:19], v[4:7], v[92:95]
    ds_read_b64_tr_b16 v[50:51], v201 offset:32256
    ds_read_b128 v[32:35], v204 offset:20480
    v_mfma_f32_16x16x32_bf16 v[96:99], v[20:23], v[4:7], v[96:99]
    ds_read_b128 v[36:39], v205 offset:20480
    ds_read_b128 v[40:43], v206 offset:20480
    s_waitcnt lgkmcnt(11)
    v_mfma_f32_16x16x32_bf16 v[100:103], v[16:19], v[8:11], v[100:103]
    ds_read_b64_tr_b16 v[52:53], v202 offset:31744
    ds_read_b64_tr_b16 v[54:55], v202 offset:36352
    v_mfma_f32_16x16x32_bf16 v[104:107], v[20:23], v[8:11], v[104:107]
    s_waitcnt lgkmcnt(12)
    v_mfma_f32_16x16x32_bf16 v[108:111], v[16:19], v[12:15], v[108:111]
    v_mfma_f32_16x16x32_bf16 v[112:115], v[20:23], v[12:15], v[112:115]
    s_waitcnt lgkmcnt(10)
    v_mfma_f32_16x16x32_bf16 v[116:119], v[24:27], v[0:3], v[116:119]
    v_mfma_f32_16x16x32_bf16 v[120:123], v[16:19], v[132:135], v[120:123]
    v_mfma_f32_16x16x32_bf16 v[124:127], v[20:23], v[132:135], v[124:127]
    v_mfma_f32_16x16x32_bf16 v[128:131], v[24:27], v[132:135], v[128:131]
    s_waitcnt lgkmcnt(7)
    v_mfma_f32_16x16x32_bf16 v[84:87], v[44:47], v[28:31], v[84:87]
    s_waitcnt lgkmcnt(5)
    v_mfma_f32_16x16x32_bf16 v[88:91], v[48:51], v[28:31], v[88:91]
    s_waitcnt lgkmcnt(4)
    v_mfma_f32_16x16x32_bf16 v[92:95], v[44:47], v[32:35], v[92:95]
    v_mfma_f32_16x16x32_bf16 v[96:99], v[48:51], v[32:35], v[96:99]
    s_waitcnt lgkmcnt(3)
    v_mfma_f32_16x16x32_bf16 v[100:103], v[44:47], v[36:39], v[100:103]
    v_mfma_f32_16x16x32_bf16 v[104:107], v[48:51], v[36:39], v[104:107]
    s_barrier
    s_cmp_eq_u32 s58, 8
    s_cbranch_scc1 L_res_34
L_resb_35:
    s_cmp_eq_u32 s59, 8
    s_cbranch_scc1 L_res_36
L_resb_37:
    s_waitcnt vmcnt(0)
    v_readfirstlane_b32 s55, v221
    s_nop 1
    s_cmp_eq_u32 s55, 0
    s_cbranch_scc1 L_nslow_38
L_nback_39:
    v_mov_b32 v229, s55
    v_lshrrev_b32 v219, 2, v255
    s_mov_b32 exec_lo, 0x00000001
    s_mov_b32 exec_hi, 0x00000001
    buffer_store_dwordx2 v[228:229], v219, s[44:47], s101 offen sc1
    s_mov_b64 exec, -1
    ds_read_b64_tr_b16 v[16:17], v200 offset:36864
    ds_read_b64_tr_b16 v[18:19], v200 offset:41472
    ds_read_b128 v[0:3], v203 offset:24576
    s_waitcnt lgkmcnt(5)
    v_mfma_f32_16x16x32_bf16 v[108:111], v[44:47], v[40:43], v[108:111]
    ds_read_b64_tr_b16 v[20:21], v201 offset:36864
    ds_read_b64_tr_b16 v[22:23], v201 offset:41472
    ds_read_b128 v[4:7], v204 offset:24576
    v_mfma_f32_16x16x32_bf16 v[112:115], v[48:51], v[40:43], v[112:115]
    ds_read_b128 v[8:11], v205 offset:24576
    ds_read_b128 v[12:15], v206 offset:24576
    ds_read_b64_tr_b16 v[24:25], v202 offset:40960
    s_waitcnt lgkmcnt(9)
    v_mfma_f32_16x16x32_bf16 v[116:119], v[52:55], v[28:31], v[116:119]
    ds_read_b64_tr_b16 v[26:27], v202 offset:45568
    v_mfma_f32_16x16x32_bf16 v[120:123], v[44:47], v[132:135], v[120:123]
    v_mfma_f32_16x16x32_bf16 v[124:127], v[48:51], v[132:135], v[124:127]
    v_mfma_f32_16x16x32_bf16 v[128:131], v[52:55], v[132:135], v[128:131]
    s_waitcnt lgkmcnt(7)
    v_mfma_f32_16x16x32_bf16 v[84:87], v[16:19], v[0:3], v[84:87]
    ds_read_b64_tr_b16 v[44:45], v200 offset:46080
    ds_read_b64_tr_b16 v[46:47], v200 offset:50688
    s_waitcnt lgkmcnt(7)
    v_mfma_f32_16x16x32_bf16 v[88:91], v[20:23], v[0:3], v[88:91]
    ds_read_b128 v[28:31], v203 offset:28672
    ds_read_b64_tr_b16 v[48:49], v201 offset:46080
    s_waitcnt lgkmcnt(8)
    v_mfma_f32_16x16x32_bf16 v[92:95], v[16:19], v[4:7], v[92:95]
    ds_read_b64_tr_b16 v[50:51], v201 offset:50688
    ds_read_b128 v[32:35], v204 offset:28672
    v_mfma_f32_16x16x32_bf16 v[96:99], v[20:23], v[4:7], v[96:99]
    ds_read_b128 v[36:39], v205 offset:28672
    ds_read_b128 v[40:43], v206 offset:28672
    s_waitcnt lgkmcnt(11)
    v_mfma_f32_16x16x32_bf16 v[100:103], v[16:19], v[8:11], v[100:103]
    ds_read_b64_tr_b16 v[52:53], v202 offset:50176
    ds_read_b64_tr_b16 v[54:55], v202 offset:54784
    v_mfma_f32_16x16x32_bf16 v[104:107], v[20:23], v[8:11], v[104:107]
    s_waitcnt lgkmcnt(12)
    v_mfma_f32_16x16x32_bf16 v[108:111], v[16:19], v[12:15], v[108:111]
    v_mfma_f32_16x16x32_bf16 v[112:115], v[20:23], v[12:15], v[112:115]
    s_waitcnt lgkmcnt(10)
    v_mfma_f32_16x16x32_bf16 v[116:119], v[24:27], v[0:3], v[116:119]
    v_mfma_f32_16x16x32_bf16 v[120:123], v[16:19], v[132:135], v[120:123]
    v_mfma_f32_16x16x32_bf16 v[124:127], v[20:23], v[132:135], v[124:127]
    v_mfma_f32_16x16x32_bf16 v[128:131], v[24:27], v[132:135], v[128:131]
    s_waitcnt lgkmcnt(7)
    v_mfma_f32_16x16x32_bf16 v[84:87], v[44:47], v[28:31], v[84:87]
    s_waitcnt lgkmcnt(5)
    v_mfma_f32_16x16x32_bf16 v[88:91], v[48:51], v[28:31], v[88:91]
    s_waitcnt lgkmcnt(4)
    v_mfma_f32_16x16x32_bf16 v[92:95], v[44:47], v[32:35], v[92:95]
    v_mfma_f32_16x16x32_bf16 v[96:99], v[48:51], v[32:35], v[96:99]
    s_waitcnt lgkmcnt(3)
    v_mfma_f32_16x16x32_bf16 v[100:103], v[44:47], v[36:39], v[100:103]
    v_mfma_f32_16x16x32_bf16 v[104:107], v[48:51], v[36:39], v[104:107]
    s_waitcnt lgkmcnt(2)
    v_mfma_f32_16x16x32_bf16 v[108:111], v[44:47], v[40:43], v[108:111]
    v_mfma_f32_16x16x32_bf16 v[112:115], v[48:51], v[40:43], v[112:115]
    s_waitcnt lgkmcnt(0)
    v_mfma_f32_16x16x32_bf16 v[116:119], v[52:55], v[28:31], v[116:119]
    v_mfma_f32_16x16x32_bf16 v[120:123], v[44:47], v[132:135], v[120:123]
    v_mfma_f32_16x16x32_bf16 v[124:127], v[48:51], v[132:135], v[124:127]
    v_mfma_f32_16x16x32_bf16 v[128:131], v[52:55], v[132:135], v[128:131]
    s_barrier
    s_lshr_b32 s64, s96, 1
    v_add_u32 v218, s64, v220
    ds_read_b128 v[156:159], v218
    ds_read_b64 v[172:173], v218 offset:16
    s_lshr_b32 s64, s97, 1
    v_add_u32 v218, s64, v220
    ds_read_b128 v[160:163], v218
    ds_read_b64 v[174:175], v218 offset:16
    s_lshr_b32 s64, s98, 1
    v_add_u32 v218, s64, v220
    ds_read_b128 v[164:167], v218
    ds_read_b64 v[176:177], v218 offset:16
    s_lshr_b32 s64, s99, 1
    v_add_u32 v218, s64, v220
    ds_read_b128 v[168:171], v218
    ds_read_b64 v[178:179], v218 offset:16
    s_waitcnt lgkmcnt(7)
    v_pk_fma_f32 v[116:117], v[128:129], v[156:157], v[116:117] op_sel_hi:[1,0,1]
    v_pk_fma_f32 v[118:119], v[130:131], v[156:157], v[118:119] op_sel_hi:[1,0,1]
    v_pk_mul_f32 v[180:181], v[116:117], v[116:117]
    v_pk_mul_f32 v[182:183], v[118:119], v[118:119]
    v_pk_fma_f32 v[180:181], v[180:181], v[158:159], v[156:157] op_sel:[0,0,1] op_sel_hi:[1,0,1]
    v_pk_fma_f32 v[182:183], v[182:183], v[158:159], v[156:157] op_sel:[0,0,1] op_sel_hi:[1,0,1]
    v_pk_mul_f32 v[180:181], v[180:181], v[116:117]
    v_pk_mul_f32 v[182:183], v[182:183], v[118:119]
    v_exp_f32 v180, v180
    v_exp_f32 v181, v181
    v_exp_f32 v182, v182
    v_exp_f32 v183, v183
    v_pk_fma_f32 v[180:181], v[180:181], v[158:159], v[158:159] op_sel:[0,1,1] op_sel_hi:[1,1,1]
    v_pk_fma_f32 v[182:183], v[182:183], v[158:159], v[158:159] op_sel:[0,1,1] op_sel_hi:[1,1,1]
    v_rcp_f32 v180, v180
    v_rcp_f32 v181, v181
    v_rcp_f32 v182, v182
    v_rcp_f32 v183, v183
    v_pk_mul_f32 v[180:181], v[180:181], v[116:117]
    v_pk_mul_f32 v[182:183], v[182:183], v[118:119]
    v_cvt_pk_bf16_f32 v226, v180, v181
    v_cvt_pk_bf16_f32 v227, v182, v183
    buffer_store_dwordx2 v[226:227], v211, s[44:47], s61 offen sc1
    v_pk_fma_f32 v[84:85], v[120:121], v[156:157], v[84:85] op_sel_hi:[1,0,1]
    v_pk_fma_f32 v[86:87], v[122:123], v[156:157], v[86:87] op_sel_hi:[1,0,1]
    v_pk_fma_f32 v[88:89], v[124:125], v[156:157], v[88:89] op_sel_hi:[1,0,1]
    v_pk_fma_f32 v[90:91], v[126:127], v[156:157], v[90:91] op_sel_hi:[1,0,1]
    v_pk_mul_f32 v[180:181], v[84:85], v[84:85]
    v_pk_mul_f32 v[182:183], v[86:87], v[86:87]
    v_pk_mul_f32 v[184:185], v[88:89], v[88:89]
    v_pk_mul_f32 v[186:187], v[90:91], v[90:91]
    v_pk_fma_f32 v[180:181], v[180:181], v[158:159], v[156:157] op_sel:[0,0,1] op_sel_hi:[1,0,1]
    v_pk_fma_f32 v[182:183], v[182:183], v[158:159], v[156:157] op_sel:[0,0,1] op_sel_hi:[1,0,1]
    v_pk_fma_f32 v[184:185], v[184:185], v[158:159], v[156:157] op_sel:[0,0,1] op_sel_hi:[1,0,1]
    v_pk_fma_f32 v[186:187], v[186:187], v[158:159], v[156:157] op_sel:[0,0,1] op_sel_hi:[1,0,1]
    v_pk_mul_f32 v[180:181], v[180:181], v[84:85]
    v_pk_mul_f32 v[182:183], v[182:183], v[86:87]
    v_pk_mul_f32 v[184:185], v[184:185], v[88:89]
    v_pk_mul_f32 v[186:187], v[186:187], v[90:91]
    v_exp_f32 v180, v180
    v_exp_f32 v181, v181
    v_exp_f32 v182, v182
    v_exp_f32 v183, v183
    v_exp_f32 v184, v184
    v_exp_f32 v185, v185
    v_exp_f32 v186, v186
    v_exp_f32 v187, v187
    v_pk_fma_f32 v[180:181], v[180:181], v[158:159], v[158:159] op_sel:[0,1,1] op_sel_hi:[1,1,1]
    v_pk_fma_f32 v[182:183], v[182:183], v[158:159], v[158:159] op_sel:[0,1,1] op_sel_hi:[1,1,1]
    v_pk_fma_f32 v[184:185], v[184:185], v[158:159], v[158:159] op_sel:[0,1,1] op_sel_hi:[1,1,1]
    v_pk_fma_f32 v[186:187], v[186:187], v[158:159], v[158:159] op_sel:[0,1,1] op_sel_hi:[1,1,1]
    v_rcp_f32 v180, v180
    v_rcp_f32 v181, v181
    v_rcp_f32 v182, v182
    v_rcp_f32 v183, v183
    v_rcp_f32 v184, v184
    v_rcp_f32 v185, v185
    v_rcp_f32 v186, v186
    v_rcp_f32 v187, v187
    v_pk_mul_f32 v[180:181], v[180:181], v[84:85]
    v_pk_mul_f32 v[182:183], v[182:183], v[86:87]
    v_pk_mul_f32 v[184:185], v[184:185], v[88:89]
    v_pk_mul_f32 v[186:187], v[186:187], v[90:91]
    v_cvt_pk_bf16_f32 v56, v180, v181
    v_cvt_pk_bf16_f32 v57, v182, v183
    v_cvt_pk_bf16_f32 v58, v184, v185
    v_cvt_pk_bf16_f32 v59, v186, v187
    buffer_store_dwordx4 v[56:59], v211, s[44:47], s60 offen sc1
    s_waitcnt lgkmcnt(5)
    v_pk_fma_f32 v[92:93], v[120:121], v[160:161], v[92:93] op_sel_hi:[1,0,1]
    v_pk_fma_f32 v[94:95], v[122:123], v[160:161], v[94:95] op_sel_hi:[1,0,1]
    v_pk_fma_f32 v[96:97], v[124:125], v[160:161], v[96:97] op_sel_hi:[1,0,1]
    v_pk_fma_f32 v[98:99], v[126:127], v[160:161], v[98:99] op_sel_hi:[1,0,1]
    v_pk_mul_f32 v[180:181], v[92:93], v[92:93]
    v_pk_mul_f32 v[182:183], v[94:95], v[94:95]
    v_pk_mul_f32 v[184:185], v[96:97], v[96:97]
    v_pk_mul_f32 v[186:187], v[98:99], v[98:99]
    v_pk_fma_f32 v[180:181], v[180:181], v[162:163], v[160:161] op_sel:[0,0,1] op_sel_hi:[1,0,1]
    v_pk_fma_f32 v[182:183], v[182:183], v[162:163], v[160:161] op_sel:[0,0,1] op_sel_hi:[1,0,1]
    v_pk_fma_f32 v[184:185], v[184:185], v[162:163], v[160:161] op_sel:[0,0,1] op_sel_hi:[1,0,1]
    v_pk_fma_f32 v[186:187], v[186:187], v[162:163], v[160:161] op_sel:[0,0,1] op_sel_hi:[1,0,1]
    v_pk_mul_f32 v[180:181], v[180:181], v[92:93]
    v_pk_mul_f32 v[182:183], v[182:183], v[94:95]
    v_pk_mul_f32 v[184:185], v[184:185], v[96:97]
    v_pk_mul_f32 v[186:187], v[186:187], v[98:99]
    v_exp_f32 v180, v180
    v_exp_f32 v181, v181
    v_exp_f32 v182, v182
    v_exp_f32 v183, v183
    v_exp_f32 v184, v184
    v_exp_f32 v185, v185
    v_exp_f32 v186, v186
    v_exp_f32 v187, v187
    v_pk_fma_f32 v[180:181], v[180:181], v[162:163], v[162:163] op_sel:[0,1,1] op_sel_hi:[1,1,1]
    v_pk_fma_f32 v[182:183], v[182:183], v[162:163], v[162:163] op_sel:[0,1,1] op_sel_hi:[1,1,1]
    v_pk_fma_f32 v[184:185], v[184:185], v[162:163], v[162:163] op_sel:[0,1,1] op_sel_hi:[1,1,1]
    v_pk_fma_f32 v[186:187], v[186:187], v[162:163], v[162:163] op_sel:[0,1,1] op_sel_hi:[1,1,1]
    v_rcp_f32 v180, v180
    v_rcp_f32 v181, v181
    v_rcp_f32 v182, v182
    v_rcp_f32 v183, v183
    v_rcp_f32 v184, v184
    v_rcp_f32 v185, v185
    v_rcp_f32 v186, v186
    v_rcp_f32 v187, v187
    v_pk_mul_f32 v[180:181], v[180:181], v[92:93]
    v_pk_mul_f32 v[182:183], v[182:183], v[94:95]
    v_pk_mul_f32 v[184:185], v[184:185], v[96:97]
    v_pk_mul_f32 v[186:187], v[186:187], v[98:99]
    v_cvt_pk_bf16_f32 v60, v180, v181
    v_cvt_pk_bf16_f32 v61, v182, v183
    v_cvt_pk_bf16_f32 v62, v184, v185
    v_cvt_pk_bf16_f32 v63, v186, v187
    buffer_store_dwordx4 v[60:63], v212, s[44:47], s60 offen sc1
    s_waitcnt lgkmcnt(3)
    v_pk_fma_f32 v[100:101], v[120:121], v[164:165], v[100:101] op_sel_hi:[1,0,1]
    v_pk_fma_f32 v[102:103], v[122:123], v[164:165], v[102:103] op_sel_hi:[1,0,1]
    v_pk_fma_f32 v[104:105], v[124:125], v[164:165], v[104:105] op_sel_hi:[1,0,1]
    v_pk_fma_f32 v[106:107], v[126:127], v[164:165], v[106:107] op_sel_hi:[1,0,1]
    v_pk_mul_f32 v[180:181], v[100:101], v[100:101]
    v_pk_mul_f32 v[182:183], v[102:103], v[102:103]
    v_pk_mul_f32 v[184:185], v[104:105], v[104:105]
    v_pk_mul_f32 v[186:187], v[106:107], v[106:107]
    v_pk_fma_f32 v[180:181], v[180:181], v[166:167], v[164:165] op_sel:[0,0,1] op_sel_hi:[1,0,1]
    v_pk_fma_f32 v[182:183], v[182:183], v[166:167], v[164:165] op_sel:[0,0,1] op_sel_hi:[1,0,1]
    v_pk_fma_f32 v[184:185], v[184:185], v[166:167], v[164:165] op_sel:[0,0,1] op_sel_hi:[1,0,1]
    v_pk_fma_f32 v[186:187], v[186:187], v[166:167], v[164:165] op_sel:[0,0,1] op_sel_hi:[1,0,1]
    v_pk_mul_f32 v[180:181], v[180:181], v[100:101]
    v_pk_mul_f32 v[182:183], v[182:183], v[102:103]
    v_pk_mul_f32 v[184:185], v[184:185], v[104:105]
    v_pk_mul_f32 v[186:187], v[186:187], v[106:107]
    v_exp_f32 v180, v180
    v_exp_f32 v181, v181
    v_exp_f32 v182, v182
    v_exp_f32 v183, v183
    v_exp_f32 v184, v184
    v_exp_f32 v185, v185
    v_exp_f32 v186, v186
    v_exp_f32 v187, v187
    v_pk_fma_f32 v[180:181], v[180:181], v[166:167], v[166:167] op_sel:[0,1,1] op_sel_hi:[1,1,1]
    v_pk_fma_f32 v[182:183], v[182:183], v[166:167], v[166:167] op_sel:[0,1,1] op_sel_hi:[1,1,1]
    v_pk_fma_f32 v[184:185], v[184:185], v[166:167], v[166:167] op_sel:[0,1,1] op_sel_hi:[1,1,1]
    v_pk_fma_f32 v[186:187], v[186:187], v[166:167], v[166:167] op_sel:[0,1,1] op_sel_hi:[1,1,1]
    v_rcp_f32 v180, v180
    v_rcp_f32 v181, v181
    v_rcp_f32 v182, v182
    v_rcp_f32 v183, v183
    v_rcp_f32 v184, v184
    v_rcp_f32 v185, v185
    v_rcp_f32 v186, v186
    v_rcp_f32 v187, v187
    v_pk_mul_f32 v[180:181], v[180:181], v[100:101]
    v_pk_mul_f32 v[182:183], v[182:183], v[102:103]
    v_pk_mul_f32 v[184:185], v[184:185], v[104:105]
    v_pk_mul_f32 v[186:187], v[186:187], v[106:107]
    v_cvt_pk_bf16_f32 v64, v180, v181
    v_cvt_pk_bf16_f32 v65, v182, v183
    v_cvt_pk_bf16_f32 v66, v184, v185
    v_cvt_pk_bf16_f32 v67, v186, v187
    buffer_store_dwordx4 v[64:67], v213, s[44:47], s60 offen sc1
    s_waitcnt lgkmcnt(1)
    v_pk_fma_f32 v[108:109], v[120:121], v[168:169], v[108:109] op_sel_hi:[1,0,1]
    v_pk_fma_f32 v[110:111], v[122:123], v[168:169], v[110:111] op_sel_hi:[1,0,1]
    v_pk_fma_f32 v[112:113], v[124:125], v[168:169], v[112:113] op_sel_hi:[1,0,1]
    v_pk_fma_f32 v[114:115], v[126:127], v[168:169], v[114:115] op_sel_hi:[1,0,1]
    v_pk_mul_f32 v[180:181], v[108:109], v[108:109]
    v_pk_mul_f32 v[182:183], v[110:111], v[110:111]
    v_pk_mul_f32 v[184:185], v[112:113], v[112:113]
    v_pk_mul_f32 v[186:187], v[114:115], v[114:115]
    v_pk_fma_f32 v[180:181], v[180:181], v[170:171], v[168:169] op_sel:[0,0,1] op_sel_hi:[1,0,1]
    v_pk_fma_f32 v[182:183], v[182:183], v[170:171], v[168:169] op_sel:[0,0,1] op_sel_hi:[1,0,1]
    v_pk_fma_f32 v[184:185], v[184:185], v[170:171], v[168:169] op_sel:[0,0,1] op_sel_hi:[1,0,1]
    v_pk_fma_f32 v[186:187], v[186:187], v[170:171], v[168:169] op_sel:[0,0,1] op_sel_hi:[1,0,1]
    v_pk_mul_f32 v[180:181], v[180:181], v[108:109]
    v_pk_mul_f32 v[182:183], v[182:183], v[110:111]
    v_pk_mul_f32 v[184:185], v[184:185], v[112:113]
    v_pk_mul_f32 v[186:187], v[186:187], v[114:115]
    v_exp_f32 v180, v180
    v_exp_f32 v181, v181
    v_exp_f32 v182, v182
    v_exp_f32 v183, v183
    v_exp_f32 v184, v184
    v_exp_f32 v185, v185
    v_exp_f32 v186, v186
    v_exp_f32 v187, v187
    v_pk_fma_f32 v[180:181], v[180:181], v[170:171], v[170:171] op_sel:[0,1,1] op_sel_hi:[1,1,1]
    v_pk_fma_f32 v[182:183], v[182:183], v[170:171], v[170:171] op_sel:[0,1,1] op_sel_hi:[1,1,1]
    v_pk_fma_f32 v[184:185], v[184:185], v[170:171], v[170:171] op_sel:[0,1,1] op_sel_hi:[1,1,1]
    v_pk_fma_f32 v[186:187], v[186:187], v[170:171], v[170:171] op_sel:[0,1,1] op_sel_hi:[1,1,1]
    v_rcp_f32 v180, v180
    v_rcp_f32 v181, v181
    v_rcp_f32 v182, v182
    v_rcp_f32 v183, v183
    v_rcp_f32 v184, v184
    v_rcp_f32 v185, v185
    v_rcp_f32 v186, v186
    v_rcp_f32 v187, v187
    v_pk_mul_f32 v[180:181], v[180:181], v[108:109]
    v_pk_mul_f32 v[182:183], v[182:183], v[110:111]
    v_pk_mul_f32 v[184:185], v[184:185], v[112:113]
    v_pk_mul_f32 v[186:187], v[186:187], v[114:115]
    v_cvt_pk_bf16_f32 v68, v180, v181
    v_cvt_pk_bf16_f32 v69, v182, v183
    v_cvt_pk_bf16_f32 v70, v184, v185
    v_cvt_pk_bf16_f32 v71, v186, v187
    buffer_store_dwordx4 v[68:71], v214, s[44:47], s60 offen sc1
    s_mul_i32 s68, s49, 1152
    s_add_u32 s68, s68, 905216
    s_mov_b32 exec_hi, 0x0000000f
    buffer_load_dwordx4 v[0:3], v254, s[44:47], s68 offen offset:0 sc1
    buffer_load_dwordx4 v[4:7], v254, s[44:47], s68 offen offset:576 sc1
    s_mov_b64 exec, -1
    v_lshlrev_b32 v84, 16, v236
    v_and_b32 v85, 0xffff0000, v236
    v_lshlrev_b32 v86, 16, v237
    v_and_b32 v87, 0xffff0000, v237
    v_lshlrev_b32 v88, 16, v238
    v_and_b32 v89, 0xffff0000, v238
    v_lshlrev_b32 v90, 16, v239
    v_and_b32 v91, 0xffff0000, v239
    v_pk_fma_f32 v[84:85], v[84:85], v[172:173], v[172:173] op_sel:[0,1,0] op_sel_hi:[1,1,0]
    v_pk_fma_f32 v[86:87], v[86:87], v[172:173], v[172:173] op_sel:[0,1,0] op_sel_hi:[1,1,0]
    v_pk_fma_f32 v[88:89], v[88:89], v[172:173], v[172:173] op_sel:[0,1,0] op_sel_hi:[1,1,0]
    v_pk_fma_f32 v[90:91], v[90:91], v[172:173], v[172:173] op_sel:[0,1,0] op_sel_hi:[1,1,0]
    v_lshlrev_b32 v92, 16, v240
    v_and_b32 v93, 0xffff0000, v240
    v_lshlrev_b32 v94, 16, v241
    v_and_b32 v95, 0xffff0000, v241
    v_lshlrev_b32 v96, 16, v242
    v_and_b32 v97, 0xffff0000, v242
    v_lshlrev_b32 v98, 16, v243
    v_and_b32 v99, 0xffff0000, v243
    v_pk_fma_f32 v[92:93], v[92:93], v[174:175], v[174:175] op_sel:[0,1,0] op_sel_hi:[1,1,0]
    v_pk_fma_f32 v[94:95], v[94:95], v[174:175], v[174:175] op_sel:[0,1,0] op_sel_hi:[1,1,0]
    v_pk_fma_f32 v[96:97], v[96:97], v[174:175], v[174:175] op_sel:[0,1,0] op_sel_hi:[1,1,0]
    v_pk_fma_f32 v[98:99], v[98:99], v[174:175], v[174:175] op_sel:[0,1,0] op_sel_hi:[1,1,0]
    v_lshlrev_b32 v100, 16, v244
    v_and_b32 v101, 0xffff0000, v244
    v_lshlrev_b32 v102, 16, v245
    v_and_b32 v103, 0xffff0000, v245
    v_lshlrev_b32 v104, 16, v246
    v_and_b32 v105, 0xffff0000, v246
    v_lshlrev_b32 v106, 16, v247
    v_and_b32 v107, 0xffff0000, v247
    v_pk_fma_f32 v[100:101], v[100:101], v[176:177], v[176:177] op_sel:[0,1,0] op_sel_hi:[1,1,0]
    v_pk_fma_f32 v[102:103], v[102:103], v[176:177], v[176:177] op_sel:[0,1,0] op_sel_hi:[1,1,0]
    v_pk_fma_f32 v[104:105], v[104:105], v[176:177], v[176:177] op_sel:[0,1,0] op_sel_hi:[1,1,0]
    v_pk_fma_f32 v[106:107], v[106:107], v[176:177], v[176:177] op_sel:[0,1,0] op_sel_hi:[1,1,0]
    v_lshlrev_b32 v108, 16, v248
    v_and_b32 v109, 0xffff0000, v248
    v_lshlrev_b32 v110, 16, v249
    v_and_b32 v111, 0xffff0000, v249
    v_lshlrev_b32 v112, 16, v250
    v_and_b32 v113, 0xffff0000, v250
    v_lshlrev_b32 v114, 16, v251
    v_and_b32 v115, 0xffff0000, v251
    s_waitcnt lgkmcnt(0)
    v_pk_fma_f32 v[108:109], v[108:109], v[178:179], v[178:179] op_sel:[0,1,0] op_sel_hi:[1,1,0]
    v_pk_fma_f32 v[110:111], v[110:111], v[178:179], v[178:179] op_sel:[0,1,0] op_sel_hi:[1,1,0]
    v_pk_fma_f32 v[112:113], v[112:113], v[178:179], v[178:179] op_sel:[0,1,0] op_sel_hi:[1,1,0]
    v_pk_fma_f32 v[114:115], v[114:115], v[178:179], v[178:179] op_sel:[0,1,0] op_sel_hi:[1,1,0]
    v_lshlrev_b32 v116, 16, v252
    v_and_b32 v117, 0xffff0000, v252
    v_lshlrev_b32 v118, 16, v253
    v_and_b32 v119, 0xffff0000, v253
    v_pk_fma_f32 v[116:117], v[116:117], v[172:173], v[172:173] op_sel:[0,1,0] op_sel_hi:[1,1,0]
    v_pk_fma_f32 v[118:119], v[118:119], v[172:173], v[172:173] op_sel:[0,1,0] op_sel_hi:[1,1,0]
    v_add_u32 v203, s96, v254
    v_add_u32 v204, s97, v254
    v_add_u32 v205, s98, v254
    v_add_u32 v206, s99, v254
    s_barrier
    ds_read_b64_tr_b16 v[120:121], v200 offset:55296
    ds_read_b64_tr_b16 v[122:123], v200 offset:59904
    ds_read_b64_tr_b16 v[124:125], v201 offset:55296
    ds_read_b64_tr_b16 v[126:127], v201 offset:59904
    ds_read_b64_tr_b16 v[128:129], v202 offset:59392
    ds_read_b64_tr_b16 v[130:131], v202 offset:64000
    ds_read_b64_tr_b16 v[132:133], v200 offset:64512
    v_add_u32 v200, 0x0000ec00, v200
    ds_read_b64_tr_b16 v[134:135], v200 offset:8704
    ds_read_b64_tr_b16 v[136:137], v201 offset:64512
    v_add_u32 v201, 0x0000ec00, v201
    ds_read_b64_tr_b16 v[138:139], v201 offset:8704
    v_add_u32 v202, 0x0000ec00, v202
    ds_read_b64_tr_b16 v[140:141], v202 offset:8192
    ds_read_b64_tr_b16 v[142:143], v202 offset:12800
    ds_read_b64_tr_b16 v[144:145], v200 offset:13312
    ds_read_b64_tr_b16 v[146:147], v200 offset:17920
    ds_read_b64_tr_b16 v[148:149], v201 offset:13312
    ds_read_b64_tr_b16 v[150:151], v201 offset:17920
    ds_read_b64_tr_b16 v[152:153], v202 offset:17408
    ds_read_b64_tr_b16 v[154:155], v202 offset:22016
    ds_read_b64_tr_b16 v[156:157], v200 offset:22528
    ds_read_b64_tr_b16 v[158:159], v200 offset:27136
    ds_read_b64_tr_b16 v[160:161], v201 offset:22528
    ds_read_b64_tr_b16 v[162:163], v201 offset:27136
    ds_read_b64_tr_b16 v[164:165], v202 offset:26624
    ds_read_b64_tr_b16 v[166:167], v202 offset:31232
    ds_read_b64_tr_b16 v[168:169], v200 offset:31744
    ds_read_b64_tr_b16 v[170:171], v200 offset:36352
    ds_read_b64_tr_b16 v[172:173], v201 offset:31744
    ds_read_b64_tr_b16 v[174:175], v201 offset:36352
    ds_read_b64_tr_b16 v[176:177], v202 offset:35840
    ds_read_b64_tr_b16 v[178:179], v202 offset:40448
    ds_read_b64_tr_b16 v[180:181], v200 offset:40960
    ds_read_b64_tr_b16 v[182:183], v200 offset:45568
    ds_read_b64_tr_b16 v[184:185], v201 offset:40960
    ds_read_b64_tr_b16 v[186:187], v201 offset:45568
    ds_read_b64_tr_b16 v[188:189], v202 offset:45056
    ds_read_b64_tr_b16 v[190:191], v202 offset:49664
    s_mul_i32 s64, s49, 288
    s_add_u32 s64, s64, 159744
    v_lshl_add_u32 v218, v255, 2, s64
    s_mov_b32 s62, 0
    s_mov_b32 exec_hi, 0x0000000f
    s_waitcnt vmcnt(0)
L_wb_41:
    v_cmp_ne_u32 s[70:71], s55, v1
    v_cmp_ne_u32 vcc, s55, v3
    s_nop 1
    s_or_b64 s[70:71], s[70:71], vcc
    v_cmp_ne_u32 vcc, s55, v5
    s_nop 1
    s_or_b64 s[70:71], s[70:71], vcc
    v_cmp_ne_u32 vcc, s55, v7
    s_nop 1
    s_or_b64 s[70:71], s[70:71], vcc
    s_cbranch_scc1 L_wbre_43
L_wbok_42:
    v_cvt_pk_bf16_f32 v0, v0, v2
    ds_write_b32 v218, v0 offset:0
    ds_write_b32 v218, v0 offset:1152
    v_cvt_pk_bf16_f32 v4, v4, v6
    ds_write_b32 v218, v4 offset:144
    ds_write_b32 v218, v4 offset:1296
    s_mov_b64 exec, -1
    s_waitcnt lgkmcnt(0)
    s_barrier
    s_lshr_b32 s64, s96, 4
    s_add_u32 s64, s64, 159744
    v_and_b32 v218, 15, v255
    v_lshl_add_u32 v207, v218, 2, s64
    s_lshr_b32 s64, s97, 4
    s_add_u32 s64, s64, 159744
    v_and_b32 v218, 15, v255
    v_lshl_add_u32 v208, v218, 2, s64
    s_lshr_b32 s64, s98, 4
    s_add_u32 s64, s64, 159744
    v_and_b32 v218, 15, v255
    v_lshl_add_u32 v209, v218, 2, s64
    s_lshr_b32 s64, s99, 4
    s_add_u32 s64, s64, 159744
    v_and_b32 v218, 15, v255
    v_lshl_add_u32 v210, v218, 2, s64
    s_lshl_b32 s64, s57, 2
    s_add_u32 s64, s64, s49
    s_lshl_b32 s64, s64, 10
    s_mul_i32 s65, s56, 73728
    s_add_u32 s65, s65, 6553600
    s_add_u32 s64, s64, s65
    s_mul_i32 s61, s96, 18
    s_add_u32 s61, s61, s65
    s_lshl_b32 s65, s57, 9
    s_add_u32 s61, s61, s65
    s_add_u32 s61, s61, 16384
    s_mul_i32 s96, s96, 18
    s_add_u32 s96, s96, s64
    s_mul_i32 s97, s97, 18
    s_add_u32 s97, s97, s64
    s_mul_i32 s98, s98, 18
    s_add_u32 s98, s98, s64
    s_mul_i32 s99, s99, 18
    s_add_u32 s99, s99, s64
    s_and_b32 s64, s49, 1
    s_lshl_b32 s64, s64, 5
    v_xor_b32 v218, s64, v255
    s_lshl_b32 s64, s49, 9
    s_lshr_b32 s65, s49, 1
    s_lshl_b32 s65, s65, 8
    s_add_u32 s64, s64, s65
    s_add_u32 s64, s64, 161792
    v_lshl_add_u32 v211, v218, 2, s64
    v_xor_b32 v212, 256, v211
    v_lshlrev_b32 v215, 3, v255
    v_lshlrev_b32 v213, 7, v255
    s_lshl_b32 s58, s56, 12
    s_lshl_b32 s65, s57, 2
    s_add_u32 s58, s58, s65
    s_add_u32 s58, s58, 20480
    s_lshl_b32 s65, s49, 10
    s_add_u32 s58, s58, s65
    s_getpc_b64 s[70:71]
L_pc_44:
    s_lshl_b32 s64, s51, 3
    s_add_u32 s64, s64, s48
    s_mul_i32 s64, s64, 192
    s_sub_u32 s70, s70, L_pc_44-parallel_sum__linear_kernel_hedgehog__mixer_s_mlp__prompt_kernel
    s_subb_u32 s71, s71, 0
    s_add_u32 s64, s64, L_S34-parallel_sum__linear_kernel_hedgehog__mixer_s_mlp__prompt_kernel
    s_min_u32 s64, s64, L_code_end-parallel_sum__linear_kernel_hedgehog__mixer_s_mlp__prompt_kernel-192
    s_load_dword s62, s[70:71], s64 offset:0
    s_load_dword s62, s[70:71], s64 offset:64
    s_load_dword s62, s[70:71], s64 offset:128
    s_waitcnt lgkmcnt(0)
    s_barrier
    v_add_u32 v200, 0xffff1400, v200
    ds_read_b64_tr_b16 v[16:17], v200 offset:0
    ds_read_b64_tr_b16 v[18:19], v200 offset:4608
    v_add_u32 v203, 0x00019000, v203
    ds_read_b128 v[0:3], v203 offset:8192
    v_add_u32 v201, 0xffff1400, v201
    ds_read_b64_tr_b16 v[20:21], v201 offset:0
    ds_read_b64_tr_b16 v[22:23], v201 offset:4608
    v_add_u32 v204, 0x00019000, v204
    ds_read_b128 v[4:7], v204 offset:8192
    v_add_u32 v205, 0x00019000, v205
    ds_read_b128 v[8:11], v205 offset:8192
    v_add_u32 v206, 0x00019000, v206
    ds_read_b128 v[12:15], v206 offset:8192
    v_add_u32 v202, 0xffff1400, v202
    ds_read_b64_tr_b16 v[24:25], v202 offset:4096
    ds_read_b64_tr_b16 v[26:27], v202 offset:8704
    ds_read_b64_tr_b16 v[44:45], v200 offset:9216
    ds_read_b64_tr_b16 v[46:47], v200 offset:13824
    ds_read_b128 v[28:31], v203 offset:12288
    ds_read_b64_tr_b16 v[48:49], v201 offset:9216
    ds_read_b64_tr_b16 v[50:51], v201 offset:13824
    ds_read_b128 v[32:35], v204 offset:12288
    ds_read_b128 v[36:39], v205 offset:12288
    ds_read_b128 v[40:43], v206 offset:12288
    ds_read_b64_tr_b16 v[52:53], v202 offset:13312
    ds_read_b64_tr_b16 v[54:55], v202 offset:17920
    s_barrier
    s_waitcnt lgkmcnt(15)
    v_mfma_f32_16x16x32_bf16 v[84:87], v[16:19], v[0:3], v[84:87]
    ds_read_b64_tr_b16 v[72:73], v200 offset:18432
    ds_read_b64_tr_b16 v[74:75], v200 offset:23040
    v_mfma_f32_16x16x32_bf16 v[88:91], v[20:23], v[0:3], v[88:91]
    ds_read_b128 v[56:59], v203 offset:16384
    ds_read_b64_tr_b16 v[76:77], v201 offset:18432
    s_waitcnt lgkmcnt(15)
    v_mfma_f32_16x16x32_bf16 v[92:95], v[16:19], v[4:7], v[92:95]
    ds_read_b64_tr_b16 v[78:79], v201 offset:23040
    ds_read_b128 v[60:63], v204 offset:16384
    v_mfma_f32_16x16x32_bf16 v[96:99], v[20:23], v[4:7], v[96:99]
    ds_read_b128 v[64:67], v205 offset:16384
    ds_read_b128 v[68:71], v206 offset:16384
    v_mfma_f32_16x16x32_bf16 v[100:103], v[16:19], v[8:11], v[100:103]
    ds_read_b64_tr_b16 v[80:81], v202 offset:22528
    ds_read_b64_tr_b16 v[82:83], v202 offset:27136
    v_mfma_f32_16x16x32_bf16 v[104:107], v[20:23], v[8:11], v[104:107]
    v_mfma_f32_16x16x32_bf16 v[108:111], v[16:19], v[12:15], v[108:111]
    v_mfma_f32_16x16x32_bf16 v[112:115], v[20:23], v[12:15], v[112:115]
    s_waitcnt lgkmcnt(15)
    v_mfma_f32_16x16x32_bf16 v[116:119], v[24:27], v[0:3], v[116:119]
    v_mfma_f32_16x16x32_bf16 v[84:87], v[44:47], v[28:31], v[84:87]
    ds_read_b64_tr_b16 v[16:17], v200 offset:27648
    ds_read_b64_tr_b16 v[18:19], v200 offset:32256
    v_mfma_f32_16x16x32_bf16 v[88:91], v[48:51], v[28:31], v[88:91]
    ds_read_b128 v[0:3], v203 offset:20480
    ds_read_b64_tr_b16 v[20:21], v201 offset:27648
    s_waitcnt lgkmcnt(15)
    v_mfma_f32_16x16x32_bf16 v[92:95], v[44:47], v[32:35], v[92:95]
    ds_read_b64_tr_b16 v[22:23], v201 offset:32256
    ds_read_b128 v[4:7], v204 offset:20480
    v_mfma_f32_16x16x32_bf16 v[96:99], v[48:51], v[32:35], v[96:99]
    ds_read_b128 v[8:11], v205 offset:20480
    ds_read_b128 v[12:15], v206 offset:20480
    v_mfma_f32_16x16x32_bf16 v[100:103], v[44:47], v[36:39], v[100:103]
    ds_read_b64_tr_b16 v[24:25], v202 offset:31744
    ds_read_b64_tr_b16 v[26:27], v202 offset:36352
    v_mfma_f32_16x16x32_bf16 v[104:107], v[48:51], v[36:39], v[104:107]
    v_mfma_f32_16x16x32_bf16 v[108:111], v[44:47], v[40:43], v[108:111]
    v_mfma_f32_16x16x32_bf16 v[112:115], v[48:51], v[40:43], v[112:115]
    s_waitcnt lgkmcnt(15)
    v_mfma_f32_16x16x32_bf16 v[116:119], v[52:55], v[28:31], v[116:119]
    s_barrier
    v_mfma_f32_16x16x32_bf16 v[84:87], v[72:75], v[56:59], v[84:87]
    ds_read_b64_tr_b16 v[44:45], v200 offset:36864
    ds_read_b64_tr_b16 v[46:47], v200 offset:41472
    v_mfma_f32_16x16x32_bf16 v[88:91], v[76:79], v[56:59], v[88:91]
    ds_read_b128 v[28:31], v203 offset:24576
    ds_read_b64_tr_b16 v[48:49], v201 offset:36864
    s_waitcnt lgkmcnt(15)
    v_mfma_f32_16x16x32_bf16 v[92:95], v[72:75], v[60:63], v[92:95]
    ds_read_b64_tr_b16 v[50:51], v201 offset:41472
    ds_read_b128 v[32:35], v204 offset:24576
    v_mfma_f32_16x16x32_bf16 v[96:99], v[76:79], v[60:63], v[96:99]
    ds_read_b128 v[36:39], v205 offset:24576
    ds_read_b128 v[40:43], v206 offset:24576
    v_mfma_f32_16x16x32_bf16 v[100:103], v[72:75], v[64:67], v[100:103]
    ds_read_b64_tr_b16 v[52:53], v202 offset:40960
    ds_read_b64_tr_b16 v[54:55], v202 offset:45568
    v_mfma_f32_16x16x32_bf16 v[104:107], v[76:79], v[64:67], v[104:107]
    v_mfma_f32_16x16x32_bf16 v[108:111], v[72:75], v[68:71], v[108:111]
    v_mfma_f32_16x16x32_bf16 v[112:115], v[76:79], v[68:71], v[112:115]
    s_waitcnt lgkmcnt(15)
    v_mfma_f32_16x16x32_bf16 v[116:119], v[80:83], v[56:59], v[116:119]
    v_mfma_f32_16x16x32_bf16 v[84:87], v[16:19], v[0:3], v[84:87]
    ds_read_b64_tr_b16 v[72:73], v200 offset:46080
    ds_read_b64_tr_b16 v[74:75], v200 offset:50688
    v_mfma_f32_16x16x32_bf16 v[88:91], v[20:23], v[0:3], v[88:91]
    ds_read_b128 v[56:59], v203 offset:28672
    ds_read_b64_tr_b16 v[76:77], v201 offset:46080
    s_waitcnt lgkmcnt(15)
    v_mfma_f32_16x16x32_bf16 v[92:95], v[16:19], v[4:7], v[92:95]
    ds_read_b64_tr_b16 v[78:79], v201 offset:50688
    ds_read_b128 v[60:63], v204 offset:28672
    v_mfma_f32_16x16x32_bf16 v[96:99], v[20:23], v[4:7], v[96:99]
    ds_read_b128 v[64:67], v205 offset:28672
    ds_read_b128 v[68:71], v206 offset:28672
    v_mfma_f32_16x16x32_bf16 v[100:103], v[16:19], v[8:11], v[100:103]
    ds_read_b64_tr_b16 v[80:81], v202 offset:50176
    ds_read_b64_tr_b16 v[82:83], v202 offset:54784
    v_mfma_f32_16x16x32_bf16 v[104:107], v[20:23], v[8:11], v[104:107]
    v_mfma_f32_16x16x32_bf16 v[108:111], v[16:19], v[12:15], v[108:111]
    v_mfma_f32_16x16x32_bf16 v[112:115], v[20:23], v[12:15], v[112:115]
    s_waitcnt lgkmcnt(15)
    v_mfma_f32_16x16x32_bf16 v[116:119], v[24:27], v[0:3], v[116:119]
    s_barrier
    v_mfma_f32_16x16x32_bf16 v[84:87], v[44:47], v[28:31], v[84:87]
    ds_read_b64_tr_b16 v[16:17], v200 offset:55296
    ds_read_b64_tr_b16 v[18:19], v200 offset:59904
    v_mfma_f32_16x16x32_bf16 v[88:91], v[48:51], v[28:31], v[88:91]
    ds_read_b128 v[0:3], v203 offset:32768
    ds_read_b64_tr_b16 v[20:21], v201 offset:55296
    s_waitcnt lgkmcnt(15)
    v_mfma_f32_16x16x32_bf16 v[92:95], v[44:47], v[32:35], v[92:95]
    ds_read_b64_tr_b16 v[22:23], v201 offset:59904
    ds_read_b128 v[4:7], v204 offset:32768
    v_mfma_f32_16x16x32_bf16 v[96:99], v[48:51], v[32:35], v[96:99]
    ds_read_b128 v[8:11], v205 offset:32768
    ds_read_b128 v[12:15], v206 offset:32768
    v_mfma_f32_16x16x32_bf16 v[100:103], v[44:47], v[36:39], v[100:103]
    ds_read_b64_tr_b16 v[24:25], v202 offset:59392
    ds_read_b64_tr_b16 v[26:27], v202 offset:64000
    v_mfma_f32_16x16x32_bf16 v[104:107], v[48:51], v[36:39], v[104:107]
    v_mfma_f32_16x16x32_bf16 v[108:111], v[44:47], v[40:43], v[108:111]
    v_mfma_f32_16x16x32_bf16 v[112:115], v[48:51], v[40:43], v[112:115]
    s_waitcnt lgkmcnt(15)
    v_mfma_f32_16x16x32_bf16 v[116:119], v[52:55], v[28:31], v[116:119]
    v_mfma_f32_16x16x32_bf16 v[84:87], v[72:75], v[56:59], v[84:87]
    ds_read_b64_tr_b16 v[44:45], v200 offset:64512
    v_add_u32 v200, 0x0000ec00, v200
    ds_read_b64_tr_b16 v[46:47], v200 offset:8704
    v_mfma_f32_16x16x32_bf16 v[88:91], v[76:79], v[56:59], v[88:91]
    ds_read_b128 v[28:31], v203 offset:36864
    ds_read_b64_tr_b16 v[48:49], v201 offset:64512
    s_waitcnt lgkmcnt(15)
    v_mfma_f32_16x16x32_bf16 v[92:95], v[72:75], v[60:63], v[92:95]
    v_add_u32 v201, 0x0000ec00, v201
    ds_read_b64_tr_b16 v[50:51], v201 offset:8704
    ds_read_b128 v[32:35], v204 offset:36864
    v_mfma_f32_16x16x32_bf16 v[96:99], v[76:79], v[60:63], v[96:99]
    ds_read_b128 v[36:39], v205 offset:36864
    ds_read_b128 v[40:43], v206 offset:36864
    v_mfma_f32_16x16x32_bf16 v[100:103], v[72:75], v[64:67], v[100:103]
    v_add_u32 v202, 0x0000ec00, v202
    ds_read_b64_tr_b16 v[52:53], v202 offset:8192
    ds_read_b64_tr_b16 v[54:55], v202 offset:12800
    v_mfma_f32_16x16x32_bf16 v[104:107], v[76:79], v[64:67], v[104:107]
    v_mfma_f32_16x16x32_bf16 v[108:111], v[72:75], v[68:71], v[108:111]
    v_mfma_f32_16x16x32_bf16 v[112:115], v[76:79], v[68:71], v[112:115]
    s_waitcnt lgkmcnt(15)
    v_mfma_f32_16x16x32_bf16 v[116:119], v[80:83], v[56:59], v[116:119]
    s_barrier
    v_mfma_f32_16x16x32_bf16 v[84:87], v[16:19], v[0:3], v[84:87]
    ds_read_b64_tr_b16 v[72:73], v200 offset:13312
    ds_read_b64_tr_b16 v[74:75], v200 offset:17920
    v_mfma_f32_16x16x32_bf16 v[88:91], v[20:23], v[0:3], v[88:91]
    ds_read_b128 v[56:59], v203 offset:40960
    ds_read_b64_tr_b16 v[76:77], v201 offset:13312
    s_waitcnt lgkmcnt(15)
    v_mfma_f32_16x16x32_bf16 v[92:95], v[16:19], v[4:7], v[92:95]
    ds_read_b64_tr_b16 v[78:79], v201 offset:17920
    ds_read_b128 v[60:63], v204 offset:40960
    v_mfma_f32_16x16x32_bf16 v[96:99], v[20:23], v[4:7], v[96:99]
    ds_read_b128 v[64:67], v205 offset:40960
    ds_read_b128 v[68:71], v206 offset:40960
    v_mfma_f32_16x16x32_bf16 v[100:103], v[16:19], v[8:11], v[100:103]
    ds_read_b64_tr_b16 v[80:81], v202 offset:17408
    ds_read_b64_tr_b16 v[82:83], v202 offset:22016
    v_mfma_f32_16x16x32_bf16 v[104:107], v[20:23], v[8:11], v[104:107]
    v_mfma_f32_16x16x32_bf16 v[108:111], v[16:19], v[12:15], v[108:111]
    v_mfma_f32_16x16x32_bf16 v[112:115], v[20:23], v[12:15], v[112:115]
    s_waitcnt lgkmcnt(15)
    v_mfma_f32_16x16x32_bf16 v[116:119], v[24:27], v[0:3], v[116:119]
    v_mfma_f32_16x16x32_bf16 v[84:87], v[44:47], v[28:31], v[84:87]
    ds_read_b64_tr_b16 v[16:17], v200 offset:22528
    ds_read_b64_tr_b16 v[18:19], v200 offset:27136
    v_mfma_f32_16x16x32_bf16 v[88:91], v[48:51], v[28:31], v[88:91]
    ds_read_b128 v[0:3], v203 offset:45056
    ds_read_b64_tr_b16 v[20:21], v201 offset:22528
    s_waitcnt lgkmcnt(15)
    v_mfma_f32_16x16x32_bf16 v[92:95], v[44:47], v[32:35], v[92:95]
    ds_read_b64_tr_b16 v[22:23], v201 offset:27136
    ds_read_b128 v[4:7], v204 offset:45056
    v_mfma_f32_16x16x32_bf16 v[96:99], v[48:51], v[32:35], v[96:99]
    ds_read_b128 v[8:11], v205 offset:45056
    ds_read_b128 v[12:15], v206 offset:45056
    v_mfma_f32_16x16x32_bf16 v[100:103], v[44:47], v[36:39], v[100:103]
    ds_read_b64_tr_b16 v[24:25], v202 offset:26624
    ds_read_b64_tr_b16 v[26:27], v202 offset:31232
    v_mfma_f32_16x16x32_bf16 v[104:107], v[48:51], v[36:39], v[104:107]
    v_mfma_f32_16x16x32_bf16 v[108:111], v[44:47], v[40:43], v[108:111]
    v_mfma_f32_16x16x32_bf16 v[112:115], v[48:51], v[40:43], v[112:115]
    s_waitcnt lgkmcnt(15)
    v_mfma_f32_16x16x32_bf16 v[116:119], v[52:55], v[28:31], v[116:119]
    s_barrier
    v_mfma_f32_16x16x32_bf16 v[84:87], v[72:75], v[56:59], v[84:87]
    ds_read_b64_tr_b16 v[44:45], v200 offset:31744
    ds_read_b64_tr_b16 v[46:47], v200 offset:36352
    v_mfma_f32_16x16x32_bf16 v[88:91], v[76:79], v[56:59], v[88:91]
    ds_read_b128 v[28:31], v203 offset:49152
    ds_read_b64_tr_b16 v[48:49], v201 offset:31744
    s_waitcnt lgkmcnt(15)
    v_mfma_f32_16x16x32_bf16 v[92:95], v[72:75], v[60:63], v[92:95]
    ds_read_b64_tr_b16 v[50:51], v201 offset:36352
    ds_read_b128 v[32:35], v204 offset:49152
    v_mfma_f32_16x16x32_bf16 v[96:99], v[76:79], v[60:63], v[96:99]
    ds_read_b128 v[36:39], v205 offset:49152
    ds_read_b128 v[40:43], v206 offset:49152
    v_mfma_f32_16x16x32_bf16 v[100:103], v[72:75], v[64:67], v[100:103]
    ds_read_b64_tr_b16 v[52:53], v202 offset:35840
    ds_read_b64_tr_b16 v[54:55], v202 offset:40448
    v_mfma_f32_16x16x32_bf16 v[104:107], v[76:79], v[64:67], v[104:107]
    v_mfma_f32_16x16x32_bf16 v[108:111], v[72:75], v[68:71], v[108:111]
    v_mfma_f32_16x16x32_bf16 v[112:115], v[76:79], v[68:71], v[112:115]
    s_waitcnt lgkmcnt(15)
    v_mfma_f32_16x16x32_bf16 v[116:119], v[80:83], v[56:59], v[116:119]
    v_mfma_f32_16x16x32_bf16 v[84:87], v[16:19], v[0:3], v[84:87]
    ds_read_b64_tr_b16 v[72:73], v200 offset:40960
    ds_read_b64_tr_b16 v[74:75], v200 offset:45568
    v_mfma_f32_16x16x32_bf16 v[88:91], v[20:23], v[0:3], v[88:91]
    ds_read_b128 v[56:59], v203 offset:53248
    ds_read_b64_tr_b16 v[76:77], v201 offset:40960
    s_waitcnt lgkmcnt(15)
    v_mfma_f32_16x16x32_bf16 v[92:95], v[16:19], v[4:7], v[92:95]
    ds_read_b64_tr_b16 v[78:79], v201 offset:45568
    ds_read_b128 v[60:63], v204 offset:53248
    v_mfma_f32_16x16x32_bf16 v[96:99], v[20:23], v[4:7], v[96:99]
    ds_read_b128 v[64:67], v205 offset:53248
    ds_read_b128 v[68:71], v206 offset:53248
    v_mfma_f32_16x16x32_bf16 v[100:103], v[16:19], v[8:11], v[100:103]
    ds_read_b64_tr_b16 v[80:81], v202 offset:45056
    ds_read_b64_tr_b16 v[82:83], v202 offset:49664
    v_mfma_f32_16x16x32_bf16 v[104:107], v[20:23], v[8:11], v[104:107]
    v_mfma_f32_16x16x32_bf16 v[108:111], v[16:19], v[12:15], v[108:111]
    v_mfma_f32_16x16x32_bf16 v[112:115], v[20:23], v[12:15], v[112:115]
    s_waitcnt lgkmcnt(15)
    v_mfma_f32_16x16x32_bf16 v[116:119], v[24:27], v[0:3], v[116:119]
    s_barrier
    v_mfma_f32_16x16x32_bf16 v[84:87], v[44:47], v[28:31], v[84:87]
    ds_read_b128 v[0:3], v203 offset:8192
    ds_read_b128 v[4:7], v204 offset:8192
    v_mfma_f32_16x16x32_bf16 v[88:91], v[48:51], v[28:31], v[88:91]
    ds_read_b128 v[8:11], v205 offset:8192
    ds_read_b128 v[12:15], v206 offset:8192
    s_waitcnt lgkmcnt(15)
    v_mfma_f32_16x16x32_bf16 v[92:95], v[44:47], v[32:35], v[92:95]
    v_mfma_f32_16x16x32_bf16 v[96:99], v[48:51], v[32:35], v[96:99]
    v_mfma_f32_16x16x32_bf16 v[100:103], v[44:47], v[36:39], v[100:103]
    v_mfma_f32_16x16x32_bf16 v[104:107], v[48:51], v[36:39], v[104:107]
    v_mfma_f32_16x16x32_bf16 v[108:111], v[44:47], v[40:43], v[108:111]
    v_mfma_f32_16x16x32_bf16 v[112:115], v[48:51], v[40:43], v[112:115]
    s_waitcnt lgkmcnt(14)
    v_mfma_f32_16x16x32_bf16 v[116:119], v[52:55], v[28:31], v[116:119]
    s_waitcnt lgkmcnt(11)
    v_mfma_f32_16x16x32_bf16 v[84:87], v[72:75], v[56:59], v[84:87]
    ds_read_b128 v[28:31], v203 offset:12288
    ds_read_b128 v[32:35], v204 offset:12288
    s_waitcnt lgkmcnt(11)
    v_mfma_f32_16x16x32_bf16 v[88:91], v[76:79], v[56:59], v[88:91]
    ds_read_b128 v[36:39], v205 offset:12288
    ds_read_b128 v[40:43], v206 offset:12288
    s_waitcnt lgkmcnt(12)
    v_mfma_f32_16x16x32_bf16 v[92:95], v[72:75], v[60:63], v[92:95]
    v_mfma_f32_16x16x32_bf16 v[96:99], v[76:79], v[60:63], v[96:99]
    s_waitcnt lgkmcnt(11)
    v_mfma_f32_16x16x32_bf16 v[100:103], v[72:75], v[64:67], v[100:103]
    v_mfma_f32_16x16x32_bf16 v[104:107], v[76:79], v[64:67], v[104:107]
    s_waitcnt lgkmcnt(10)
    v_mfma_f32_16x16x32_bf16 v[108:111], v[72:75], v[68:71], v[108:111]
    v_mfma_f32_16x16x32_bf16 v[112:115], v[76:79], v[68:71], v[112:115]
    s_waitcnt lgkmcnt(8)
    v_mfma_f32_16x16x32_bf16 v[116:119], v[80:83], v[56:59], v[116:119]
    s_barrier
    s_waitcnt lgkmcnt(7)
    v_mfma_f32_16x16x32_bf16 v[84:87], v[120:123], v[0:3], v[84:87]
    ds_read_b128 v[56:59], v203 offset:16384
    ds_read_b128 v[60:63], v204 offset:16384
    v_mfma_f32_16x16x32_bf16 v[88:91], v[124:127], v[0:3], v[88:91]
    ds_read_b128 v[64:67], v205 offset:16384
    ds_read_b128 v[68:71], v206 offset:16384
    s_waitcnt lgkmcnt(10)
    v_mfma_f32_16x16x32_bf16 v[92:95], v[120:123], v[4:7], v[92:95]
    v_mfma_f32_16x16x32_bf16 v[96:99], v[124:127], v[4:7], v[96:99]
    s_waitcnt lgkmcnt(9)
    v_mfma_f32_16x16x32_bf16 v[100:103], v[120:123], v[8:11], v[100:103]
    v_mfma_f32_16x16x32_bf16 v[104:107], v[124:127], v[8:11], v[104:107]
    s_waitcnt lgkmcnt(8)
    v_mfma_f32_16x16x32_bf16 v[108:111], v[120:123], v[12:15], v[108:111]
    v_mfma_f32_16x16x32_bf16 v[112:115], v[124:127], v[12:15], v[112:115]
    v_mfma_f32_16x16x32_bf16 v[116:119], v[128:131], v[0:3], v[116:119]
    s_waitcnt lgkmcnt(7)
    v_mfma_f32_16x16x32_bf16 v[84:87], v[132:135], v[28:31], v[84:87]
    ds_read_b128 v[0:3], v203 offset:20480
    ds_read_b128 v[4:7], v204 offset:20480
    v_mfma_f32_16x16x32_bf16 v[88:91], v[136:139], v[28:31], v[88:91]
    ds_read_b128 v[8:11], v205 offset:20480
    ds_read_b128 v[12:15], v206 offset:20480
    s_waitcnt lgkmcnt(10)
    v_mfma_f32_16x16x32_bf16 v[92:95], v[132:135], v[32:35], v[92:95]
    v_mfma_f32_16x16x32_bf16 v[96:99], v[136:139], v[32:35], v[96:99]
    s_waitcnt lgkmcnt(9)
    v_mfma_f32_16x16x32_bf16 v[100:103], v[132:135], v[36:39], v[100:103]
    v_mfma_f32_16x16x32_bf16 v[104:107], v[136:139], v[36:39], v[104:107]
    s_waitcnt lgkmcnt(8)
    v_mfma_f32_16x16x32_bf16 v[108:111], v[132:135], v[40:43], v[108:111]
    v_mfma_f32_16x16x32_bf16 v[112:115], v[136:139], v[40:43], v[112:115]
    v_mfma_f32_16x16x32_bf16 v[116:119], v[140:143], v[28:31], v[116:119]
    s_barrier
    s_waitcnt lgkmcnt(7)
    v_mfma_f32_16x16x32_bf16 v[84:87], v[144:147], v[56:59], v[84:87]
    ds_read_b128 v[28:31], v203 offset:24576
    ds_read_b128 v[32:35], v204 offset:24576
    v_mfma_f32_16x16x32_bf16 v[88:91], v[148:151], v[56:59], v[88:91]
    ds_read_b128 v[36:39], v205 offset:24576
    ds_read_b128 v[40:43], v206 offset:24576
    s_waitcnt lgkmcnt(10)
    v_mfma_f32_16x16x32_bf16 v[92:95], v[144:147], v[60:63], v[92:95]
    v_mfma_f32_16x16x32_bf16 v[96:99], v[148:151], v[60:63], v[96:99]
    s_waitcnt lgkmcnt(9)
    v_mfma_f32_16x16x32_bf16 v[100:103], v[144:147], v[64:67], v[100:103]
    v_mfma_f32_16x16x32_bf16 v[104:107], v[148:151], v[64:67], v[104:107]
    s_waitcnt lgkmcnt(8)
    v_mfma_f32_16x16x32_bf16 v[108:111], v[144:147], v[68:71], v[108:111]
    v_mfma_f32_16x16x32_bf16 v[112:115], v[148:151], v[68:71], v[112:115]
    v_mfma_f32_16x16x32_bf16 v[116:119], v[152:155], v[56:59], v[116:119]
    s_waitcnt lgkmcnt(7)
    v_mfma_f32_16x16x32_bf16 v[84:87], v[156:159], v[0:3], v[84:87]
    ds_read_b128 v[56:59], v203 offset:28672
    ds_read_b128 v[60:63], v204 offset:28672
    v_mfma_f32_16x16x32_bf16 v[88:91], v[160:163], v[0:3], v[88:91]
    ds_read_b128 v[64:67], v205 offset:28672
    ds_read_b128 v[68:71], v206 offset:28672
    s_waitcnt lgkmcnt(10)
    v_mfma_f32_16x16x32_bf16 v[92:95], v[156:159], v[4:7], v[92:95]
    v_mfma_f32_16x16x32_bf16 v[96:99], v[160:163], v[4:7], v[96:99]
    s_waitcnt lgkmcnt(9)
    v_mfma_f32_16x16x32_bf16 v[100:103], v[156:159], v[8:11], v[100:103]
    v_mfma_f32_16x16x32_bf16 v[104:107], v[160:163], v[8:11], v[104:107]
    s_waitcnt lgkmcnt(8)
    v_mfma_f32_16x16x32_bf16 v[108:111], v[156:159], v[12:15], v[108:111]
    v_mfma_f32_16x16x32_bf16 v[112:115], v[160:163], v[12:15], v[112:115]
    v_mfma_f32_16x16x32_bf16 v[116:119], v[164:167], v[0:3], v[116:119]
    s_waitcnt lgkmcnt(7)
    v_mfma_f32_16x16x32_bf16 v[84:87], v[168:171], v[28:31], v[84:87]
    v_mfma_f32_16x16x32_bf16 v[88:91], v[172:175], v[28:31], v[88:91]
    s_waitcnt lgkmcnt(6)
    v_mfma_f32_16x16x32_bf16 v[92:95], v[168:171], v[32:35], v[92:95]
    v_mfma_f32_16x16x32_bf16 v[96:99], v[172:175], v[32:35], v[96:99]
    s_waitcnt lgkmcnt(5)
    v_mfma_f32_16x16x32_bf16 v[100:103], v[168:171], v[36:39], v[100:103]
    v_mfma_f32_16x16x32_bf16 v[104:107], v[172:175], v[36:39], v[104:107]
    s_waitcnt lgkmcnt(4)
    v_mfma_f32_16x16x32_bf16 v[108:111], v[168:171], v[40:43], v[108:111]
    v_mfma_f32_16x16x32_bf16 v[112:115], v[172:175], v[40:43], v[112:115]
    v_mfma_f32_16x16x32_bf16 v[116:119], v[176:179], v[28:31], v[116:119]
    s_waitcnt lgkmcnt(3)
    v_mfma_f32_16x16x32_bf16 v[84:87], v[180:183], v[56:59], v[84:87]
    v_mfma_f32_16x16x32_bf16 v[88:91], v[184:187], v[56:59], v[88:91]
    s_waitcnt lgkmcnt(2)
    v_mfma_f32_16x16x32_bf16 v[92:95], v[180:183], v[60:63], v[92:95]
    v_mfma_f32_16x16x32_bf16 v[96:99], v[184:187], v[60:63], v[96:99]
    s_waitcnt lgkmcnt(1)
    v_mfma_f32_16x16x32_bf16 v[100:103], v[180:183], v[64:67], v[100:103]
    v_mfma_f32_16x16x32_bf16 v[104:107], v[184:187], v[64:67], v[104:107]
    s_waitcnt lgkmcnt(0)
    v_mfma_f32_16x16x32_bf16 v[108:111], v[180:183], v[68:71], v[108:111]
    v_mfma_f32_16x16x32_bf16 v[112:115], v[184:187], v[68:71], v[112:115]
    v_mfma_f32_16x16x32_bf16 v[116:119], v[188:191], v[56:59], v[116:119]
    v_pk_add_f32 v[156:157], v[84:85], v[86:87]
    v_pk_mul_f32 v[164:165], v[84:85], v[84:85]
    v_pk_add_f32 v[158:159], v[92:93], v[94:95]
    v_pk_mul_f32 v[166:167], v[92:93], v[92:93]
    v_pk_add_f32 v[160:161], v[100:101], v[102:103]
    v_pk_mul_f32 v[168:169], v[100:101], v[100:101]
    v_pk_add_f32 v[162:163], v[108:109], v[110:111]
    v_pk_mul_f32 v[170:171], v[108:109], v[108:109]
    v_pk_fma_f32 v[164:165], v[86:87], v[86:87], v[164:165]
    v_pk_fma_f32 v[166:167], v[94:95], v[94:95], v[166:167]
    v_pk_fma_f32 v[168:169], v[102:103], v[102:103], v[168:169]
    v_pk_fma_f32 v[170:171], v[110:111], v[110:111], v[170:171]
    v_pk_add_f32 v[156:157], v[156:157], v[88:89]
    v_pk_fma_f32 v[164:165], v[88:89], v[88:89], v[164:165]
    v_pk_add_f32 v[158:159], v[158:159], v[96:97]
    v_pk_fma_f32 v[166:167], v[96:97], v[96:97], v[166:167]
    v_pk_add_f32 v[160:161], v[160:161], v[104:105]
    v_pk_fma_f32 v[168:169], v[104:105], v[104:105], v[168:169]
    v_pk_add_f32 v[162:163], v[162:163], v[112:113]
    v_pk_fma_f32 v[170:171], v[112:113], v[112:113], v[170:171]
    v_pk_add_f32 v[156:157], v[156:157], v[90:91]
    v_pk_fma_f32 v[164:165], v[90:91], v[90:91], v[164:165]
    v_pk_add_f32 v[158:159], v[158:159], v[98:99]
    v_pk_fma_f32 v[166:167], v[98:99], v[98:99], v[166:167]
    v_pk_add_f32 v[160:161], v[160:161], v[106:107]
    v_pk_fma_f32 v[168:169], v[106:107], v[106:107], v[168:169]
    v_pk_add_f32 v[162:163], v[162:163], v[114:115]
    v_pk_fma_f32 v[170:171], v[114:115], v[114:115], v[170:171]
    v_pk_add_f32 v[156:157], v[156:157], v[116:117]
    v_pk_fma_f32 v[164:165], v[116:117], v[116:117], v[164:165]
    v_pk_add_f32 v[156:157], v[156:157], v[118:119]
    v_pk_fma_f32 v[164:165], v[118:119], v[118:119], v[164:165]
    v_add_f32 v156, v156, v157
    v_add_f32 v158, v158, v159
    v_add_f32 v160, v160, v161
    v_add_f32 v162, v162, v163
    v_add_f32 v164, v164, v165
    v_add_f32 v166, v166, v167
    v_add_f32 v168, v168, v169
    v_add_f32 v170, v170, v171
    v_permlane32_swap_b32 v156, v158
    v_permlane32_swap_b32 v160, v162
    v_permlane32_swap_b32 v164, v166
    v_permlane32_swap_b32 v168, v170
    v_add_f32 v156, v156, v158
    v_add_f32 v160, v160, v162
    v_add_f32 v164, v164, v166
    v_add_f32 v168, v168, v170
    s_nop 0
    v_permlane16_swap_b32 v156, v164
    v_permlane16_swap_b32 v160, v168
    v_add_f32 v156, v156, v164
    ds_write_b32 v211, v156
    v_add_f32 v160, v160, v168
    ds_write_b32 v212, v160
    s_waitcnt lgkmcnt(0)
    s_barrier
    ds_read_b32 v20, v207
    ds_read_b32 v22, v208
    ds_read_b32 v24, v209
    ds_read_b32 v26, v210
    s_waitcnt lgkmcnt(3)
    v_pk_add_f32 v[28:29], v[84:85], v[20:21] op_sel_hi:[1,0] neg_lo:[0,1] neg_hi:[0,1]
    v_pk_add_f32 v[30:31], v[86:87], v[20:21] op_sel_hi:[1,0] neg_lo:[0,1] neg_hi:[0,1]
    v_pk_add_f32 v[32:33], v[88:89], v[20:21] op_sel_hi:[1,0] neg_lo:[0,1] neg_hi:[0,1]
    v_pk_add_f32 v[34:35], v[90:91], v[20:21] op_sel_hi:[1,0] neg_lo:[0,1] neg_hi:[0,1]
    v_cvt_pk_bf16_f32 v0, v28, v29
    v_cvt_pk_bf16_f32 v1, v30, v31
    v_cvt_pk_bf16_f32 v2, v32, v33
    v_cvt_pk_bf16_f32 v3, v34, v35
    buffer_store_dwordx4 v[0:3], v254, s[44:47], s96 offen sc1
    s_waitcnt lgkmcnt(2)
    v_pk_add_f32 v[28:29], v[92:93], v[22:23] op_sel_hi:[1,0] neg_lo:[0,1] neg_hi:[0,1]
    v_pk_add_f32 v[30:31], v[94:95], v[22:23] op_sel_hi:[1,0] neg_lo:[0,1] neg_hi:[0,1]
    v_pk_add_f32 v[32:33], v[96:97], v[22:23] op_sel_hi:[1,0] neg_lo:[0,1] neg_hi:[0,1]
    v_pk_add_f32 v[34:35], v[98:99], v[22:23] op_sel_hi:[1,0] neg_lo:[0,1] neg_hi:[0,1]
    v_cvt_pk_bf16_f32 v4, v28, v29
    v_cvt_pk_bf16_f32 v5, v30, v31
    v_cvt_pk_bf16_f32 v6, v32, v33
    v_cvt_pk_bf16_f32 v7, v34, v35
    buffer_store_dwordx4 v[4:7], v254, s[44:47], s97 offen sc1
    s_waitcnt lgkmcnt(1)
    v_pk_add_f32 v[28:29], v[100:101], v[24:25] op_sel_hi:[1,0] neg_lo:[0,1] neg_hi:[0,1]
    v_pk_add_f32 v[30:31], v[102:103], v[24:25] op_sel_hi:[1,0] neg_lo:[0,1] neg_hi:[0,1]
    v_pk_add_f32 v[32:33], v[104:105], v[24:25] op_sel_hi:[1,0] neg_lo:[0,1] neg_hi:[0,1]
    v_pk_add_f32 v[34:35], v[106:107], v[24:25] op_sel_hi:[1,0] neg_lo:[0,1] neg_hi:[0,1]
    v_cvt_pk_bf16_f32 v8, v28, v29
    v_cvt_pk_bf16_f32 v9, v30, v31
    v_cvt_pk_bf16_f32 v10, v32, v33
    v_cvt_pk_bf16_f32 v11, v34, v35
    buffer_store_dwordx4 v[8:11], v254, s[44:47], s98 offen sc1
    s_waitcnt lgkmcnt(0)
    v_pk_add_f32 v[28:29], v[108:109], v[26:27] op_sel_hi:[1,0] neg_lo:[0,1] neg_hi:[0,1]
    v_pk_add_f32 v[30:31], v[110:111], v[26:27] op_sel_hi:[1,0] neg_lo:[0,1] neg_hi:[0,1]
    v_pk_add_f32 v[32:33], v[112:113], v[26:27] op_sel_hi:[1,0] neg_lo:[0,1] neg_hi:[0,1]
    v_pk_add_f32 v[34:35], v[114:115], v[26:27] op_sel_hi:[1,0] neg_lo:[0,1] neg_hi:[0,1]
    v_cvt_pk_bf16_f32 v12, v28, v29
    v_cvt_pk_bf16_f32 v13, v30, v31
    v_cvt_pk_bf16_f32 v14, v32, v33
    v_cvt_pk_bf16_f32 v15, v34, v35
    buffer_store_dwordx4 v[12:15], v254, s[44:47], s99 offen sc1
    v_pk_add_f32 v[28:29], v[116:117], v[20:21] op_sel_hi:[1,0] neg_lo:[0,1] neg_hi:[0,1]
    v_pk_add_f32 v[30:31], v[118:119], v[20:21] op_sel_hi:[1,0] neg_lo:[0,1] neg_hi:[0,1]
    v_cvt_pk_bf16_f32 v226, v28, v29
    v_cvt_pk_bf16_f32 v227, v30, v31
    buffer_store_dwordx2 v[226:227], v215, s[44:47], s61 offen sc1
    v_add_u32 v218, 4980736, v254
    v_add_u32 v215, 4980736, v215
    v_lshlrev_b32 v28, 16, v236
    v_and_b32 v29, 0xffff0000, v236
    v_lshlrev_b32 v30, 16, v237
    v_and_b32 v31, 0xffff0000, v237
    v_lshlrev_b32 v32, 16, v238
    v_and_b32 v33, 0xffff0000, v238
    v_lshlrev_b32 v34, 16, v239
    v_and_b32 v35, 0xffff0000, v239
    v_pk_add_f32 v[28:29], v[28:29], v[84:85]
    v_pk_add_f32 v[30:31], v[30:31], v[86:87]
    v_pk_add_f32 v[32:33], v[32:33], v[88:89]
    v_pk_add_f32 v[34:35], v[34:35], v[90:91]
    v_cvt_pk_bf16_f32 v40, v28, v29
    v_cvt_pk_bf16_f32 v41, v30, v31
    v_cvt_pk_bf16_f32 v42, v32, v33
    v_cvt_pk_bf16_f32 v43, v34, v35
    v_lshlrev_b32 v28, 16, v240
    v_and_b32 v29, 0xffff0000, v240
    v_lshlrev_b32 v30, 16, v241
    v_and_b32 v31, 0xffff0000, v241
    v_lshlrev_b32 v32, 16, v242
    v_and_b32 v33, 0xffff0000, v242
    v_lshlrev_b32 v34, 16, v243
    v_and_b32 v35, 0xffff0000, v243
    v_pk_add_f32 v[28:29], v[28:29], v[92:93]
    v_pk_add_f32 v[30:31], v[30:31], v[94:95]
    v_pk_add_f32 v[32:33], v[32:33], v[96:97]
    v_pk_add_f32 v[34:35], v[34:35], v[98:99]
    v_cvt_pk_bf16_f32 v44, v28, v29
    v_cvt_pk_bf16_f32 v45, v30, v31
    v_cvt_pk_bf16_f32 v46, v32, v33
    v_cvt_pk_bf16_f32 v47, v34, v35
    v_lshlrev_b32 v28, 16, v244
    v_and_b32 v29, 0xffff0000, v244
    v_lshlrev_b32 v30, 16, v245
    v_and_b32 v31, 0xffff0000, v245
    v_lshlrev_b32 v32, 16, v246
    v_and_b32 v33, 0xffff0000, v246
    v_lshlrev_b32 v34, 16, v247
    v_and_b32 v35, 0xffff0000, v247
    v_pk_add_f32 v[28:29], v[28:29], v[100:101]
    v_pk_add_f32 v[30:31], v[30:31], v[102:103]
    v_pk_add_f32 v[32:33], v[32:33], v[104:105]
    v_pk_add_f32 v[34:35], v[34:35], v[106:107]
    v_cvt_pk_bf16_f32 v48, v28, v29
    v_cvt_pk_bf16_f32 v49, v30, v31
    v_cvt_pk_bf16_f32 v50, v32, v33
    v_cvt_pk_bf16_f32 v51, v34, v35
    v_lshlrev_b32 v28, 16, v248
    v_and_b32 v29, 0xffff0000, v248
    v_lshlrev_b32 v30, 16, v249
    v_and_b32 v31, 0xffff0000, v249
    v_lshlrev_b32 v32, 16, v250
    v_and_b32 v33, 0xffff0000, v250
    v_lshlrev_b32 v34, 16, v251
    v_and_b32 v35, 0xffff0000, v251
    v_pk_add_f32 v[28:29], v[28:29], v[108:109]
    v_pk_add_f32 v[30:31], v[30:31], v[110:111]
    v_pk_add_f32 v[32:33], v[32:33], v[112:113]
    v_pk_add_f32 v[34:35], v[34:35], v[114:115]
    v_cvt_pk_bf16_f32 v52, v28, v29
    v_cvt_pk_bf16_f32 v53, v30, v31
    v_cvt_pk_bf16_f32 v54, v32, v33
    v_cvt_pk_bf16_f32 v55, v34, v35
    v_lshlrev_b32 v28, 16, v252
    v_and_b32 v29, 0xffff0000, v252
    v_lshlrev_b32 v30, 16, v253
    v_and_b32 v31, 0xffff0000, v253
    v_pk_add_f32 v[28:29], v[28:29], v[116:117]
    v_pk_add_f32 v[30:31], v[30:31], v[118:119]
    v_cvt_pk_bf16_f32 v56, v28, v29
    v_cvt_pk_bf16_f32 v57, v30, v31
    s_lshr_b32 s64, s56, 2
    s_lshl_b32 s64, s64, 2
    s_add_u32 s64, s64, s57
    s_lshl_b32 s64, s64, 2
    s_and_b32 s65, s56, 3
    s_add_u32 s64, s64, s65
    s_lshl_b32 s64, s64, 6
    s_add_u32 s64, s64, s49
    s_lshl_b32 s64, s64, 2
    s_add_u32 s101, s64, 512096
    s_lshl_b32 s64, s52, 3
    s_add_u32 s64, s64, s53
    s_lshl_b32 s65, s64, 3
    s_add_u32 s65, s65, s48
    s_mul_i32 s0, s65, 36864
    s_add_u32 s0, s0, 14680064
    s_lshl_b32 s1, s65, 9
    s_add_u32 s1, s1, 249856
    s_lshl_b32 s64, s52, 2
    s_add_u32 s64, s64, s54
    s_lshl_b32 s64, s64, 3
    s_add_u32 s64, s64, s48
    s_mul_i32 s63, s64, 73728
    s_lshl_b32 s65, s53, 10
    s_add_u32 s63, s63, s65
    s_add_u32 s63, s63, 33554432
    s_lshl_b32 s65, s53, 3
    s_add_u32 s65, s65, s53
    s_bfe_u32 s65, s65, 0x30001
    s_cmp_eq_u32 s48, s65
    s_cselect_b32 s63, 0x40000000, s63
    s_lshl_b32 s20, s54, 13
    s_add_u32 s20, s20, s0
    s_add_u32 s21, s20, 4096
    s_lshl_b32 s22, s54, 10
    s_add_u32 s22, s22, s0
    s_add_u32 s22, s22, 32768
    s_mul_i32 s23, s49, 2560
    s_lshl_b32 s24, s49, 11
    s_mul_i32 s8, s54, 147456
    s_add_u32 s9, s8, 73728
    s_and_b32 s64, s52, 3
    s_lshl_b32 s64, s64, 1
    s_lshr_b32 s64, 0xe79, s64
    s_add_u32 s65, s64, s54
    s_and_b32 s65, s65, 3
    s_mul_i32 s10, s65, 147456
    s_add_u32 s13, s10, 73728
    s_lshl_b32 s65, s65, 13
    s_add_u32 s25, s65, s0
    s_lshr_b32 s64, s64, 2
    s_add_u32 s65, s64, s54
    s_and_b32 s65, s65, 3
    s_mul_i32 s11, s65, 147456
    s_add_u32 s14, s11, 73728
    s_lshl_b32 s65, s65, 13
    s_add_u32 s26, s65, s0
    s_lshr_b32 s64, s64, 2
    s_add_u32 s65, s64, s54
    s_and_b32 s65, s65, 3
    s_mul_i32 s12, s65, 147456
    s_add_u32 s15, s12, 73728
    s_lshl_b32 s65, s65, 13
    s_add_u32 s27, s65, s0
    s_lshl_b32 s64, s52, 2
    s_add_u32 s64, s64, s54
    s_lshl_b32 s64, s64, 3
    s_add_u32 s64, s64, s48
    s_lshl_b32 s42, s64, 5
    s_add_u32 s42, s42, s53
    s_lshl_b32 s42, s42, 2
    s_add_u32 s42, s42, 512000
    s_lshl_b32 s40, s54, 7
    s_add_u32 s40, s40, s1
    s_lshl_b32 s41, s54, 2
    s_add_u32 s41, s41, s1
    s_mov_b32 s43, 0
    s_lshl_b32 s64, s52, 2
    s_lshr_b32 s65, s48, 1
    s_add_u32 s64, s64, s65
    s_lshl_b32 s64, s64, 3
    s_add_u32 s64, s64, s53
    s_lshl_b32 s64, s64, 2
    s_add_u32 s64, s64, s54
    s_lshl_b32 s64, s64, 7
    s_add_u32 s100, s64, 20480
    s_waitcnt vmcnt(0)
    s_barrier
    s_buffer_atomic_swap s55, s[44:47], s58 offset:0
    s_buffer_atomic_swap s55, s[44:47], s58 offset:128
    s_buffer_atomic_swap s55, s[44:47], s58 offset:256
    s_buffer_atomic_swap s55, s[44:47], s58 offset:384
    s_buffer_atomic_swap s55, s[44:47], s58 offset:512
    s_buffer_atomic_swap s55, s[44:47], s58 offset:640
    s_buffer_atomic_swap s55, s[44:47], s58 offset:768
    s_buffer_atomic_swap s55, s[44:47], s58 offset:896
    buffer_store_dwordx4 v[40:43], v218, s[44:47], s96 offen sc1
    buffer_store_dwordx4 v[44:47], v218, s[44:47], s97 offen sc1
    buffer_store_dwordx4 v[48:51], v218, s[44:47], s98 offen sc1
    buffer_store_dwordx4 v[52:55], v218, s[44:47], s99 offen sc1
    buffer_store_dwordx2 v[56:57], v215, s[44:47], s61 offen sc1
    s_lshl_b32 s64, s52, 3
    s_add_u32 s64, s64, s48
    s_lshl_b32 s61, s64, 10
    s_add_u32 s61, s61, 151552
    s_mul_i32 s60, s64, 36864
    s_add_u32 s60, s60, 6553600
    s_add_u32 s64, s3, 0
    s_and_b32 s64, s64, 7
    s_lshl_b32 s64, s64, 11
    s_add_u32 s92, s64, s60
    s_add_u32 s64, s3, 1
    s_and_b32 s64, s64, 7
    s_lshl_b32 s64, s64, 11
    s_add_u32 s93, s64, s60
    s_add_u32 s64, s3, 2
    s_and_b32 s64, s64, 7
    s_lshl_b32 s64, s64, 11
    s_add_u32 s94, s64, s60
    s_add_u32 s64, s3, 3
    s_and_b32 s64, s64, 7
    s_lshl_b32 s64, s64, 11
    s_add_u32 s95, s64, s60
    s_add_u32 s64, s3, 4
    s_and_b32 s64, s64, 7
    s_lshl_b32 s64, s64, 11
    s_add_u32 s96, s64, s60
    s_add_u32 s64, s3, 5
    s_and_b32 s64, s64, 7
    s_lshl_b32 s64, s64, 11
    s_add_u32 s97, s64, s60
    s_add_u32 s64, s3, 6
    s_and_b32 s64, s64, 7
    s_lshl_b32 s64, s64, 11
    s_add_u32 s98, s64, s60
    s_add_u32 s64, s3, 7
    s_and_b32 s64, s64, 7
    s_lshl_b32 s64, s64, 11
    s_add_u32 s99, s64, s60
    s_add_u32 s60, s60, 16384
    v_add_u32 v251, 18432, v254
    v_lshlrev_b32 v252, 3, v255
    v_add_u32 v253, 18432, v252
    v_lshrrev_b32 v247, 2, v255
    v_lshlrev_b32 v232, 6, v247
    v_and_b32 v247, 3, v255
    v_lshl_add_u32 v232, v247, 3, v232
    v_and_b32 v247, 16, v255
    v_lshl_add_u32 v232, v247, 1, v232
    v_xor_b32 v233, 32, v232
    v_lshlrev_b32 v234, 3, v255
    v_lshrrev_b32 v248, 2, v255
    v_mul_u32_u24 v248, 9216, v248
    v_lshrrev_b32 v247, 3, v255
    v_and_b32 v247, 2, v247
    v_xor_b32 v247, v247, v255
    v_and_b32 v247, 3, v247
    v_lshl_add_u32 v235, v247, 4, v248
    s_mul_i32 s64, s53, 1152
    s_add_u32 s64, s64, 4718592
    s_lshl_b32 s65, s54, 8
    s_add_u32 s65, s65, s64
    v_add_u32 v235, s65, v235
    s_branch L_SO
L_BY2:
    s_load_dwordx2 s[12:13], s[0:1], 16
    s_load_dwordx2 s[16:17], s[0:1], 24
    s_load_dwordx2 s[24:25], s[0:1], 48
    s_load_dwordx2 s[28:29], s[0:1], 56
    s_load_dwordx2 s[32:33], s[0:1], 64
    s_load_dwordx2 s[36:37], s[0:1], 72
    s_load_dwordx2 s[40:41], s[0:1], 80
    s_waitcnt lgkmcnt(0)
    s_cmp_lg_u32 s49, 1
    s_cbranch_scc1 L_nowarm_45
L_nowarm_45:
    v_and_b32 v206, 15, v255
    v_lshlrev_b32 v203, 6, v206
    v_lshrrev_b32 v206, 2, v255
    v_and_b32 v206, 2, v206
    v_lshrrev_b32 v208, 4, v255
    v_xor_b32 v206, v206, v208
    v_lshl_add_u32 v203, v206, 4, v203
    v_add_u32 v203, s59, v203
    v_mov_b32 v16, 0x3f803f80
    v_mov_b32 v17, 0x3f803f80
    v_mov_b32 v18, 0x3f803f80
    v_mov_b32 v19, 0x3f803f80
    s_add_u32 s67, s94, 1
    s_cmp_ge_u32 s67, 9
    s_cselect_b32 s95, 9, 0
    s_sub_u32 s67, s67, s95
    s_mul_i32 s67, s67, 128
    s_add_u32 m0, s59, 0x0001d000
    s_nop 0
    buffer_load_dwordx4 v202, s[4:7], s67 offen lds
    s_add_u32 m0, s59, 0x0001dfc0
    s_nop 0
    buffer_load_dwordx4 v202, s[4:7], s67 offen offset:64 lds
    s_mul_i32 s66, s67, 576
    s_add_u32 m0, s58, 0x00004800
    s_nop 0
    buffer_load_dwordx4 v200, s[20:23], s66 offen lds
    s_add_u32 m0, s58, 0x00004bc0
    s_nop 0
    buffer_load_dwordx4 v200, s[20:23], s66 offen offset:64 lds
    s_add_u32 m0, s58, 0x00004f80
    s_nop 0
    buffer_load_dwordx4 v200, s[20:23], s66 offen offset:128 lds
    s_add_u32 m0, s58, 0x00005340
    s_nop 0
    buffer_load_dwordx4 v200, s[20:23], s66 offen offset:192 lds
    s_add_u32 m0, s58, 0x00005800
    s_mov_b32 exec_hi, 0x00000000
    buffer_load_dwordx4 v201, s[20:23], s66 offen lds
    s_mov_b64 exec, -1
    s_waitcnt vmcnt(7)
    s_barrier
    v_add_u32 v203, 0x00019000, v203
    ds_read_b128 v[0:3], v203 offset:8192
    ds_read_b128 v[4:7], v203 offset:12288
    s_add_u32 s67, s94, 2
    s_cmp_ge_u32 s67, 9
    s_cselect_b32 s95, 9, 0
    s_sub_u32 s67, s67, s95
    s_mul_i32 s67, s67, 128
    s_add_u32 m0, s59, 0x0001f000
    s_nop 0
    buffer_load_dwordx4 v202, s[4:7], s67 offen lds
    s_add_u32 m0, s59, 0x0001ffc0
    s_nop 0
    buffer_load_dwordx4 v202, s[4:7], s67 offen offset:64 lds
    s_mul_i32 s66, s67, 576
    s_add_u32 m0, s58, 0x00009000
    s_nop 0
    buffer_load_dwordx4 v200, s[20:23], s66 offen lds
    s_waitcnt lgkmcnt(1)
    v_mfma_f32_16x16x32_bf16 v[8:11], v[0:3], v[0:3], 0
    s_add_u32 m0, s58, 0x000093c0
    s_nop 0
    buffer_load_dwordx4 v200, s[20:23], s66 offen offset:64 lds
    v_mfma_f32_16x16x32_bf16 v[12:15], v[16:19], v[0:3], 0
    s_add_u32 m0, s58, 0x00009780
    s_nop 0
    buffer_load_dwordx4 v200, s[20:23], s66 offen offset:128 lds
    s_waitcnt lgkmcnt(0)
    v_mfma_f32_16x16x32_bf16 v[8:11], v[4:7], v[4:7], v[8:11]
    s_add_u32 m0, s58, 0x00009b40
    s_nop 0
    buffer_load_dwordx4 v200, s[20:23], s66 offen offset:192 lds
    v_mfma_f32_16x16x32_bf16 v[12:15], v[16:19], v[4:7], v[12:15]
    s_add_u32 m0, s58, 0x0000a000
    s_mov_b32 exec_hi, 0x00000000
    buffer_load_dwordx4 v201, s[20:23], s66 offen lds
    s_mov_b64 exec, -1
    s_waitcnt vmcnt(7)
    s_barrier
    ds_read_b128 v[0:3], v203 offset:16384
    ds_read_b128 v[4:7], v203 offset:20480
    s_add_u32 s67, s94, 3
    s_cmp_ge_u32 s67, 9
    s_cselect_b32 s95, 9, 0
    s_sub_u32 s67, s67, s95
    s_mul_i32 s67, s67, 128
    s_add_u32 m0, s59, 0x00021000
    s_nop 0
    buffer_load_dwordx4 v202, s[4:7], s67 offen lds
    s_add_u32 m0, s59, 0x00021fc0
    s_nop 0
    buffer_load_dwordx4 v202, s[4:7], s67 offen offset:64 lds
    s_mul_i32 s66, s67, 576
    s_add_u32 m0, s58, 0x0000d800
    s_nop 0
    buffer_load_dwordx4 v200, s[20:23], s66 offen lds
    s_waitcnt lgkmcnt(1)
    v_mfma_f32_16x16x32_bf16 v[8:11], v[0:3], v[0:3], v[8:11]
    s_add_u32 m0, s58, 0x0000dbc0
    s_nop 0
    buffer_load_dwordx4 v200, s[20:23], s66 offen offset:64 lds
    v_mfma_f32_16x16x32_bf16 v[12:15], v[16:19], v[0:3], v[12:15]
    s_add_u32 m0, s58, 0x0000df80
    s_nop 0
    buffer_load_dwordx4 v200, s[20:23], s66 offen offset:128 lds
    s_waitcnt lgkmcnt(0)
    v_mfma_f32_16x16x32_bf16 v[8:11], v[4:7], v[4:7], v[8:11]
    s_add_u32 m0, s58, 0x0000e340
    s_nop 0
    buffer_load_dwordx4 v200, s[20:23], s66 offen offset:192 lds
    v_mfma_f32_16x16x32_bf16 v[12:15], v[16:19], v[4:7], v[12:15]
    s_add_u32 m0, s58, 0x0000e800
    s_mov_b32 exec_hi, 0x00000000
    buffer_load_dwordx4 v201, s[20:23], s66 offen lds
    s_mov_b64 exec, -1
    s_waitcnt vmcnt(7)
    s_barrier
    ds_read_b128 v[0:3], v203 offset:24576
    ds_read_b128 v[4:7], v203 offset:28672
    s_add_u32 s67, s94, 4
    s_cmp_ge_u32 s67, 9
    s_cselect_b32 s95, 9, 0
    s_sub_u32 s67, s67, s95
    s_mul_i32 s67, s67, 128
    s_add_u32 m0, s59, 0x00023000
    s_nop 0
    buffer_load_dwordx4 v202, s[4:7], s67 offen lds
    s_add_u32 m0, s59, 0x00023fc0
    s_nop 0
    buffer_load_dwordx4 v202, s[4:7], s67 offen offset:64 lds
    s_mul_i32 s66, s67, 576
    s_add_u32 m0, s58, 0x00012000
    s_nop 0
    buffer_load_dwordx4 v200, s[20:23], s66 offen lds
    s_waitcnt lgkmcnt(1)
    v_mfma_f32_16x16x32_bf16 v[8:11], v[0:3], v[0:3], v[8:11]
    s_add_u32 m0, s58, 0x000123c0
    s_nop 0
    buffer_load_dwordx4 v200, s[20:23], s66 offen offset:64 lds
    v_mfma_f32_16x16x32_bf16 v[12:15], v[16:19], v[0:3], v[12:15]
    s_add_u32 m0, s58, 0x00012780
    s_nop 0
    buffer_load_dwordx4 v200, s[20:23], s66 offen offset:128 lds
    s_waitcnt lgkmcnt(0)
    v_mfma_f32_16x16x32_bf16 v[8:11], v[4:7], v[4:7], v[8:11]
    s_add_u32 m0, s58, 0x00012b40
    s_nop 0
    buffer_load_dwordx4 v200, s[20:23], s66 offen offset:192 lds
    v_mfma_f32_16x16x32_bf16 v[12:15], v[16:19], v[4:7], v[12:15]
    s_add_u32 m0, s58, 0x00013000
    s_mov_b32 exec_hi, 0x00000000
    buffer_load_dwordx4 v201, s[20:23], s66 offen lds
    s_mov_b64 exec, -1
    s_waitcnt vmcnt(7)
    s_barrier
    ds_read_b128 v[0:3], v203 offset:32768
    ds_read_b128 v[4:7], v203 offset:36864
    s_add_u32 s67, s94, 5
    s_cmp_ge_u32 s67, 9
    s_cselect_b32 s95, 9, 0
    s_sub_u32 s67, s67, s95
    s_mul_i32 s67, s67, 128
    s_add_u32 m0, s59, 0x00025000
    s_nop 0
    buffer_load_dwordx4 v202, s[4:7], s67 offen lds
    s_add_u32 m0, s59, 0x00025fc0
    s_nop 0
    buffer_load_dwordx4 v202, s[4:7], s67 offen offset:64 lds
    s_mul_i32 s66, s67, 576
    s_add_u32 m0, s58, 0x00016800
    s_nop 0
    buffer_load_dwordx4 v200, s[20:23], s66 offen lds
    s_waitcnt lgkmcnt(1)
    v_mfma_f32_16x16x32_bf16 v[8:11], v[0:3], v[0:3], v[8:11]
    s_add_u32 m0, s58, 0x00016bc0
    s_nop 0
    buffer_load_dwordx4 v200, s[20:23], s66 offen offset:64 lds
    v_mfma_f32_16x16x32_bf16 v[12:15], v[16:19], v[0:3], v[12:15]
    s_add_u32 m0, s58, 0x00016f80
    s_nop 0
    buffer_load_dwordx4 v200, s[20:23], s66 offen offset:128 lds
    s_waitcnt lgkmcnt(0)
    v_mfma_f32_16x16x32_bf16 v[8:11], v[4:7], v[4:7], v[8:11]
    s_add_u32 m0, s58, 0x00017340
    s_nop 0
    buffer_load_dwordx4 v200, s[20:23], s66 offen offset:192 lds
    v_mfma_f32_16x16x32_bf16 v[12:15], v[16:19], v[4:7], v[12:15]
    s_add_u32 m0, s58, 0x00017800
    s_mov_b32 exec_hi, 0x00000000
    buffer_load_dwordx4 v201, s[20:23], s66 offen lds
    s_mov_b64 exec, -1
    s_waitcnt vmcnt(7)
    s_barrier
    ds_read_b128 v[0:3], v203 offset:40960
    ds_read_b128 v[4:7], v203 offset:45056
    s_add_u32 s67, s94, 6
    s_cmp_ge_u32 s67, 9
    s_cselect_b32 s95, 9, 0
    s_sub_u32 s67, s67, s95
    s_mul_i32 s67, s67, 128
    s_add_u32 m0, s59, 0x0001b000
    s_nop 0
    buffer_load_dwordx4 v202, s[4:7], s67 offen lds
    s_add_u32 m0, s59, 0x0001bfc0
    s_nop 0
    buffer_load_dwordx4 v202, s[4:7], s67 offen offset:64 lds
    s_mul_i32 s66, s67, 576
    s_add_u32 m0, s58, 0x00000000
    s_nop 0
    buffer_load_dwordx4 v200, s[20:23], s66 offen lds
    s_waitcnt lgkmcnt(1)
    v_mfma_f32_16x16x32_bf16 v[8:11], v[0:3], v[0:3], v[8:11]
    s_add_u32 m0, s58, 0x000003c0
    s_nop 0
    buffer_load_dwordx4 v200, s[20:23], s66 offen offset:64 lds
    v_mfma_f32_16x16x32_bf16 v[12:15], v[16:19], v[0:3], v[12:15]
    s_add_u32 m0, s58, 0x00000780
    s_nop 0
    buffer_load_dwordx4 v200, s[20:23], s66 offen offset:128 lds
    s_waitcnt lgkmcnt(0)
    v_mfma_f32_16x16x32_bf16 v[8:11], v[4:7], v[4:7], v[8:11]
    s_add_u32 m0, s58, 0x00000b40
    s_nop 0
    buffer_load_dwordx4 v200, s[20:23], s66 offen offset:192 lds
    v_mfma_f32_16x16x32_bf16 v[12:15], v[16:19], v[4:7], v[12:15]
    s_add_u32 m0, s58, 0x00001000
    s_mov_b32 exec_hi, 0x00000000
    buffer_load_dwordx4 v201, s[20:23], s66 offen lds
    s_mov_b64 exec, -1
    s_waitcnt vmcnt(7)
    s_barrier
    ds_read_b128 v[0:3], v203 offset:49152
    ds_read_b128 v[4:7], v203 offset:53248
    s_add_u32 s67, s94, 7
    s_cmp_ge_u32 s67, 9
    s_cselect_b32 s95, 9, 0
    s_sub_u32 s67, s67, s95
    s_mul_i32 s67, s67, 128
    s_add_u32 m0, s59, 0x0001d000
    s_nop 0
    buffer_load_dwordx4 v202, s[4:7], s67 offen lds
    s_add_u32 m0, s59, 0x0001dfc0
    s_nop 0
    buffer_load_dwordx4 v202, s[4:7], s67 offen offset:64 lds
    s_mul_i32 s66, s67, 576
    s_add_u32 m0, s58, 0x00004800
    s_nop 0
    buffer_load_dwordx4 v200, s[20:23], s66 offen lds
    s_waitcnt lgkmcnt(1)
    v_mfma_f32_16x16x32_bf16 v[8:11], v[0:3], v[0:3], v[8:11]
    s_add_u32 m0, s58, 0x00004bc0
    s_nop 0
    buffer_load_dwordx4 v200, s[20:23], s66 offen offset:64 lds
    v_mfma_f32_16x16x32_bf16 v[12:15], v[16:19], v[0:3], v[12:15]
    s_add_u32 m0, s58, 0x00004f80
    s_nop 0
    buffer_load_dwordx4 v200, s[20:23], s66 offen offset:128 lds
    s_waitcnt lgkmcnt(0)
    v_mfma_f32_16x16x32_bf16 v[8:11], v[4:7], v[4:7], v[8:11]
    s_add_u32 m0, s58, 0x00005340
    s_nop 0
    buffer_load_dwordx4 v200, s[20:23], s66 offen offset:192 lds
    v_mfma_f32_16x16x32_bf16 v[12:15], v[16:19], v[4:7], v[12:15]
    s_add_u32 m0, s58, 0x00005800
    s_mov_b32 exec_hi, 0x00000000
    buffer_load_dwordx4 v201, s[20:23], s66 offen lds
    s_mov_b64 exec, -1
    s_waitcnt vmcnt(7)
    s_barrier
    ds_read_b128 v[0:3], v203 offset:8192
    ds_read_b128 v[4:7], v203 offset:12288
    v_mov_b32 v207, 0
    buffer_load_dword v207, v207, s[40:43], 0 offen sc1
    s_add_u32 s67, s94, 8
    s_cmp_ge_u32 s67, 9
    s_cselect_b32 s95, 9, 0
    s_sub_u32 s67, s67, s95
    s_mul_i32 s67, s67, 128
    s_add_u32 m0, s59, 0x0001f000
    s_nop 0
    buffer_load_dwordx4 v202, s[4:7], s67 offen lds
    s_add_u32 m0, s59, 0x0001ffc0
    s_nop 0
    buffer_load_dwordx4 v202, s[4:7], s67 offen offset:64 lds
    s_mul_i32 s66, s67, 576
    s_add_u32 m0, s58, 0x00009000
    s_nop 0
    buffer_load_dwordx4 v200, s[20:23], s66 offen lds
    s_waitcnt lgkmcnt(1)
    v_mfma_f32_16x16x32_bf16 v[8:11], v[0:3], v[0:3], v[8:11]
    s_add_u32 m0, s58, 0x000093c0
    s_nop 0
    buffer_load_dwordx4 v200, s[20:23], s66 offen offset:64 lds
    v_mfma_f32_16x16x32_bf16 v[12:15], v[16:19], v[0:3], v[12:15]
    s_add_u32 m0, s58, 0x00009780
    s_nop 0
    buffer_load_dwordx4 v200, s[20:23], s66 offen offset:128 lds
    s_waitcnt lgkmcnt(0)
    v_mfma_f32_16x16x32_bf16 v[8:11], v[4:7], v[4:7], v[8:11]
    s_add_u32 m0, s58, 0x00009b40
    s_nop 0
    buffer_load_dwordx4 v200, s[20:23], s66 offen offset:192 lds
    v_mfma_f32_16x16x32_bf16 v[12:15], v[16:19], v[4:7], v[12:15]
    s_add_u32 m0, s58, 0x0000a000
    s_mov_b32 exec_hi, 0x00000000
    buffer_load_dwordx4 v201, s[20:23], s66 offen lds
    s_mov_b64 exec, -1
    s_waitcnt vmcnt(8)
    s_barrier
    ds_read_b128 v[0:3], v203 offset:16384
    ds_read_b128 v[4:7], v203 offset:20480
    v_lshrrev_b32 v204, 2, v255
    v_mul_u32_u24 v204, 1152, v204
    v_lshrrev_b32 v205, 3, v255
    v_and_b32 v205, 2, v205
    v_xor_b32 v205, v205, v255
    v_and_b32 v205, 3, v205
    v_lshl_add_u32 v200, v205, 4, v204
    v_bfe_u32 v204, v255, 1, 4
    v_mul_u32_u24 v204, 1152, v204
    v_and_b32 v205, 1, v255
    v_lshl_add_u32 v201, v205, 4, v204
    s_mul_i32 s64, s49, 18432
    s_lshl_b32 s65, s57, 8
    s_add_u32 s65, s65, s64
    v_add_u32 v200, s65, v200
    s_lshl_b32 s65, s57, 5
    s_add_u32 s65, s65, s64
    s_add_u32 s65, s65, 1024
    v_add_u32 v201, s65, v201
    s_add_u32 s94, s57, s56
    s_and_b32 s94, s94, 3
    s_lshl_b32 s94, s94, 1
    s_add_u32 s66, s94, 6
    s_cmp_ge_u32 s66, 9
    s_cselect_b32 s95, 9, 0
    s_sub_u32 s66, s66, s95
    s_mul_i32 s66, s66, 73728
    s_add_u32 m0, s58, 0x0000d800
    s_nop 0
    buffer_load_dwordx4 v200, s[24:27], s66 offen lds
    s_add_u32 m0, s58, 0x0000dbc0
    s_nop 0
    buffer_load_dwordx4 v200, s[24:27], s66 offen offset:64 lds
    s_add_u32 m0, s58, 0x0000df80
    s_nop 0
    buffer_load_dwordx4 v200, s[24:27], s66 offen offset:128 lds
    s_waitcnt lgkmcnt(1)
    v_mfma_f32_16x16x32_bf16 v[8:11], v[0:3], v[0:3], v[8:11]
    s_add_u32 m0, s58, 0x0000e340
    s_nop 0
    buffer_load_dwordx4 v200, s[24:27], s66 offen offset:192 lds
    v_mfma_f32_16x16x32_bf16 v[12:15], v[16:19], v[0:3], v[12:15]
    s_add_u32 m0, s58, 0x0000e800
    s_mov_b32 exec_hi, 0x00000000
    buffer_load_dwordx4 v201, s[24:27], s66 offen lds
    s_mov_b64 exec, -1
    s_waitcnt lgkmcnt(0)
    v_mfma_f32_16x16x32_bf16 v[8:11], v[4:7], v[4:7], v[8:11]
    s_add_u32 s66, s94, 7
    s_cmp_ge_u32 s66, 9
    s_cselect_b32 s95, 9, 0
    s_sub_u32 s66, s66, s95
    s_mul_i32 s66, s66, 73728
    s_add_u32 m0, s58, 0x00012000
    s_nop 0
    buffer_load_dwordx4 v200, s[24:27], s66 offen lds
    v_mfma_f32_16x16x32_bf16 v[12:15], v[16:19], v[4:7], v[12:15]
    s_add_u32 m0, s58, 0x000123c0
    s_nop 0
    buffer_load_dwordx4 v200, s[24:27], s66 offen offset:64 lds
    s_waitcnt vmcnt(7)
    s_barrier
    ds_read_b128 v[0:3], v203 offset:24576
    ds_read_b128 v[4:7], v203 offset:28672
    s_add_u32 m0, s58, 0x00012780
    s_nop 0
    buffer_load_dwordx4 v200, s[24:27], s66 offen offset:128 lds
    s_add_u32 m0, s58, 0x00012b40
    s_nop 0
    buffer_load_dwordx4 v200, s[24:27], s66 offen offset:192 lds
    s_waitcnt lgkmcnt(1)
    v_mfma_f32_16x16x32_bf16 v[8:11], v[0:3], v[0:3], v[8:11]
    v_mfma_f32_16x16x32_bf16 v[12:15], v[16:19], v[0:3], v[12:15]
    s_waitcnt lgkmcnt(0)
    v_mfma_f32_16x16x32_bf16 v[8:11], v[4:7], v[4:7], v[8:11]
    v_mfma_f32_16x16x32_bf16 v[12:15], v[16:19], v[4:7], v[12:15]
    s_lshr_b32 s64, s57, 1
    s_add_u32 s64, s64, 1
    s_sub_u32 s65, 0, s64
    s_bitcmp1_b32 s57, 0
    s_cselect_b32 s64, s65, s64
    s_lshl_b32 s65, s56, 6
    s_add_u32 s64, s64, s65
    s_lshl_b32 s65, s49, 4
    s_add_u32 s64, s64, s65
    v_and_b32 v205, 15, v255
    v_lshlrev_b32 v206, 5, v205
    v_add_u32 v205, s64, v205
    s_lshl_b32 s64, s49, 9
    s_add_u32 s64, s64, 159744
    v_add_u32 v206, s64, v206
    v_and_b32 v204, 3, v255
    v_mov_b32 v28, v8
    v_cmp_eq_u32 vcc, 1, v204
    s_nop 1
    v_cndmask_b32 v28, v28, v9, vcc
    v_cmp_eq_u32 vcc, 2, v204
    s_nop 1
    v_cndmask_b32 v28, v28, v10, vcc
    v_cmp_eq_u32 vcc, 3, v204
    s_nop 1
    v_cndmask_b32 v28, v28, v11, vcc
    v_mul_f32 v20, 0xbae38e39, v12
    v_mul_f32 v29, 0x3ae38e39, v28
    v_fma_f32 v29, -v20, v20, v29
    v_max_f32 v29, 0, v29
    v_add_f32 v30, 0x3727c5ac, v29
    v_rsq_f32 v25, v30
    v_mov_b32 v31, 0x3727c5ac
    v_mul_f32 v29, v29, v25
    v_fmac_f32 v31, v29, v25
    v_rsq_f32 v31, v31
    v_mul_f32 v24, v20, v25
    v_mul_f32 v31, v31, v25
    v_rcp_f32 v23, v31
    v_mul_f32 v22, v31, v31
    v_mul_f32 v21, 0xc0135761, v31
    v_mul_f32 v22, 0x3d372713, v22
    v_mul_f32 v22, v22, v21
    v_cmp_gt_u32 vcc, 2048, v205
    v_mov_b32 v28, 0x7f61b1e6
    s_nop 0
    v_cndmask_b32 v23, v28, v23, vcc
    s_mov_b32 exec_lo, 0x00f0000f
    s_mov_b32 exec_hi, 0xf0000f00
    ds_write_b128 v206, v[20:23]
    ds_write_b64 v206, v[24:25] offset:16
    s_mov_b64 exec, -1
    s_waitcnt lgkmcnt(0)
    v_readfirstlane_b32 s55, v207
    s_nop 1
    s_cmp_eq_u32 s55, 0
    s_cbranch_scc1 L_nslow_46
L_nback_47:
    s_cmp_lg_u32 s57, s49
    s_cbranch_scc1 L_nost_49
    v_mov_b32 v21, s55
    v_mov_b32 v22, v25
    v_mov_b32 v23, s55
    v_and_b32 v204, 0xf0, v254
    s_lshl_b32 s64, s56, 2
    s_add_u32 s64, s64, s49
    s_lshl_b32 s64, s64, 8
    s_add_u32 s64, s64, 872448
    s_mov_b32 exec_lo, 0x00f0000f
    s_mov_b32 exec_hi, 0xf0000f00
    buffer_store_dwordx4 v[20:23], v204, s[44:47], s64 offen sc1
    s_mov_b64 exec, -1
L_nost_49:
    s_setprio 0
    s_barrier
    s_add_u32 m0, s58, 0x00013000
    s_mov_b32 exec_hi, 0x00000000
    buffer_load_dwordx4 v201, s[24:27], s66 offen lds
    s_mov_b64 exec, -1
    s_add_u32 s66, s94, 8
    s_cmp_ge_u32 s66, 9
    s_cselect_b32 s95, 9, 0
    s_sub_u32 s66, s66, s95
    s_mul_i32 s66, s66, 73728
    s_add_u32 m0, s58, 0x00016800
    s_nop 0
    buffer_load_dwordx4 v200, s[24:27], s66 offen lds
    s_add_u32 m0, s58, 0x00016bc0
    s_nop 0
    buffer_load_dwordx4 v200, s[24:27], s66 offen offset:64 lds
    s_add_u32 m0, s58, 0x00016f80
    s_nop 0
    buffer_load_dwordx4 v200, s[24:27], s66 offen offset:128 lds
    s_add_u32 m0, s58, 0x00017340
    s_nop 0
    buffer_load_dwordx4 v200, s[24:27], s66 offen offset:192 lds
    s_mov_b32 exec_hi, 0x00000000
    s_add_u32 m0, s58, 0x00017800
    s_nop 0
    buffer_load_dwordx4 v201, s[24:27], s66 offen lds
    s_mov_b64 exec, -1
    s_bitcmp1_b32 s57, 0
    s_cselect_b32 s64, 31, 1
    s_cselect_b32 s65, 24, 16
    s_add_u32 s64, s64, s56
    s_and_b32 s64, s64, 31
    s_lshl_b32 s64, s64, 9
    s_add_u32 s64, s64, s65
    s_and_b32 s65, s57, 2
    s_lshl_b32 s65, s65, 1
    s_add_u32 s64, s64, s65
    s_lshl_b32 s65, s56, 9
    s_lshl_b32 s67, s57, 2
    s_add_u32 s65, s65, s67
    s_lshl_b32 s67, s49, 7
    s_add_u32 s67, s67, 4096
    s_add_u32 s68, s64, s67
    s_add_u32 s69, s65, s67
    v_mov_b32 v204, s64
    v_mov_b32 v205, s65
    v_cmp_gt_u32 vcc, 4, v255
    s_nop 1
    v_cndmask_b32 v204, v204, v205, vcc
    v_and_b32 v205, 3, v255
    v_lshl_add_u32 v204, v205, 7, v204
    v_lshrrev_b32 v246, 2, v255
    v_mul_u32_u24 v246, 9216, v246
    v_lshrrev_b32 v247, 3, v255
    v_and_b32 v247, 2, v247
    v_xor_b32 v247, v247, v255
    v_and_b32 v247, 3, v247
    v_lshl_add_u32 v208, v247, 4, v246
    v_bfe_u32 v246, v255, 1, 4
    v_mul_u32_u24 v246, 9216, v246
    v_and_b32 v247, 1, v255
    v_lshl_add_u32 v209, v247, 4, v246
    s_mul_i32 s64, s49, 147456
    s_mul_i32 s65, s53, 1152
    s_add_u32 s64, s64, s65
    s_lshl_b32 s65, s54, 8
    s_add_u32 s65, s65, s64
    v_add_u32 v208, s65, v208
    s_lshl_b32 s65, s54, 5
    s_add_u32 s65, s65, s64
    s_add_u32 s65, s65, 1024
    v_add_u32 v209, s65, v209
    s_mul_i32 s101, s49, 2560
    s_lshl_b32 s59, s49, 10
    s_getpc_b64 s[70:71]
L_pc_50:
    s_lshl_b32 s64, s51, 3
    s_add_u32 s64, s64, s48
    s_mul_i32 s64, s64, 192
    s_sub_u32 s70, s70, L_pc_50-parallel_sum__linear_kernel_hedgehog__mixer_s_mlp__prompt_kernel
    s_subb_u32 s71, s71, 0
    s_add_u32 s64, s64, L_S34-parallel_sum__linear_kernel_hedgehog__mixer_s_mlp__prompt_kernel
    s_min_u32 s64, s64, L_code_end-parallel_sum__linear_kernel_hedgehog__mixer_s_mlp__prompt_kernel-192
    s_load_dword s62, s[70:71], s64 offset:0
    s_load_dword s62, s[70:71], s64 offset:64
    s_load_dword s62, s[70:71], s64 offset:128
    s_waitcnt lgkmcnt(0)
    s_waitcnt vmcnt(0)
    s_barrier
    s_add_u32 s66, s94, 0
    s_cmp_ge_u32 s66, 9
    s_cselect_b32 s95, 9, 0
    s_sub_u32 s66, s66, s95
    s_mul_i32 s66, s66, 73728
    s_add_u32 m0, s58, 0x00000000
    s_nop 0
    buffer_load_dwordx4 v200, s[24:27], s66 offen lds
    s_add_u32 m0, s58, 0x000003c0
    s_nop 0
    buffer_load_dwordx4 v200, s[24:27], s66 offen offset:64 lds
    s_add_u32 m0, s58, 0x00000780
    s_nop 0
    buffer_load_dwordx4 v200, s[24:27], s66 offen offset:128 lds
    s_add_u32 m0, s58, 0x00000b40
    s_nop 0
    buffer_load_dwordx4 v200, s[24:27], s66 offen offset:192 lds
    s_mov_b32 exec_hi, 0x00000000
    s_add_u32 m0, s58, 0x00001000
    s_nop 0
    buffer_load_dwordx4 v201, s[24:27], s66 offen lds
    s_mov_b64 exec, -1
    s_add_u32 s66, s94, 1
    s_cmp_ge_u32 s66, 9
    s_cselect_b32 s95, 9, 0
    s_sub_u32 s66, s66, s95
    s_mul_i32 s66, s66, 73728
    s_add_u32 m0, s58, 0x00004800
    s_nop 0
    buffer_load_dwordx4 v200, s[24:27], s66 offen lds
    s_add_u32 m0, s58, 0x00004bc0
    s_nop 0
    buffer_load_dwordx4 v200, s[24:27], s66 offen offset:64 lds
    s_add_u32 m0, s58, 0x00004f80
    s_nop 0
    buffer_load_dwordx4 v200, s[24:27], s66 offen offset:128 lds
    s_add_u32 m0, s58, 0x00005340
    s_nop 0
    buffer_load_dwordx4 v200, s[24:27], s66 offen offset:192 lds
    s_mov_b32 exec_hi, 0x00000000
    s_add_u32 m0, s58, 0x00005800
    s_nop 0
    buffer_load_dwordx4 v201, s[24:27], s66 offen lds
    s_mov_b64 exec, -1
    s_add_u32 s66, s94, 2
    s_cmp_ge_u32 s66, 9
    s_cselect_b32 s95, 9, 0
    s_sub_u32 s66, s66, s95
    s_mul_i32 s66, s66, 73728
    s_add_u32 m0, s58, 0x00009000
    s_nop 0
    buffer_load_dwordx4 v200, s[24:27], s66 offen lds
    s_add_u32 m0, s58, 0x000093c0
    s_nop 0
    buffer_load_dwordx4 v200, s[24:27], s66 offen offset:64 lds
    s_add_u32 m0, s58, 0x00009780
    s_nop 0
    buffer_load_dwordx4 v200, s[24:27], s66 offen offset:128 lds
    s_add_u32 m0, s58, 0x00009b40
    s_nop 0
    buffer_load_dwordx4 v200, s[24:27], s66 offen offset:192 lds
    s_mov_b32 exec_hi, 0x00000000
    s_add_u32 m0, s58, 0x0000a000
    s_nop 0
    buffer_load_dwordx4 v201, s[24:27], s66 offen lds
    s_mov_b64 exec, -1
    v_mul_u32_u24 v206, 7282, v255
    v_lshrrev_b32 v206, 16, v206
    v_mul_u32_u24 v206, 63, v206
    v_add_u32 v206, v206, v255
    v_lshlrev_b32 v206, 7, v206
    s_and_b32 s64, s51, 15
    s_lshl_b32 s64, s64, 2
    s_add_u32 s64, s64, s49
    s_mul_i32 s64, s64, 46080
    s_mul_i32 s65, s50, 1152
    s_add_u32 s64, s64, s65
    s_mov_b32 exec_hi, 0x00001fff
    buffer_load_dword v221, v206, s[28:31], s64 offen
    s_mov_b64 exec, -1
    s_lshl_b32 s64, s56, 2
    s_add_u32 s64, s64, s57
    s_lshl_b32 s64, s64, 7
    s_add_u32 s60, s64, 4096
    s_mov_b32 s67, 4096
    s_barrier
    s_buffer_atomic_swap s55, s[44:47], s69 offset:0
    s_buffer_atomic_swap s55, s[44:47], s68 offset:0
    v_lshrrev_b32 v206, 4, v255
    s_lshl_b32 s64, s94, 7
    s_add_u32 s64, s64, 159744
    v_lshl_add_u32 v206, v206, 3, s64
    ds_read_b64 v[40:41], v206 offset:0
    ds_read_b64 v[42:43], v206 offset:32
    ds_read_b64 v[44:45], v206 offset:64
    ds_read_b64 v[46:47], v206 offset:96
    ds_read_b64 v[48:49], v206 offset:128
    ds_read_b64 v[50:51], v206 offset:160
    ds_read_b64 v[52:53], v206 offset:192
    ds_read_b64 v[54:55], v206 offset:224
    ds_read_b64 v[56:57], v206 offset:256
    ds_read_b64 v[58:59], v206 offset:288
    ds_read_b64 v[60:61], v206 offset:320
    ds_read_b64 v[62:63], v206 offset:352
    ds_read_b64 v[64:65], v206 offset:384
    ds_read_b64 v[66:67], v206 offset:416
    ds_read_b64 v[68:69], v206 offset:448
    ds_read_b64 v[70:71], v206 offset:480
    ds_read_b64 v[72:73], v206 offset:512
    ds_read_b64 v[74:75], v206 offset:544
    ds_read_b64 v[76:77], v206 offset:576
    ds_read_b64 v[78:79], v206 offset:608
    ds_read_b64 v[80:81], v206 offset:640
    ds_read_b64 v[82:83], v206 offset:672
    ds_read_b64 v[84:85], v206 offset:704
    ds_read_b64 v[86:87], v206 offset:736
    ds_read_b64 v[88:89], v206 offset:768
    ds_read_b64 v[90:91], v206 offset:800
    ds_read_b64 v[92:93], v206 offset:832
    ds_read_b64 v[94:95], v206 offset:864
    ds_read_b64 v[96:97], v206 offset:896
    ds_read_b64 v[98:99], v206 offset:928
    ds_read_b64 v[100:101], v206 offset:960
    ds_read_b64 v[102:103], v206 offset:992
    ds_read_b64 v[104:105], v206 offset:1024
    ds_read_b64 v[106:107], v206 offset:1056
    ds_read_b64 v[108:109], v206 offset:1088
    ds_read_b64 v[110:111], v206 offset:1120
    v_add_u32 v203, s59, v254
    s_add_u32 s66, s94, 3
    s_cmp_ge_u32 s66, 9
    s_cselect_b32 s95, 9, 0
    s_sub_u32 s66, s66, s95
    s_mul_i32 s66, s66, 73728
    s_add_u32 m0, s58, 0x0000d800
    s_nop 0
    buffer_load_dwordx4 v200, s[24:27], s66 offen lds
    s_add_u32 m0, s58, 0x0000dbc0
    s_nop 0
    buffer_load_dwordx4 v200, s[24:27], s66 offen offset:64 lds
    s_add_u32 m0, s58, 0x0000df80
    s_nop 0
    buffer_load_dwordx4 v200, s[24:27], s66 offen offset:128 lds
    s_add_u32 m0, s58, 0x0000e340
    s_nop 0
    buffer_load_dwordx4 v200, s[24:27], s66 offen offset:192 lds
    s_mov_b32 exec_hi, 0x00000000
    s_add_u32 m0, s58, 0x0000e800
    s_nop 0
    buffer_load_dwordx4 v201, s[24:27], s66 offen lds
    s_mov_b64 exec, -1
    s_add_u32 s66, s94, 4
    s_cmp_ge_u32 s66, 9
    s_cselect_b32 s95, 9, 0
    s_sub_u32 s66, s66, s95
    s_mul_i32 s66, s66, 73728
    s_add_u32 m0, s58, 0x00012000
    s_nop 0
    buffer_load_dwordx4 v200, s[24:27], s66 offen lds
    s_add_u32 m0, s58, 0x000123c0
    s_nop 0
    buffer_load_dwordx4 v200, s[24:27], s66 offen offset:64 lds
    s_add_u32 m0, s58, 0x00012780
    s_nop 0
    buffer_load_dwordx4 v200, s[24:27], s66 offen offset:128 lds
    s_add_u32 m0, s58, 0x00012b40
    s_nop 0
    buffer_load_dwordx4 v200, s[24:27], s66 offen offset:192 lds
    s_mov_b32 exec_hi, 0x00000000
    s_add_u32 m0, s58, 0x00013000
    s_nop 0
    buffer_load_dwordx4 v201, s[24:27], s66 offen lds
    s_mov_b64 exec, -1
    s_add_u32 s66, s94, 5
    s_cmp_ge_u32 s66, 9
    s_cselect_b32 s95, 9, 0
    s_sub_u32 s66, s66, s95
    s_mul_i32 s66, s66, 73728
    s_add_u32 m0, s58, 0x00016800
    s_nop 0
    buffer_load_dwordx4 v200, s[24:27], s66 offen lds
    s_add_u32 m0, s58, 0x00016bc0
    s_nop 0
    buffer_load_dwordx4 v200, s[24:27], s66 offen offset:64 lds
    s_add_u32 m0, s58, 0x00016f80
    s_nop 0
    buffer_load_dwordx4 v200, s[24:27], s66 offen offset:128 lds
    s_add_u32 m0, s58, 0x00017340
    s_nop 0
    buffer_load_dwordx4 v200, s[24:27], s66 offen offset:192 lds
    s_mov_b32 exec_hi, 0x00000000
    s_add_u32 m0, s58, 0x00017800
    s_nop 0
    buffer_load_dwordx4 v201, s[24:27], s66 offen lds
    s_mov_b64 exec, -1
    s_buffer_load_dwordx8 s[64:71], s[44:47], s60 glc
    s_waitcnt lgkmcnt(0)
    s_xor_b32 s64, s64, s55
    s_xor_b32 s65, s65, s55
    s_xor_b32 s66, s66, s55
    s_xor_b32 s67, s67, s55
    s_xor_b32 s68, s68, s55
    s_xor_b32 s69, s69, s55
    s_xor_b32 s70, s70, s55
    s_xor_b32 s71, s71, s55
    s_or_b64 s[64:65], s[64:65], s[70:71]
    s_or_b64 s[64:65], s[64:65], s[68:69]
    s_or_b64 s[64:65], s[64:65], s[66:67]
    s_cbranch_scc1 L_pslow_51
L_pback_52:
    s_add_u32 s66, s94, 0
    s_cmp_ge_u32 s66, 9
    s_cselect_b32 s95, 9, 0
    s_sub_u32 s66, s66, s95
    s_mul_i32 s66, s66, 2048
    s_add_u32 s66, s61, s66
    s_add_u32 m0, s59, 0x0001b000
    s_nop 0
    buffer_load_dwordx4 v254, s[44:47], s66 offen sc1 lds
    s_add_u32 m0, s59, 0x0001bc00
    s_nop 0
    buffer_load_dwordx4 v254, s[44:47], s66 offen offset:1024 sc1 lds
    s_add_u32 s66, s94, 1
    s_cmp_ge_u32 s66, 9
    s_cselect_b32 s95, 9, 0
    s_sub_u32 s66, s66, s95
    s_mul_i32 s66, s66, 2048
    s_add_u32 s66, s61, s66
    s_add_u32 m0, s59, 0x0001d000
    s_nop 0
    buffer_load_dwordx4 v254, s[44:47], s66 offen sc1 lds
    s_add_u32 m0, s59, 0x0001dc00
    s_nop 0
    buffer_load_dwordx4 v254, s[44:47], s66 offen offset:1024 sc1 lds
    s_add_u32 s66, s94, 2
    s_cmp_ge_u32 s66, 9
    s_cselect_b32 s95, 9, 0
    s_sub_u32 s66, s66, s95
    s_mul_i32 s66, s66, 2048
    s_add_u32 s66, s61, s66
    s_add_u32 m0, s59, 0x0001f000
    s_nop 0
    buffer_load_dwordx4 v254, s[44:47], s66 offen sc1 lds
    s_add_u32 m0, s59, 0x0001fc00
    s_nop 0
    buffer_load_dwordx4 v254, s[44:47], s66 offen offset:1024 sc1 lds
    s_add_u32 s66, s94, 3
    s_cmp_ge_u32 s66, 9
    s_cselect_b32 s95, 9, 0
    s_sub_u32 s66, s66, s95
    s_mul_i32 s66, s66, 2048
    s_add_u32 s66, s61, s66
    s_add_u32 m0, s59, 0x00021000
    s_nop 0
    buffer_load_dwordx4 v254, s[44:47], s66 offen sc1 lds
    s_add_u32 m0, s59, 0x00021c00
    s_nop 0
    buffer_load_dwordx4 v254, s[44:47], s66 offen offset:1024 sc1 lds
    s_waitcnt vmcnt(6)
    s_barrier
    v_add_u32 v203, 0x00019000, v203
    ds_read_b128 v[0:3], v203 offset:8192
    ds_read_b128 v[4:7], v203 offset:12288
    s_add_u32 s66, s94, 4
    s_cmp_ge_u32 s66, 9
    s_cselect_b32 s95, 9, 0
    s_sub_u32 s66, s66, s95
    s_mul_i32 s66, s66, 2048
    s_add_u32 s66, s61, s66
    s_add_u32 m0, s59, 0x00023000
    s_nop 0
    buffer_load_dwordx4 v254, s[44:47], s66 offen sc1 lds
    s_add_u32 m0, s59, 0x00023c00
    s_nop 0
    buffer_load_dwordx4 v254, s[44:47], s66 offen offset:1024 sc1 lds
    s_setprio 1
    s_waitcnt lgkmcnt(1)
    v_mfma_f32_16x16x32_bf16 v[8:11], v[40:43], v[0:3], 0
    s_waitcnt lgkmcnt(0)
    v_mfma_f32_16x16x32_bf16 v[8:11], v[44:47], v[4:7], v[8:11]
    s_setprio 0
    s_waitcnt vmcnt(6)
    s_barrier
    ds_read_b128 v[0:3], v203 offset:16384
    ds_read_b128 v[4:7], v203 offset:20480
    s_add_u32 s66, s94, 5
    s_cmp_ge_u32 s66, 9
    s_cselect_b32 s95, 9, 0
    s_sub_u32 s66, s66, s95
    s_mul_i32 s66, s66, 2048
    s_add_u32 s66, s61, s66
    s_add_u32 m0, s59, 0x00025000
    s_nop 0
    buffer_load_dwordx4 v254, s[44:47], s66 offen sc1 lds
    s_add_u32 m0, s59, 0x00025c00
    s_nop 0
    buffer_load_dwordx4 v254, s[44:47], s66 offen offset:1024 sc1 lds
    s_setprio 1
    s_waitcnt lgkmcnt(1)
    v_mfma_f32_16x16x32_bf16 v[8:11], v[48:51], v[0:3], v[8:11]
    s_waitcnt lgkmcnt(0)
    v_mfma_f32_16x16x32_bf16 v[8:11], v[52:55], v[4:7], v[8:11]
    s_setprio 0
    s_waitcnt vmcnt(6)
    s_barrier
    ds_read_b128 v[0:3], v203 offset:24576
    ds_read_b128 v[4:7], v203 offset:28672
    s_add_u32 s66, s94, 6
    s_cmp_ge_u32 s66, 9
    s_cselect_b32 s95, 9, 0
    s_sub_u32 s66, s66, s95
    s_mul_i32 s66, s66, 2048
    s_add_u32 s66, s61, s66
    s_add_u32 m0, s59, 0x0001b000
    s_nop 0
    buffer_load_dwordx4 v254, s[44:47], s66 offen sc1 lds
    s_add_u32 m0, s59, 0x0001bc00
    s_nop 0
    buffer_load_dwordx4 v254, s[44:47], s66 offen offset:1024 sc1 lds
    s_setprio 1
    s_waitcnt lgkmcnt(1)
    v_mfma_f32_16x16x32_bf16 v[8:11], v[56:59], v[0:3], v[8:11]
    s_waitcnt lgkmcnt(0)
    v_mfma_f32_16x16x32_bf16 v[8:11], v[60:63], v[4:7], v[8:11]
    s_setprio 0
    s_add_u32 s66, s3, 0
    s_and_b32 s66, s66, 7
    s_mul_i32 s66, s66, 589824
    s_add_u32 m0, s101, 0x00000000
    s_nop 0
    buffer_load_dwordx4 v208, s[28:31], s66 offen lds
    s_add_u32 m0, s101, 0x000003c0
    s_nop 0
    buffer_load_dwordx4 v208, s[28:31], s66 offen offset:64 lds
    s_add_u32 s66, s3, 0
    s_and_b32 s66, s66, 7
    s_mul_i32 s66, s66, 589824
    s_mov_b32 exec_hi, 0x00000000
    s_add_u32 m0, s101, 0x00000800
    s_nop 0
    buffer_load_dwordx4 v209, s[28:31], s66 offen lds
    s_mov_b64 exec, -1
    s_waitcnt vmcnt(9)
    s_barrier
    ds_read_b128 v[0:3], v203 offset:32768
    ds_read_b128 v[4:7], v203 offset:36864
    s_add_u32 s66, s94, 7
    s_cmp_ge_u32 s66, 9
    s_cselect_b32 s95, 9, 0
    s_sub_u32 s66, s66, s95
    s_mul_i32 s66, s66, 2048
    s_add_u32 s66, s61, s66
    s_add_u32 m0, s59, 0x0001d000
    s_nop 0
    buffer_load_dwordx4 v254, s[44:47], s66 offen sc1 lds
    s_add_u32 m0, s59, 0x0001dc00
    s_nop 0
    buffer_load_dwordx4 v254, s[44:47], s66 offen offset:1024 sc1 lds
    s_setprio 1
    s_waitcnt lgkmcnt(1)
    v_mfma_f32_16x16x32_bf16 v[8:11], v[64:67], v[0:3], v[8:11]
    s_waitcnt lgkmcnt(0)
    v_mfma_f32_16x16x32_bf16 v[8:11], v[68:71], v[4:7], v[8:11]
    s_setprio 0
    s_add_u32 s66, s3, 1
    s_and_b32 s66, s66, 7
    s_mul_i32 s66, s66, 589824
    s_add_u32 m0, s101, 0x00002800
    s_nop 0
    buffer_load_dwordx4 v208, s[28:31], s66 offen lds
    s_add_u32 m0, s101, 0x00002bc0
    s_nop 0
    buffer_load_dwordx4 v208, s[28:31], s66 offen offset:64 lds
    s_add_u32 s66, s3, 1
    s_and_b32 s66, s66, 7
    s_mul_i32 s66, s66, 589824
    s_mov_b32 exec_hi, 0x00000000
    s_add_u32 m0, s101, 0x00003000
    s_nop 0
    buffer_load_dwordx4 v209, s[28:31], s66 offen lds
    s_mov_b64 exec, -1
    s_waitcnt vmcnt(12)
    s_barrier
    ds_read_b128 v[0:3], v203 offset:40960
    ds_read_b128 v[4:7], v203 offset:45056
    s_add_u32 s66, s94, 8
    s_cmp_ge_u32 s66, 9
    s_cselect_b32 s95, 9, 0
    s_sub_u32 s66, s66, s95
    s_mul_i32 s66, s66, 2048
    s_add_u32 s66, s61, s66
    s_add_u32 m0, s59, 0x0001f000
    s_nop 0
    buffer_load_dwordx4 v254, s[44:47], s66 offen sc1 lds
    s_add_u32 m0, s59, 0x0001fc00
    s_nop 0
    buffer_load_dwordx4 v254, s[44:47], s66 offen offset:1024 sc1 lds
    s_setprio 1
    s_waitcnt lgkmcnt(1)
    v_mfma_f32_16x16x32_bf16 v[8:11], v[72:75], v[0:3], v[8:11]
    s_waitcnt lgkmcnt(0)
    v_mfma_f32_16x16x32_bf16 v[8:11], v[76:79], v[4:7], v[8:11]
    s_setprio 0
    s_add_u32 s66, s3, 2
    s_and_b32 s66, s66, 7
    s_mul_i32 s66, s66, 589824
    s_add_u32 m0, s101, 0x00005000
    s_nop 0
    buffer_load_dwordx4 v208, s[28:31], s66 offen lds
    s_add_u32 m0, s101, 0x000053c0
    s_nop 0
    buffer_load_dwordx4 v208, s[28:31], s66 offen offset:64 lds
    s_add_u32 s66, s3, 2
    s_and_b32 s66, s66, 7
    s_mul_i32 s66, s66, 589824
    s_mov_b32 exec_hi, 0x00000000
    s_add_u32 m0, s101, 0x00005800
    s_nop 0
    buffer_load_dwordx4 v209, s[28:31], s66 offen lds
    s_mov_b64 exec, -1
    s_waitcnt vmcnt(15)
    s_barrier
    ds_read_b128 v[0:3], v203 offset:49152
    ds_read_b128 v[4:7], v203 offset:53248
    s_setprio 1
    s_waitcnt lgkmcnt(1)
    v_mfma_f32_16x16x32_bf16 v[8:11], v[80:83], v[0:3], v[8:11]
    s_waitcnt lgkmcnt(0)
    v_mfma_f32_16x16x32_bf16 v[8:11], v[84:87], v[4:7], v[8:11]
    s_setprio 0
    s_add_u32 s66, s3, 3
    s_and_b32 s66, s66, 7
    s_mul_i32 s66, s66, 589824
    s_add_u32 m0, s101, 0x00007800
    s_nop 0
    buffer_load_dwordx4 v208, s[28:31], s66 offen lds
    s_add_u32 m0, s101, 0x00007bc0
    s_nop 0
    buffer_load_dwordx4 v208, s[28:31], s66 offen offset:64 lds
    s_add_u32 s66, s3, 3
    s_and_b32 s66, s66, 7
    s_mul_i32 s66, s66, 589824
    s_mov_b32 exec_hi, 0x00000000
    s_add_u32 m0, s101, 0x00008000
    s_nop 0
    buffer_load_dwordx4 v209, s[28:31], s66 offen lds
    s_mov_b64 exec, -1
    s_waitcnt vmcnt(16)
    s_barrier
    ds_read_b128 v[0:3], v203 offset:8192
    ds_read_b128 v[4:7], v203 offset:12288
    s_setprio 1
    s_waitcnt lgkmcnt(1)
    v_mfma_f32_16x16x32_bf16 v[8:11], v[88:91], v[0:3], v[8:11]
    s_waitcnt lgkmcnt(0)
    v_mfma_f32_16x16x32_bf16 v[8:11], v[92:95], v[4:7], v[8:11]
    s_setprio 0
    s_add_u32 s66, s3, 4
    s_and_b32 s66, s66, 7
    s_mul_i32 s66, s66, 589824
    s_add_u32 m0, s101, 0x0000a000
    s_nop 0
    buffer_load_dwordx4 v208, s[28:31], s66 offen lds
    s_add_u32 m0, s101, 0x0000a3c0
    s_nop 0
    buffer_load_dwordx4 v208, s[28:31], s66 offen offset:64 lds
    s_add_u32 s66, s3, 4
    s_and_b32 s66, s66, 7
    s_mul_i32 s66, s66, 589824
    s_mov_b32 exec_hi, 0x00000000
    s_add_u32 m0, s101, 0x0000a800
    s_nop 0
    buffer_load_dwordx4 v209, s[28:31], s66 offen lds
    s_mov_b64 exec, -1
    s_waitcnt vmcnt(14)
    s_barrier
    ds_read_b128 v[0:3], v203 offset:16384
    ds_read_b128 v[4:7], v203 offset:20480
    s_setprio 1
    s_waitcnt lgkmcnt(1)
    v_mfma_f32_16x16x32_bf16 v[8:11], v[96:99], v[0:3], v[8:11]
    s_waitcnt lgkmcnt(0)
    v_mfma_f32_16x16x32_bf16 v[8:11], v[100:103], v[4:7], v[8:11]
    s_setprio 0
    s_add_u32 s66, s3, 5
    s_and_b32 s66, s66, 7
    s_mul_i32 s66, s66, 589824
    s_add_u32 m0, s101, 0x0000c800
    s_nop 0
    buffer_load_dwordx4 v208, s[28:31], s66 offen lds
    s_add_u32 m0, s101, 0x0000cbc0
    s_nop 0
    buffer_load_dwordx4 v208, s[28:31], s66 offen offset:64 lds
    s_add_u32 s66, s3, 5
    s_and_b32 s66, s66, 7
    s_mul_i32 s66, s66, 589824
    s_mov_b32 exec_hi, 0x00000000
    s_add_u32 m0, s101, 0x0000d000
    s_nop 0
    buffer_load_dwordx4 v209, s[28:31], s66 offen lds
    s_mov_b64 exec, -1
    s_add_u32 s66, s3, 6
    s_and_b32 s66, s66, 7
    s_mul_i32 s66, s66, 589824
    s_add_u32 m0, s101, 0x0000f000
    s_nop 0
    buffer_load_dwordx4 v208, s[28:31], s66 offen lds
    s_add_u32 m0, s101, 0x0000f3c0
    s_nop 0
    buffer_load_dwordx4 v208, s[28:31], s66 offen offset:64 lds
    s_add_u32 s66, s3, 6
    s_and_b32 s66, s66, 7
    s_mul_i32 s66, s66, 589824
    s_mov_b32 exec_hi, 0x00000000
    s_add_u32 m0, s101, 0x0000f800
    s_nop 0
    buffer_load_dwordx4 v209, s[28:31], s66 offen lds
    s_mov_b64 exec, -1
    s_waitcnt vmcnt(15)
    s_barrier
    ds_read_b128 v[0:3], v203 offset:24576
    ds_read_b128 v[4:7], v203 offset:28672
    s_setprio 1
    s_waitcnt lgkmcnt(1)
    v_mfma_f32_16x16x32_bf16 v[8:11], v[104:107], v[0:3], v[8:11]
    s_waitcnt lgkmcnt(0)
    v_mfma_f32_16x16x32_bf16 v[8:11], v[108:111], v[4:7], v[8:11]
    s_setprio 0
    s_add_u32 s66, s3, 7
    s_and_b32 s66, s66, 7
    s_mul_i32 s66, s66, 589824
    s_add_u32 m0, s101, 0x00011800
    s_nop 0
    buffer_load_dwordx4 v208, s[28:31], s66 offen lds
    s_add_u32 m0, s101, 0x00011bc0
    s_nop 0
    buffer_load_dwordx4 v208, s[28:31], s66 offen offset:64 lds
    s_add_u32 s66, s3, 7
    s_and_b32 s66, s66, 7
    s_mul_i32 s66, s66, 589824
    s_mov_b32 exec_hi, 0x00000000
    s_add_u32 m0, s101, 0x00012000
    s_nop 0
    buffer_load_dwordx4 v209, s[28:31], s66 offen lds
    s_mov_b64 exec, -1
    s_mov_b32 s66, 4718592
    s_add_u32 m0, s101, 0x00014000
    s_nop 0
    buffer_load_dwordx4 v208, s[28:31], s66 offen lds
    s_add_u32 m0, s101, 0x000143c0
    s_nop 0
    buffer_load_dwordx4 v208, s[28:31], s66 offen offset:64 lds
    s_mov_b32 s66, 4718592
    s_mov_b32 exec_hi, 0x00000000
    s_add_u32 m0, s101, 0x00014800
    s_nop 0
    buffer_load_dwordx4 v209, s[28:31], s66 offen lds
    s_mov_b64 exec, -1
    s_lshl_b32 s64, s49, 6
    s_add_u32 s64, s64, 159744
    v_lshl_add_u32 v204, v255, 2, s64
    s_mov_b64 exec, 0x0000ffff
    ds_write_b32 v204, v8
    s_mov_b64 exec, -1
    s_waitcnt lgkmcnt(0)
    s_and_b32 s64, s49, 1
    s_lshl_b32 s65, s64, 8
    s_add_u32 s65, s65, 161792
    v_lshl_add_u32 v204, v255, 2, s65
    s_lshl_b32 s65, s56, 1
    s_add_u32 s64, s64, s65
    s_lshl_b32 s64, s64, 10
    s_lshl_b32 s65, s57, 2
    s_add_u32 s64, s64, s65
    s_add_u32 s68, s64, 151552
    s_cmp_ge_u32 s49, 2
    s_cselect_b32 s70, 0, -1
    s_cselect_b32 s71, -1, 0
    s_barrier
    ds_read_b32 v28, v204 offset:0
    ds_read_b32 v29, v204 offset:512
    ds_read_b32 v30, v204 offset:1024
    ds_read_b32 v31, v204 offset:1536
    s_waitcnt lgkmcnt(2)
    v_add_f32 v28, v28, v29
    s_waitcnt lgkmcnt(0)
    v_add_f32 v30, v30, v31
    v_add_f32 v28, v28, v30
    s_mov_b64 exec, s[70:71]
    buffer_store_dword v28, v254, s[44:47], s68 offen sc1
    s_mov_b64 exec, -1
    s_lshl_b32 s64, s52, 3
    s_add_u32 s64, s64, s53
    s_lshl_b32 s65, s64, 3
    s_add_u32 s65, s65, s48
    s_mul_i32 s0, s65, 36864
    s_add_u32 s0, s0, 14680064
    s_lshl_b32 s1, s65, 9
    s_add_u32 s1, s1, 249856
    s_lshl_b32 s64, s52, 2
    s_add_u32 s64, s64, s54
    s_lshl_b32 s64, s64, 3
    s_add_u32 s64, s64, s48
    s_mul_i32 s63, s64, 73728
    s_lshl_b32 s65, s53, 10
    s_add_u32 s63, s63, s65
    s_add_u32 s63, s63, 33554432
    s_lshl_b32 s65, s53, 3
    s_add_u32 s65, s65, s53
    s_bfe_u32 s65, s65, 0x30001
    s_cmp_eq_u32 s48, s65
    s_cselect_b32 s63, 0x40000000, s63
    s_lshl_b32 s20, s54, 13
    s_add_u32 s20, s20, s0
    s_add_u32 s21, s20, 4096
    s_lshl_b32 s22, s54, 10
    s_add_u32 s22, s22, s0
    s_add_u32 s22, s22, 32768
    s_mul_i32 s23, s49, 2560
    s_lshl_b32 s24, s49, 11
    s_mul_i32 s8, s54, 147456
    s_add_u32 s9, s8, 73728
    s_and_b32 s64, s52, 3
    s_lshl_b32 s64, s64, 1
    s_lshr_b32 s64, 0xe79, s64
    s_add_u32 s65, s64, s54
    s_and_b32 s65, s65, 3
    s_mul_i32 s10, s65, 147456
    s_add_u32 s13, s10, 73728
    s_lshl_b32 s65, s65, 13
    s_add_u32 s25, s65, s0
    s_lshr_b32 s64, s64, 2
    s_add_u32 s65, s64, s54
    s_and_b32 s65, s65, 3
    s_mul_i32 s11, s65, 147456
    s_add_u32 s14, s11, 73728
    s_lshl_b32 s65, s65, 13
    s_add_u32 s26, s65, s0
    s_lshr_b32 s64, s64, 2
    s_add_u32 s65, s64, s54
    s_and_b32 s65, s65, 3
    s_mul_i32 s12, s65, 147456
    s_add_u32 s15, s12, 73728
    s_lshl_b32 s65, s65, 13
    s_add_u32 s27, s65, s0
    s_lshl_b32 s64, s52, 2
    s_add_u32 s64, s64, s54
    s_lshl_b32 s64, s64, 3
    s_add_u32 s64, s64, s48
    s_lshl_b32 s42, s64, 5
    s_add_u32 s42, s42, s53
    s_lshl_b32 s42, s42, 2
    s_add_u32 s42, s42, 512000
    s_lshl_b32 s40, s54, 7
    s_add_u32 s40, s40, s1
    s_lshl_b32 s41, s54, 2
    s_add_u32 s41, s41, s1
    s_mov_b32 s43, 0
    s_add_u32 s66, s3, 0
    s_and_b32 s66, s66, 7
    s_mul_i32 s66, s66, 589824
    s_add_u32 m0, s59, 0x00016780
    s_nop 0
    buffer_load_dwordx4 v208, s[28:31], s66 offen offset:128 lds
    s_add_u32 m0, s59, 0x0001f740
    s_nop 0
    buffer_load_dwordx4 v208, s[28:31], s66 offen offset:192 lds
    s_add_u32 s66, s3, 1
    s_and_b32 s66, s66, 7
    s_mul_i32 s66, s66, 589824
    s_add_u32 m0, s59, 0x00017780
    s_nop 0
    buffer_load_dwordx4 v208, s[28:31], s66 offen offset:128 lds
    s_add_u32 m0, s59, 0x00020740
    s_nop 0
    buffer_load_dwordx4 v208, s[28:31], s66 offen offset:192 lds
    s_add_u32 s66, s3, 2
    s_and_b32 s66, s66, 7
    s_mul_i32 s66, s66, 589824
    s_add_u32 m0, s59, 0x00018780
    s_nop 0
    buffer_load_dwordx4 v208, s[28:31], s66 offen offset:128 lds
    s_add_u32 m0, s59, 0x00021740
    s_nop 0
    buffer_load_dwordx4 v208, s[28:31], s66 offen offset:192 lds
    s_add_u32 s66, s3, 3
    s_and_b32 s66, s66, 7
    s_mul_i32 s66, s66, 589824
    s_add_u32 m0, s59, 0x00019780
    s_nop 0
    buffer_load_dwordx4 v208, s[28:31], s66 offen offset:128 lds
    s_add_u32 m0, s59, 0x00022740
    s_nop 0
    buffer_load_dwordx4 v208, s[28:31], s66 offen offset:192 lds
    s_add_u32 s66, s3, 4
    s_and_b32 s66, s66, 7
    s_mul_i32 s66, s66, 589824
    s_add_u32 m0, s59, 0x0001a780
    s_nop 0
    buffer_load_dwordx4 v208, s[28:31], s66 offen offset:128 lds
    s_add_u32 m0, s59, 0x00023740
    s_nop 0
    buffer_load_dwordx4 v208, s[28:31], s66 offen offset:192 lds
    s_waitcnt vmcnt(10)
    s_barrier
    s_add_u32 s66, s3, 5
    s_and_b32 s66, s66, 7
    s_mul_i32 s66, s66, 589824
    s_add_u32 m0, s59, 0x0001b780
    s_nop 0
    buffer_load_dwordx4 v208, s[28:31], s66 offen offset:128 lds
    s_add_u32 m0, s59, 0x00024740
    s_nop 0
    buffer_load_dwordx4 v208, s[28:31], s66 offen offset:192 lds
    s_add_u32 s66, s3, 6
    s_and_b32 s66, s66, 7
    s_mul_i32 s66, s66, 589824
    s_add_u32 m0, s59, 0x0001c780
    s_nop 0
    buffer_load_dwordx4 v208, s[28:31], s66 offen offset:128 lds
    s_add_u32 m0, s59, 0x00025740
    s_nop 0
    buffer_load_dwordx4 v208, s[28:31], s66 offen offset:192 lds
    s_add_u32 s66, s3, 7
    s_and_b32 s66, s66, 7
    s_mul_i32 s66, s66, 589824
    s_add_u32 m0, s59, 0x0001d780
    s_nop 0
    buffer_load_dwordx4 v208, s[28:31], s66 offen offset:128 lds
    s_add_u32 m0, s59, 0x00026740
    s_nop 0
    buffer_load_dwordx4 v208, s[28:31], s66 offen offset:192 lds
    s_mov_b32 s66, 4718592
    s_add_u32 m0, s59, 0x0001e780
    s_nop 0
    buffer_load_dwordx4 v208, s[28:31], s66 offen offset:128 lds
    s_lshl_b32 s64, s52, 3
    s_add_u32 s64, s64, s48
    s_lshl_b32 s61, s64, 10
    s_add_u32 s61, s61, 151552
    s_mul_i32 s60, s64, 36864
    s_add_u32 s60, s60, 6553600
    s_add_u32 s64, s3, 0
    s_and_b32 s64, s64, 7
    s_lshl_b32 s64, s64, 11
    s_add_u32 s92, s64, s60
    s_add_u32 s64, s3, 1
    s_and_b32 s64, s64, 7
    s_lshl_b32 s64, s64, 11
    s_add_u32 s93, s64, s60
    s_add_u32 s64, s3, 2
    s_and_b32 s64, s64, 7
    s_lshl_b32 s64, s64, 11
    s_add_u32 s94, s64, s60
    s_add_u32 s64, s3, 3
    s_and_b32 s64, s64, 7
    s_lshl_b32 s64, s64, 11
    s_add_u32 s95, s64, s60
    s_add_u32 s64, s3, 4
    s_and_b32 s64, s64, 7
    s_lshl_b32 s64, s64, 11
    s_add_u32 s96, s64, s60
    s_add_u32 s64, s3, 5
    s_and_b32 s64, s64, 7
    s_lshl_b32 s64, s64, 11
    s_add_u32 s97, s64, s60
    s_add_u32 s64, s3, 6
    s_and_b32 s64, s64, 7
    s_lshl_b32 s64, s64, 11
    s_add_u32 s98, s64, s60
    s_add_u32 s64, s3, 7
    s_and_b32 s64, s64, 7
    s_lshl_b32 s64, s64, 11
    s_add_u32 s99, s64, s60
    s_add_u32 s60, s60, 16384
    v_add_u32 v251, 18432, v254
    v_lshlrev_b32 v252, 3, v255
    v_add_u32 v253, 18432, v252
    v_lshrrev_b32 v247, 2, v255
    v_lshlrev_b32 v232, 6, v247
    v_and_b32 v247, 3, v255
    v_lshl_add_u32 v232, v247, 3, v232
    v_and_b32 v247, 16, v255
    v_lshl_add_u32 v232, v247, 1, v232
    v_xor_b32 v233, 32, v232
    v_lshlrev_b32 v234, 3, v255
    v_lshrrev_b32 v247, 2, v255
    v_mul_u32_u24 v247, 1152, v247
    v_lshrrev_b32 v236, 3, v255
    v_and_b32 v236, 2, v236
    v_xor_b32 v236, v236, v255
    v_and_b32 v236, 3, v236
    v_lshl_add_u32 v235, v236, 4, v247
    v_bfe_u32 v247, v255, 1, 4
    v_mul_u32_u24 v247, 1152, v247
    v_and_b32 v236, 1, v255
    v_lshl_add_u32 v236, v236, 4, v247
    s_mul_i32 s64, s49, 18432
    s_mul_i32 s65, s53, 663552
    s_add_u32 s64, s64, s65
    s_lshl_b32 s65, s54, 8
    s_add_u32 s65, s65, s64
    v_add_u32 v235, s65, v235
    s_lshl_b32 s65, s54, 5
    s_add_u32 s65, s65, s64
    s_add_u32 s65, s65, 1024
    v_add_u32 v236, s65, v236
    s_lshl_b32 s64, s52, 2
    s_lshr_b32 s65, s48, 1
    s_add_u32 s64, s64, s65
    s_lshl_b32 s64, s64, 3
    s_add_u32 s64, s64, s53
    s_lshl_b32 s64, s64, 2
    s_add_u32 s64, s64, s54
    s_lshl_b32 s64, s64, 7
    s_add_u32 s100, s64, 20480
    s_waitcnt vmcnt(0)
    s_barrier
    s_buffer_load_dwordx4 s[64:67], s[44:47], s100 glc
    s_waitcnt lgkmcnt(0)
    s_xor_b32 s64, s64, s55
    s_xor_b32 s65, s65, s55
    s_xor_b32 s66, s66, s55
    s_xor_b32 s67, s67, s55
    s_or_b64 s[64:65], s[64:65], s[66:67]
    s_cbranch_scc1 L_pslow_55
L_pback_56:
    buffer_load_dwordx4 v[144:147], v254, s[44:47], s61 offen sc1
    buffer_load_dwordx4 v[0:3], v254, s[44:47], s92 offen offset:0 sc1
    buffer_load_dwordx4 v[4:7], v251, s[44:47], s92 offen offset:0 sc1
    buffer_load_dwordx4 v[8:11], v254, s[44:47], s92 offen offset:1024 sc1
    buffer_load_dwordx4 v[12:15], v251, s[44:47], s92 offen offset:1024 sc1
    buffer_load_dwordx4 v[16:19], v254, s[44:47], s93 offen offset:0 sc1
    buffer_load_dwordx4 v[20:23], v251, s[44:47], s93 offen offset:0 sc1
    buffer_load_dwordx4 v[24:27], v254, s[44:47], s93 offen offset:1024 sc1
    buffer_load_dwordx4 v[28:31], v251, s[44:47], s93 offen offset:1024 sc1
    buffer_load_dwordx4 v[32:35], v254, s[44:47], s94 offen offset:0 sc1
    buffer_load_dwordx4 v[36:39], v251, s[44:47], s94 offen offset:0 sc1
    buffer_load_dwordx4 v[40:43], v254, s[44:47], s94 offen offset:1024 sc1
    buffer_load_dwordx4 v[44:47], v251, s[44:47], s94 offen offset:1024 sc1
    s_branch L_SY
L_A:
    s_lshr_b32 s64, s50, 1
    s_lshl_b32 s64, s64, 2
    s_bfe_u32 s65, s51, 0x20002
    s_add_u32 s56, s64, s65
    s_and_b32 s64, s50, 1
    s_lshl_b32 s64, s64, 2
    s_and_b32 s65, s51, 3
    s_add_u32 s57, s64, s65
    s_waitcnt lgkmcnt(0)
    s_lshr_b32 s64, s50, 1
    s_lshl_b32 s64, s64, 5
    s_lshl_b32 s65, s50, 4
    s_add_u32 s65, s65, s51
    s_and_b32 s65, s65, 31
    s_add_u32 s64, s64, s65
    s_lshl_b32 s64, s64, 2
    s_add_u32 s64, s64, s49
    s_mul_i32 s64, s64, 4608
    v_lshlrev_b32 v238, 7, v255
    s_mov_b32 exec_hi, 0x0000000f
    buffer_load_dword v240, v238, s[4:7], s64 offen
    s_mov_b64 exec, -1
    s_lshl_b32 s64, s2, 2
    s_add_u32 s64, s64, s49
    s_mul_i32 s64, s64, 640
    s_add_u32 s64, s64, 4220
    v_lshlrev_b32 v238, 7, v255
    v_mov_b32 v239, 0
    s_mov_b64 exec, 0x0000001f
    buffer_atomic_add v239, v238, s[44:47], s64 offen
    s_mov_b64 exec, -1
    s_load_dwordx2 s[12:13], s[0:1], 16
    s_load_dwordx2 s[16:17], s[0:1], 24
    s_load_dwordx2 s[24:25], s[0:1], 48
    s_load_dwordx2 s[28:29], s[0:1], 56
    s_load_dwordx2 s[32:33], s[0:1], 64
    s_load_dwordx2 s[36:37], s[0:1], 72
    s_load_dwordx2 s[40:41], s[0:1], 80
    s_waitcnt lgkmcnt(0)
    v_bfe_u32 v230, v255, 2, 1
    v_bfe_u32 v231, v255, 5, 1
    v_lshl_add_u32 v230, v231, 1, v230
    v_bfe_u32 v231, v255, 3, 2
    v_lshl_add_u32 v230, v231, 2, v230
    v_mul_u32_u24 v228, 144, v230
    v_and_b32 v230, 1, v255
    v_lshl_add_u32 v228, v230, 5, v228
    v_bfe_u32 v230, v255, 1, 1
    v_mul_u32_u24 v230, 72, v230
    v_add_u32 v228, v228, v230
    v_and_b32 v230, 15, v255
    v_lshlrev_b32 v229, 6, v230
    v_lshrrev_b32 v230, 2, v255
    v_and_b32 v230, 2, v230
    v_lshrrev_b32 v231, 4, v255
    v_xor_b32 v230, v230, v231
    v_lshl_add_u32 v229, v230, 4, v229
    s_lshl_b32 s64, s49, 11
    v_add_u32 v229, s64, v229
    s_lshl_b32 s64, s49, 3
    v_add_u32 v234, s64, v228
    s_lshl_b32 s64, s49, 6
    s_mul_i32 s65, s57, 2592
    v_add_u32 v230, s64, v255
    v_lshlrev_b32 v231, 2, v230
    buffer_load_dword v176, v231, s[12:15], s65 offen
    v_mul_u32_u24 v231, 7282, v230
    v_lshrrev_b32 v231, 16, v231
    v_mul_u32_u24 v232, 9, v231
    v_sub_u32 v179, v230, v232
    v_lshlrev_b32 v179, 2, v179
    v_mul_u32_u24 v232, 3641, v231
    v_lshrrev_b32 v232, 16, v232
    v_mul_u32_u24 v230, 18, v232
    v_sub_u32 v231, v231, v230
    v_mul_u32_u24 v230, 800, v232
    v_add_u32 v179, v179, v230
    v_and_b32 v232, 1, v232
    v_lshl_add_u32 v231, v232, 1, v231
    v_add_u32 v230, 16, v231
    v_subrev_u32 v231, 2, v231
    v_min_u32 v231, v231, v230
    v_mul_u32_u24 v231, 40, v231
    v_add_u32 v179, v179, v231
    v_add_u32 v179, 71680, v179
    v_add_u32 v230, s64, v255
    v_add_u32 v230, 256, v230
    v_lshlrev_b32 v231, 2, v230
    buffer_load_dword v177, v231, s[12:15], s65 offen
    v_mul_u32_u24 v231, 7282, v230
    v_lshrrev_b32 v231, 16, v231
    v_mul_u32_u24 v232, 9, v231
    v_sub_u32 v180, v230, v232
    v_lshlrev_b32 v180, 2, v180
    v_mul_u32_u24 v232, 3641, v231
    v_lshrrev_b32 v232, 16, v232
    v_mul_u32_u24 v230, 18, v232
    v_sub_u32 v231, v231, v230
    v_mul_u32_u24 v230, 800, v232
    v_add_u32 v180, v180, v230
    v_and_b32 v232, 1, v232
    v_lshl_add_u32 v231, v232, 1, v231
    v_add_u32 v230, 16, v231
    v_subrev_u32 v231, 2, v231
    v_min_u32 v231, v231, v230
    v_mul_u32_u24 v231, 40, v231
    v_add_u32 v180, v180, v231
    v_add_u32 v180, 71680, v180
    v_add_u32 v230, s64, v255
    v_add_u32 v230, 512, v230
    v_lshlrev_b32 v231, 2, v230
    buffer_load_dword v178, v231, s[12:15], s65 offen
    v_mul_u32_u24 v231, 7282, v230
    v_lshrrev_b32 v231, 16, v231
    v_mul_u32_u24 v232, 9, v231
    v_sub_u32 v181, v230, v232
    v_lshlrev_b32 v181, 2, v181
    v_mul_u32_u24 v232, 3641, v231
    v_lshrrev_b32 v232, 16, v232
    v_mul_u32_u24 v230, 18, v232
    v_sub_u32 v231, v231, v230
    v_mul_u32_u24 v230, 800, v232
    v_add_u32 v181, v181, v230
    v_and_b32 v232, 1, v232
    v_lshl_add_u32 v231, v232, 1, v231
    v_add_u32 v230, 16, v231
    v_subrev_u32 v231, 2, v231
    v_min_u32 v231, v231, v230
    v_mul_u32_u24 v231, 40, v231
    v_add_u32 v181, v181, v231
    v_add_u32 v181, 71680, v181
    s_lshl_b32 s64, s49, 10
    s_add_u32 s64, s64, 71680
    v_add_u32 v230, s64, v254
    v_mov_b32 v184, 0
    v_mov_b32 v185, 0
    v_mov_b32 v186, 0
    v_mov_b32 v187, 0
    ds_write_b128 v230, v[184:187]
    v_mov_b32 v230, 163584
    ds_write_b32 v230, v184
    v_and_b32 v242, 15, v255
    v_lshlrev_b32 v242, 3, v242
    s_lshl_b32 s64, s49, 8
    s_add_u32 s64, s64, 75776
    v_add_u32 v242, s64, v242
    v_and_b32 v237, 48, v255
    v_add_u32 v237, 76800, v237
    v_bfe_u32 v230, v255, 4, 2
    v_and_b32 v243, 3, v255
    v_cmp_eq_u32 vcc, v230, v243
    s_nop 1
    v_cndmask_b32 v230, 4, v230, vcc
    v_mul_u32_u24 v230, 800, v230
    v_bfe_u32 v243, v255, 2, 2
    v_mul_u32_u24 v243, 40, v243
    v_add_u32 v243, v243, v230
    v_add_u32 v243, 71680, v243
    v_lshrrev_b32 v230, 4, v255
    v_mul_u32_u24 v230, 9216, v230
    s_lshl_b32 s64, s49, 5
    v_and_or_b32 v245, v255, 15, s64
    v_lshl_add_u32 v244, v245, 5, v230
    v_lshl_add_u32 v245, v245, 3, v230
    v_add_u32 v244, 0, v244
    v_add_u32 v245, 8192, v245
    v_lshrrev_b32 v230, 4, v255
    v_mul_u32_u24 v230, 5120, v230
    s_lshl_b32 s64, s49, 5
    v_and_or_b32 v247, v255, 15, s64
    v_lshl_add_u32 v246, v247, 5, v230
    v_lshl_add_u32 v247, v247, 3, v230
    v_add_u32 v246, 36864, v246
    v_add_u32 v247, 40960, v247
    v_lshlrev_b32 v230, 3, v255
    v_and_b32 v231, 60, v255
    v_lshlrev_b32 v231, 1, v231
    s_mul_i32 s64, s49, 9216
    s_add_u32 s64, s64, 0
    s_mul_i32 s65, s49, 5120
    s_add_u32 s65, s65, 36864
    v_add_u32 v248, s64, v230
    v_add_u32 v250, s64, v231
    v_add_u32 v249, s65, v230
    v_add_u32 v251, s65, v231
    v_lshrrev_b32 v230, 4, v255
    v_mul_u32_u24 v230, 320, v230
    v_and_b32 v231, 15, v255
    v_lshl_add_u32 v252, v231, 4, v230
    s_lshl_b32 s58, s57, 2
    s_add_u32 s58, s58, s49
    s_lshl_b32 s64, s58, 4
    s_add_u32 s64, s64, s56
    s_mul_i32 s59, s64, 3072
    s_add_u32 s59, s59, 1572864
    s_mul_i32 s64, s56, 24
    v_and_b32 v230, 31, v255
    v_add_u32 v230, s64, v230
    v_lshrrev_b32 v231, 5, v255
    v_mul_u32_u24 v231, 24576, v231
    v_lshl_add_u32 v226, v230, 3, v231
    v_lshrrev_b32 v227, 1, v230
    v_mul_u32_u24 v231, 3277, v227
    v_lshrrev_b32 v231, 16, v231
    v_mul_u32_u24 v232, 20, v231
    v_sub_u32 v227, v227, v232
    v_lshrrev_b32 v232, 2, v227
    v_mul_u32_u24 v232, 76, v232
    v_add_u32 v227, v227, v232
    v_lshlrev_b32 v227, 4, v227
    v_and_b32 v232, 1, v230
    v_lshl_add_u32 v227, v232, 2, v227
    v_and_b32 v232, 1, v231
    v_lshl_add_u32 v227, v232, 3, v227
    v_lshrrev_b32 v231, 1, v231
    v_lshl_add_u32 v227, v231, 8, v227
    s_lshl_b32 s64, s52, 3
    s_add_u32 s64, s64, s53
    s_lshl_b32 s65, s64, 3
    s_add_u32 s65, s65, s48
    s_mul_i32 s0, s65, 36864
    s_add_u32 s0, s0, 14680064
    s_lshl_b32 s1, s65, 9
    s_add_u32 s1, s1, 249856
    s_lshl_b32 s64, s52, 2
    s_add_u32 s64, s64, s54
    s_lshl_b32 s64, s64, 3
    s_add_u32 s64, s64, s48
    s_mul_i32 s63, s64, 73728
    s_lshl_b32 s65, s53, 10
    s_add_u32 s63, s63, s65
    s_add_u32 s63, s63, 33554432
    s_lshl_b32 s65, s53, 3
    s_add_u32 s65, s65, s53
    s_bfe_u32 s65, s65, 0x30001
    s_cmp_eq_u32 s48, s65
    s_cselect_b32 s63, 0x40000000, s63
    s_lshl_b32 s20, s54, 13
    s_add_u32 s20, s20, s0
    s_add_u32 s21, s20, 4096
    s_lshl_b32 s22, s54, 10
    s_add_u32 s22, s22, s0
    s_add_u32 s22, s22, 32768
    s_mul_i32 s23, s49, 2560
    s_lshl_b32 s24, s49, 11
    s_mul_i32 s8, s54, 147456
    s_add_u32 s9, s8, 73728
    s_and_b32 s64, s52, 3
    s_lshl_b32 s64, s64, 1
    s_lshr_b32 s64, 0xe79, s64
    s_add_u32 s65, s64, s54
    s_and_b32 s65, s65, 3
    s_mul_i32 s10, s65, 147456
    s_add_u32 s13, s10, 73728
    s_lshl_b32 s65, s65, 13
    s_add_u32 s25, s65, s0
    s_lshr_b32 s64, s64, 2
    s_add_u32 s65, s64, s54
    s_and_b32 s65, s65, 3
    s_mul_i32 s11, s65, 147456
    s_add_u32 s14, s11, 73728
    s_lshl_b32 s65, s65, 13
    s_add_u32 s26, s65, s0
    s_lshr_b32 s64, s64, 2
    s_add_u32 s65, s64, s54
    s_and_b32 s65, s65, 3
    s_mul_i32 s12, s65, 147456
    s_add_u32 s15, s12, 73728
    s_lshl_b32 s65, s65, 13
    s_add_u32 s27, s65, s0
    s_lshl_b32 s64, s52, 3
    s_add_u32 s64, s64, s48
    s_lshl_b32 s61, s64, 10
    s_add_u32 s61, s61, 151552
    s_mul_i32 s60, s64, 36864
    s_add_u32 s60, s60, 6553600
    s_add_u32 s64, s3, 0
    s_and_b32 s64, s64, 7
    s_lshl_b32 s64, s64, 11
    s_add_u32 s92, s64, s60
    s_add_u32 s64, s3, 1
    s_and_b32 s64, s64, 7
    s_lshl_b32 s64, s64, 11
    s_add_u32 s93, s64, s60
    s_add_u32 s64, s3, 2
    s_and_b32 s64, s64, 7
    s_lshl_b32 s64, s64, 11
    s_add_u32 s94, s64, s60
    s_add_u32 s64, s3, 3
    s_and_b32 s64, s64, 7
    s_lshl_b32 s64, s64, 11
    s_add_u32 s95, s64, s60
    s_add_u32 s64, s3, 4
    s_and_b32 s64, s64, 7
    s_lshl_b32 s64, s64, 11
    s_add_u32 s96, s64, s60
    s_add_u32 s64, s3, 5
    s_and_b32 s64, s64, 7
    s_lshl_b32 s64, s64, 11
    s_add_u32 s97, s64, s60
    s_add_u32 s64, s3, 6
    s_and_b32 s64, s64, 7
    s_lshl_b32 s64, s64, 11
    s_add_u32 s98, s64, s60
    s_add_u32 s64, s3, 7
    s_and_b32 s64, s64, 7
    s_lshl_b32 s64, s64, 11
    s_add_u32 s99, s64, s60
    s_add_u32 s60, s60, 16384
    s_lshl_b32 s64, s52, 2
    s_lshr_b32 s65, s48, 1
    s_add_u32 s64, s64, s65
    s_lshl_b32 s64, s64, 3
    s_add_u32 s64, s64, s53
    s_lshl_b32 s64, s64, 2
    s_add_u32 s64, s64, s54
    s_lshl_b32 s64, s64, 7
    s_add_u32 s100, s64, 20480
    v_mov_b32 v230, v246
    v_mov_b32 v231, v247
    v_lshrrev_b32 v246, 2, v255
    v_mul_u32_u24 v246, 9216, v246
    v_lshrrev_b32 v247, 3, v255
    v_and_b32 v247, 2, v247
    v_xor_b32 v247, v247, v255
    v_and_b32 v247, 3, v247
    v_lshl_add_u32 v241, v247, 4, v246
    v_bfe_u32 v246, v255, 1, 4
    v_mul_u32_u24 v246, 9216, v246
    v_and_b32 v247, 1, v255
    v_lshl_add_u32 v236, v247, 4, v246
    s_mul_i32 s64, s49, 147456
    s_mul_i32 s65, s53, 1152
    s_add_u32 s64, s64, s65
    s_lshl_b32 s65, s54, 8
    s_add_u32 s65, s65, s64
    v_add_u32 v241, s65, v241
    s_lshl_b32 s65, s54, 5
    s_add_u32 s65, s65, s64
    s_add_u32 s65, s65, 1024
    v_add_u32 v236, s65, v236
    s_mul_i32 s101, s49, 2560
    s_lshl_b32 s67, s49, 10
    v_mov_b32 v246, v230
    v_mov_b32 v247, v231
    s_waitcnt lgkmcnt(0)
    s_barrier
    ds_read_b128 v[0:3], v229 offset:53248
    ds_read_b128 v[4:7], v229 offset:54272
    ds_read_b64_tr_b16 v[8:9], v228 offset:34816
    ds_read_b64_tr_b16 v[10:11], v228 offset:37120
    ds_read_b64_tr_b16 v[12:13], v228 offset:34824
    ds_read_b64_tr_b16 v[14:15], v228 offset:37128
    ds_read_b64_tr_b16 v[16:17], v228 offset:34832
    ds_read_b64_tr_b16 v[18:19], v228 offset:37136
    ds_read_b64_tr_b16 v[20:21], v228 offset:34840
    ds_read_b64_tr_b16 v[22:23], v228 offset:37144
    ds_read_b64_tr_b16 v[24:25], v228 offset:34848
    ds_read_b64_tr_b16 v[26:27], v228 offset:37152
    ds_read_b64_tr_b16 v[28:29], v228 offset:44032
    ds_read_b64_tr_b16 v[30:31], v228 offset:46336
    ds_read_b64_tr_b16 v[32:33], v228 offset:44040
    ds_read_b64_tr_b16 v[34:35], v228 offset:46344
    ds_read_b64_tr_b16 v[36:37], v228 offset:44048
    ds_read_b64_tr_b16 v[38:39], v228 offset:46352
    ds_read_b64_tr_b16 v[40:41], v228 offset:44056
    ds_read_b64_tr_b16 v[42:43], v228 offset:46360
    ds_read_b64_tr_b16 v[44:45], v228 offset:44064
    ds_read_b64_tr_b16 v[46:47], v228 offset:46368
    s_waitcnt lgkmcnt(15)
    v_mfma_f32_16x16x32_bf16 v[96:99], v[8:11], v[0:3], 0
    ds_read_b128 v[48:51], v229 offset:61440
    v_mfma_f32_16x16x32_bf16 v[116:119], v[8:11], v[4:7], 0
    ds_read_b128 v[52:55], v229 offset:62464
    v_mfma_f32_16x16x32_bf16 v[100:103], v[12:15], v[0:3], 0
    ds_read_b64_tr_b16 v[56:57], v228 offset:39424
    v_mfma_f32_16x16x32_bf16 v[120:123], v[12:15], v[4:7], 0
    ds_read_b64_tr_b16 v[58:59], v228 offset:41728
    s_waitcnt lgkmcnt(15)
    v_mfma_f32_16x16x32_bf16 v[104:107], v[16:19], v[0:3], 0
    ds_read_b64_tr_b16 v[60:61], v228 offset:39432
    v_mfma_f32_16x16x32_bf16 v[124:127], v[16:19], v[4:7], 0
    ds_read_b64_tr_b16 v[62:63], v228 offset:41736
    v_mfma_f32_16x16x32_bf16 v[108:111], v[20:23], v[0:3], 0
    ds_read_b64_tr_b16 v[64:65], v228 offset:39440
    v_mfma_f32_16x16x32_bf16 v[128:131], v[20:23], v[4:7], 0
    ds_read_b64_tr_b16 v[66:67], v228 offset:41744
    s_waitcnt lgkmcnt(15)
    v_mfma_f32_16x16x32_bf16 v[112:115], v[24:27], v[0:3], 0
    ds_read_b64_tr_b16 v[68:69], v228 offset:39448
    v_mfma_f32_16x16x32_bf16 v[132:135], v[24:27], v[4:7], 0
    ds_read_b64_tr_b16 v[70:71], v228 offset:41752
    v_mfma_f32_16x16x32_bf16 v[136:139], v[28:31], v[0:3], 0
    ds_read_b64_tr_b16 v[72:73], v228 offset:39456
    v_mfma_f32_16x16x32_bf16 v[156:159], v[28:31], v[4:7], 0
    ds_read_b64_tr_b16 v[74:75], v228 offset:41760
    s_waitcnt lgkmcnt(15)
    v_mfma_f32_16x16x32_bf16 v[140:143], v[32:35], v[0:3], 0
    ds_read_b64_tr_b16 v[76:77], v228 offset:48640
    v_mfma_f32_16x16x32_bf16 v[160:163], v[32:35], v[4:7], 0
    ds_read_b64_tr_b16 v[78:79], v228 offset:50944
    v_mfma_f32_16x16x32_bf16 v[144:147], v[36:39], v[0:3], 0
    ds_read_b64_tr_b16 v[80:81], v228 offset:48648
    v_mfma_f32_16x16x32_bf16 v[164:167], v[36:39], v[4:7], 0
    ds_read_b64_tr_b16 v[82:83], v228 offset:50952
    s_waitcnt lgkmcnt(15)
    v_mfma_f32_16x16x32_bf16 v[148:151], v[40:43], v[0:3], 0
    ds_read_b64_tr_b16 v[84:85], v228 offset:48656
    v_mfma_f32_16x16x32_bf16 v[168:171], v[40:43], v[4:7], 0
    ds_read_b64_tr_b16 v[86:87], v228 offset:50960
    v_mfma_f32_16x16x32_bf16 v[152:155], v[44:47], v[0:3], 0
    ds_read_b64_tr_b16 v[88:89], v228 offset:48664
    v_mfma_f32_16x16x32_bf16 v[172:175], v[44:47], v[4:7], 0
    ds_read_b64_tr_b16 v[90:91], v228 offset:50968
    ds_read_b64_tr_b16 v[92:93], v228 offset:48672
    ds_read_b64_tr_b16 v[94:95], v228 offset:50976
    s_barrier
    s_waitcnt lgkmcnt(15)
    v_mfma_f32_16x16x32_bf16 v[96:99], v[56:59], v[48:51], v[96:99]
    v_add_u32 v229, 0x00019400, v229
    ds_read_b128 v[0:3], v229 offset:8192
    v_mfma_f32_16x16x32_bf16 v[116:119], v[56:59], v[52:55], v[116:119]
    ds_read_b128 v[4:7], v229 offset:9216
    v_mfma_f32_16x16x32_bf16 v[100:103], v[60:63], v[48:51], v[100:103]
    v_add_u32 v228, 0x00014c00, v228
    ds_read_b64_tr_b16 v[8:9], v228 offset:8192
    v_mfma_f32_16x16x32_bf16 v[120:123], v[60:63], v[52:55], v[120:123]
    ds_read_b64_tr_b16 v[10:11], v228 offset:10496
    s_waitcnt lgkmcnt(15)
    v_mfma_f32_16x16x32_bf16 v[104:107], v[64:67], v[48:51], v[104:107]
    ds_read_b64_tr_b16 v[12:13], v228 offset:8200
    v_mfma_f32_16x16x32_bf16 v[124:127], v[64:67], v[52:55], v[124:127]
    ds_read_b64_tr_b16 v[14:15], v228 offset:10504
    v_mfma_f32_16x16x32_bf16 v[108:111], v[68:71], v[48:51], v[108:111]
    ds_read_b64_tr_b16 v[16:17], v228 offset:8208
    v_mfma_f32_16x16x32_bf16 v[128:131], v[68:71], v[52:55], v[128:131]
    ds_read_b64_tr_b16 v[18:19], v228 offset:10512
    s_waitcnt lgkmcnt(15)
    v_mfma_f32_16x16x32_bf16 v[112:115], v[72:75], v[48:51], v[112:115]
    ds_read_b64_tr_b16 v[20:21], v228 offset:8216
    v_mfma_f32_16x16x32_bf16 v[132:135], v[72:75], v[52:55], v[132:135]
    ds_read_b64_tr_b16 v[22:23], v228 offset:10520
    v_mfma_f32_16x16x32_bf16 v[136:139], v[76:79], v[48:51], v[136:139]
    ds_read_b64_tr_b16 v[24:25], v228 offset:8224
    v_mfma_f32_16x16x32_bf16 v[156:159], v[76:79], v[52:55], v[156:159]
    ds_read_b64_tr_b16 v[26:27], v228 offset:10528
    s_waitcnt lgkmcnt(15)
    v_mfma_f32_16x16x32_bf16 v[140:143], v[80:83], v[48:51], v[140:143]
    ds_read_b64_tr_b16 v[28:29], v228 offset:17408
    v_mfma_f32_16x16x32_bf16 v[160:163], v[80:83], v[52:55], v[160:163]
    ds_read_b64_tr_b16 v[30:31], v228 offset:19712
    v_mfma_f32_16x16x32_bf16 v[144:147], v[84:87], v[48:51], v[144:147]
    ds_read_b64_tr_b16 v[32:33], v228 offset:17416
    v_mfma_f32_16x16x32_bf16 v[164:167], v[84:87], v[52:55], v[164:167]
    ds_read_b64_tr_b16 v[34:35], v228 offset:19720
    s_waitcnt lgkmcnt(15)
    v_mfma_f32_16x16x32_bf16 v[148:151], v[88:91], v[48:51], v[148:151]
    ds_read_b64_tr_b16 v[36:37], v228 offset:17424
    v_mfma_f32_16x16x32_bf16 v[168:171], v[88:91], v[52:55], v[168:171]
    ds_read_b64_tr_b16 v[38:39], v228 offset:19728
    v_mfma_f32_16x16x32_bf16 v[152:155], v[92:95], v[48:51], v[152:155]
    ds_read_b64_tr_b16 v[40:41], v228 offset:17432
    v_mfma_f32_16x16x32_bf16 v[172:175], v[92:95], v[52:55], v[172:175]
    ds_read_b64_tr_b16 v[42:43], v228 offset:19736
    ds_read_b64_tr_b16 v[44:45], v228 offset:17440
    ds_read_b64_tr_b16 v[46:47], v228 offset:19744
    s_waitcnt lgkmcnt(15)
    v_mfma_f32_16x16x32_bf16 v[96:99], v[8:11], v[0:3], v[96:99]
    ds_read_b128 v[48:51], v229 offset:16384
    v_mfma_f32_16x16x32_bf16 v[116:119], v[8:11], v[4:7], v[116:119]
    ds_read_b128 v[52:55], v229 offset:17408
    v_mfma_f32_16x16x32_bf16 v[100:103], v[12:15], v[0:3], v[100:103]
    ds_read_b64_tr_b16 v[56:57], v228 offset:12800
    v_mfma_f32_16x16x32_bf16 v[120:123], v[12:15], v[4:7], v[120:123]
    ds_read_b64_tr_b16 v[58:59], v228 offset:15104
    s_waitcnt lgkmcnt(15)
    v_mfma_f32_16x16x32_bf16 v[104:107], v[16:19], v[0:3], v[104:107]
    ds_read_b64_tr_b16 v[60:61], v228 offset:12808
    v_mfma_f32_16x16x32_bf16 v[124:127], v[16:19], v[4:7], v[124:127]
    ds_read_b64_tr_b16 v[62:63], v228 offset:15112
    v_mfma_f32_16x16x32_bf16 v[108:111], v[20:23], v[0:3], v[108:111]
    ds_read_b64_tr_b16 v[64:65], v228 offset:12816
    v_mfma_f32_16x16x32_bf16 v[128:131], v[20:23], v[4:7], v[128:131]
    ds_read_b64_tr_b16 v[66:67], v228 offset:15120
    s_waitcnt lgkmcnt(15)
    v_mfma_f32_16x16x32_bf16 v[112:115], v[24:27], v[0:3], v[112:115]
    ds_read_b64_tr_b16 v[68:69], v228 offset:12824
    v_mfma_f32_16x16x32_bf16 v[132:135], v[24:27], v[4:7], v[132:135]
    ds_read_b64_tr_b16 v[70:71], v228 offset:15128
    v_mfma_f32_16x16x32_bf16 v[136:139], v[28:31], v[0:3], v[136:139]
    ds_read_b64_tr_b16 v[72:73], v228 offset:12832
    v_mfma_f32_16x16x32_bf16 v[156:159], v[28:31], v[4:7], v[156:159]
    ds_read_b64_tr_b16 v[74:75], v228 offset:15136
    s_waitcnt lgkmcnt(15)
    v_mfma_f32_16x16x32_bf16 v[140:143], v[32:35], v[0:3], v[140:143]
    ds_read_b64_tr_b16 v[76:77], v228 offset:22016
    v_mfma_f32_16x16x32_bf16 v[160:163], v[32:35], v[4:7], v[160:163]
    ds_read_b64_tr_b16 v[78:79], v228 offset:24320
    v_mfma_f32_16x16x32_bf16 v[144:147], v[36:39], v[0:3], v[144:147]
    ds_read_b64_tr_b16 v[80:81], v228 offset:22024
    v_mfma_f32_16x16x32_bf16 v[164:167], v[36:39], v[4:7], v[164:167]
    ds_read_b64_tr_b16 v[82:83], v228 offset:24328
    s_waitcnt lgkmcnt(15)
    v_mfma_f32_16x16x32_bf16 v[148:151], v[40:43], v[0:3], v[148:151]
    ds_read_b64_tr_b16 v[84:85], v228 offset:22032
    v_mfma_f32_16x16x32_bf16 v[168:171], v[40:43], v[4:7], v[168:171]
    ds_read_b64_tr_b16 v[86:87], v228 offset:24336
    v_mfma_f32_16x16x32_bf16 v[152:155], v[44:47], v[0:3], v[152:155]
    ds_read_b64_tr_b16 v[88:89], v228 offset:22040
    v_mfma_f32_16x16x32_bf16 v[172:175], v[44:47], v[4:7], v[172:175]
    ds_read_b64_tr_b16 v[90:91], v228 offset:24344
    ds_read_b64_tr_b16 v[92:93], v228 offset:22048
    ds_read_b64_tr_b16 v[94:95], v228 offset:24352
    s_barrier
    s_waitcnt vmcnt(2)
    ds_write_b32 v179, v176
    s_waitcnt vmcnt(1)
    ds_write_b32 v180, v177
    s_lshl_b32 s64, s49, 6
    v_add_u32 v230, s64, v255
    v_cmp_gt_u32 vcc, 136, v230
    s_nop 1
    v_cndmask_b32 v181, v180, v181, vcc
    s_waitcnt vmcnt(0)
    v_cndmask_b32 v178, v177, v178, vcc
    ds_write_b32 v181, v178
    s_waitcnt lgkmcnt(15)
    v_mfma_f32_16x16x32_bf16 v[96:99], v[56:59], v[48:51], v[96:99]
    ds_read_b128 v[0:3], v229 offset:43008
    v_mfma_f32_16x16x32_bf16 v[116:119], v[56:59], v[52:55], v[116:119]
    ds_read_b128 v[4:7], v229 offset:44032
    v_mfma_f32_16x16x32_bf16 v[100:103], v[60:63], v[48:51], v[100:103]
    ds_read_b64_tr_b16 v[8:9], v228 offset:43008
    v_mfma_f32_16x16x32_bf16 v[120:123], v[60:63], v[52:55], v[120:123]
    ds_read_b64_tr_b16 v[10:11], v228 offset:45312
    v_mfma_f32_16x16x32_bf16 v[104:107], v[64:67], v[48:51], v[104:107]
    ds_read_b64_tr_b16 v[12:13], v228 offset:43016
    v_mfma_f32_16x16x32_bf16 v[124:127], v[64:67], v[52:55], v[124:127]
    ds_read_b64_tr_b16 v[14:15], v228 offset:45320
    v_mfma_f32_16x16x32_bf16 v[108:111], v[68:71], v[48:51], v[108:111]
    ds_read_b64_tr_b16 v[16:17], v228 offset:43024
    v_mfma_f32_16x16x32_bf16 v[128:131], v[68:71], v[52:55], v[128:131]
    ds_read_b64_tr_b16 v[18:19], v228 offset:45328
    s_waitcnt lgkmcnt(15)
    v_mfma_f32_16x16x32_bf16 v[112:115], v[72:75], v[48:51], v[112:115]
    ds_read_b64_tr_b16 v[20:21], v228 offset:43032
    v_mfma_f32_16x16x32_bf16 v[132:135], v[72:75], v[52:55], v[132:135]
    ds_read_b64_tr_b16 v[22:23], v228 offset:45336
    v_mfma_f32_16x16x32_bf16 v[136:139], v[76:79], v[48:51], v[136:139]
    ds_read_b64_tr_b16 v[24:25], v228 offset:43040
    v_mfma_f32_16x16x32_bf16 v[156:159], v[76:79], v[52:55], v[156:159]
    ds_read_b64_tr_b16 v[26:27], v228 offset:45344
    v_mfma_f32_16x16x32_bf16 v[140:143], v[80:83], v[48:51], v[140:143]
    ds_read_b64_tr_b16 v[28:29], v228 offset:52224
    v_mfma_f32_16x16x32_bf16 v[160:163], v[80:83], v[52:55], v[160:163]
    ds_read_b64_tr_b16 v[30:31], v228 offset:54528
    v_mfma_f32_16x16x32_bf16 v[144:147], v[84:87], v[48:51], v[144:147]
    ds_read_b64_tr_b16 v[32:33], v228 offset:52232
    v_mfma_f32_16x16x32_bf16 v[164:167], v[84:87], v[52:55], v[164:167]
    ds_read_b64_tr_b16 v[34:35], v228 offset:54536
    s_waitcnt lgkmcnt(15)
    v_mfma_f32_16x16x32_bf16 v[148:151], v[88:91], v[48:51], v[148:151]
    ds_read_b64_tr_b16 v[36:37], v228 offset:52240
    v_mfma_f32_16x16x32_bf16 v[168:171], v[88:91], v[52:55], v[168:171]
    ds_read_b64_tr_b16 v[38:39], v228 offset:54544
    v_mfma_f32_16x16x32_bf16 v[152:155], v[92:95], v[48:51], v[152:155]
    ds_read_b64_tr_b16 v[40:41], v228 offset:52248
    v_mfma_f32_16x16x32_bf16 v[172:175], v[92:95], v[52:55], v[172:175]
    ds_read_b64_tr_b16 v[42:43], v228 offset:54552
    ds_read_b64_tr_b16 v[44:45], v228 offset:52256
    ds_read_b64_tr_b16 v[46:47], v228 offset:54560
    s_waitcnt lgkmcnt(15)
    v_mfma_f32_16x16x32_bf16 v[96:99], v[8:11], v[0:3], v[96:99]
    ds_read_b128 v[48:51], v229 offset:51200
    v_mfma_f32_16x16x32_bf16 v[116:119], v[8:11], v[4:7], v[116:119]
    ds_read_b128 v[52:55], v229 offset:52224
    v_mfma_f32_16x16x32_bf16 v[100:103], v[12:15], v[0:3], v[100:103]
    ds_read_b64_tr_b16 v[56:57], v228 offset:47616
    v_mfma_f32_16x16x32_bf16 v[120:123], v[12:15], v[4:7], v[120:123]
    ds_read_b64_tr_b16 v[58:59], v228 offset:49920
    s_waitcnt lgkmcnt(15)
    v_mfma_f32_16x16x32_bf16 v[104:107], v[16:19], v[0:3], v[104:107]
    ds_read_b64_tr_b16 v[60:61], v228 offset:47624
    v_mfma_f32_16x16x32_bf16 v[124:127], v[16:19], v[4:7], v[124:127]
    ds_read_b64_tr_b16 v[62:63], v228 offset:49928
    v_mfma_f32_16x16x32_bf16 v[108:111], v[20:23], v[0:3], v[108:111]
    ds_read_b64_tr_b16 v[64:65], v228 offset:47632
    v_mfma_f32_16x16x32_bf16 v[128:131], v[20:23], v[4:7], v[128:131]
    ds_read_b64_tr_b16 v[66:67], v228 offset:49936
    s_waitcnt lgkmcnt(15)
    v_mfma_f32_16x16x32_bf16 v[112:115], v[24:27], v[0:3], v[112:115]
    ds_read_b64_tr_b16 v[68:69], v228 offset:47640
    v_mfma_f32_16x16x32_bf16 v[132:135], v[24:27], v[4:7], v[132:135]
    ds_read_b64_tr_b16 v[70:71], v228 offset:49944
    v_mfma_f32_16x16x32_bf16 v[136:139], v[28:31], v[0:3], v[136:139]
    ds_read_b64_tr_b16 v[72:73], v228 offset:47648
    v_mfma_f32_16x16x32_bf16 v[156:159], v[28:31], v[4:7], v[156:159]
    ds_read_b64_tr_b16 v[74:75], v228 offset:49952
    s_waitcnt lgkmcnt(15)
    v_mfma_f32_16x16x32_bf16 v[140:143], v[32:35], v[0:3], v[140:143]
    ds_read_b64_tr_b16 v[76:77], v228 offset:56832
    v_mfma_f32_16x16x32_bf16 v[160:163], v[32:35], v[4:7], v[160:163]
    ds_read_b64_tr_b16 v[78:79], v228 offset:59136
    v_mfma_f32_16x16x32_bf16 v[144:147], v[36:39], v[0:3], v[144:147]
    ds_read_b64_tr_b16 v[80:81], v228 offset:56840
    v_mfma_f32_16x16x32_bf16 v[164:167], v[36:39], v[4:7], v[164:167]
    ds_read_b64_tr_b16 v[82:83], v228 offset:59144
    s_waitcnt lgkmcnt(15)
    v_mfma_f32_16x16x32_bf16 v[148:151], v[40:43], v[0:3], v[148:151]
    ds_read_b64_tr_b16 v[84:85], v228 offset:56848
    v_mfma_f32_16x16x32_bf16 v[168:171], v[40:43], v[4:7], v[168:171]
    ds_read_b64_tr_b16 v[86:87], v228 offset:59152
    v_mfma_f32_16x16x32_bf16 v[152:155], v[44:47], v[0:3], v[152:155]
    ds_read_b64_tr_b16 v[88:89], v228 offset:56856
    v_mfma_f32_16x16x32_bf16 v[172:175], v[44:47], v[4:7], v[172:175]
    ds_read_b64_tr_b16 v[90:91], v228 offset:59160
    ds_read_b64_tr_b16 v[92:93], v228 offset:56864
    ds_read_b64_tr_b16 v[94:95], v228 offset:59168
    s_barrier
    s_waitcnt lgkmcnt(15)
    v_mfma_f32_16x16x32_bf16 v[96:99], v[56:59], v[48:51], v[96:99]
    v_add_u32 v229, 0xfffe9400, v229
    ds_read_b128 v[0:3], v229 offset:8192
    v_mfma_f32_16x16x32_bf16 v[116:119], v[56:59], v[52:55], v[116:119]
    ds_read_b128 v[4:7], v229 offset:9216
    v_mfma_f32_16x16x32_bf16 v[100:103], v[60:63], v[48:51], v[100:103]
    v_add_u32 v228, 0xfffeb400, v228
    ds_read_b64_tr_b16 v[8:9], v228 offset:0
    v_mfma_f32_16x16x32_bf16 v[120:123], v[60:63], v[52:55], v[120:123]
    ds_read_b64_tr_b16 v[10:11], v228 offset:2304
    s_waitcnt lgkmcnt(15)
    v_mfma_f32_16x16x32_bf16 v[104:107], v[64:67], v[48:51], v[104:107]
    ds_read_b64_tr_b16 v[12:13], v228 offset:8
    v_mfma_f32_16x16x32_bf16 v[124:127], v[64:67], v[52:55], v[124:127]
    ds_read_b64_tr_b16 v[14:15], v228 offset:2312
    v_mfma_f32_16x16x32_bf16 v[108:111], v[68:71], v[48:51], v[108:111]
    ds_read_b64_tr_b16 v[16:17], v228 offset:16
    v_mfma_f32_16x16x32_bf16 v[128:131], v[68:71], v[52:55], v[128:131]
    ds_read_b64_tr_b16 v[18:19], v228 offset:2320
    s_waitcnt lgkmcnt(15)
    v_mfma_f32_16x16x32_bf16 v[112:115], v[72:75], v[48:51], v[112:115]
    ds_read_b64_tr_b16 v[20:21], v228 offset:24
    v_mfma_f32_16x16x32_bf16 v[132:135], v[72:75], v[52:55], v[132:135]
    ds_read_b64_tr_b16 v[22:23], v228 offset:2328
    v_mfma_f32_16x16x32_bf16 v[136:139], v[76:79], v[48:51], v[136:139]
    ds_read_b64_tr_b16 v[24:25], v228 offset:32
    v_mfma_f32_16x16x32_bf16 v[156:159], v[76:79], v[52:55], v[156:159]
    ds_read_b64_tr_b16 v[26:27], v228 offset:2336
    s_waitcnt lgkmcnt(15)
    v_mfma_f32_16x16x32_bf16 v[140:143], v[80:83], v[48:51], v[140:143]
    ds_read_b64_tr_b16 v[28:29], v228 offset:9216
    v_mfma_f32_16x16x32_bf16 v[160:163], v[80:83], v[52:55], v[160:163]
    ds_read_b64_tr_b16 v[30:31], v228 offset:11520
    v_mfma_f32_16x16x32_bf16 v[144:147], v[84:87], v[48:51], v[144:147]
    ds_read_b64_tr_b16 v[32:33], v228 offset:9224
    v_mfma_f32_16x16x32_bf16 v[164:167], v[84:87], v[52:55], v[164:167]
    ds_read_b64_tr_b16 v[34:35], v228 offset:11528
    s_waitcnt lgkmcnt(15)
    v_mfma_f32_16x16x32_bf16 v[148:151], v[88:91], v[48:51], v[148:151]
    ds_read_b64_tr_b16 v[36:37], v228 offset:9232
    v_mfma_f32_16x16x32_bf16 v[168:171], v[88:91], v[52:55], v[168:171]
    ds_read_b64_tr_b16 v[38:39], v228 offset:11536
    v_mfma_f32_16x16x32_bf16 v[152:155], v[92:95], v[48:51], v[152:155]
    ds_read_b64_tr_b16 v[40:41], v228 offset:9240
    v_mfma_f32_16x16x32_bf16 v[172:175], v[92:95], v[52:55], v[172:175]
    ds_read_b64_tr_b16 v[42:43], v228 offset:11544
    ds_read_b64_tr_b16 v[44:45], v228 offset:9248
    ds_read_b64_tr_b16 v[46:47], v228 offset:11552
    s_waitcnt lgkmcnt(15)
    v_mfma_f32_16x16x32_bf16 v[96:99], v[8:11], v[0:3], v[96:99]
    ds_read_b128 v[48:51], v229 offset:16384
    v_mfma_f32_16x16x32_bf16 v[116:119], v[8:11], v[4:7], v[116:119]
    ds_read_b128 v[52:55], v229 offset:17408
    v_mfma_f32_16x16x32_bf16 v[100:103], v[12:15], v[0:3], v[100:103]
    ds_read_b64_tr_b16 v[56:57], v228 offset:4608
    v_mfma_f32_16x16x32_bf16 v[120:123], v[12:15], v[4:7], v[120:123]
    ds_read_b64_tr_b16 v[58:59], v228 offset:6912
    s_waitcnt lgkmcnt(15)
    v_mfma_f32_16x16x32_bf16 v[104:107], v[16:19], v[0:3], v[104:107]
    ds_read_b64_tr_b16 v[60:61], v228 offset:4616
    v_mfma_f32_16x16x32_bf16 v[124:127], v[16:19], v[4:7], v[124:127]
    ds_read_b64_tr_b16 v[62:63], v228 offset:6920
    v_mfma_f32_16x16x32_bf16 v[108:111], v[20:23], v[0:3], v[108:111]
    ds_read_b64_tr_b16 v[64:65], v228 offset:4624
    v_mfma_f32_16x16x32_bf16 v[128:131], v[20:23], v[4:7], v[128:131]
    ds_read_b64_tr_b16 v[66:67], v228 offset:6928
    s_waitcnt lgkmcnt(15)
    v_mfma_f32_16x16x32_bf16 v[112:115], v[24:27], v[0:3], v[112:115]
    ds_read_b64_tr_b16 v[68:69], v228 offset:4632
    v_mfma_f32_16x16x32_bf16 v[132:135], v[24:27], v[4:7], v[132:135]
    ds_read_b64_tr_b16 v[70:71], v228 offset:6936
    v_mfma_f32_16x16x32_bf16 v[136:139], v[28:31], v[0:3], v[136:139]
    ds_read_b64_tr_b16 v[72:73], v228 offset:4640
    v_mfma_f32_16x16x32_bf16 v[156:159], v[28:31], v[4:7], v[156:159]
    ds_read_b64_tr_b16 v[74:75], v228 offset:6944
    s_waitcnt lgkmcnt(15)
    v_mfma_f32_16x16x32_bf16 v[140:143], v[32:35], v[0:3], v[140:143]
    ds_read_b64_tr_b16 v[76:77], v228 offset:13824
    v_mfma_f32_16x16x32_bf16 v[160:163], v[32:35], v[4:7], v[160:163]
    ds_read_b64_tr_b16 v[78:79], v228 offset:16128
    v_mfma_f32_16x16x32_bf16 v[144:147], v[36:39], v[0:3], v[144:147]
    ds_read_b64_tr_b16 v[80:81], v228 offset:13832
    v_mfma_f32_16x16x32_bf16 v[164:167], v[36:39], v[4:7], v[164:167]
    ds_read_b64_tr_b16 v[82:83], v228 offset:16136
    s_waitcnt lgkmcnt(15)
    v_mfma_f32_16x16x32_bf16 v[148:151], v[40:43], v[0:3], v[148:151]
    ds_read_b64_tr_b16 v[84:85], v228 offset:13840
    v_mfma_f32_16x16x32_bf16 v[168:171], v[40:43], v[4:7], v[168:171]
    ds_read_b64_tr_b16 v[86:87], v228 offset:16144
    v_mfma_f32_16x16x32_bf16 v[152:155], v[44:47], v[0:3], v[152:155]
    ds_read_b64_tr_b16 v[88:89], v228 offset:13848
    v_mfma_f32_16x16x32_bf16 v[172:175], v[44:47], v[4:7], v[172:175]
    ds_read_b64_tr_b16 v[90:91], v228 offset:16152
    ds_read_b64_tr_b16 v[92:93], v228 offset:13856
    ds_read_b64_tr_b16 v[94:95], v228 offset:16160
    s_barrier
    s_waitcnt lgkmcnt(15)
    v_mfma_f32_16x16x32_bf16 v[96:99], v[56:59], v[48:51], v[96:99]
    ds_read_b128 v[0:3], v229 offset:43008
    v_mfma_f32_16x16x32_bf16 v[116:119], v[56:59], v[52:55], v[116:119]
    ds_read_b128 v[4:7], v229 offset:44032
    v_mfma_f32_16x16x32_bf16 v[100:103], v[60:63], v[48:51], v[100:103]
    ds_read_b64_tr_b16 v[8:9], v228 offset:34816
    v_mfma_f32_16x16x32_bf16 v[120:123], v[60:63], v[52:55], v[120:123]
    ds_read_b64_tr_b16 v[10:11], v228 offset:37120
    s_waitcnt lgkmcnt(15)
    v_mfma_f32_16x16x32_bf16 v[104:107], v[64:67], v[48:51], v[104:107]
    ds_read_b64_tr_b16 v[12:13], v228 offset:34824
    v_mfma_f32_16x16x32_bf16 v[124:127], v[64:67], v[52:55], v[124:127]
    ds_read_b64_tr_b16 v[14:15], v228 offset:37128
    v_mfma_f32_16x16x32_bf16 v[108:111], v[68:71], v[48:51], v[108:111]
    ds_read_b64_tr_b16 v[16:17], v228 offset:34832
    v_mfma_f32_16x16x32_bf16 v[128:131], v[68:71], v[52:55], v[128:131]
    ds_read_b64_tr_b16 v[18:19], v228 offset:37136
    s_waitcnt lgkmcnt(15)
    v_mfma_f32_16x16x32_bf16 v[112:115], v[72:75], v[48:51], v[112:115]
    ds_read_b64_tr_b16 v[20:21], v228 offset:34840
    v_mfma_f32_16x16x32_bf16 v[132:135], v[72:75], v[52:55], v[132:135]
    ds_read_b64_tr_b16 v[22:23], v228 offset:37144
    v_mfma_f32_16x16x32_bf16 v[136:139], v[76:79], v[48:51], v[136:139]
    ds_read_b64_tr_b16 v[24:25], v228 offset:34848
    v_mfma_f32_16x16x32_bf16 v[156:159], v[76:79], v[52:55], v[156:159]
    ds_read_b64_tr_b16 v[26:27], v228 offset:37152
    s_waitcnt lgkmcnt(15)
    v_mfma_f32_16x16x32_bf16 v[140:143], v[80:83], v[48:51], v[140:143]
    ds_read_b64_tr_b16 v[28:29], v228 offset:44032
    v_mfma_f32_16x16x32_bf16 v[160:163], v[80:83], v[52:55], v[160:163]
    ds_read_b64_tr_b16 v[30:31], v228 offset:46336
    v_mfma_f32_16x16x32_bf16 v[144:147], v[84:87], v[48:51], v[144:147]
    ds_read_b64_tr_b16 v[32:33], v228 offset:44040
    v_mfma_f32_16x16x32_bf16 v[164:167], v[84:87], v[52:55], v[164:167]
    ds_read_b64_tr_b16 v[34:35], v228 offset:46344
    s_waitcnt lgkmcnt(15)
    v_mfma_f32_16x16x32_bf16 v[148:151], v[88:91], v[48:51], v[148:151]
    ds_read_b64_tr_b16 v[36:37], v228 offset:44048
    v_mfma_f32_16x16x32_bf16 v[168:171], v[88:91], v[52:55], v[168:171]
    ds_read_b64_tr_b16 v[38:39], v228 offset:46352
    v_mfma_f32_16x16x32_bf16 v[152:155], v[92:95], v[48:51], v[152:155]
    ds_read_b64_tr_b16 v[40:41], v228 offset:44056
    v_mfma_f32_16x16x32_bf16 v[172:175], v[92:95], v[52:55], v[172:175]
    ds_read_b64_tr_b16 v[42:43], v228 offset:46360
    ds_read_b64_tr_b16 v[44:45], v228 offset:44064
    ds_read_b64_tr_b16 v[46:47], v228 offset:46368
    s_waitcnt lgkmcnt(15)
    v_mfma_f32_16x16x32_bf16 v[96:99], v[8:11], v[0:3], v[96:99]
    ds_read_b128 v[48:51], v229 offset:51200
    v_mfma_f32_16x16x32_bf16 v[116:119], v[8:11], v[4:7], v[116:119]
    ds_read_b128 v[52:55], v229 offset:52224
    v_mfma_f32_16x16x32_bf16 v[100:103], v[12:15], v[0:3], v[100:103]
    ds_read_b64_tr_b16 v[56:57], v228 offset:39424
    v_mfma_f32_16x16x32_bf16 v[120:123], v[12:15], v[4:7], v[120:123]
    ds_read_b64_tr_b16 v[58:59], v228 offset:41728
    s_waitcnt lgkmcnt(15)
    v_mfma_f32_16x16x32_bf16 v[104:107], v[16:19], v[0:3], v[104:107]
    ds_read_b64_tr_b16 v[60:61], v228 offset:39432
    v_mfma_f32_16x16x32_bf16 v[124:127], v[16:19], v[4:7], v[124:127]
    ds_read_b64_tr_b16 v[62:63], v228 offset:41736
    v_mfma_f32_16x16x32_bf16 v[108:111], v[20:23], v[0:3], v[108:111]
    ds_read_b64_tr_b16 v[64:65], v228 offset:39440
    v_mfma_f32_16x16x32_bf16 v[128:131], v[20:23], v[4:7], v[128:131]
    ds_read_b64_tr_b16 v[66:67], v228 offset:41744
    s_waitcnt lgkmcnt(15)
    v_mfma_f32_16x16x32_bf16 v[112:115], v[24:27], v[0:3], v[112:115]
    ds_read_b64_tr_b16 v[68:69], v228 offset:39448
    v_mfma_f32_16x16x32_bf16 v[132:135], v[24:27], v[4:7], v[132:135]
    ds_read_b64_tr_b16 v[70:71], v228 offset:41752
    v_mfma_f32_16x16x32_bf16 v[136:139], v[28:31], v[0:3], v[136:139]
    ds_read_b64_tr_b16 v[72:73], v228 offset:39456
    v_mfma_f32_16x16x32_bf16 v[156:159], v[28:31], v[4:7], v[156:159]
    ds_read_b64_tr_b16 v[74:75], v228 offset:41760
    s_waitcnt lgkmcnt(15)
    v_mfma_f32_16x16x32_bf16 v[140:143], v[32:35], v[0:3], v[140:143]
    ds_read_b64_tr_b16 v[76:77], v228 offset:48640
    v_mfma_f32_16x16x32_bf16 v[160:163], v[32:35], v[4:7], v[160:163]
    ds_read_b64_tr_b16 v[78:79], v228 offset:50944
    v_mfma_f32_16x16x32_bf16 v[144:147], v[36:39], v[0:3], v[144:147]
    ds_read_b64_tr_b16 v[80:81], v228 offset:48648
    v_mfma_f32_16x16x32_bf16 v[164:167], v[36:39], v[4:7], v[164:167]
    ds_read_b64_tr_b16 v[82:83], v228 offset:50952
    s_waitcnt lgkmcnt(15)
    v_mfma_f32_16x16x32_bf16 v[148:151], v[40:43], v[0:3], v[148:151]
    ds_read_b64_tr_b16 v[84:85], v228 offset:48656
    v_mfma_f32_16x16x32_bf16 v[168:171], v[40:43], v[4:7], v[168:171]
    ds_read_b64_tr_b16 v[86:87], v228 offset:50960
    v_mfma_f32_16x16x32_bf16 v[152:155], v[44:47], v[0:3], v[152:155]
    ds_read_b64_tr_b16 v[88:89], v228 offset:48664
    v_mfma_f32_16x16x32_bf16 v[172:175], v[44:47], v[4:7], v[172:175]
    ds_read_b64_tr_b16 v[90:91], v228 offset:50968
    ds_read_b64_tr_b16 v[92:93], v228 offset:48672
    ds_read_b64_tr_b16 v[94:95], v228 offset:50976
    s_barrier
    s_waitcnt lgkmcnt(15)
    v_mfma_f32_16x16x32_bf16 v[96:99], v[56:59], v[48:51], v[96:99]
    v_add_u32 v229, 0x00016c00, v229
    ds_read_b128 v[0:3], v229 offset:8192
    v_mfma_f32_16x16x32_bf16 v[116:119], v[56:59], v[52:55], v[116:119]
    ds_read_b128 v[4:7], v229 offset:9216
    v_mfma_f32_16x16x32_bf16 v[100:103], v[60:63], v[48:51], v[100:103]
    v_add_u32 v228, 0x00014c00, v228
    ds_read_b64_tr_b16 v[8:9], v228 offset:8192
    v_mfma_f32_16x16x32_bf16 v[120:123], v[60:63], v[52:55], v[120:123]
    ds_read_b64_tr_b16 v[10:11], v228 offset:10496
    s_waitcnt lgkmcnt(15)
    v_mfma_f32_16x16x32_bf16 v[104:107], v[64:67], v[48:51], v[104:107]
    ds_read_b64_tr_b16 v[12:13], v228 offset:8200
    v_mfma_f32_16x16x32_bf16 v[124:127], v[64:67], v[52:55], v[124:127]
    ds_read_b64_tr_b16 v[14:15], v228 offset:10504
    v_mfma_f32_16x16x32_bf16 v[108:111], v[68:71], v[48:51], v[108:111]
    ds_read_b64_tr_b16 v[16:17], v228 offset:8208
    v_mfma_f32_16x16x32_bf16 v[128:131], v[68:71], v[52:55], v[128:131]
    ds_read_b64_tr_b16 v[18:19], v228 offset:10512
    s_waitcnt lgkmcnt(15)
    v_mfma_f32_16x16x32_bf16 v[112:115], v[72:75], v[48:51], v[112:115]
    ds_read_b64_tr_b16 v[20:21], v228 offset:8216
    v_mfma_f32_16x16x32_bf16 v[132:135], v[72:75], v[52:55], v[132:135]
    ds_read_b64_tr_b16 v[22:23], v228 offset:10520
    v_mfma_f32_16x16x32_bf16 v[136:139], v[76:79], v[48:51], v[136:139]
    ds_read_b64_tr_b16 v[24:25], v228 offset:8224
    v_mfma_f32_16x16x32_bf16 v[156:159], v[76:79], v[52:55], v[156:159]
    ds_read_b64_tr_b16 v[26:27], v228 offset:10528
    s_waitcnt lgkmcnt(15)
    v_mfma_f32_16x16x32_bf16 v[140:143], v[80:83], v[48:51], v[140:143]
    ds_read_b64_tr_b16 v[28:29], v228 offset:17408
    v_mfma_f32_16x16x32_bf16 v[160:163], v[80:83], v[52:55], v[160:163]
    ds_read_b64_tr_b16 v[30:31], v228 offset:19712
    v_mfma_f32_16x16x32_bf16 v[144:147], v[84:87], v[48:51], v[144:147]
    ds_read_b64_tr_b16 v[32:33], v228 offset:17416
    v_mfma_f32_16x16x32_bf16 v[164:167], v[84:87], v[52:55], v[164:167]
    ds_read_b64_tr_b16 v[34:35], v228 offset:19720
    s_waitcnt lgkmcnt(15)
    v_mfma_f32_16x16x32_bf16 v[148:151], v[88:91], v[48:51], v[148:151]
    ds_read_b64_tr_b16 v[36:37], v228 offset:17424
    v_mfma_f32_16x16x32_bf16 v[168:171], v[88:91], v[52:55], v[168:171]
    ds_read_b64_tr_b16 v[38:39], v228 offset:19728
    v_mfma_f32_16x16x32_bf16 v[152:155], v[92:95], v[48:51], v[152:155]
    ds_read_b64_tr_b16 v[40:41], v228 offset:17432
    v_mfma_f32_16x16x32_bf16 v[172:175], v[92:95], v[52:55], v[172:175]
    ds_read_b64_tr_b16 v[42:43], v228 offset:19736
    ds_read_b64_tr_b16 v[44:45], v228 offset:17440
    ds_read_b64_tr_b16 v[46:47], v228 offset:19744
    s_waitcnt lgkmcnt(15)
    v_mfma_f32_16x16x32_bf16 v[96:99], v[8:11], v[0:3], v[96:99]
    ds_read_b128 v[48:51], v229 offset:16384
    v_mfma_f32_16x16x32_bf16 v[116:119], v[8:11], v[4:7], v[116:119]
    ds_read_b128 v[52:55], v229 offset:17408
    v_mfma_f32_16x16x32_bf16 v[100:103], v[12:15], v[0:3], v[100:103]
    ds_read_b64_tr_b16 v[56:57], v228 offset:12800
    v_mfma_f32_16x16x32_bf16 v[120:123], v[12:15], v[4:7], v[120:123]
    ds_read_b64_tr_b16 v[58:59], v228 offset:15104
    s_waitcnt lgkmcnt(15)
    v_mfma_f32_16x16x32_bf16 v[104:107], v[16:19], v[0:3], v[104:107]
    ds_read_b64_tr_b16 v[60:61], v228 offset:12808
    v_mfma_f32_16x16x32_bf16 v[124:127], v[16:19], v[4:7], v[124:127]
    ds_read_b64_tr_b16 v[62:63], v228 offset:15112
    v_mfma_f32_16x16x32_bf16 v[108:111], v[20:23], v[0:3], v[108:111]
    ds_read_b64_tr_b16 v[64:65], v228 offset:12816
    v_mfma_f32_16x16x32_bf16 v[128:131], v[20:23], v[4:7], v[128:131]
    ds_read_b64_tr_b16 v[66:67], v228 offset:15120
    s_waitcnt lgkmcnt(15)
    v_mfma_f32_16x16x32_bf16 v[112:115], v[24:27], v[0:3], v[112:115]
    ds_read_b64_tr_b16 v[68:69], v228 offset:12824
    v_mfma_f32_16x16x32_bf16 v[132:135], v[24:27], v[4:7], v[132:135]
    ds_read_b64_tr_b16 v[70:71], v228 offset:15128
    v_mfma_f32_16x16x32_bf16 v[136:139], v[28:31], v[0:3], v[136:139]
    ds_read_b64_tr_b16 v[72:73], v228 offset:12832
    v_mfma_f32_16x16x32_bf16 v[156:159], v[28:31], v[4:7], v[156:159]
    ds_read_b64_tr_b16 v[74:75], v228 offset:15136
    s_waitcnt lgkmcnt(15)
    v_mfma_f32_16x16x32_bf16 v[140:143], v[32:35], v[0:3], v[140:143]
    ds_read_b64_tr_b16 v[76:77], v228 offset:22016
    v_mfma_f32_16x16x32_bf16 v[160:163], v[32:35], v[4:7], v[160:163]
    ds_read_b64_tr_b16 v[78:79], v228 offset:24320
    v_mfma_f32_16x16x32_bf16 v[144:147], v[36:39], v[0:3], v[144:147]
    ds_read_b64_tr_b16 v[80:81], v228 offset:22024
    v_mfma_f32_16x16x32_bf16 v[164:167], v[36:39], v[4:7], v[164:167]
    ds_read_b64_tr_b16 v[82:83], v228 offset:24328
    s_waitcnt lgkmcnt(15)
    v_mfma_f32_16x16x32_bf16 v[148:151], v[40:43], v[0:3], v[148:151]
    ds_read_b64_tr_b16 v[84:85], v228 offset:22032
    v_mfma_f32_16x16x32_bf16 v[168:171], v[40:43], v[4:7], v[168:171]
    ds_read_b64_tr_b16 v[86:87], v228 offset:24336
    v_mfma_f32_16x16x32_bf16 v[152:155], v[44:47], v[0:3], v[152:155]
    ds_read_b64_tr_b16 v[88:89], v228 offset:22040
    v_mfma_f32_16x16x32_bf16 v[172:175], v[44:47], v[4:7], v[172:175]
    ds_read_b64_tr_b16 v[90:91], v228 offset:24344
    ds_read_b64_tr_b16 v[92:93], v228 offset:22048
    ds_read_b64_tr_b16 v[94:95], v228 offset:24352
    s_barrier
    v_mov_b32 v233, 0
    buffer_load_dword v233, v233, s[40:43], 0 offen sc1
    s_waitcnt lgkmcnt(15)
    v_mfma_f32_16x16x32_bf16 v[96:99], v[56:59], v[48:51], v[96:99]
    ds_read_b128 v[0:3], v229 offset:43008
    v_mfma_f32_16x16x32_bf16 v[116:119], v[56:59], v[52:55], v[116:119]
    ds_read_b128 v[4:7], v229 offset:44032
    v_mfma_f32_16x16x32_bf16 v[100:103], v[60:63], v[48:51], v[100:103]
    ds_read_b64_tr_b16 v[8:9], v228 offset:43008
    v_mfma_f32_16x16x32_bf16 v[120:123], v[60:63], v[52:55], v[120:123]
    ds_read_b64_tr_b16 v[10:11], v228 offset:45312
    s_waitcnt lgkmcnt(15)
    v_mfma_f32_16x16x32_bf16 v[104:107], v[64:67], v[48:51], v[104:107]
    ds_read_b64_tr_b16 v[12:13], v228 offset:43016
    v_mfma_f32_16x16x32_bf16 v[124:127], v[64:67], v[52:55], v[124:127]
    ds_read_b64_tr_b16 v[14:15], v228 offset:45320
    v_mfma_f32_16x16x32_bf16 v[108:111], v[68:71], v[48:51], v[108:111]
    ds_read_b64_tr_b16 v[16:17], v228 offset:43024
    v_mfma_f32_16x16x32_bf16 v[128:131], v[68:71], v[52:55], v[128:131]
    ds_read_b64_tr_b16 v[18:19], v228 offset:45328
    s_waitcnt lgkmcnt(15)
    v_mfma_f32_16x16x32_bf16 v[112:115], v[72:75], v[48:51], v[112:115]
    ds_read_b64_tr_b16 v[20:21], v228 offset:43032
    v_mfma_f32_16x16x32_bf16 v[132:135], v[72:75], v[52:55], v[132:135]
    ds_read_b64_tr_b16 v[22:23], v228 offset:45336
    v_mfma_f32_16x16x32_bf16 v[136:139], v[76:79], v[48:51], v[136:139]
    ds_read_b64_tr_b16 v[24:25], v228 offset:43040
    v_mfma_f32_16x16x32_bf16 v[156:159], v[76:79], v[52:55], v[156:159]
    ds_read_b64_tr_b16 v[26:27], v228 offset:45344
    s_waitcnt lgkmcnt(15)
    v_mfma_f32_16x16x32_bf16 v[140:143], v[80:83], v[48:51], v[140:143]
    ds_read_b64_tr_b16 v[28:29], v228 offset:52224
    v_mfma_f32_16x16x32_bf16 v[160:163], v[80:83], v[52:55], v[160:163]
    ds_read_b64_tr_b16 v[30:31], v228 offset:54528
    v_mfma_f32_16x16x32_bf16 v[144:147], v[84:87], v[48:51], v[144:147]
    ds_read_b64_tr_b16 v[32:33], v228 offset:52232
    v_mfma_f32_16x16x32_bf16 v[164:167], v[84:87], v[52:55], v[164:167]
    ds_read_b64_tr_b16 v[34:35], v228 offset:54536
    s_waitcnt lgkmcnt(15)
    v_mfma_f32_16x16x32_bf16 v[148:151], v[88:91], v[48:51], v[148:151]
    ds_read_b64_tr_b16 v[36:37], v228 offset:52240
    v_mfma_f32_16x16x32_bf16 v[168:171], v[88:91], v[52:55], v[168:171]
    ds_read_b64_tr_b16 v[38:39], v228 offset:54544
    v_mfma_f32_16x16x32_bf16 v[152:155], v[92:95], v[48:51], v[152:155]
    ds_read_b64_tr_b16 v[40:41], v228 offset:52248
    v_mfma_f32_16x16x32_bf16 v[172:175], v[92:95], v[52:55], v[172:175]
    ds_read_b64_tr_b16 v[42:43], v228 offset:54552
    ds_read_b64_tr_b16 v[44:45], v228 offset:52256
    ds_read_b64_tr_b16 v[46:47], v228 offset:54560
    s_waitcnt lgkmcnt(15)
    v_mfma_f32_16x16x32_bf16 v[96:99], v[8:11], v[0:3], v[96:99]
    ds_read_b128 v[48:51], v229 offset:51200
    v_mfma_f32_16x16x32_bf16 v[116:119], v[8:11], v[4:7], v[116:119]
    ds_read_b128 v[52:55], v229 offset:52224
    v_mfma_f32_16x16x32_bf16 v[100:103], v[12:15], v[0:3], v[100:103]
    ds_read_b64_tr_b16 v[56:57], v228 offset:47616
    v_mfma_f32_16x16x32_bf16 v[120:123], v[12:15], v[4:7], v[120:123]
    ds_read_b64_tr_b16 v[58:59], v228 offset:49920
    s_waitcnt lgkmcnt(15)
    v_mfma_f32_16x16x32_bf16 v[104:107], v[16:19], v[0:3], v[104:107]
    ds_read_b64_tr_b16 v[60:61], v228 offset:47624
    v_mfma_f32_16x16x32_bf16 v[124:127], v[16:19], v[4:7], v[124:127]
    ds_read_b64_tr_b16 v[62:63], v228 offset:49928
    v_mfma_f32_16x16x32_bf16 v[108:111], v[20:23], v[0:3], v[108:111]
    ds_read_b64_tr_b16 v[64:65], v228 offset:47632
    v_mfma_f32_16x16x32_bf16 v[128:131], v[20:23], v[4:7], v[128:131]
    ds_read_b64_tr_b16 v[66:67], v228 offset:49936
    s_waitcnt lgkmcnt(15)
    v_mfma_f32_16x16x32_bf16 v[112:115], v[24:27], v[0:3], v[112:115]
    ds_read_b64_tr_b16 v[68:69], v228 offset:47640
    v_mfma_f32_16x16x32_bf16 v[132:135], v[24:27], v[4:7], v[132:135]
    ds_read_b64_tr_b16 v[70:71], v228 offset:49944
    v_mfma_f32_16x16x32_bf16 v[136:139], v[28:31], v[0:3], v[136:139]
    ds_read_b64_tr_b16 v[72:73], v228 offset:47648
    v_mfma_f32_16x16x32_bf16 v[156:159], v[28:31], v[4:7], v[156:159]
    ds_read_b64_tr_b16 v[74:75], v228 offset:49952
    s_waitcnt lgkmcnt(15)
    v_mfma_f32_16x16x32_bf16 v[140:143], v[32:35], v[0:3], v[140:143]
    ds_read_b64_tr_b16 v[76:77], v228 offset:56832
    v_mfma_f32_16x16x32_bf16 v[160:163], v[32:35], v[4:7], v[160:163]
    ds_read_b64_tr_b16 v[78:79], v228 offset:59136
    v_mfma_f32_16x16x32_bf16 v[144:147], v[36:39], v[0:3], v[144:147]
    ds_read_b64_tr_b16 v[80:81], v228 offset:56840
    v_mfma_f32_16x16x32_bf16 v[164:167], v[36:39], v[4:7], v[164:167]
    ds_read_b64_tr_b16 v[82:83], v228 offset:59144
    s_waitcnt lgkmcnt(15)
    v_mfma_f32_16x16x32_bf16 v[148:151], v[40:43], v[0:3], v[148:151]
    ds_read_b64_tr_b16 v[84:85], v228 offset:56848
    v_mfma_f32_16x16x32_bf16 v[168:171], v[40:43], v[4:7], v[168:171]
    ds_read_b64_tr_b16 v[86:87], v228 offset:59152
    v_mfma_f32_16x16x32_bf16 v[152:155], v[44:47], v[0:3], v[152:155]
    ds_read_b64_tr_b16 v[88:89], v228 offset:56856
    v_mfma_f32_16x16x32_bf16 v[172:175], v[44:47], v[4:7], v[172:175]
    ds_read_b64_tr_b16 v[90:91], v228 offset:59160
    ds_read_b64_tr_b16 v[92:93], v228 offset:56864
    ds_read_b64_tr_b16 v[94:95], v228 offset:59168
    s_barrier
    s_waitcnt lgkmcnt(15)
    v_mfma_f32_16x16x32_bf16 v[96:99], v[56:59], v[48:51], v[96:99]
    v_add_u32 v229, 0xfffe9400, v229
    ds_read_b128 v[0:3], v229 offset:8192
    v_mfma_f32_16x16x32_bf16 v[116:119], v[56:59], v[52:55], v[116:119]
    ds_read_b128 v[4:7], v229 offset:9216
    v_mfma_f32_16x16x32_bf16 v[100:103], v[60:63], v[48:51], v[100:103]
    v_add_u32 v228, 0xfffeb400, v228
    ds_read_b64_tr_b16 v[8:9], v228 offset:0
    v_mfma_f32_16x16x32_bf16 v[120:123], v[60:63], v[52:55], v[120:123]
    ds_read_b64_tr_b16 v[10:11], v228 offset:2304
    s_waitcnt lgkmcnt(15)
    v_mfma_f32_16x16x32_bf16 v[104:107], v[64:67], v[48:51], v[104:107]
    ds_read_b64_tr_b16 v[12:13], v228 offset:8
    v_mfma_f32_16x16x32_bf16 v[124:127], v[64:67], v[52:55], v[124:127]
    ds_read_b64_tr_b16 v[14:15], v228 offset:2312
    v_mfma_f32_16x16x32_bf16 v[108:111], v[68:71], v[48:51], v[108:111]
    ds_read_b64_tr_b16 v[16:17], v228 offset:16
    v_mfma_f32_16x16x32_bf16 v[128:131], v[68:71], v[52:55], v[128:131]
    ds_read_b64_tr_b16 v[18:19], v228 offset:2320
    s_waitcnt lgkmcnt(15)
    v_mfma_f32_16x16x32_bf16 v[112:115], v[72:75], v[48:51], v[112:115]
    ds_read_b64_tr_b16 v[20:21], v228 offset:24
    v_mfma_f32_16x16x32_bf16 v[132:135], v[72:75], v[52:55], v[132:135]
    ds_read_b64_tr_b16 v[22:23], v228 offset:2328
    v_mfma_f32_16x16x32_bf16 v[136:139], v[76:79], v[48:51], v[136:139]
    ds_read_b64_tr_b16 v[24:25], v228 offset:32
    v_mfma_f32_16x16x32_bf16 v[156:159], v[76:79], v[52:55], v[156:159]
    ds_read_b64_tr_b16 v[26:27], v228 offset:2336
    s_waitcnt lgkmcnt(15)
    v_mfma_f32_16x16x32_bf16 v[140:143], v[80:83], v[48:51], v[140:143]
    ds_read_b64_tr_b16 v[28:29], v228 offset:9216
    v_mfma_f32_16x16x32_bf16 v[160:163], v[80:83], v[52:55], v[160:163]
    ds_read_b64_tr_b16 v[30:31], v228 offset:11520
    v_mfma_f32_16x16x32_bf16 v[144:147], v[84:87], v[48:51], v[144:147]
    ds_read_b64_tr_b16 v[32:33], v228 offset:9224
    v_mfma_f32_16x16x32_bf16 v[164:167], v[84:87], v[52:55], v[164:167]
    ds_read_b64_tr_b16 v[34:35], v228 offset:11528
    s_waitcnt lgkmcnt(15)
    v_mfma_f32_16x16x32_bf16 v[148:151], v[88:91], v[48:51], v[148:151]
    ds_read_b64_tr_b16 v[36:37], v228 offset:9232
    v_mfma_f32_16x16x32_bf16 v[168:171], v[88:91], v[52:55], v[168:171]
    ds_read_b64_tr_b16 v[38:39], v228 offset:11536
    v_mfma_f32_16x16x32_bf16 v[152:155], v[92:95], v[48:51], v[152:155]
    ds_read_b64_tr_b16 v[40:41], v228 offset:9240
    v_mfma_f32_16x16x32_bf16 v[172:175], v[92:95], v[52:55], v[172:175]
    ds_read_b64_tr_b16 v[42:43], v228 offset:11544
    ds_read_b64_tr_b16 v[44:45], v228 offset:9248
    ds_read_b64_tr_b16 v[46:47], v228 offset:11552
    s_waitcnt lgkmcnt(15)
    v_mfma_f32_16x16x32_bf16 v[96:99], v[8:11], v[0:3], v[96:99]
    ds_read_b128 v[48:51], v229 offset:16384
    v_mfma_f32_16x16x32_bf16 v[116:119], v[8:11], v[4:7], v[116:119]
    ds_read_b128 v[52:55], v229 offset:17408
    v_mfma_f32_16x16x32_bf16 v[100:103], v[12:15], v[0:3], v[100:103]
    ds_read_b64_tr_b16 v[56:57], v228 offset:4608
    v_mfma_f32_16x16x32_bf16 v[120:123], v[12:15], v[4:7], v[120:123]
    ds_read_b64_tr_b16 v[58:59], v228 offset:6912
    s_waitcnt lgkmcnt(15)
    v_mfma_f32_16x16x32_bf16 v[104:107], v[16:19], v[0:3], v[104:107]
    ds_read_b64_tr_b16 v[60:61], v228 offset:4616
    v_mfma_f32_16x16x32_bf16 v[124:127], v[16:19], v[4:7], v[124:127]
    ds_read_b64_tr_b16 v[62:63], v228 offset:6920
    v_mfma_f32_16x16x32_bf16 v[108:111], v[20:23], v[0:3], v[108:111]
    ds_read_b64_tr_b16 v[64:65], v228 offset:4624
    v_mfma_f32_16x16x32_bf16 v[128:131], v[20:23], v[4:7], v[128:131]
    ds_read_b64_tr_b16 v[66:67], v228 offset:6928
    s_waitcnt lgkmcnt(15)
    v_mfma_f32_16x16x32_bf16 v[112:115], v[24:27], v[0:3], v[112:115]
    ds_read_b64_tr_b16 v[68:69], v228 offset:4632
    v_mfma_f32_16x16x32_bf16 v[132:135], v[24:27], v[4:7], v[132:135]
    ds_read_b64_tr_b16 v[70:71], v228 offset:6936
    v_mfma_f32_16x16x32_bf16 v[136:139], v[28:31], v[0:3], v[136:139]
    ds_read_b64_tr_b16 v[72:73], v228 offset:4640
    v_mfma_f32_16x16x32_bf16 v[156:159], v[28:31], v[4:7], v[156:159]
    ds_read_b64_tr_b16 v[74:75], v228 offset:6944
    s_waitcnt lgkmcnt(15)
    v_mfma_f32_16x16x32_bf16 v[140:143], v[32:35], v[0:3], v[140:143]
    ds_read_b64_tr_b16 v[76:77], v228 offset:13824
    v_mfma_f32_16x16x32_bf16 v[160:163], v[32:35], v[4:7], v[160:163]
    ds_read_b64_tr_b16 v[78:79], v228 offset:16128
    v_mfma_f32_16x16x32_bf16 v[144:147], v[36:39], v[0:3], v[144:147]
    ds_read_b64_tr_b16 v[80:81], v228 offset:13832
    v_mfma_f32_16x16x32_bf16 v[164:167], v[36:39], v[4:7], v[164:167]
    ds_read_b64_tr_b16 v[82:83], v228 offset:16136
    s_waitcnt lgkmcnt(15)
    v_mfma_f32_16x16x32_bf16 v[148:151], v[40:43], v[0:3], v[148:151]
    ds_read_b64_tr_b16 v[84:85], v228 offset:13840
    v_mfma_f32_16x16x32_bf16 v[168:171], v[40:43], v[4:7], v[168:171]
    ds_read_b64_tr_b16 v[86:87], v228 offset:16144
    v_mfma_f32_16x16x32_bf16 v[152:155], v[44:47], v[0:3], v[152:155]
    ds_read_b64_tr_b16 v[88:89], v228 offset:13848
    v_mfma_f32_16x16x32_bf16 v[172:175], v[44:47], v[4:7], v[172:175]
    ds_read_b64_tr_b16 v[90:91], v228 offset:16152
    ds_read_b64_tr_b16 v[92:93], v228 offset:13856
    ds_read_b64_tr_b16 v[94:95], v228 offset:16160
    s_waitcnt lgkmcnt(15)
    v_mfma_f32_16x16x32_bf16 v[96:99], v[56:59], v[48:51], v[96:99]
    v_mfma_f32_16x16x32_bf16 v[116:119], v[56:59], v[52:55], v[116:119]
    v_mfma_f32_16x16x32_bf16 v[100:103], v[60:63], v[48:51], v[100:103]
    v_mfma_f32_16x16x32_bf16 v[120:123], v[60:63], v[52:55], v[120:123]
    s_waitcnt lgkmcnt(14)
    v_mfma_f32_16x16x32_bf16 v[104:107], v[64:67], v[48:51], v[104:107]
    v_mfma_f32_16x16x32_bf16 v[124:127], v[64:67], v[52:55], v[124:127]
    s_waitcnt lgkmcnt(12)
    v_mfma_f32_16x16x32_bf16 v[108:111], v[68:71], v[48:51], v[108:111]
    v_mfma_f32_16x16x32_bf16 v[128:131], v[68:71], v[52:55], v[128:131]
    s_waitcnt lgkmcnt(10)
    v_mfma_f32_16x16x32_bf16 v[112:115], v[72:75], v[48:51], v[112:115]
    v_mfma_f32_16x16x32_bf16 v[132:135], v[72:75], v[52:55], v[132:135]
    s_waitcnt lgkmcnt(8)
    v_mfma_f32_16x16x32_bf16 v[136:139], v[76:79], v[48:51], v[136:139]
    v_mfma_f32_16x16x32_bf16 v[156:159], v[76:79], v[52:55], v[156:159]
    s_waitcnt lgkmcnt(6)
    v_mfma_f32_16x16x32_bf16 v[140:143], v[80:83], v[48:51], v[140:143]
    v_mfma_f32_16x16x32_bf16 v[160:163], v[80:83], v[52:55], v[160:163]
    s_barrier
    ds_read_b128 v[0:3], v229 offset:43008
    ds_read_b128 v[4:7], v229 offset:44032
    ds_read_b64_tr_b16 v[8:9], v228 offset:34816
    s_waitcnt lgkmcnt(7)
    v_mfma_f32_16x16x32_bf16 v[144:147], v[84:87], v[48:51], v[144:147]
    ds_read_b64_tr_b16 v[10:11], v228 offset:37120
    ds_read_b64_tr_b16 v[12:13], v228 offset:34824
    ds_read_b64_tr_b16 v[14:15], v228 offset:37128
    v_mfma_f32_16x16x32_bf16 v[164:167], v[84:87], v[52:55], v[164:167]
    ds_read_b64_tr_b16 v[16:17], v228 offset:34832
    ds_read_b64_tr_b16 v[18:19], v228 offset:37136
    ds_read_b64_tr_b16 v[20:21], v228 offset:34840
    s_waitcnt lgkmcnt(11)
    v_mfma_f32_16x16x32_bf16 v[148:151], v[88:91], v[48:51], v[148:151]
    ds_read_b64_tr_b16 v[22:23], v228 offset:37144
    ds_read_b64_tr_b16 v[24:25], v228 offset:34848
    ds_read_b64_tr_b16 v[26:27], v228 offset:37152
    v_mfma_f32_16x16x32_bf16 v[168:171], v[88:91], v[52:55], v[168:171]
    ds_read_b64_tr_b16 v[28:29], v228 offset:44032
    ds_read_b64_tr_b16 v[30:31], v228 offset:46336
    ds_read_b64_tr_b16 v[32:33], v228 offset:44040
    s_waitcnt lgkmcnt(15)
    v_mfma_f32_16x16x32_bf16 v[152:155], v[92:95], v[48:51], v[152:155]
    ds_read_b64_tr_b16 v[34:35], v228 offset:46344
    ds_read_b64_tr_b16 v[36:37], v228 offset:44048
    ds_read_b64_tr_b16 v[38:39], v228 offset:46352
    v_mfma_f32_16x16x32_bf16 v[172:175], v[92:95], v[52:55], v[172:175]
    ds_read_b64_tr_b16 v[40:41], v228 offset:44056
    ds_read_b64_tr_b16 v[42:43], v228 offset:46360
    ds_read_b64_tr_b16 v[44:45], v228 offset:44064
    ds_read_b64_tr_b16 v[46:47], v228 offset:46368
    s_waitcnt lgkmcnt(15)
    v_mfma_f32_16x16x32_bf16 v[96:99], v[8:11], v[0:3], v[96:99]
    ds_read_b128 v[48:51], v229 offset:51200
    v_mfma_f32_16x16x32_bf16 v[116:119], v[8:11], v[4:7], v[116:119]
    ds_read_b128 v[52:55], v229 offset:52224
    v_mfma_f32_16x16x32_bf16 v[100:103], v[12:15], v[0:3], v[100:103]
    ds_read_b64_tr_b16 v[56:57], v228 offset:39424
    v_mfma_f32_16x16x32_bf16 v[120:123], v[12:15], v[4:7], v[120:123]
    ds_read_b64_tr_b16 v[58:59], v228 offset:41728
    s_waitcnt lgkmcnt(15)
    v_mfma_f32_16x16x32_bf16 v[104:107], v[16:19], v[0:3], v[104:107]
    ds_read_b64_tr_b16 v[60:61], v228 offset:39432
    v_mfma_f32_16x16x32_bf16 v[124:127], v[16:19], v[4:7], v[124:127]
    ds_read_b64_tr_b16 v[62:63], v228 offset:41736
    v_mfma_f32_16x16x32_bf16 v[108:111], v[20:23], v[0:3], v[108:111]
    ds_read_b64_tr_b16 v[64:65], v228 offset:39440
    v_mfma_f32_16x16x32_bf16 v[128:131], v[20:23], v[4:7], v[128:131]
    ds_read_b64_tr_b16 v[66:67], v228 offset:41744
    s_waitcnt lgkmcnt(15)
    v_mfma_f32_16x16x32_bf16 v[112:115], v[24:27], v[0:3], v[112:115]
    ds_read_b64_tr_b16 v[68:69], v228 offset:39448
    v_mfma_f32_16x16x32_bf16 v[132:135], v[24:27], v[4:7], v[132:135]
    ds_read_b64_tr_b16 v[70:71], v228 offset:41752
    v_mfma_f32_16x16x32_bf16 v[136:139], v[28:31], v[0:3], v[136:139]
    ds_read_b64_tr_b16 v[72:73], v228 offset:39456
    v_mfma_f32_16x16x32_bf16 v[156:159], v[28:31], v[4:7], v[156:159]
    ds_read_b64_tr_b16 v[74:75], v228 offset:41760
    s_waitcnt lgkmcnt(15)
    v_mfma_f32_16x16x32_bf16 v[140:143], v[32:35], v[0:3], v[140:143]
    ds_read_b64_tr_b16 v[76:77], v228 offset:48640
    v_mfma_f32_16x16x32_bf16 v[160:163], v[32:35], v[4:7], v[160:163]
    ds_read_b64_tr_b16 v[78:79], v228 offset:50944
    v_mfma_f32_16x16x32_bf16 v[144:147], v[36:39], v[0:3], v[144:147]
    ds_read_b64_tr_b16 v[80:81], v228 offset:48648
    v_mfma_f32_16x16x32_bf16 v[164:167], v[36:39], v[4:7], v[164:167]
    ds_read_b64_tr_b16 v[82:83], v228 offset:50952
    s_waitcnt lgkmcnt(15)
    v_mfma_f32_16x16x32_bf16 v[148:151], v[40:43], v[0:3], v[148:151]
    ds_read_b64_tr_b16 v[84:85], v228 offset:48656
    v_mfma_f32_16x16x32_bf16 v[168:171], v[40:43], v[4:7], v[168:171]
    ds_read_b64_tr_b16 v[86:87], v228 offset:50960
    v_mfma_f32_16x16x32_bf16 v[152:155], v[44:47], v[0:3], v[152:155]
    ds_read_b64_tr_b16 v[88:89], v228 offset:48664
    v_mfma_f32_16x16x32_bf16 v[172:175], v[44:47], v[4:7], v[172:175]
    ds_read_b64_tr_b16 v[90:91], v228 offset:50968
    ds_read_b64_tr_b16 v[92:93], v228 offset:48672
    ds_read_b64_tr_b16 v[94:95], v228 offset:50976
    s_waitcnt lgkmcnt(15)
    v_mfma_f32_16x16x32_bf16 v[96:99], v[56:59], v[48:51], v[96:99]
    v_mfma_f32_16x16x32_bf16 v[116:119], v[56:59], v[52:55], v[116:119]
    v_mfma_f32_16x16x32_bf16 v[100:103], v[60:63], v[48:51], v[100:103]
    v_mfma_f32_16x16x32_bf16 v[120:123], v[60:63], v[52:55], v[120:123]
    s_waitcnt lgkmcnt(14)
    v_mfma_f32_16x16x32_bf16 v[104:107], v[64:67], v[48:51], v[104:107]
    v_mfma_f32_16x16x32_bf16 v[124:127], v[64:67], v[52:55], v[124:127]
    s_waitcnt lgkmcnt(12)
    v_mfma_f32_16x16x32_bf16 v[108:111], v[68:71], v[48:51], v[108:111]
    v_mfma_f32_16x16x32_bf16 v[128:131], v[68:71], v[52:55], v[128:131]
    s_waitcnt lgkmcnt(10)
    v_mfma_f32_16x16x32_bf16 v[112:115], v[72:75], v[48:51], v[112:115]
    v_mfma_f32_16x16x32_bf16 v[132:135], v[72:75], v[52:55], v[132:135]
    s_waitcnt lgkmcnt(8)
    v_mfma_f32_16x16x32_bf16 v[136:139], v[76:79], v[48:51], v[136:139]
    v_mfma_f32_16x16x32_bf16 v[156:159], v[76:79], v[52:55], v[156:159]
    s_waitcnt lgkmcnt(6)
    v_mfma_f32_16x16x32_bf16 v[140:143], v[80:83], v[48:51], v[140:143]
    v_mfma_f32_16x16x32_bf16 v[160:163], v[80:83], v[52:55], v[160:163]
    s_waitcnt lgkmcnt(4)
    v_mfma_f32_16x16x32_bf16 v[144:147], v[84:87], v[48:51], v[144:147]
    v_mfma_f32_16x16x32_bf16 v[164:167], v[84:87], v[52:55], v[164:167]
    s_waitcnt lgkmcnt(2)
    v_mfma_f32_16x16x32_bf16 v[148:151], v[88:91], v[48:51], v[148:151]
    v_mfma_f32_16x16x32_bf16 v[168:171], v[88:91], v[52:55], v[168:171]
    s_waitcnt lgkmcnt(0)
    v_mfma_f32_16x16x32_bf16 v[152:155], v[92:95], v[48:51], v[152:155]
    v_mfma_f32_16x16x32_bf16 v[172:175], v[92:95], v[52:55], v[172:175]
    ds_read_b64_tr_b16 v[176:177], v243 offset:0
    ds_read_b64_tr_b16 v[178:179], v243 offset:160
    ds_read_b64_tr_b16 v[180:181], v243 offset:320
    ds_read_b64_tr_b16 v[182:183], v243 offset:480
    ds_read_b64_tr_b16 v[184:185], v243 offset:640
    ds_read_b64_tr_b16 v[186:187], v243 offset:8
    ds_read_b64_tr_b16 v[188:189], v243 offset:168
    ds_read_b64_tr_b16 v[190:191], v243 offset:328
    ds_read_b64_tr_b16 v[192:193], v243 offset:488
    ds_read_b64_tr_b16 v[194:195], v243 offset:648
    ds_read_b64_tr_b16 v[196:197], v243 offset:16
    ds_read_b64_tr_b16 v[198:199], v243 offset:176
    ds_read_b64_tr_b16 v[200:201], v243 offset:336
    ds_read_b64_tr_b16 v[202:203], v243 offset:496
    ds_read_b64_tr_b16 v[204:205], v243 offset:656
    ds_read_b64_tr_b16 v[206:207], v243 offset:24
    ds_read_b64_tr_b16 v[208:209], v243 offset:184
    ds_read_b64_tr_b16 v[210:211], v243 offset:344
    ds_read_b64_tr_b16 v[212:213], v243 offset:504
    ds_read_b64_tr_b16 v[214:215], v243 offset:664
    ds_read_b64_tr_b16 v[216:217], v243 offset:32
    ds_read_b64_tr_b16 v[218:219], v243 offset:192
    ds_read_b64_tr_b16 v[220:221], v243 offset:352
    ds_read_b64_tr_b16 v[222:223], v243 offset:512
    ds_read_b64_tr_b16 v[224:225], v243 offset:672
    s_barrier
    ds_read_b64 v[0:1], v242
    ds_read_b64 v[2:3], v242 offset:128
    ds_read_b128 v[4:7], v237 offset:0
    ds_read_b128 v[8:11], v237 offset:64
    ds_read_b128 v[12:15], v237 offset:128
    ds_read_b128 v[16:19], v237 offset:192
    ds_read_b128 v[20:23], v237 offset:256
    ds_read_b128 v[24:27], v237 offset:320
    ds_read_b128 v[28:31], v237 offset:384
    ds_read_b128 v[32:35], v237 offset:448
    ds_read_b128 v[36:39], v237 offset:512
    ds_read_b128 v[40:43], v237 offset:576
    s_mov_b32 s70, 0xffff
    s_mov_b32 s71, 0xffff
    s_waitcnt lgkmcnt(9)
    v_pk_fma_f32 v[96:97], v[4:5], v[0:1], v[96:97] op_sel_hi:[1,0,1]
    v_pk_fma_f32 v[98:99], v[6:7], v[0:1], v[98:99] op_sel_hi:[1,0,1]
    s_waitcnt lgkmcnt(8)
    v_pk_fma_f32 v[100:101], v[8:9], v[0:1], v[100:101] op_sel_hi:[1,0,1]
    v_pk_fma_f32 v[102:103], v[10:11], v[0:1], v[102:103] op_sel_hi:[1,0,1]
    s_waitcnt lgkmcnt(7)
    v_pk_fma_f32 v[104:105], v[12:13], v[0:1], v[104:105] op_sel_hi:[1,0,1]
    v_pk_fma_f32 v[106:107], v[14:15], v[0:1], v[106:107] op_sel_hi:[1,0,1]
    s_waitcnt lgkmcnt(6)
    v_pk_fma_f32 v[108:109], v[16:17], v[0:1], v[108:109] op_sel_hi:[1,0,1]
    v_pk_fma_f32 v[110:111], v[18:19], v[0:1], v[110:111] op_sel_hi:[1,0,1]
    s_waitcnt lgkmcnt(5)
    v_pk_fma_f32 v[112:113], v[20:21], v[0:1], v[112:113] op_sel_hi:[1,0,1]
    v_pk_fma_f32 v[114:115], v[22:23], v[0:1], v[114:115] op_sel_hi:[1,0,1]
    v_cndmask_b32 v114, v114, v96, s[70:71]
    v_cndmask_b32 v115, v115, v97, s[70:71]
    v_cvt_pk_bf16_f32 v44, v98, v99
    v_cvt_pk_bf16_f32 v45, v100, v101
    v_cvt_pk_bf16_f32 v46, v102, v103
    v_cvt_pk_bf16_f32 v47, v104, v105
    v_cvt_pk_bf16_f32 v48, v106, v107
    v_cvt_pk_bf16_f32 v49, v108, v109
    v_cvt_pk_bf16_f32 v50, v110, v111
    v_cvt_pk_bf16_f32 v51, v112, v113
    v_cvt_pk_bf16_f32 v52, v114, v115
    v_mov_b32 v53, 0
    s_mov_b32 s70, 0xffff
    s_mov_b32 s71, 0xffff
    v_pk_fma_f32 v[116:117], v[4:5], v[2:3], v[116:117] op_sel_hi:[1,0,1]
    v_pk_fma_f32 v[118:119], v[6:7], v[2:3], v[118:119] op_sel_hi:[1,0,1]
    v_pk_fma_f32 v[120:121], v[8:9], v[2:3], v[120:121] op_sel_hi:[1,0,1]
    v_pk_fma_f32 v[122:123], v[10:11], v[2:3], v[122:123] op_sel_hi:[1,0,1]
    v_pk_fma_f32 v[124:125], v[12:13], v[2:3], v[124:125] op_sel_hi:[1,0,1]
    v_pk_fma_f32 v[126:127], v[14:15], v[2:3], v[126:127] op_sel_hi:[1,0,1]
    v_pk_fma_f32 v[128:129], v[16:17], v[2:3], v[128:129] op_sel_hi:[1,0,1]
    v_pk_fma_f32 v[130:131], v[18:19], v[2:3], v[130:131] op_sel_hi:[1,0,1]
    v_pk_fma_f32 v[132:133], v[20:21], v[2:3], v[132:133] op_sel_hi:[1,0,1]
    v_pk_fma_f32 v[134:135], v[22:23], v[2:3], v[134:135] op_sel_hi:[1,0,1]
    v_cndmask_b32 v134, v134, v116, s[70:71]
    v_cndmask_b32 v135, v135, v117, s[70:71]
    v_cvt_pk_bf16_f32 v54, v118, v119
    v_cvt_pk_bf16_f32 v55, v120, v121
    v_cvt_pk_bf16_f32 v56, v122, v123
    v_cvt_pk_bf16_f32 v57, v124, v125
    v_cvt_pk_bf16_f32 v58, v126, v127
    v_cvt_pk_bf16_f32 v59, v128, v129
    v_cvt_pk_bf16_f32 v60, v130, v131
    v_cvt_pk_bf16_f32 v61, v132, v133
    v_cvt_pk_bf16_f32 v62, v134, v135
    v_mov_b32 v63, 0
    v_mfma_f32_16x16x32_bf16 v[96:99], v[176:179], v[44:47], 0
    s_waitcnt lgkmcnt(4)
    v_fmac_f32 v136, v0, v24
    v_fmac_f32 v137, v0, v25
    v_mfma_f32_16x16x32_bf16 v[100:103], v[186:189], v[44:47], 0
    v_fmac_f32 v138, v0, v26
    v_fmac_f32 v139, v0, v27
    v_mfma_f32_16x16x32_bf16 v[104:107], v[196:199], v[44:47], 0
    s_waitcnt lgkmcnt(3)
    v_fmac_f32 v140, v0, v28
    v_fmac_f32 v141, v0, v29
    v_mfma_f32_16x16x32_bf16 v[108:111], v[206:209], v[44:47], 0
    v_fmac_f32 v142, v0, v30
    v_fmac_f32 v143, v0, v31
    v_mfma_f32_16x16x32_bf16 v[112:115], v[216:219], v[44:47], 0
    s_waitcnt lgkmcnt(2)
    v_fmac_f32 v144, v0, v32
    v_fmac_f32 v145, v0, v33
    v_mfma_f32_16x16x32_bf16 v[96:99], v[180:183], v[48:51], v[96:99]
    v_fmac_f32 v146, v0, v34
    v_fmac_f32 v147, v0, v35
    v_mfma_f32_16x16x32_bf16 v[100:103], v[190:193], v[48:51], v[100:103]
    s_waitcnt lgkmcnt(1)
    v_fmac_f32 v148, v0, v36
    v_fmac_f32 v149, v0, v37
    v_mfma_f32_16x16x32_bf16 v[104:107], v[200:203], v[48:51], v[104:107]
    v_fmac_f32 v150, v0, v38
    v_fmac_f32 v151, v0, v39
    v_mfma_f32_16x16x32_bf16 v[108:111], v[210:213], v[48:51], v[108:111]
    s_waitcnt lgkmcnt(0)
    v_fmac_f32 v152, v0, v40
    v_fmac_f32 v153, v0, v41
    v_mfma_f32_16x16x32_bf16 v[112:115], v[220:223], v[48:51], v[112:115]
    v_fmac_f32 v154, v0, v42
    v_fmac_f32 v155, v0, v43
    v_mfma_f32_16x16x16_bf16 v[96:99], v[184:185], v[52:53], v[96:99]
    v_cndmask_b32 v154, v154, v136, s[70:71]
    v_cndmask_b32 v155, v155, v137, s[70:71]
    v_mfma_f32_16x16x16_bf16 v[100:103], v[194:195], v[52:53], v[100:103]
    v_fmac_f32 v156, v2, v24
    v_fmac_f32 v157, v2, v25
    v_mfma_f32_16x16x16_bf16 v[104:107], v[204:205], v[52:53], v[104:107]
    v_fmac_f32 v158, v2, v26
    v_fmac_f32 v159, v2, v27
    v_mfma_f32_16x16x16_bf16 v[108:111], v[214:215], v[52:53], v[108:111]
    v_fmac_f32 v160, v2, v28
    v_fmac_f32 v161, v2, v29
    v_mfma_f32_16x16x16_bf16 v[112:115], v[224:225], v[52:53], v[112:115]
    v_fmac_f32 v162, v2, v30
    v_fmac_f32 v163, v2, v31
    v_mfma_f32_16x16x32_bf16 v[116:119], v[176:179], v[54:57], 0
    v_fmac_f32 v164, v2, v32
    v_fmac_f32 v165, v2, v33
    v_mfma_f32_16x16x32_bf16 v[120:123], v[186:189], v[54:57], 0
    v_fmac_f32 v166, v2, v34
    v_fmac_f32 v167, v2, v35
    v_mfma_f32_16x16x32_bf16 v[124:127], v[196:199], v[54:57], 0
    v_fmac_f32 v168, v2, v36
    v_fmac_f32 v169, v2, v37
    v_mfma_f32_16x16x32_bf16 v[128:131], v[206:209], v[54:57], 0
    v_fmac_f32 v170, v2, v38
    v_fmac_f32 v171, v2, v39
    v_mfma_f32_16x16x32_bf16 v[132:135], v[216:219], v[54:57], 0
    v_fmac_f32 v172, v2, v40
    v_fmac_f32 v173, v2, v41
    v_mfma_f32_16x16x32_bf16 v[116:119], v[180:183], v[58:61], v[116:119]
    v_fmac_f32 v174, v2, v42
    v_fmac_f32 v175, v2, v43
    v_mfma_f32_16x16x32_bf16 v[120:123], v[190:193], v[58:61], v[120:123]
    v_cndmask_b32 v174, v174, v156, s[70:71]
    v_cndmask_b32 v175, v175, v157, s[70:71]
    v_mfma_f32_16x16x32_bf16 v[124:127], v[200:203], v[58:61], v[124:127]
    v_mul_f32 v138, v138, v1
    v_mul_f32 v139, v139, v1
    v_mfma_f32_16x16x32_bf16 v[128:131], v[210:213], v[58:61], v[128:131]
    v_mul_f32 v140, v140, v1
    v_mul_f32 v141, v141, v1
    v_mfma_f32_16x16x32_bf16 v[132:135], v[220:223], v[58:61], v[132:135]
    v_mul_f32 v142, v142, v1
    v_mul_f32 v143, v143, v1
    v_mfma_f32_16x16x16_bf16 v[116:119], v[184:185], v[62:63], v[116:119]
    v_mul_f32 v144, v144, v1
    v_mul_f32 v145, v145, v1
    v_mfma_f32_16x16x16_bf16 v[120:123], v[194:195], v[62:63], v[120:123]
    v_mul_f32 v146, v146, v1
    v_mul_f32 v147, v147, v1
    v_mfma_f32_16x16x16_bf16 v[124:127], v[204:205], v[62:63], v[124:127]
    v_mul_f32 v148, v148, v1
    v_mul_f32 v149, v149, v1
    v_mfma_f32_16x16x16_bf16 v[128:131], v[214:215], v[62:63], v[128:131]
    v_mul_f32 v150, v150, v1
    v_mul_f32 v151, v151, v1
    v_mfma_f32_16x16x16_bf16 v[132:135], v[224:225], v[62:63], v[132:135]
    v_mul_f32 v152, v152, v1
    v_mul_f32 v153, v153, v1
    s_waitcnt vmcnt(0)
    v_readfirstlane_b32 s55, v233
    s_nop 1
    s_cmp_eq_u32 s55, 0
    s_cbranch_scc1 L_nslow_59
L_nback_60:
    v_pk_mul_f32 v[154:155], v[154:155], v[0:1] op_sel:[0,1] op_sel_hi:[1,1]
    v_cvt_pk_bf16_f32 v4, v138, v139
    v_cvt_pk_bf16_f32 v5, v140, v141
    v_cvt_pk_bf16_f32 v6, v142, v143
    v_cvt_pk_bf16_f32 v7, v144, v145
    v_cvt_pk_bf16_f32 v8, v146, v147
    v_cvt_pk_bf16_f32 v9, v148, v149
    v_cvt_pk_bf16_f32 v10, v150, v151
    v_cvt_pk_bf16_f32 v11, v152, v153
    v_cvt_pk_bf16_f32 v12, v154, v155
    v_mov_b32 v13, 0x3f80
    ds_write_b128 v246, v[4:7] offset:0
    ds_write_b128 v246, v[8:11] offset:16
    ds_write_b64 v247, v[12:13] offset:0
    v_mul_f32 v1, 0x3fb8aa3b, v1
    v_pk_mul_f32 v[158:159], v[158:159], v[2:3] op_sel:[0,1] op_sel_hi:[1,1]
    v_pk_mul_f32 v[160:161], v[160:161], v[2:3] op_sel:[0,1] op_sel_hi:[1,1]
    v_pk_mul_f32 v[162:163], v[162:163], v[2:3] op_sel:[0,1] op_sel_hi:[1,1]
    v_pk_mul_f32 v[164:165], v[164:165], v[2:3] op_sel:[0,1] op_sel_hi:[1,1]
    v_pk_mul_f32 v[166:167], v[166:167], v[2:3] op_sel:[0,1] op_sel_hi:[1,1]
    v_pk_mul_f32 v[168:169], v[168:169], v[2:3] op_sel:[0,1] op_sel_hi:[1,1]
    v_pk_mul_f32 v[170:171], v[170:171], v[2:3] op_sel:[0,1] op_sel_hi:[1,1]
    v_pk_mul_f32 v[172:173], v[172:173], v[2:3] op_sel:[0,1] op_sel_hi:[1,1]
    v_pk_mul_f32 v[174:175], v[174:175], v[2:3] op_sel:[0,1] op_sel_hi:[1,1]
    v_cvt_pk_bf16_f32 v14, v158, v159
    v_cvt_pk_bf16_f32 v15, v160, v161
    v_cvt_pk_bf16_f32 v16, v162, v163
    v_cvt_pk_bf16_f32 v17, v164, v165
    v_cvt_pk_bf16_f32 v18, v166, v167
    v_cvt_pk_bf16_f32 v19, v168, v169
    v_cvt_pk_bf16_f32 v20, v170, v171
    v_cvt_pk_bf16_f32 v21, v172, v173
    v_cvt_pk_bf16_f32 v22, v174, v175
    v_mov_b32 v23, 0x3f80
    ds_write_b128 v246, v[14:17] offset:512
    ds_write_b128 v246, v[18:21] offset:528
    ds_write_b64 v247, v[22:23] offset:128
    v_mul_f32 v3, 0x3fb8aa3b, v3
    v_max3_f32 v64, v96, v97, v98
    v_min3_f32 v65, v96, v97, v98
    v_max3_f32 v64, v64, v99, v100
    v_min3_f32 v65, v65, v99, v100
    v_max3_f32 v64, v64, v101, v102
    v_min3_f32 v65, v65, v101, v102
    v_max3_f32 v64, v64, v103, v104
    v_min3_f32 v65, v65, v103, v104
    v_max3_f32 v64, v64, v105, v106
    v_min3_f32 v65, v65, v105, v106
    v_max3_f32 v64, v64, v107, v108
    v_min3_f32 v65, v65, v107, v108
    v_max3_f32 v64, v64, v109, v110
    v_min3_f32 v65, v65, v109, v110
    v_max3_f32 v64, v64, v111, v112
    v_min3_f32 v65, v65, v111, v112
    v_max_f32 v64, v64, v113
    v_min_f32 v65, v65, v113
    v_pk_mul_f32 v[64:65], v[64:65], v[0:1] op_sel:[0,1] op_sel_hi:[1,1]
    v_pk_fma_f32 v[72:73], v[96:97], v[0:1], v[64:65] op_sel:[0,1,0] op_sel_hi:[1,1,0] neg_lo:[0,0,1] neg_hi:[0,0,1]
    v_pk_fma_f32 v[74:75], v[98:99], v[0:1], v[64:65] op_sel:[0,1,0] op_sel_hi:[1,1,0] neg_lo:[0,0,1] neg_hi:[0,0,1]
    v_pk_fma_f32 v[76:77], v[100:101], v[0:1], v[64:65] op_sel:[0,1,0] op_sel_hi:[1,1,0] neg_lo:[0,0,1] neg_hi:[0,0,1]
    v_pk_fma_f32 v[78:79], v[102:103], v[0:1], v[64:65] op_sel:[0,1,0] op_sel_hi:[1,1,0] neg_lo:[0,0,1] neg_hi:[0,0,1]
    v_pk_fma_f32 v[80:81], v[104:105], v[0:1], v[64:65] op_sel:[0,1,0] op_sel_hi:[1,1,0] neg_lo:[0,0,1] neg_hi:[0,0,1]
    v_pk_fma_f32 v[82:83], v[106:107], v[0:1], v[64:65] op_sel:[0,1,0] op_sel_hi:[1,1,0] neg_lo:[0,0,1] neg_hi:[0,0,1]
    v_pk_fma_f32 v[84:85], v[108:109], v[0:1], v[64:65] op_sel:[0,1,0] op_sel_hi:[1,1,0] neg_lo:[0,0,1] neg_hi:[0,0,1]
    v_pk_fma_f32 v[86:87], v[110:111], v[0:1], v[64:65] op_sel:[0,1,0] op_sel_hi:[1,1,0] neg_lo:[0,0,1] neg_hi:[0,0,1]
    v_pk_fma_f32 v[88:89], v[112:113], v[0:1], v[64:65] op_sel:[0,1,0] op_sel_hi:[1,1,0] neg_lo:[0,0,1] neg_hi:[0,0,1]
    v_pk_fma_f32 v[96:97], v[96:97], v[0:1], v[64:65] op_sel:[0,1,1] op_sel_hi:[1,1,1] neg_lo:[1,0,0] neg_hi:[1,0,0]
    v_pk_fma_f32 v[98:99], v[98:99], v[0:1], v[64:65] op_sel:[0,1,1] op_sel_hi:[1,1,1] neg_lo:[1,0,0] neg_hi:[1,0,0]
    v_pk_fma_f32 v[100:101], v[100:101], v[0:1], v[64:65] op_sel:[0,1,1] op_sel_hi:[1,1,1] neg_lo:[1,0,0] neg_hi:[1,0,0]
    v_pk_fma_f32 v[102:103], v[102:103], v[0:1], v[64:65] op_sel:[0,1,1] op_sel_hi:[1,1,1] neg_lo:[1,0,0] neg_hi:[1,0,0]
    v_pk_fma_f32 v[104:105], v[104:105], v[0:1], v[64:65] op_sel:[0,1,1] op_sel_hi:[1,1,1] neg_lo:[1,0,0] neg_hi:[1,0,0]
    v_pk_fma_f32 v[106:107], v[106:107], v[0:1], v[64:65] op_sel:[0,1,1] op_sel_hi:[1,1,1] neg_lo:[1,0,0] neg_hi:[1,0,0]
    v_pk_fma_f32 v[108:109], v[108:109], v[0:1], v[64:65] op_sel:[0,1,1] op_sel_hi:[1,1,1] neg_lo:[1,0,0] neg_hi:[1,0,0]
    v_pk_fma_f32 v[110:111], v[110:111], v[0:1], v[64:65] op_sel:[0,1,1] op_sel_hi:[1,1,1] neg_lo:[1,0,0] neg_hi:[1,0,0]
    v_pk_fma_f32 v[112:113], v[112:113], v[0:1], v[64:65] op_sel:[0,1,1] op_sel_hi:[1,1,1] neg_lo:[1,0,0] neg_hi:[1,0,0]
    v_exp_f32 v72, v72
    v_exp_f32 v73, v73
    v_exp_f32 v74, v74
    v_exp_f32 v75, v75
    v_exp_f32 v76, v76
    v_exp_f32 v77, v77
    v_exp_f32 v78, v78
    v_exp_f32 v79, v79
    v_exp_f32 v80, v80
    v_exp_f32 v81, v81
    v_exp_f32 v82, v82
    v_exp_f32 v83, v83
    v_exp_f32 v84, v84
    v_exp_f32 v85, v85
    v_exp_f32 v86, v86
    v_exp_f32 v87, v87
    v_exp_f32 v88, v88
    v_exp_f32 v89, v89
    v_exp_f32 v96, v96
    v_exp_f32 v97, v97
    v_exp_f32 v98, v98
    v_exp_f32 v99, v99
    v_exp_f32 v100, v100
    v_exp_f32 v101, v101
    v_exp_f32 v102, v102
    v_exp_f32 v103, v103
    v_exp_f32 v104, v104
    v_exp_f32 v105, v105
    v_exp_f32 v106, v106
    v_exp_f32 v107, v107
    v_exp_f32 v108, v108
    v_exp_f32 v109, v109
    v_exp_f32 v110, v110
    v_exp_f32 v111, v111
    v_exp_f32 v112, v112
    v_exp_f32 v113, v113
    v_pk_add_f32 v[66:67], v[72:73], v[74:75]
    v_pk_add_f32 v[68:69], v[96:97], v[98:99]
    v_pk_add_f32 v[66:67], v[66:67], v[76:77]
    v_pk_add_f32 v[68:69], v[68:69], v[100:101]
    v_pk_add_f32 v[66:67], v[66:67], v[78:79]
    v_pk_add_f32 v[68:69], v[68:69], v[102:103]
    v_pk_add_f32 v[66:67], v[66:67], v[80:81]
    v_pk_add_f32 v[68:69], v[68:69], v[104:105]
    v_pk_add_f32 v[66:67], v[66:67], v[82:83]
    v_pk_add_f32 v[68:69], v[68:69], v[106:107]
    v_pk_add_f32 v[66:67], v[66:67], v[84:85]
    v_pk_add_f32 v[68:69], v[68:69], v[108:109]
    v_pk_add_f32 v[66:67], v[66:67], v[86:87]
    v_pk_add_f32 v[68:69], v[68:69], v[110:111]
    v_pk_add_f32 v[66:67], v[66:67], v[88:89]
    v_pk_add_f32 v[68:69], v[68:69], v[112:113]
    v_add_f32 v66, v66, v67
    v_add_f32 v68, v68, v69
    v_rcp_f32 v66, v66
    v_rcp_f32 v68, v68
    v_pk_mul_f32 v[72:73], v[72:73], v[66:67] op_sel_hi:[1,0]
    v_pk_mul_f32 v[74:75], v[74:75], v[66:67] op_sel_hi:[1,0]
    v_pk_mul_f32 v[76:77], v[76:77], v[66:67] op_sel_hi:[1,0]
    v_pk_mul_f32 v[78:79], v[78:79], v[66:67] op_sel_hi:[1,0]
    v_pk_mul_f32 v[80:81], v[80:81], v[66:67] op_sel_hi:[1,0]
    v_pk_mul_f32 v[82:83], v[82:83], v[66:67] op_sel_hi:[1,0]
    v_pk_mul_f32 v[84:85], v[84:85], v[66:67] op_sel_hi:[1,0]
    v_pk_mul_f32 v[86:87], v[86:87], v[66:67] op_sel_hi:[1,0]
    v_pk_mul_f32 v[88:89], v[88:89], v[66:67] op_sel_hi:[1,0]
    v_cvt_pk_bf16_f32 v136, v72, v73
    v_cvt_pk_bf16_f32 v137, v74, v75
    v_cvt_pk_bf16_f32 v138, v76, v77
    v_cvt_pk_bf16_f32 v139, v78, v79
    v_cvt_pk_bf16_f32 v140, v80, v81
    v_cvt_pk_bf16_f32 v141, v82, v83
    v_cvt_pk_bf16_f32 v142, v84, v85
    v_cvt_pk_bf16_f32 v143, v86, v87
    v_cvt_pk_bf16_f32 v144, v88, v89
    ds_write_b128 v244, v[136:139] offset:0
    ds_write_b128 v244, v[140:143] offset:16
    v_pk_mul_f32 v[96:97], v[96:97], v[68:69] op_sel_hi:[1,0]
    v_pk_mul_f32 v[98:99], v[98:99], v[68:69] op_sel_hi:[1,0]
    v_pk_mul_f32 v[100:101], v[100:101], v[68:69] op_sel_hi:[1,0]
    v_pk_mul_f32 v[102:103], v[102:103], v[68:69] op_sel_hi:[1,0]
    v_pk_mul_f32 v[104:105], v[104:105], v[68:69] op_sel_hi:[1,0]
    v_pk_mul_f32 v[106:107], v[106:107], v[68:69] op_sel_hi:[1,0]
    v_pk_mul_f32 v[108:109], v[108:109], v[68:69] op_sel_hi:[1,0]
    v_pk_mul_f32 v[110:111], v[110:111], v[68:69] op_sel_hi:[1,0]
    v_pk_mul_f32 v[112:113], v[112:113], v[68:69] op_sel_hi:[1,0]
    v_cvt_pk_bf16_f32 v145, v96, v97
    v_cvt_pk_bf16_f32 v146, v98, v99
    v_cvt_pk_bf16_f32 v147, v100, v101
    v_cvt_pk_bf16_f32 v148, v102, v103
    v_cvt_pk_bf16_f32 v149, v104, v105
    v_cvt_pk_bf16_f32 v150, v106, v107
    v_cvt_pk_bf16_f32 v151, v108, v109
    v_cvt_pk_bf16_f32 v152, v110, v111
    v_cvt_pk_bf16_f32 v153, v112, v113
    ds_write_b128 v244, v[144:147] offset:4096
    ds_write_b128 v244, v[148:151] offset:4112
    ds_write_b64 v245, v[152:153] offset:0
    v_max3_f32 v64, v116, v117, v118
    v_min3_f32 v65, v116, v117, v118
    v_max3_f32 v64, v64, v119, v120
    v_min3_f32 v65, v65, v119, v120
    v_max3_f32 v64, v64, v121, v122
    v_min3_f32 v65, v65, v121, v122
    v_max3_f32 v64, v64, v123, v124
    v_min3_f32 v65, v65, v123, v124
    v_max3_f32 v64, v64, v125, v126
    v_min3_f32 v65, v65, v125, v126
    v_max3_f32 v64, v64, v127, v128
    v_min3_f32 v65, v65, v127, v128
    v_max3_f32 v64, v64, v129, v130
    v_min3_f32 v65, v65, v129, v130
    v_max3_f32 v64, v64, v131, v132
    v_min3_f32 v65, v65, v131, v132
    v_max_f32 v64, v64, v133
    v_min_f32 v65, v65, v133
    v_pk_mul_f32 v[64:65], v[64:65], v[2:3] op_sel:[0,1] op_sel_hi:[1,1]
    v_pk_fma_f32 v[72:73], v[116:117], v[2:3], v[64:65] op_sel:[0,1,0] op_sel_hi:[1,1,0] neg_lo:[0,0,1] neg_hi:[0,0,1]
    v_pk_fma_f32 v[74:75], v[118:119], v[2:3], v[64:65] op_sel:[0,1,0] op_sel_hi:[1,1,0] neg_lo:[0,0,1] neg_hi:[0,0,1]
    v_pk_fma_f32 v[76:77], v[120:121], v[2:3], v[64:65] op_sel:[0,1,0] op_sel_hi:[1,1,0] neg_lo:[0,0,1] neg_hi:[0,0,1]
    v_pk_fma_f32 v[78:79], v[122:123], v[2:3], v[64:65] op_sel:[0,1,0] op_sel_hi:[1,1,0] neg_lo:[0,0,1] neg_hi:[0,0,1]
    v_pk_fma_f32 v[80:81], v[124:125], v[2:3], v[64:65] op_sel:[0,1,0] op_sel_hi:[1,1,0] neg_lo:[0,0,1] neg_hi:[0,0,1]
    v_pk_fma_f32 v[82:83], v[126:127], v[2:3], v[64:65] op_sel:[0,1,0] op_sel_hi:[1,1,0] neg_lo:[0,0,1] neg_hi:[0,0,1]
    v_pk_fma_f32 v[84:85], v[128:129], v[2:3], v[64:65] op_sel:[0,1,0] op_sel_hi:[1,1,0] neg_lo:[0,0,1] neg_hi:[0,0,1]
    v_pk_fma_f32 v[86:87], v[130:131], v[2:3], v[64:65] op_sel:[0,1,0] op_sel_hi:[1,1,0] neg_lo:[0,0,1] neg_hi:[0,0,1]
    v_pk_fma_f32 v[88:89], v[132:133], v[2:3], v[64:65] op_sel:[0,1,0] op_sel_hi:[1,1,0] neg_lo:[0,0,1] neg_hi:[0,0,1]
    v_pk_fma_f32 v[116:117], v[116:117], v[2:3], v[64:65] op_sel:[0,1,1] op_sel_hi:[1,1,1] neg_lo:[1,0,0] neg_hi:[1,0,0]
    v_pk_fma_f32 v[118:119], v[118:119], v[2:3], v[64:65] op_sel:[0,1,1] op_sel_hi:[1,1,1] neg_lo:[1,0,0] neg_hi:[1,0,0]
    v_pk_fma_f32 v[120:121], v[120:121], v[2:3], v[64:65] op_sel:[0,1,1] op_sel_hi:[1,1,1] neg_lo:[1,0,0] neg_hi:[1,0,0]
    v_pk_fma_f32 v[122:123], v[122:123], v[2:3], v[64:65] op_sel:[0,1,1] op_sel_hi:[1,1,1] neg_lo:[1,0,0] neg_hi:[1,0,0]
    v_pk_fma_f32 v[124:125], v[124:125], v[2:3], v[64:65] op_sel:[0,1,1] op_sel_hi:[1,1,1] neg_lo:[1,0,0] neg_hi:[1,0,0]
    v_pk_fma_f32 v[126:127], v[126:127], v[2:3], v[64:65] op_sel:[0,1,1] op_sel_hi:[1,1,1] neg_lo:[1,0,0] neg_hi:[1,0,0]
    v_pk_fma_f32 v[128:129], v[128:129], v[2:3], v[64:65] op_sel:[0,1,1] op_sel_hi:[1,1,1] neg_lo:[1,0,0] neg_hi:[1,0,0]
    v_pk_fma_f32 v[130:131], v[130:131], v[2:3], v[64:65] op_sel:[0,1,1] op_sel_hi:[1,1,1] neg_lo:[1,0,0] neg_hi:[1,0,0]
    v_pk_fma_f32 v[132:133], v[132:133], v[2:3], v[64:65] op_sel:[0,1,1] op_sel_hi:[1,1,1] neg_lo:[1,0,0] neg_hi:[1,0,0]
    v_exp_f32 v72, v72
    v_exp_f32 v73, v73
    v_exp_f32 v74, v74
    v_exp_f32 v75, v75
    v_exp_f32 v76, v76
    v_exp_f32 v77, v77
    v_exp_f32 v78, v78
    v_exp_f32 v79, v79
    v_exp_f32 v80, v80
    v_exp_f32 v81, v81
    v_exp_f32 v82, v82
    v_exp_f32 v83, v83
    v_exp_f32 v84, v84
    v_exp_f32 v85, v85
    v_exp_f32 v86, v86
    v_exp_f32 v87, v87
    v_exp_f32 v88, v88
    v_exp_f32 v89, v89
    v_exp_f32 v116, v116
    v_exp_f32 v117, v117
    v_exp_f32 v118, v118
    v_exp_f32 v119, v119
    v_exp_f32 v120, v120
    v_exp_f32 v121, v121
    v_exp_f32 v122, v122
    v_exp_f32 v123, v123
    v_exp_f32 v124, v124
    v_exp_f32 v125, v125
    v_exp_f32 v126, v126
    v_exp_f32 v127, v127
    v_exp_f32 v128, v128
    v_exp_f32 v129, v129
    v_exp_f32 v130, v130
    v_exp_f32 v131, v131
    v_exp_f32 v132, v132
    v_exp_f32 v133, v133
    v_pk_add_f32 v[66:67], v[72:73], v[74:75]
    v_pk_add_f32 v[68:69], v[116:117], v[118:119]
    v_pk_add_f32 v[66:67], v[66:67], v[76:77]
    v_pk_add_f32 v[68:69], v[68:69], v[120:121]
    v_pk_add_f32 v[66:67], v[66:67], v[78:79]
    v_pk_add_f32 v[68:69], v[68:69], v[122:123]
    v_pk_add_f32 v[66:67], v[66:67], v[80:81]
    v_pk_add_f32 v[68:69], v[68:69], v[124:125]
    v_pk_add_f32 v[66:67], v[66:67], v[82:83]
    v_pk_add_f32 v[68:69], v[68:69], v[126:127]
    v_pk_add_f32 v[66:67], v[66:67], v[84:85]
    v_pk_add_f32 v[68:69], v[68:69], v[128:129]
    v_pk_add_f32 v[66:67], v[66:67], v[86:87]
    v_pk_add_f32 v[68:69], v[68:69], v[130:131]
    v_pk_add_f32 v[66:67], v[66:67], v[88:89]
    v_pk_add_f32 v[68:69], v[68:69], v[132:133]
    v_add_f32 v66, v66, v67
    v_add_f32 v68, v68, v69
    v_rcp_f32 v66, v66
    v_rcp_f32 v68, v68
    v_pk_mul_f32 v[72:73], v[72:73], v[66:67] op_sel_hi:[1,0]
    v_pk_mul_f32 v[74:75], v[74:75], v[66:67] op_sel_hi:[1,0]
    v_pk_mul_f32 v[76:77], v[76:77], v[66:67] op_sel_hi:[1,0]
    v_pk_mul_f32 v[78:79], v[78:79], v[66:67] op_sel_hi:[1,0]
    v_pk_mul_f32 v[80:81], v[80:81], v[66:67] op_sel_hi:[1,0]
    v_pk_mul_f32 v[82:83], v[82:83], v[66:67] op_sel_hi:[1,0]
    v_pk_mul_f32 v[84:85], v[84:85], v[66:67] op_sel_hi:[1,0]
    v_pk_mul_f32 v[86:87], v[86:87], v[66:67] op_sel_hi:[1,0]
    v_pk_mul_f32 v[88:89], v[88:89], v[66:67] op_sel_hi:[1,0]
    v_cvt_pk_bf16_f32 v156, v72, v73
    v_cvt_pk_bf16_f32 v157, v74, v75
    v_cvt_pk_bf16_f32 v158, v76, v77
    v_cvt_pk_bf16_f32 v159, v78, v79
    v_cvt_pk_bf16_f32 v160, v80, v81
    v_cvt_pk_bf16_f32 v161, v82, v83
    v_cvt_pk_bf16_f32 v162, v84, v85
    v_cvt_pk_bf16_f32 v163, v86, v87
    v_cvt_pk_bf16_f32 v164, v88, v89
    ds_write_b128 v244, v[156:159] offset:512
    ds_write_b128 v244, v[160:163] offset:528
    v_pk_mul_f32 v[116:117], v[116:117], v[68:69] op_sel_hi:[1,0]
    v_pk_mul_f32 v[118:119], v[118:119], v[68:69] op_sel_hi:[1,0]
    v_pk_mul_f32 v[120:121], v[120:121], v[68:69] op_sel_hi:[1,0]
    v_pk_mul_f32 v[122:123], v[122:123], v[68:69] op_sel_hi:[1,0]
    v_pk_mul_f32 v[124:125], v[124:125], v[68:69] op_sel_hi:[1,0]
    v_pk_mul_f32 v[126:127], v[126:127], v[68:69] op_sel_hi:[1,0]
    v_pk_mul_f32 v[128:129], v[128:129], v[68:69] op_sel_hi:[1,0]
    v_pk_mul_f32 v[130:131], v[130:131], v[68:69] op_sel_hi:[1,0]
    v_pk_mul_f32 v[132:133], v[132:133], v[68:69] op_sel_hi:[1,0]
    v_cvt_pk_bf16_f32 v165, v116, v117
    v_cvt_pk_bf16_f32 v166, v118, v119
    v_cvt_pk_bf16_f32 v167, v120, v121
    v_cvt_pk_bf16_f32 v168, v122, v123
    v_cvt_pk_bf16_f32 v169, v124, v125
    v_cvt_pk_bf16_f32 v170, v126, v127
    v_cvt_pk_bf16_f32 v171, v128, v129
    v_cvt_pk_bf16_f32 v172, v130, v131
    v_cvt_pk_bf16_f32 v173, v132, v133
    ds_write_b128 v244, v[164:167] offset:4608
    ds_write_b128 v244, v[168:171] offset:4624
    ds_write_b64 v245, v[172:173] offset:128
    s_waitcnt lgkmcnt(0)
    s_barrier
    ds_read_b64_tr_b16 v[44:45], v249 offset:0
    ds_read_b64_tr_b16 v[32:33], v248 offset:0
    ds_read_b64_tr_b16 v[46:47], v249 offset:512
    ds_read_b64_tr_b16 v[34:35], v248 offset:512
    ds_read_b64_tr_b16 v[48:49], v251 offset:4096
    ds_read_b64_tr_b16 v[36:37], v248 offset:4096
    ds_read_b64_tr_b16 v[50:51], v251 offset:4224
    ds_read_b64_tr_b16 v[38:39], v248 offset:4608
    ds_read_b64_tr_b16 v[40:41], v250 offset:8192
    ds_read_b64_tr_b16 v[42:43], v250 offset:8320
    ds_read_b64_tr_b16 v[64:65], v249 offset:1024
    ds_read_b64_tr_b16 v[52:53], v248 offset:1024
    ds_read_b64_tr_b16 v[66:67], v249 offset:1536
    ds_read_b64_tr_b16 v[54:55], v248 offset:1536
    ds_read_b64_tr_b16 v[68:69], v251 offset:4352
    ds_read_b64_tr_b16 v[56:57], v248 offset:5120
    ds_read_b64_tr_b16 v[70:71], v251 offset:4480
    ds_read_b64_tr_b16 v[58:59], v248 offset:5632
    ds_read_b64_tr_b16 v[60:61], v250 offset:8448
    ds_read_b64_tr_b16 v[62:63], v250 offset:8576
    s_waitcnt lgkmcnt(15)
    v_mfma_f32_16x16x32_bf16 v[112:115], v[32:35], v[44:47], 0
    s_waitcnt lgkmcnt(13)
    v_mfma_f32_16x16x32_bf16 v[116:119], v[32:35], v[48:51], 0
    s_waitcnt lgkmcnt(12)
    v_mfma_f32_16x16x32_bf16 v[120:123], v[36:39], v[44:47], 0
    v_mfma_f32_16x16x32_bf16 v[124:127], v[36:39], v[48:51], 0
    s_waitcnt lgkmcnt(10)
    v_mfma_f32_16x16x32_bf16 v[128:131], v[40:43], v[44:47], 0
    v_mfma_f32_16x16x32_bf16 v[132:135], v[40:43], v[48:51], 0
    ds_read_b64_tr_b16 v[84:85], v249 offset:2048
    ds_read_b64_tr_b16 v[72:73], v248 offset:2048
    ds_read_b64_tr_b16 v[86:87], v249 offset:2560
    ds_read_b64_tr_b16 v[74:75], v248 offset:2560
    ds_read_b64_tr_b16 v[88:89], v251 offset:4608
    ds_read_b64_tr_b16 v[76:77], v248 offset:6144
    ds_read_b64_tr_b16 v[90:91], v251 offset:4736
    ds_read_b64_tr_b16 v[78:79], v248 offset:6656
    ds_read_b64_tr_b16 v[80:81], v250 offset:8704
    ds_read_b64_tr_b16 v[82:83], v250 offset:8832
    s_waitcnt lgkmcnt(15)
    v_mfma_f32_16x16x32_bf16 v[112:115], v[52:55], v[64:67], v[112:115]
    s_waitcnt lgkmcnt(13)
    v_mfma_f32_16x16x32_bf16 v[116:119], v[52:55], v[68:71], v[116:119]
    s_waitcnt lgkmcnt(12)
    v_mfma_f32_16x16x32_bf16 v[120:123], v[56:59], v[64:67], v[120:123]
    v_mfma_f32_16x16x32_bf16 v[124:127], v[56:59], v[68:71], v[124:127]
    s_waitcnt lgkmcnt(10)
    v_mfma_f32_16x16x32_bf16 v[128:131], v[60:63], v[64:67], v[128:131]
    v_mfma_f32_16x16x32_bf16 v[132:135], v[60:63], v[68:71], v[132:135]
    ds_read_b64_tr_b16 v[104:105], v249 offset:3072
    ds_read_b64_tr_b16 v[92:93], v248 offset:3072
    ds_read_b64_tr_b16 v[106:107], v249 offset:3584
    ds_read_b64_tr_b16 v[94:95], v248 offset:3584
    ds_read_b64_tr_b16 v[108:109], v251 offset:4864
    ds_read_b64_tr_b16 v[96:97], v248 offset:7168
    ds_read_b64_tr_b16 v[110:111], v251 offset:4992
    ds_read_b64_tr_b16 v[98:99], v248 offset:7680
    ds_read_b64_tr_b16 v[100:101], v250 offset:8960
    ds_read_b64_tr_b16 v[102:103], v250 offset:9088
    s_waitcnt lgkmcnt(15)
    v_mfma_f32_16x16x32_bf16 v[112:115], v[72:75], v[84:87], v[112:115]
    s_waitcnt lgkmcnt(13)
    v_mfma_f32_16x16x32_bf16 v[116:119], v[72:75], v[88:91], v[116:119]
    s_waitcnt lgkmcnt(12)
    v_mfma_f32_16x16x32_bf16 v[120:123], v[76:79], v[84:87], v[120:123]
    v_mfma_f32_16x16x32_bf16 v[124:127], v[76:79], v[88:91], v[124:127]
    s_waitcnt lgkmcnt(10)
    v_mfma_f32_16x16x32_bf16 v[128:131], v[80:83], v[84:87], v[128:131]
    v_mfma_f32_16x16x32_bf16 v[132:135], v[80:83], v[88:91], v[132:135]
    v_mov_b32 v1, s55
    v_mov_b32 v3, s55
    v_mov_b32 v5, s55
    v_mov_b32 v7, s55
    v_mov_b32 v9, s55
    v_mov_b32 v11, s55
    v_mov_b32 v13, s55
    v_mov_b32 v15, s55
    v_mov_b32 v17, s55
    v_mov_b32 v19, s55
    v_mov_b32 v21, s55
    v_mov_b32 v23, s55
    s_waitcnt lgkmcnt(6)
    v_mfma_f32_16x16x32_bf16 v[112:115], v[92:95], v[104:107], v[112:115]
    s_waitcnt lgkmcnt(3)
    v_mfma_f32_16x16x32_bf16 v[116:119], v[92:95], v[108:111], v[116:119]
    s_waitcnt lgkmcnt(2)
    v_mfma_f32_16x16x32_bf16 v[120:123], v[96:99], v[104:107], v[120:123]
    v_mfma_f32_16x16x32_bf16 v[124:127], v[96:99], v[108:111], v[124:127]
    s_waitcnt lgkmcnt(0)
    v_mfma_f32_16x16x32_bf16 v[128:131], v[100:103], v[104:107], v[128:131]
    v_mfma_f32_16x16x32_bf16 v[132:135], v[100:103], v[108:111], v[132:135]
    v_cvt_pk_bf16_f32 v0, v112, v113
    v_cvt_pk_bf16_f32 v2, v114, v115
    buffer_store_dwordx4 v[0:3], v252, s[44:47], s59 offen offset:0 sc1
    s_nop 0
    v_cvt_pk_bf16_f32 v8, v120, v121
    v_cvt_pk_bf16_f32 v10, v122, v123
    buffer_store_dwordx4 v[8:11], v252, s[44:47], s59 offen offset:1280 sc1
    s_mov_b64 exec, 0x0000ffff
    v_cvt_pk_bf16_f32 v16, v128, v129
    v_cvt_pk_bf16_f32 v18, v130, v131
    buffer_store_dwordx4 v[16:19], v252, s[44:47], s59 offen offset:2560 sc1
    s_mov_b64 exec, 0x0000000f
    v_cvt_pk_bf16_f32 v20, v132, v133
    v_cvt_pk_bf16_f32 v22, v134, v135
    buffer_store_dwordx4 v[20:23], v252, s[44:47], s59 offen offset:2816 sc1
    s_mov_b32 exec_lo, 0x000f000f
    s_mov_b32 exec_hi, 0x000f000f
    v_cvt_pk_bf16_f32 v4, v116, v117
    v_cvt_pk_bf16_f32 v6, v118, v119
    buffer_store_dwordx4 v[4:7], v252, s[44:47], s59 offen offset:256 sc1
    v_cvt_pk_bf16_f32 v12, v124, v125
    v_cvt_pk_bf16_f32 v14, v126, v127
    buffer_store_dwordx4 v[12:15], v252, s[44:47], s59 offen offset:1536 sc1
    s_mov_b64 exec, -1
    s_barrier
    v_mov_b32 v148, 0x3f803f80
    v_mov_b32 v149, 0x3f803f80
    v_mov_b32 v150, 0x3f803f80
    v_mov_b32 v151, 0x3f803f80
    s_mul_i32 s64, s49, 20736
    v_add_u32 v228, s64, v228
    v_add_u32 v234, 0x00011800, v234
    ds_read_b64_tr_b16 v[32:33], v234 offset:8192
    ds_read_b64_tr_b16 v[34:35], v234 offset:10496
    v_add_u32 v228, 0x00011800, v228
    ds_read_b64_tr_b16 v[36:37], v228 offset:8224
    ds_read_b64_tr_b16 v[38:39], v228 offset:10528
    ds_read_b64_tr_b16 v[40:41], v234 offset:12800
    ds_read_b64_tr_b16 v[42:43], v234 offset:15104
    ds_read_b64_tr_b16 v[44:45], v234 offset:17408
    ds_read_b64_tr_b16 v[46:47], v234 offset:19712
    ds_read_b64_tr_b16 v[48:49], v234 offset:22016
    ds_read_b64_tr_b16 v[50:51], v234 offset:24320
    s_waitcnt lgkmcnt(8)
    v_mfma_f32_16x16x32_bf16 v[140:143], v[32:35], v[148:151], 0
    ds_read_b64_tr_b16 v[52:53], v234 offset:26624
    ds_read_b64_tr_b16 v[54:55], v234 offset:28928
    s_add_u32 s66, s3, 0
    s_and_b32 s66, s66, 7
    s_mul_i32 s66, s66, 589824
    s_add_u32 m0, s101, 0x00000000
    s_nop 0
    buffer_load_dwordx4 v241, s[28:31], s66 offen lds
    s_add_u32 m0, s101, 0x000003c0
    s_nop 0
    buffer_load_dwordx4 v241, s[28:31], s66 offen offset:64 lds
    s_waitcnt lgkmcnt(8)
    v_mfma_f32_16x16x32_bf16 v[144:147], v[36:39], v[148:151], 0
    ds_read_b64_tr_b16 v[32:33], v228 offset:12832
    ds_read_b64_tr_b16 v[34:35], v228 offset:15136
    s_waitcnt lgkmcnt(8)
    v_mfma_f32_16x16x32_bf16 v[140:143], v[40:43], v[148:151], v[140:143]
    ds_read_b64_tr_b16 v[36:37], v234 offset:31232
    ds_read_b64_tr_b16 v[38:39], v234 offset:33536
    s_add_u32 s66, s3, 0
    s_and_b32 s66, s66, 7
    s_mul_i32 s66, s66, 589824
    s_mov_b32 exec_hi, 0x00000000
    s_add_u32 m0, s101, 0x00000800
    s_nop 0
    buffer_load_dwordx4 v236, s[28:31], s66 offen lds
    s_mov_b64 exec, -1
    s_waitcnt lgkmcnt(8)
    v_mfma_f32_16x16x32_bf16 v[140:143], v[44:47], v[148:151], v[140:143]
    ds_read_b64_tr_b16 v[40:41], v234 offset:35840
    ds_read_b64_tr_b16 v[42:43], v234 offset:38144
    s_waitcnt lgkmcnt(8)
    v_mfma_f32_16x16x32_bf16 v[140:143], v[48:51], v[148:151], v[140:143]
    ds_read_b64_tr_b16 v[44:45], v234 offset:40448
    ds_read_b64_tr_b16 v[46:47], v234 offset:42752
    s_add_u32 s66, s3, 1
    s_and_b32 s66, s66, 7
    s_mul_i32 s66, s66, 589824
    s_add_u32 m0, s101, 0x00002800
    s_nop 0
    buffer_load_dwordx4 v241, s[28:31], s66 offen lds
    s_add_u32 m0, s101, 0x00002bc0
    s_nop 0
    buffer_load_dwordx4 v241, s[28:31], s66 offen offset:64 lds
    s_waitcnt lgkmcnt(8)
    v_mfma_f32_16x16x32_bf16 v[140:143], v[52:55], v[148:151], v[140:143]
    ds_read_b64_tr_b16 v[48:49], v234 offset:45056
    ds_read_b64_tr_b16 v[50:51], v234 offset:47360
    s_waitcnt lgkmcnt(8)
    v_mfma_f32_16x16x32_bf16 v[144:147], v[32:35], v[148:151], v[144:147]
    ds_read_b64_tr_b16 v[52:53], v228 offset:17440
    ds_read_b64_tr_b16 v[54:55], v228 offset:19744
    s_add_u32 s66, s3, 1
    s_and_b32 s66, s66, 7
    s_mul_i32 s66, s66, 589824
    s_mov_b32 exec_hi, 0x00000000
    s_add_u32 m0, s101, 0x00003000
    s_nop 0
    buffer_load_dwordx4 v236, s[28:31], s66 offen lds
    s_mov_b64 exec, -1
    s_waitcnt lgkmcnt(8)
    v_mfma_f32_16x16x32_bf16 v[140:143], v[36:39], v[148:151], v[140:143]
    ds_read_b64_tr_b16 v[32:33], v234 offset:49664
    ds_read_b64_tr_b16 v[34:35], v234 offset:51968
    s_waitcnt lgkmcnt(8)
    v_mfma_f32_16x16x32_bf16 v[140:143], v[40:43], v[148:151], v[140:143]
    ds_read_b64_tr_b16 v[36:37], v234 offset:54272
    ds_read_b64_tr_b16 v[38:39], v234 offset:56576
    s_add_u32 s66, s3, 2
    s_and_b32 s66, s66, 7
    s_mul_i32 s66, s66, 589824
    s_add_u32 m0, s101, 0x00005000
    s_nop 0
    buffer_load_dwordx4 v241, s[28:31], s66 offen lds
    s_add_u32 m0, s101, 0x000053c0
    s_nop 0
    buffer_load_dwordx4 v241, s[28:31], s66 offen offset:64 lds
    s_waitcnt lgkmcnt(8)
    v_mfma_f32_16x16x32_bf16 v[140:143], v[44:47], v[148:151], v[140:143]
    ds_read_b64_tr_b16 v[40:41], v234 offset:58880
    ds_read_b64_tr_b16 v[42:43], v234 offset:61184
    s_waitcnt lgkmcnt(8)
    v_mfma_f32_16x16x32_bf16 v[140:143], v[48:51], v[148:151], v[140:143]
    ds_read_b64_tr_b16 v[44:45], v234 offset:63488
    v_add_u32 v234, 0x0000e000, v234
    ds_read_b64_tr_b16 v[46:47], v234 offset:8448
    s_add_u32 s66, s3, 2
    s_and_b32 s66, s66, 7
    s_mul_i32 s66, s66, 589824
    s_mov_b32 exec_hi, 0x00000000
    s_add_u32 m0, s101, 0x00005800
    s_nop 0
    buffer_load_dwordx4 v236, s[28:31], s66 offen lds
    s_mov_b64 exec, -1
    s_waitcnt lgkmcnt(8)
    v_mfma_f32_16x16x32_bf16 v[144:147], v[52:55], v[148:151], v[144:147]
    ds_read_b64_tr_b16 v[48:49], v228 offset:22048
    ds_read_b64_tr_b16 v[50:51], v228 offset:24352
    s_waitcnt lgkmcnt(8)
    v_mfma_f32_16x16x32_bf16 v[140:143], v[32:35], v[148:151], v[140:143]
    ds_read_b64_tr_b16 v[52:53], v234 offset:10752
    ds_read_b64_tr_b16 v[54:55], v234 offset:13056
    s_add_u32 s66, s3, 3
    s_and_b32 s66, s66, 7
    s_mul_i32 s66, s66, 589824
    s_add_u32 m0, s101, 0x00007800
    s_nop 0
    buffer_load_dwordx4 v241, s[28:31], s66 offen lds
    s_add_u32 m0, s101, 0x00007bc0
    s_nop 0
    buffer_load_dwordx4 v241, s[28:31], s66 offen offset:64 lds
    s_waitcnt lgkmcnt(8)
    v_mfma_f32_16x16x32_bf16 v[140:143], v[36:39], v[148:151], v[140:143]
    ds_read_b64_tr_b16 v[32:33], v234 offset:15360
    ds_read_b64_tr_b16 v[34:35], v234 offset:17664
    s_waitcnt lgkmcnt(8)
    v_mfma_f32_16x16x32_bf16 v[140:143], v[40:43], v[148:151], v[140:143]
    ds_read_b64_tr_b16 v[36:37], v234 offset:19968
    ds_read_b64_tr_b16 v[38:39], v234 offset:22272
    s_add_u32 s66, s3, 3
    s_and_b32 s66, s66, 7
    s_mul_i32 s66, s66, 589824
    s_mov_b32 exec_hi, 0x00000000
    s_add_u32 m0, s101, 0x00008000
    s_nop 0
    buffer_load_dwordx4 v236, s[28:31], s66 offen lds
    s_mov_b64 exec, -1
    s_waitcnt lgkmcnt(8)
    v_mfma_f32_16x16x32_bf16 v[140:143], v[44:47], v[148:151], v[140:143]
    ds_read_b64_tr_b16 v[40:41], v234 offset:24576
    ds_read_b64_tr_b16 v[42:43], v234 offset:26880
    s_waitcnt lgkmcnt(8)
    v_mfma_f32_16x16x32_bf16 v[144:147], v[48:51], v[148:151], v[144:147]
    ds_read_b64_tr_b16 v[44:45], v228 offset:26656
    s_waitcnt lgkmcnt(7)
    v_mfma_f32_16x16x32_bf16 v[140:143], v[52:55], v[148:151], v[140:143]
    ds_read_b64_tr_b16 v[48:49], v234 offset:29184
    ds_read_b64_tr_b16 v[50:51], v234 offset:31488
    s_waitcnt lgkmcnt(7)
    v_mfma_f32_16x16x32_bf16 v[140:143], v[32:35], v[148:151], v[140:143]
    s_waitcnt lgkmcnt(5)
    v_mfma_f32_16x16x32_bf16 v[140:143], v[36:39], v[148:151], v[140:143]
    s_waitcnt lgkmcnt(3)
    v_mfma_f32_16x16x32_bf16 v[140:143], v[40:43], v[148:151], v[140:143]
    s_waitcnt lgkmcnt(2)
    v_mfma_f32_16x16x16_bf16 v[144:147], v[44:45], v[148:149], v[144:147]
    s_waitcnt lgkmcnt(0)
    v_mfma_f32_16x16x32_bf16 v[140:143], v[48:51], v[148:151], v[140:143]
    v_and_b32 v231, 48, v255
    s_lshl_b32 s64, s49, 6
    s_add_u32 s64, s64, 162816
    v_add_u32 v231, s64, v231
    s_mov_b32 exec_lo, 0x00010001
    s_mov_b32 exec_hi, 0x00010001
    s_nop 1
    ds_write_b128 v231, v[140:143]
    ds_write_b128 v231, v[144:147] offset:256
    s_mov_b64 exec, -1
    v_lshlrev_b32 v230, 8, v255
    s_lshl_b32 s64, s57, 12
    s_lshl_b32 s65, s56, 2
    s_add_u32 s64, s64, s65
    s_add_u32 s69, s64, 217088
    s_mul_i32 s68, s58, 49152
    s_add_u32 s68, s68, 1572864
    v_mov_b32 v64, 0
    v_mov_b32 v65, 0
    v_mov_b32 v66, 0
    v_mov_b32 v67, 0
    v_mov_b32 v68, 0
    v_mov_b32 v69, 0
    v_mov_b32 v70, 0
    v_mov_b32 v71, 0
    v_mov_b32 v72, 0
    v_mov_b32 v73, 0
    v_mov_b32 v74, 0
    v_mov_b32 v75, 0
    v_mov_b32 v76, 0
    v_mov_b32 v77, 0
    v_mov_b32 v78, 0
    v_mov_b32 v79, 0
    s_mov_b32 exec_lo, 0x00ffffff
    s_mov_b32 exec_hi, 0x00ffffff
    buffer_atomic_add_x2 v[64:65], v226, s[44:47], s68 offen offset:0 sc0
    buffer_atomic_add_x2 v[66:67], v226, s[44:47], s68 offen offset:3072 sc0
    s_add_u32 s68, s68, 6144
    buffer_atomic_add_x2 v[68:69], v226, s[44:47], s68 offen offset:0 sc0
    buffer_atomic_add_x2 v[70:71], v226, s[44:47], s68 offen offset:3072 sc0
    s_add_u32 s68, s68, 6144
    buffer_atomic_add_x2 v[72:73], v226, s[44:47], s68 offen offset:0 sc0
    buffer_atomic_add_x2 v[74:75], v226, s[44:47], s68 offen offset:3072 sc0
    s_add_u32 s68, s68, 6144
    buffer_atomic_add_x2 v[76:77], v226, s[44:47], s68 offen offset:0 sc0
    buffer_atomic_add_x2 v[78:79], v226, s[44:47], s68 offen offset:3072 sc0
    s_mov_b64 exec, -1
    s_add_u32 s66, s3, 4
    s_and_b32 s66, s66, 7
    s_mul_i32 s66, s66, 589824
    s_add_u32 m0, s101, 0x0000a000
    s_nop 0
    buffer_load_dwordx4 v241, s[28:31], s66 offen lds
    s_add_u32 m0, s101, 0x0000a3c0
    s_nop 0
    buffer_load_dwordx4 v241, s[28:31], s66 offen offset:64 lds
    s_add_u32 s66, s3, 4
    s_and_b32 s66, s66, 7
    s_mul_i32 s66, s66, 589824
    s_mov_b32 exec_hi, 0x00000000
    s_add_u32 m0, s101, 0x0000a800
    s_nop 0
    buffer_load_dwordx4 v236, s[28:31], s66 offen lds
    s_mov_b64 exec, -1
    s_add_u32 s66, s3, 5
    s_and_b32 s66, s66, 7
    s_mul_i32 s66, s66, 589824
    s_add_u32 m0, s101, 0x0000c800
    s_nop 0
    buffer_load_dwordx4 v241, s[28:31], s66 offen lds
    s_add_u32 m0, s101, 0x0000cbc0
    s_nop 0
    buffer_load_dwordx4 v241, s[28:31], s66 offen offset:64 lds
    s_add_u32 s66, s3, 5
    s_and_b32 s66, s66, 7
    s_mul_i32 s66, s66, 589824
    s_mov_b32 exec_hi, 0x00000000
    s_add_u32 m0, s101, 0x0000d000
    s_nop 0
    buffer_load_dwordx4 v236, s[28:31], s66 offen lds
    s_mov_b64 exec, -1
    s_add_u32 s66, s3, 6
    s_and_b32 s66, s66, 7
    s_mul_i32 s66, s66, 589824
    s_add_u32 m0, s101, 0x0000f000
    s_nop 0
    buffer_load_dwordx4 v241, s[28:31], s66 offen lds
    s_add_u32 m0, s101, 0x0000f3c0
    s_nop 0
    buffer_load_dwordx4 v241, s[28:31], s66 offen offset:64 lds
    s_add_u32 s66, s3, 6
    s_and_b32 s66, s66, 7
    s_mul_i32 s66, s66, 589824
    s_mov_b32 exec_hi, 0x00000000
    s_add_u32 m0, s101, 0x0000f800
    s_nop 0
    buffer_load_dwordx4 v236, s[28:31], s66 offen lds
    s_mov_b64 exec, -1
    s_lshl_b32 s64, s52, 2
    s_add_u32 s64, s64, s54
    s_lshl_b32 s64, s64, 3
    s_add_u32 s64, s64, s48
    s_lshl_b32 s42, s64, 5
    s_add_u32 s42, s42, s53
    s_lshl_b32 s42, s42, 2
    s_add_u32 s42, s42, 512000
    s_lshl_b32 s40, s54, 7
    s_add_u32 s40, s40, s1
    s_lshl_b32 s41, s54, 2
    s_add_u32 s41, s41, s1
    s_mov_b32 s43, 0
    v_add_u32 v251, 18432, v254
    v_lshlrev_b32 v252, 3, v255
    v_add_u32 v253, 18432, v252
    v_lshrrev_b32 v247, 2, v255
    v_lshlrev_b32 v232, 6, v247
    v_and_b32 v247, 3, v255
    v_lshl_add_u32 v232, v247, 3, v232
    v_and_b32 v247, 16, v255
    v_lshl_add_u32 v232, v247, 1, v232
    v_xor_b32 v233, 32, v232
    v_lshlrev_b32 v234, 3, v255
    v_lshrrev_b32 v248, 2, v255
    v_mul_u32_u24 v248, 9216, v248
    v_lshrrev_b32 v247, 3, v255
    v_and_b32 v247, 2, v247
    v_xor_b32 v247, v247, v255
    v_and_b32 v247, 3, v247
    v_lshl_add_u32 v235, v247, 4, v248
    s_mul_i32 s64, s53, 1152
    s_add_u32 s64, s64, 4718592
    s_lshl_b32 s65, s54, 8
    s_add_u32 s65, s65, s64
    v_add_u32 v235, s65, v235
    s_waitcnt lgkmcnt(0)
    s_barrier
    s_cmp_eq_u32 s56, 15
    s_cbranch_scc1 L_nored_62
    s_mov_b32 s62, 0
    s_mov_b32 exec_lo, 0x00ffffff
    s_mov_b32 exec_hi, 0x00ffffff
    s_waitcnt vmcnt(9)
L_red_63:
    s_mov_b64 s[70:71], 0
    v_cmp_ne_u32 vcc, s55, v65
    v_lshlrev_b32 v24, 16, v64
    v_and_b32 v25, 0xffff0000, v64
    s_or_b64 s[70:71], s[70:71], vcc
    v_cmp_ne_u32 vcc, s55, v67
    v_lshlrev_b32 v28, 16, v66
    v_and_b32 v29, 0xffff0000, v66
    v_add_f32 v24, v24, v28
    v_add_f32 v25, v25, v29
    s_or_b64 s[70:71], s[70:71], vcc
    v_cmp_ne_u32 vcc, s55, v69
    v_lshlrev_b32 v28, 16, v68
    v_and_b32 v29, 0xffff0000, v68
    v_add_f32 v24, v24, v28
    v_add_f32 v25, v25, v29
    s_or_b64 s[70:71], s[70:71], vcc
    v_cmp_ne_u32 vcc, s55, v71
    v_lshlrev_b32 v28, 16, v70
    v_and_b32 v29, 0xffff0000, v70
    v_add_f32 v24, v24, v28
    v_add_f32 v25, v25, v29
    s_or_b64 s[70:71], s[70:71], vcc
    v_cmp_ne_u32 vcc, s55, v73
    v_lshlrev_b32 v28, 16, v72
    v_and_b32 v29, 0xffff0000, v72
    v_add_f32 v24, v24, v28
    v_add_f32 v25, v25, v29
    s_or_b64 s[70:71], s[70:71], vcc
    v_cmp_ne_u32 vcc, s55, v75
    v_lshlrev_b32 v28, 16, v74
    v_and_b32 v29, 0xffff0000, v74
    v_add_f32 v24, v24, v28
    v_add_f32 v25, v25, v29
    s_or_b64 s[70:71], s[70:71], vcc
    v_cmp_ne_u32 vcc, s55, v77
    v_lshlrev_b32 v28, 16, v76
    v_and_b32 v29, 0xffff0000, v76
    v_add_f32 v24, v24, v28
    v_add_f32 v25, v25, v29
    s_or_b64 s[70:71], s[70:71], vcc
    v_cmp_ne_u32 vcc, s55, v79
    v_lshlrev_b32 v28, 16, v78
    v_and_b32 v29, 0xffff0000, v78
    v_add_f32 v24, v24, v28
    v_add_f32 v25, v25, v29
    s_or_b64 s[70:71], s[70:71], vcc
    s_cbranch_scc1 L_redo_65
L_redok_64:
    s_mov_b64 exec, -1
    v_mov_b32 v26, v24
    v_mov_b32 v27, v25
    s_nop 0
    v_permlane32_swap_b32 v24, v26
    v_permlane32_swap_b32 v25, v27
    v_add_f32 v24, v24, v26
    v_add_f32 v25, v25, v27
    v_cvt_pk_bf16_f32 v24, v24, v25
    s_lshl_b32 s68, s57, 7
    s_add_u32 s68, s68, s49
    s_lshl_b32 s68, s68, 6
    s_add_u32 s68, s68, 544768
    s_mov_b64 exec, 0x00ffffff
    buffer_store_dword v24, v227, s[44:47], s68 offen sc1
L_nored_62:
    s_mov_b64 exec, -1
    s_waitcnt lgkmcnt(0)
    s_add_u32 s66, s3, 7
    s_and_b32 s66, s66, 7
    s_mul_i32 s66, s66, 589824
    s_add_u32 m0, s101, 0x00011800
    s_nop 0
    buffer_load_dwordx4 v241, s[28:31], s66 offen lds
    s_add_u32 m0, s101, 0x00011bc0
    s_nop 0
    buffer_load_dwordx4 v241, s[28:31], s66 offen offset:64 lds
    s_add_u32 s66, s3, 7
    s_and_b32 s66, s66, 7
    s_mul_i32 s66, s66, 589824
    s_mov_b32 exec_hi, 0x00000000
    s_add_u32 m0, s101, 0x00012000
    s_nop 0
    buffer_load_dwordx4 v236, s[28:31], s66 offen lds
    s_mov_b64 exec, -1
    s_mov_b32 s66, 4718592
    s_add_u32 m0, s101, 0x00014000
    s_nop 0
    buffer_load_dwordx4 v241, s[28:31], s66 offen lds
    s_add_u32 m0, s101, 0x000143c0
    s_nop 0
    buffer_load_dwordx4 v241, s[28:31], s66 offen offset:64 lds
    s_mov_b32 s66, 4718592
    s_mov_b32 exec_hi, 0x00000000
    s_add_u32 m0, s101, 0x00014800
    s_nop 0
    buffer_load_dwordx4 v236, s[28:31], s66 offen lds
    s_mov_b64 exec, -1
    v_mov_b32 v30, 163584
    v_mov_b32 v31, 1
    s_waitcnt vmcnt(6)
    s_mov_b64 exec, 0x00000001
    ds_add_rtn_u32 v31, v30, v31
    s_mov_b64 exec, -1
    s_waitcnt lgkmcnt(0)
    v_readfirstlane_b32 s64, v31
    s_nop 1
    s_cmp_lg_u32 s64, 3
    s_cbranch_scc1 L_nok2_66
    v_mov_b32 v231, s55
    s_mov_b64 exec, 0x0000ffff
    buffer_atomic_swap v231, v230, s[44:47], s69 offen
    s_mov_b64 exec, -1
L_nok2_66:
    s_getpc_b64 s[70:71]
L_pc_67:
    s_lshl_b32 s64, s51, 3
    s_add_u32 s64, s64, s48
    s_mul_i32 s64, s64, 192
    s_sub_u32 s70, s70, L_pc_67-parallel_sum__linear_kernel_hedgehog__mixer_s_mlp__prompt_kernel
    s_subb_u32 s71, s71, 0
    s_add_u32 s64, s64, L_S34-parallel_sum__linear_kernel_hedgehog__mixer_s_mlp__prompt_kernel
    s_min_u32 s64, s64, L_code_end-parallel_sum__linear_kernel_hedgehog__mixer_s_mlp__prompt_kernel-192
    s_load_dword s62, s[70:71], s64 offset:0
    s_load_dword s62, s[70:71], s64 offset:64
    s_load_dword s62, s[70:71], s64 offset:128
    s_add_u32 s66, s3, 0
    s_and_b32 s66, s66, 7
    s_mul_i32 s66, s66, 589824
    s_add_u32 m0, s67, 0x00016780
    s_nop 0
    buffer_load_dwordx4 v241, s[28:31], s66 offen offset:128 lds
    s_add_u32 m0, s67, 0x0001f740
    s_nop 0
    buffer_load_dwordx4 v241, s[28:31], s66 offen offset:192 lds
    s_add_u32 s66, s3, 1
    s_and_b32 s66, s66, 7
    s_mul_i32 s66, s66, 589824
    s_add_u32 m0, s67, 0x00017780
    s_nop 0
    buffer_load_dwordx4 v241, s[28:31], s66 offen offset:128 lds
    s_add_u32 m0, s67, 0x00020740
    s_nop 0
    buffer_load_dwordx4 v241, s[28:31], s66 offen offset:192 lds
    s_add_u32 s66, s3, 2
    s_and_b32 s66, s66, 7
    s_mul_i32 s66, s66, 589824
    s_add_u32 m0, s67, 0x00018780
    s_nop 0
    buffer_load_dwordx4 v241, s[28:31], s66 offen offset:128 lds
    s_add_u32 m0, s67, 0x00021740
    s_nop 0
    buffer_load_dwordx4 v241, s[28:31], s66 offen offset:192 lds
    s_add_u32 s66, s3, 3
    s_and_b32 s66, s66, 7
    s_mul_i32 s66, s66, 589824
    s_add_u32 m0, s67, 0x00019780
    s_nop 0
    buffer_load_dwordx4 v241, s[28:31], s66 offen offset:128 lds
    s_add_u32 m0, s67, 0x00022740
    s_nop 0
    buffer_load_dwordx4 v241, s[28:31], s66 offen offset:192 lds
    s_add_u32 s66, s3, 4
    s_and_b32 s66, s66, 7
    s_mul_i32 s66, s66, 589824
    s_add_u32 m0, s67, 0x0001a780
    s_nop 0
    buffer_load_dwordx4 v241, s[28:31], s66 offen offset:128 lds
    s_add_u32 m0, s67, 0x00023740
    s_nop 0
    buffer_load_dwordx4 v241, s[28:31], s66 offen offset:192 lds
    s_add_u32 s66, s3, 5
    s_and_b32 s66, s66, 7
    s_mul_i32 s66, s66, 589824
    s_add_u32 m0, s67, 0x0001b780
    s_nop 0
    buffer_load_dwordx4 v241, s[28:31], s66 offen offset:128 lds
    s_add_u32 m0, s67, 0x00024740
    s_nop 0
    buffer_load_dwordx4 v241, s[28:31], s66 offen offset:192 lds
    s_add_u32 s66, s3, 6
    s_and_b32 s66, s66, 7
    s_mul_i32 s66, s66, 589824
    s_add_u32 m0, s67, 0x0001c780
    s_nop 0
    buffer_load_dwordx4 v241, s[28:31], s66 offen offset:128 lds
    s_add_u32 m0, s67, 0x00025740
    s_nop 0
    buffer_load_dwordx4 v241, s[28:31], s66 offen offset:192 lds
    s_add_u32 s66, s3, 7
    s_and_b32 s66, s66, 7
    s_mul_i32 s66, s66, 589824
    s_add_u32 m0, s67, 0x0001d780
    s_nop 0
    buffer_load_dwordx4 v241, s[28:31], s66 offen offset:128 lds
    s_add_u32 m0, s67, 0x00026740
    s_nop 0
    buffer_load_dwordx4 v241, s[28:31], s66 offen offset:192 lds
    s_mov_b32 s66, 4718592
    s_add_u32 m0, s67, 0x0001e780
    s_nop 0
    buffer_load_dwordx4 v241, s[28:31], s66 offen offset:128 lds
    s_branch L_SO
L_AY2:
    s_cmp_lg_u32 s49, 1
    s_cbranch_scc1 L_nowarm_68
    s_and_b32 s64, s2, 127
    s_mul_i32 s64, s64, 41
    v_add_u32 v238, s64, v255
    v_mul_u32_u24 v240, 7282, v238
    v_lshrrev_b32 v240, 16, v240
    v_mul_u32_u24 v240, 18, v240
    v_add_u32 v238, v238, v240
    v_lshlrev_b32 v238, 7, v238
    s_mov_b32 exec_hi, 0x000001ff
    buffer_load_dword v240, v238, s[8:11], 0 offen
    s_mov_b64 exec, -1
L_nowarm_68:
    s_load_dwordx2 s[12:13], s[0:1], 16
    s_load_dwordx2 s[16:17], s[0:1], 24
    s_load_dwordx2 s[24:25], s[0:1], 48
    s_load_dwordx2 s[28:29], s[0:1], 56
    s_load_dwordx2 s[32:33], s[0:1], 64
    s_load_dwordx2 s[36:37], s[0:1], 72
    s_load_dwordx2 s[40:41], s[0:1], 80
    s_waitcnt lgkmcnt(0)
    v_bfe_u32 v230, v255, 2, 1
    v_bfe_u32 v231, v255, 5, 1
    v_lshl_add_u32 v230, v231, 1, v230
    v_bfe_u32 v231, v255, 3, 2
    v_lshl_add_u32 v230, v231, 2, v230
    v_mul_u32_u24 v228, 144, v230
    v_and_b32 v230, 1, v255
    v_lshl_add_u32 v228, v230, 5, v228
    v_bfe_u32 v230, v255, 1, 1
    v_mul_u32_u24 v230, 72, v230
    v_add_u32 v228, v228, v230
    v_and_b32 v230, 15, v255
    v_lshlrev_b32 v229, 6, v230
    v_lshrrev_b32 v230, 2, v255
    v_and_b32 v230, 2, v230
    v_lshrrev_b32 v231, 4, v255
    v_xor_b32 v230, v230, v231
    v_lshl_add_u32 v229, v230, 4, v229
    s_lshl_b32 s64, s49, 11
    v_add_u32 v229, s64, v229
    s_lshl_b32 s64, s49, 3
    v_add_u32 v234, s64, v228
    s_and_b32 s64, s49, 1
    s_mul_i32 s64, s64, 9216
    s_add_u32 s64, s64, 32
    v_add_u32 v235, s64, v228
    v_mov_b32 v196, 0x3f803f80
    v_mov_b32 v197, 0x3f803f80
    v_mov_b32 v198, 0x3f803f80
    v_mov_b32 v199, 0x3f803f80
    v_and_b32 v242, 15, v255
    v_lshlrev_b32 v242, 3, v242
    s_lshl_b32 s64, s49, 8
    s_add_u32 s64, s64, 75776
    v_add_u32 v242, s64, v242
    v_and_b32 v237, 48, v255
    v_add_u32 v237, 76800, v237
    s_add_u32 s67, s94, 1
    s_cmp_ge_u32 s67, 9
    s_cselect_b32 s95, 9, 0
    s_sub_u32 s67, s67, s95
    s_mul_i32 s67, s67, 128
    s_add_u32 m0, s58, 0x0001b400
    s_nop 0
    buffer_load_dwordx4 v224, s[4:7], s67 offen lds
    s_add_u32 m0, s58, 0x0001d3c0
    s_nop 0
    buffer_load_dwordx4 v224, s[4:7], s67 offen offset:64 lds
    s_add_u32 s66, s67, 73728
    s_add_u32 m0, s58, 0x0001c400
    s_nop 0
    buffer_load_dwordx4 v224, s[4:7], s66 offen lds
    s_add_u32 m0, s58, 0x0001e3c0
    s_nop 0
    buffer_load_dwordx4 v224, s[4:7], s66 offen offset:64 lds
    s_mul_i32 s66, s67, 1728
    s_add_u32 s66, s66, 1152
    s_add_u32 m0, s59, 0x00016c00
    s_mov_b32 exec_hi, 0x0000ffff
    buffer_load_dwordx4 v225, s[8:11], s66 offen lds
    s_mov_b64 exec, -1
    s_waitcnt vmcnt(5)
    s_barrier
    s_add_u32 m0, s59, 0x00016f00
    s_mov_b32 exec_hi, 0x0000ffff
    buffer_load_dwordx4 v226, s[8:11], s66 offen lds
    s_mov_b64 exec, -1
    ds_read_b128 v[0:3], v229 offset:53248
    ds_read_b128 v[4:7], v229 offset:54272
    ds_read_b128 v[8:11], v229 offset:61440
    ds_read_b128 v[12:15], v229 offset:62464
    s_add_u32 m0, s59, 0x00017200
    s_mov_b32 exec_hi, 0x0000ffff
    buffer_load_dwordx4 v227, s[8:11], s66 offen lds
    s_mov_b64 exec, -1
    ds_read_b64_tr_b16 v[144:145], v234 offset:34816
    ds_read_b64_tr_b16 v[146:147], v234 offset:37120
    ds_read_b64_tr_b16 v[148:149], v234 offset:44032
    ds_read_b64_tr_b16 v[150:151], v234 offset:46336
    s_add_u32 m0, s59, 0x00018b80
    s_mov_b32 exec_hi, 0x0000ffff
    buffer_load_dwordx4 v225, s[8:11], s66 offen offset:1152 lds
    s_mov_b64 exec, -1
    ds_read_b64_tr_b16 v[152:153], v235 offset:34816
    ds_read_b64_tr_b16 v[154:155], v235 offset:37120
    ds_read_b64_tr_b16 v[156:157], v234 offset:39424
    ds_read_b64_tr_b16 v[158:159], v234 offset:41728
    s_add_u32 m0, s59, 0x00018e80
    s_mov_b32 exec_hi, 0x0000ffff
    buffer_load_dwordx4 v226, s[8:11], s66 offen offset:1152 lds
    s_mov_b64 exec, -1
    ds_read_b64_tr_b16 v[160:161], v234 offset:48640
    ds_read_b64_tr_b16 v[162:163], v234 offset:50944
    ds_read_b64_tr_b16 v[164:165], v235 offset:39424
    ds_read_b64_tr_b16 v[166:167], v235 offset:41728
    s_add_u32 m0, s59, 0x00019180
    s_mov_b32 exec_hi, 0x0000ffff
    buffer_load_dwordx4 v227, s[8:11], s66 offen offset:1152 lds
    s_mov_b64 exec, -1
    s_waitcnt lgkmcnt(10)
    v_mfma_f32_16x16x32_bf16 v[168:171], v[144:147], v[196:199], 0
    s_add_u32 s67, s94, 2
    s_cmp_ge_u32 s67, 9
    s_cselect_b32 s95, 9, 0
    s_sub_u32 s67, s67, s95
    s_mul_i32 s67, s67, 128
    s_add_u32 m0, s58, 0x00023c00
    s_nop 0
    buffer_load_dwordx4 v224, s[4:7], s67 offen lds
    s_waitcnt lgkmcnt(8)
    v_mfma_f32_16x16x32_bf16 v[172:175], v[148:151], v[196:199], 0
    s_add_u32 m0, s58, 0x00025bc0
    s_nop 0
    buffer_load_dwordx4 v224, s[4:7], s67 offen offset:64 lds
    s_waitcnt lgkmcnt(6)
    v_mfma_f32_16x16x32_bf16 v[176:179], v[152:155], v[196:199], 0
    s_add_u32 s66, s67, 73728
    s_add_u32 m0, s58, 0x00024c00
    s_nop 0
    buffer_load_dwordx4 v224, s[4:7], s66 offen lds
    s_waitcnt lgkmcnt(4)
    v_mfma_f32_16x16x32_bf16 v[168:171], v[156:159], v[196:199], v[168:171]
    s_add_u32 m0, s58, 0x00026bc0
    s_nop 0
    buffer_load_dwordx4 v224, s[4:7], s66 offen offset:64 lds
    s_waitcnt lgkmcnt(2)
    v_mfma_f32_16x16x32_bf16 v[172:175], v[160:163], v[196:199], v[172:175]
    s_mul_i32 s66, s67, 1728
    s_add_u32 s66, s66, 1152
    s_add_u32 m0, s59, 0x0001f400
    s_mov_b32 exec_hi, 0x0000ffff
    buffer_load_dwordx4 v225, s[8:11], s66 offen lds
    s_mov_b64 exec, -1
    s_waitcnt lgkmcnt(0)
    v_mfma_f32_16x16x32_bf16 v[176:179], v[164:167], v[196:199], v[176:179]
    s_waitcnt vmcnt(5)
    s_barrier
    s_add_u32 m0, s59, 0x0001f700
    s_mov_b32 exec_hi, 0x0000ffff
    buffer_load_dwordx4 v226, s[8:11], s66 offen lds
    s_mov_b64 exec, -1
    v_add_u32 v229, 0x00019400, v229
    ds_read_b128 v[16:19], v229 offset:8192
    ds_read_b128 v[20:23], v229 offset:9216
    ds_read_b128 v[24:27], v229 offset:16384
    ds_read_b128 v[28:31], v229 offset:17408
    s_add_u32 m0, s59, 0x0001fa00
    s_mov_b32 exec_hi, 0x0000ffff
    buffer_load_dwordx4 v227, s[8:11], s66 offen lds
    s_mov_b64 exec, -1
    v_add_u32 v234, 0x00014c00, v234
    ds_read_b64_tr_b16 v[144:145], v234 offset:8192
    ds_read_b64_tr_b16 v[146:147], v234 offset:10496
    ds_read_b64_tr_b16 v[148:149], v234 offset:17408
    ds_read_b64_tr_b16 v[150:151], v234 offset:19712
    s_add_u32 m0, s59, 0x00021380
    s_mov_b32 exec_hi, 0x0000ffff
    buffer_load_dwordx4 v225, s[8:11], s66 offen offset:1152 lds
    s_mov_b64 exec, -1
    v_add_u32 v235, 0x00014c00, v235
    ds_read_b64_tr_b16 v[152:153], v235 offset:8192
    ds_read_b64_tr_b16 v[154:155], v235 offset:10496
    ds_read_b64_tr_b16 v[156:157], v234 offset:12800
    ds_read_b64_tr_b16 v[158:159], v234 offset:15104
    s_add_u32 m0, s59, 0x00021680
    s_mov_b32 exec_hi, 0x0000ffff
    buffer_load_dwordx4 v226, s[8:11], s66 offen offset:1152 lds
    s_mov_b64 exec, -1
    ds_read_b64_tr_b16 v[160:161], v234 offset:22016
    ds_read_b64_tr_b16 v[162:163], v234 offset:24320
    ds_read_b64_tr_b16 v[164:165], v235 offset:12800
    ds_read_b64_tr_b16 v[166:167], v235 offset:15104
    s_add_u32 m0, s59, 0x00021980
    s_mov_b32 exec_hi, 0x0000ffff
    buffer_load_dwordx4 v227, s[8:11], s66 offen offset:1152 lds
    s_mov_b64 exec, -1
    s_waitcnt lgkmcnt(10)
    v_mfma_f32_16x16x32_bf16 v[168:171], v[144:147], v[196:199], v[168:171]
    s_add_u32 s67, s94, 3
    s_cmp_ge_u32 s67, 9
    s_cselect_b32 s95, 9, 0
    s_sub_u32 s67, s67, s95
    s_mul_i32 s67, s67, 128
    s_add_u32 m0, s58, 0x00004800
    s_nop 0
    buffer_load_dwordx4 v224, s[4:7], s67 offen lds
    s_waitcnt lgkmcnt(8)
    v_mfma_f32_16x16x32_bf16 v[172:175], v[148:151], v[196:199], v[172:175]
    s_add_u32 m0, s58, 0x000067c0
    s_nop 0
    buffer_load_dwordx4 v224, s[4:7], s67 offen offset:64 lds
    s_waitcnt lgkmcnt(6)
    v_mfma_f32_16x16x32_bf16 v[176:179], v[152:155], v[196:199], v[176:179]
    s_add_u32 s66, s67, 73728
    s_add_u32 m0, s58, 0x00005800
    s_nop 0
    buffer_load_dwordx4 v224, s[4:7], s66 offen lds
    s_waitcnt lgkmcnt(4)
    v_mfma_f32_16x16x32_bf16 v[168:171], v[156:159], v[196:199], v[168:171]
    s_add_u32 m0, s58, 0x000077c0
    s_nop 0
    buffer_load_dwordx4 v224, s[4:7], s66 offen offset:64 lds
    s_waitcnt lgkmcnt(2)
    v_mfma_f32_16x16x32_bf16 v[172:175], v[160:163], v[196:199], v[172:175]
    s_mul_i32 s66, s67, 1728
    s_add_u32 s66, s66, 1152
    s_add_u32 m0, s59, 0x00000000
    s_mov_b32 exec_hi, 0x0000ffff
    buffer_load_dwordx4 v225, s[8:11], s66 offen lds
    s_mov_b64 exec, -1
    s_waitcnt lgkmcnt(0)
    v_mfma_f32_16x16x32_bf16 v[176:179], v[164:167], v[196:199], v[176:179]
    s_waitcnt vmcnt(5)
    s_barrier
    s_add_u32 m0, s59, 0x00000300
    s_mov_b32 exec_hi, 0x0000ffff
    buffer_load_dwordx4 v226, s[8:11], s66 offen lds
    s_mov_b64 exec, -1
    ds_read_b128 v[32:35], v229 offset:43008
    ds_read_b128 v[36:39], v229 offset:44032
    ds_read_b128 v[40:43], v229 offset:51200
    ds_read_b128 v[44:47], v229 offset:52224
    s_add_u32 m0, s59, 0x00000600
    s_mov_b32 exec_hi, 0x0000ffff
    buffer_load_dwordx4 v227, s[8:11], s66 offen lds
    s_mov_b64 exec, -1
    ds_read_b64_tr_b16 v[144:145], v234 offset:43008
    ds_read_b64_tr_b16 v[146:147], v234 offset:45312
    ds_read_b64_tr_b16 v[148:149], v234 offset:52224
    ds_read_b64_tr_b16 v[150:151], v234 offset:54528
    s_add_u32 m0, s59, 0x00001f80
    s_mov_b32 exec_hi, 0x0000ffff
    buffer_load_dwordx4 v225, s[8:11], s66 offen offset:1152 lds
    s_mov_b64 exec, -1
    ds_read_b64_tr_b16 v[152:153], v235 offset:43008
    ds_read_b64_tr_b16 v[154:155], v235 offset:45312
    ds_read_b64_tr_b16 v[156:157], v234 offset:47616
    ds_read_b64_tr_b16 v[158:159], v234 offset:49920
    s_add_u32 m0, s59, 0x00002280
    s_mov_b32 exec_hi, 0x0000ffff
    buffer_load_dwordx4 v226, s[8:11], s66 offen offset:1152 lds
    s_mov_b64 exec, -1
    ds_read_b64_tr_b16 v[160:161], v234 offset:56832
    ds_read_b64_tr_b16 v[162:163], v234 offset:59136
    ds_read_b64_tr_b16 v[164:165], v235 offset:47616
    ds_read_b64_tr_b16 v[166:167], v235 offset:49920
    s_add_u32 m0, s59, 0x00002580
    s_mov_b32 exec_hi, 0x0000ffff
    buffer_load_dwordx4 v227, s[8:11], s66 offen offset:1152 lds
    s_mov_b64 exec, -1
    s_waitcnt lgkmcnt(10)
    v_mfma_f32_16x16x32_bf16 v[168:171], v[144:147], v[196:199], v[168:171]
    s_add_u32 s67, s94, 4
    s_cmp_ge_u32 s67, 9
    s_cselect_b32 s95, 9, 0
    s_sub_u32 s67, s67, s95
    s_mul_i32 s67, s67, 128
    s_add_u32 m0, s58, 0x0000d000
    s_nop 0
    buffer_load_dwordx4 v224, s[4:7], s67 offen lds
    s_waitcnt lgkmcnt(8)
    v_mfma_f32_16x16x32_bf16 v[172:175], v[148:151], v[196:199], v[172:175]
    s_add_u32 m0, s58, 0x0000efc0
    s_nop 0
    buffer_load_dwordx4 v224, s[4:7], s67 offen offset:64 lds
    s_waitcnt lgkmcnt(6)
    v_mfma_f32_16x16x32_bf16 v[176:179], v[152:155], v[196:199], v[176:179]
    s_add_u32 s66, s67, 73728
    s_add_u32 m0, s58, 0x0000e000
    s_nop 0
    buffer_load_dwordx4 v224, s[4:7], s66 offen lds
    s_waitcnt lgkmcnt(4)
    v_mfma_f32_16x16x32_bf16 v[168:171], v[156:159], v[196:199], v[168:171]
    s_add_u32 m0, s58, 0x0000ffc0
    s_nop 0
    buffer_load_dwordx4 v224, s[4:7], s66 offen offset:64 lds
    s_waitcnt lgkmcnt(2)
    v_mfma_f32_16x16x32_bf16 v[172:175], v[160:163], v[196:199], v[172:175]
    s_mul_i32 s66, s67, 1728
    s_add_u32 s66, s66, 1152
    s_add_u32 m0, s59, 0x00008800
    s_mov_b32 exec_hi, 0x0000ffff
    buffer_load_dwordx4 v225, s[8:11], s66 offen lds
    s_mov_b64 exec, -1
    s_waitcnt lgkmcnt(0)
    v_mfma_f32_16x16x32_bf16 v[176:179], v[164:167], v[196:199], v[176:179]
    s_waitcnt vmcnt(5)
    s_barrier
    s_add_u32 m0, s59, 0x00008b00
    s_mov_b32 exec_hi, 0x0000ffff
    buffer_load_dwordx4 v226, s[8:11], s66 offen lds
    s_mov_b64 exec, -1
    v_add_u32 v229, 0xfffe9400, v229
    ds_read_b128 v[48:51], v229 offset:8192
    ds_read_b128 v[52:55], v229 offset:9216
    ds_read_b128 v[56:59], v229 offset:16384
    ds_read_b128 v[60:63], v229 offset:17408
    s_add_u32 m0, s59, 0x00008e00
    s_mov_b32 exec_hi, 0x0000ffff
    buffer_load_dwordx4 v227, s[8:11], s66 offen lds
    s_mov_b64 exec, -1
    v_add_u32 v234, 0xfffeb400, v234
    ds_read_b64_tr_b16 v[144:145], v234 offset:0
    ds_read_b64_tr_b16 v[146:147], v234 offset:2304
    ds_read_b64_tr_b16 v[148:149], v234 offset:9216
    ds_read_b64_tr_b16 v[150:151], v234 offset:11520
    s_add_u32 m0, s59, 0x0000a780
    s_mov_b32 exec_hi, 0x0000ffff
    buffer_load_dwordx4 v225, s[8:11], s66 offen offset:1152 lds
    s_mov_b64 exec, -1
    v_add_u32 v235, 0xfffeb400, v235
    ds_read_b64_tr_b16 v[152:153], v235 offset:0
    ds_read_b64_tr_b16 v[154:155], v235 offset:2304
    ds_read_b64_tr_b16 v[156:157], v234 offset:4608
    ds_read_b64_tr_b16 v[158:159], v234 offset:6912
    s_add_u32 m0, s59, 0x0000aa80
    s_mov_b32 exec_hi, 0x0000ffff
    buffer_load_dwordx4 v226, s[8:11], s66 offen offset:1152 lds
    s_mov_b64 exec, -1
    ds_read_b64_tr_b16 v[160:161], v234 offset:13824
    ds_read_b64_tr_b16 v[162:163], v234 offset:16128
    ds_read_b64_tr_b16 v[164:165], v235 offset:4608
    ds_read_b64_tr_b16 v[166:167], v235 offset:6912
    s_add_u32 m0, s59, 0x0000ad80
    s_mov_b32 exec_hi, 0x0000ffff
    buffer_load_dwordx4 v227, s[8:11], s66 offen offset:1152 lds
    s_mov_b64 exec, -1
    s_waitcnt lgkmcnt(10)
    v_mfma_f32_16x16x32_bf16 v[168:171], v[144:147], v[196:199], v[168:171]
    s_add_u32 s67, s94, 5
    s_cmp_ge_u32 s67, 9
    s_cselect_b32 s95, 9, 0
    s_sub_u32 s67, s67, s95
    s_mul_i32 s67, s67, 128
    s_add_u32 m0, s58, 0x0001b400
    s_nop 0
    buffer_load_dwordx4 v224, s[4:7], s67 offen lds
    s_waitcnt lgkmcnt(8)
    v_mfma_f32_16x16x32_bf16 v[172:175], v[148:151], v[196:199], v[172:175]
    s_add_u32 m0, s58, 0x0001d3c0
    s_nop 0
    buffer_load_dwordx4 v224, s[4:7], s67 offen offset:64 lds
    s_waitcnt lgkmcnt(6)
    v_mfma_f32_16x16x32_bf16 v[176:179], v[152:155], v[196:199], v[176:179]
    s_add_u32 s66, s67, 73728
    s_add_u32 m0, s58, 0x0001c400
    s_nop 0
    buffer_load_dwordx4 v224, s[4:7], s66 offen lds
    s_waitcnt lgkmcnt(4)
    v_mfma_f32_16x16x32_bf16 v[168:171], v[156:159], v[196:199], v[168:171]
    s_add_u32 m0, s58, 0x0001e3c0
    s_nop 0
    buffer_load_dwordx4 v224, s[4:7], s66 offen offset:64 lds
    s_waitcnt lgkmcnt(2)
    v_mfma_f32_16x16x32_bf16 v[172:175], v[160:163], v[196:199], v[172:175]
    s_mul_i32 s66, s67, 1728
    s_add_u32 s66, s66, 1152
    s_add_u32 m0, s59, 0x00016c00
    s_mov_b32 exec_hi, 0x0000ffff
    buffer_load_dwordx4 v225, s[8:11], s66 offen lds
    s_mov_b64 exec, -1
    s_waitcnt lgkmcnt(0)
    v_mfma_f32_16x16x32_bf16 v[176:179], v[164:167], v[196:199], v[176:179]
    s_waitcnt vmcnt(5)
    s_barrier
    s_add_u32 m0, s59, 0x00016f00
    s_mov_b32 exec_hi, 0x0000ffff
    buffer_load_dwordx4 v226, s[8:11], s66 offen lds
    s_mov_b64 exec, -1
    ds_read_b128 v[64:67], v229 offset:43008
    ds_read_b128 v[68:71], v229 offset:44032
    ds_read_b128 v[72:75], v229 offset:51200
    ds_read_b128 v[76:79], v229 offset:52224
    s_add_u32 m0, s59, 0x00017200
    s_mov_b32 exec_hi, 0x0000ffff
    buffer_load_dwordx4 v227, s[8:11], s66 offen lds
    s_mov_b64 exec, -1
    ds_read_b64_tr_b16 v[144:145], v234 offset:34816
    ds_read_b64_tr_b16 v[146:147], v234 offset:37120
    ds_read_b64_tr_b16 v[148:149], v234 offset:44032
    ds_read_b64_tr_b16 v[150:151], v234 offset:46336
    s_add_u32 m0, s59, 0x00018b80
    s_mov_b32 exec_hi, 0x0000ffff
    buffer_load_dwordx4 v225, s[8:11], s66 offen offset:1152 lds
    s_mov_b64 exec, -1
    ds_read_b64_tr_b16 v[152:153], v235 offset:34816
    ds_read_b64_tr_b16 v[154:155], v235 offset:37120
    ds_read_b64_tr_b16 v[156:157], v234 offset:39424
    ds_read_b64_tr_b16 v[158:159], v234 offset:41728
    s_add_u32 m0, s59, 0x00018e80
    s_mov_b32 exec_hi, 0x0000ffff
    buffer_load_dwordx4 v226, s[8:11], s66 offen offset:1152 lds
    s_mov_b64 exec, -1
    ds_read_b64_tr_b16 v[160:161], v234 offset:48640
    ds_read_b64_tr_b16 v[162:163], v234 offset:50944
    ds_read_b64_tr_b16 v[164:165], v235 offset:39424
    ds_read_b64_tr_b16 v[166:167], v235 offset:41728
    s_add_u32 m0, s59, 0x00019180
    s_mov_b32 exec_hi, 0x0000ffff
    buffer_load_dwordx4 v227, s[8:11], s66 offen offset:1152 lds
    s_mov_b64 exec, -1
    s_waitcnt lgkmcnt(10)
    v_mfma_f32_16x16x32_bf16 v[168:171], v[144:147], v[196:199], v[168:171]
    s_add_u32 s67, s94, 6
    s_cmp_ge_u32 s67, 9
    s_cselect_b32 s95, 9, 0
    s_sub_u32 s67, s67, s95
    s_mul_i32 s67, s67, 128
    s_add_u32 m0, s58, 0x00023c00
    s_nop 0
    buffer_load_dwordx4 v224, s[4:7], s67 offen lds
    s_waitcnt lgkmcnt(8)
    v_mfma_f32_16x16x32_bf16 v[172:175], v[148:151], v[196:199], v[172:175]
    s_add_u32 m0, s58, 0x00025bc0
    s_nop 0
    buffer_load_dwordx4 v224, s[4:7], s67 offen offset:64 lds
    s_waitcnt lgkmcnt(6)
    v_mfma_f32_16x16x32_bf16 v[176:179], v[152:155], v[196:199], v[176:179]
    s_add_u32 s66, s67, 73728
    s_add_u32 m0, s58, 0x00024c00
    s_nop 0
    buffer_load_dwordx4 v224, s[4:7], s66 offen lds
    s_waitcnt lgkmcnt(4)
    v_mfma_f32_16x16x32_bf16 v[168:171], v[156:159], v[196:199], v[168:171]
    s_add_u32 m0, s58, 0x00026bc0
    s_nop 0
    buffer_load_dwordx4 v224, s[4:7], s66 offen offset:64 lds
    s_waitcnt lgkmcnt(2)
    v_mfma_f32_16x16x32_bf16 v[172:175], v[160:163], v[196:199], v[172:175]
    s_mul_i32 s66, s67, 1728
    s_add_u32 s66, s66, 1152
    s_add_u32 m0, s59, 0x0001f400
    s_mov_b32 exec_hi, 0x0000ffff
    buffer_load_dwordx4 v225, s[8:11], s66 offen lds
    s_mov_b64 exec, -1
    s_waitcnt lgkmcnt(0)
    v_mfma_f32_16x16x32_bf16 v[176:179], v[164:167], v[196:199], v[176:179]
    s_waitcnt vmcnt(5)
    s_barrier
    s_add_u32 m0, s59, 0x0001f700
    s_mov_b32 exec_hi, 0x0000ffff
    buffer_load_dwordx4 v226, s[8:11], s66 offen lds
    s_mov_b64 exec, -1
    v_add_u32 v229, 0x00016c00, v229
    ds_read_b128 v[80:83], v229 offset:8192
    ds_read_b128 v[84:87], v229 offset:9216
    ds_read_b128 v[88:91], v229 offset:16384
    ds_read_b128 v[92:95], v229 offset:17408
    s_add_u32 m0, s59, 0x0001fa00
    s_mov_b32 exec_hi, 0x0000ffff
    buffer_load_dwordx4 v227, s[8:11], s66 offen lds
    s_mov_b64 exec, -1
    v_add_u32 v234, 0x00014c00, v234
    ds_read_b64_tr_b16 v[144:145], v234 offset:8192
    ds_read_b64_tr_b16 v[146:147], v234 offset:10496
    ds_read_b64_tr_b16 v[148:149], v234 offset:17408
    ds_read_b64_tr_b16 v[150:151], v234 offset:19712
    s_add_u32 m0, s59, 0x00021380
    s_mov_b32 exec_hi, 0x0000ffff
    buffer_load_dwordx4 v225, s[8:11], s66 offen offset:1152 lds
    s_mov_b64 exec, -1
    v_add_u32 v235, 0x00014c00, v235
    ds_read_b64_tr_b16 v[152:153], v235 offset:8192
    ds_read_b64_tr_b16 v[154:155], v235 offset:10496
    ds_read_b64_tr_b16 v[156:157], v234 offset:12800
    ds_read_b64_tr_b16 v[158:159], v234 offset:15104
    s_add_u32 m0, s59, 0x00021680
    s_mov_b32 exec_hi, 0x0000ffff
    buffer_load_dwordx4 v226, s[8:11], s66 offen offset:1152 lds
    s_mov_b64 exec, -1
    ds_read_b64_tr_b16 v[160:161], v234 offset:22016
    ds_read_b64_tr_b16 v[162:163], v234 offset:24320
    ds_read_b64_tr_b16 v[164:165], v235 offset:12800
    ds_read_b64_tr_b16 v[166:167], v235 offset:15104
    s_add_u32 m0, s59, 0x00021980
    s_mov_b32 exec_hi, 0x0000ffff
    buffer_load_dwordx4 v227, s[8:11], s66 offen offset:1152 lds
    s_mov_b64 exec, -1
    s_waitcnt lgkmcnt(10)
    v_mfma_f32_16x16x32_bf16 v[168:171], v[144:147], v[196:199], v[168:171]
    s_add_u32 s67, s94, 7
    s_cmp_ge_u32 s67, 9
    s_cselect_b32 s95, 9, 0
    s_sub_u32 s67, s67, s95
    s_mul_i32 s67, s67, 128
    s_add_u32 m0, s58, 0x00004800
    s_nop 0
    buffer_load_dwordx4 v224, s[4:7], s67 offen lds
    s_waitcnt lgkmcnt(8)
    v_mfma_f32_16x16x32_bf16 v[172:175], v[148:151], v[196:199], v[172:175]
    s_add_u32 m0, s58, 0x000067c0
    s_nop 0
    buffer_load_dwordx4 v224, s[4:7], s67 offen offset:64 lds
    s_waitcnt lgkmcnt(6)
    v_mfma_f32_16x16x32_bf16 v[176:179], v[152:155], v[196:199], v[176:179]
    s_add_u32 s66, s67, 73728
    s_add_u32 m0, s58, 0x00005800
    s_nop 0
    buffer_load_dwordx4 v224, s[4:7], s66 offen lds
    s_waitcnt lgkmcnt(4)
    v_mfma_f32_16x16x32_bf16 v[168:171], v[156:159], v[196:199], v[168:171]
    s_add_u32 m0, s58, 0x000077c0
    s_nop 0
    buffer_load_dwordx4 v224, s[4:7], s66 offen offset:64 lds
    s_waitcnt lgkmcnt(2)
    v_mfma_f32_16x16x32_bf16 v[172:175], v[160:163], v[196:199], v[172:175]
    s_mul_i32 s66, s67, 1728
    s_add_u32 s66, s66, 1152
    s_add_u32 m0, s59, 0x00000000
    s_mov_b32 exec_hi, 0x0000ffff
    buffer_load_dwordx4 v225, s[8:11], s66 offen lds
    s_mov_b64 exec, -1
    s_waitcnt lgkmcnt(0)
    v_mfma_f32_16x16x32_bf16 v[176:179], v[164:167], v[196:199], v[176:179]
    s_waitcnt vmcnt(5)
    s_barrier
    v_mov_b32 v233, 0
    buffer_load_dword v233, v233, s[40:43], 0 offen sc1
    s_add_u32 m0, s59, 0x00000300
    s_mov_b32 exec_hi, 0x0000ffff
    buffer_load_dwordx4 v226, s[8:11], s66 offen lds
    s_mov_b64 exec, -1
    ds_read_b128 v[96:99], v229 offset:43008
    ds_read_b128 v[100:103], v229 offset:44032
    ds_read_b128 v[104:107], v229 offset:51200
    ds_read_b128 v[108:111], v229 offset:52224
    s_add_u32 m0, s59, 0x00000600
    s_mov_b32 exec_hi, 0x0000ffff
    buffer_load_dwordx4 v227, s[8:11], s66 offen lds
    s_mov_b64 exec, -1
    ds_read_b64_tr_b16 v[144:145], v234 offset:43008
    ds_read_b64_tr_b16 v[146:147], v234 offset:45312
    ds_read_b64_tr_b16 v[148:149], v234 offset:52224
    ds_read_b64_tr_b16 v[150:151], v234 offset:54528
    s_add_u32 m0, s59, 0x00001f80
    s_mov_b32 exec_hi, 0x0000ffff
    buffer_load_dwordx4 v225, s[8:11], s66 offen offset:1152 lds
    s_mov_b64 exec, -1
    ds_read_b64_tr_b16 v[152:153], v235 offset:43008
    ds_read_b64_tr_b16 v[154:155], v235 offset:45312
    ds_read_b64_tr_b16 v[156:157], v234 offset:47616
    ds_read_b64_tr_b16 v[158:159], v234 offset:49920
    s_add_u32 m0, s59, 0x00002280
    s_mov_b32 exec_hi, 0x0000ffff
    buffer_load_dwordx4 v226, s[8:11], s66 offen offset:1152 lds
    s_mov_b64 exec, -1
    ds_read_b64_tr_b16 v[160:161], v234 offset:56832
    ds_read_b64_tr_b16 v[162:163], v234 offset:59136
    ds_read_b64_tr_b16 v[164:165], v235 offset:47616
    ds_read_b64_tr_b16 v[166:167], v235 offset:49920
    s_add_u32 m0, s59, 0x00002580
    s_mov_b32 exec_hi, 0x0000ffff
    buffer_load_dwordx4 v227, s[8:11], s66 offen offset:1152 lds
    s_mov_b64 exec, -1
    s_waitcnt lgkmcnt(10)
    v_mfma_f32_16x16x32_bf16 v[168:171], v[144:147], v[196:199], v[168:171]
    s_add_u32 s67, s94, 8
    s_cmp_ge_u32 s67, 9
    s_cselect_b32 s95, 9, 0
    s_sub_u32 s67, s67, s95
    s_mul_i32 s67, s67, 128
    s_add_u32 m0, s58, 0x0000d000
    s_nop 0
    buffer_load_dwordx4 v224, s[4:7], s67 offen lds
    s_waitcnt lgkmcnt(8)
    v_mfma_f32_16x16x32_bf16 v[172:175], v[148:151], v[196:199], v[172:175]
    s_add_u32 m0, s58, 0x0000efc0
    s_nop 0
    buffer_load_dwordx4 v224, s[4:7], s67 offen offset:64 lds
    s_waitcnt lgkmcnt(6)
    v_mfma_f32_16x16x32_bf16 v[176:179], v[152:155], v[196:199], v[176:179]
    s_add_u32 s66, s67, 73728
    s_add_u32 m0, s58, 0x0000e000
    s_nop 0
    buffer_load_dwordx4 v224, s[4:7], s66 offen lds
    s_waitcnt lgkmcnt(4)
    v_mfma_f32_16x16x32_bf16 v[168:171], v[156:159], v[196:199], v[168:171]
    s_add_u32 m0, s58, 0x0000ffc0
    s_nop 0
    buffer_load_dwordx4 v224, s[4:7], s66 offen offset:64 lds
    s_waitcnt lgkmcnt(2)
    v_mfma_f32_16x16x32_bf16 v[172:175], v[160:163], v[196:199], v[172:175]
    s_mul_i32 s66, s67, 1728
    s_add_u32 s66, s66, 1152
    s_add_u32 m0, s59, 0x00008800
    s_mov_b32 exec_hi, 0x0000ffff
    buffer_load_dwordx4 v225, s[8:11], s66 offen lds
    s_mov_b64 exec, -1
    s_waitcnt lgkmcnt(0)
    v_mfma_f32_16x16x32_bf16 v[176:179], v[164:167], v[196:199], v[176:179]
    s_waitcnt vmcnt(5)
    s_barrier
    s_add_u32 m0, s59, 0x00008b00
    s_mov_b32 exec_hi, 0x0000ffff
    buffer_load_dwordx4 v226, s[8:11], s66 offen lds
    s_mov_b64 exec, -1
    v_add_u32 v229, 0xfffe9400, v229
    ds_read_b128 v[112:115], v229 offset:8192
    ds_read_b128 v[116:119], v229 offset:9216
    ds_read_b128 v[120:123], v229 offset:16384
    ds_read_b128 v[124:127], v229 offset:17408
    s_add_u32 m0, s59, 0x00008e00
    s_mov_b32 exec_hi, 0x0000ffff
    buffer_load_dwordx4 v227, s[8:11], s66 offen lds
    s_mov_b64 exec, -1
    v_add_u32 v234, 0xfffeb400, v234
    ds_read_b64_tr_b16 v[144:145], v234 offset:0
    ds_read_b64_tr_b16 v[146:147], v234 offset:2304
    ds_read_b64_tr_b16 v[148:149], v234 offset:9216
    ds_read_b64_tr_b16 v[150:151], v234 offset:11520
    s_add_u32 m0, s59, 0x0000a780
    s_mov_b32 exec_hi, 0x0000ffff
    buffer_load_dwordx4 v225, s[8:11], s66 offen offset:1152 lds
    s_mov_b64 exec, -1
    v_add_u32 v235, 0xfffeb400, v235
    ds_read_b64_tr_b16 v[152:153], v235 offset:0
    ds_read_b64_tr_b16 v[154:155], v235 offset:2304
    ds_read_b64_tr_b16 v[156:157], v234 offset:4608
    ds_read_b64_tr_b16 v[158:159], v234 offset:6912
    s_add_u32 m0, s59, 0x0000aa80
    s_mov_b32 exec_hi, 0x0000ffff
    buffer_load_dwordx4 v226, s[8:11], s66 offen offset:1152 lds
    s_mov_b64 exec, -1
    ds_read_b64_tr_b16 v[160:161], v234 offset:13824
    ds_read_b64_tr_b16 v[162:163], v234 offset:16128
    ds_read_b64_tr_b16 v[164:165], v235 offset:4608
    ds_read_b64_tr_b16 v[166:167], v235 offset:6912
    s_add_u32 m0, s59, 0x0000ad80
    s_mov_b32 exec_hi, 0x0000ffff
    buffer_load_dwordx4 v227, s[8:11], s66 offen offset:1152 lds
    s_mov_b64 exec, -1
    s_waitcnt lgkmcnt(10)
    v_mfma_f32_16x16x32_bf16 v[168:171], v[144:147], v[196:199], v[168:171]
    s_add_u32 s66, s94, 0
    s_cmp_ge_u32 s66, 9
    s_cselect_b32 s95, 9, 0
    s_sub_u32 s66, s66, s95
    s_mul_i32 s66, s66, 221184
    s_add_u32 m0, s59, 0x00013800
    s_mov_b32 exec_hi, 0x0000ffff
    buffer_load_dwordx4 v225, s[8:11], s66 offen lds
    s_mov_b64 exec, -1
    s_waitcnt lgkmcnt(8)
    v_mfma_f32_16x16x32_bf16 v[172:175], v[148:151], v[196:199], v[172:175]
    s_add_u32 m0, s59, 0x00013b00
    s_mov_b32 exec_hi, 0x0000ffff
    buffer_load_dwordx4 v226, s[8:11], s66 offen lds
    s_mov_b64 exec, -1
    s_waitcnt lgkmcnt(6)
    v_mfma_f32_16x16x32_bf16 v[176:179], v[152:155], v[196:199], v[176:179]
    s_add_u32 m0, s59, 0x00013e00
    s_mov_b32 exec_hi, 0x0000ffff
    buffer_load_dwordx4 v227, s[8:11], s66 offen lds
    s_mov_b64 exec, -1
    s_waitcnt lgkmcnt(4)
    v_mfma_f32_16x16x32_bf16 v[168:171], v[156:159], v[196:199], v[168:171]
    s_add_u32 s66, s94, 1
    s_cmp_ge_u32 s66, 9
    s_cselect_b32 s95, 9, 0
    s_sub_u32 s66, s66, s95
    s_mul_i32 s66, s66, 221184
    s_add_u32 m0, s59, 0x00015c00
    s_mov_b32 exec_hi, 0x0000ffff
    buffer_load_dwordx4 v225, s[8:11], s66 offen lds
    s_mov_b64 exec, -1
    s_waitcnt lgkmcnt(2)
    v_mfma_f32_16x16x32_bf16 v[172:175], v[160:163], v[196:199], v[172:175]
    s_add_u32 m0, s59, 0x00015f00
    s_mov_b32 exec_hi, 0x0000ffff
    buffer_load_dwordx4 v226, s[8:11], s66 offen lds
    s_mov_b64 exec, -1
    s_waitcnt lgkmcnt(0)
    v_mfma_f32_16x16x32_bf16 v[176:179], v[164:167], v[196:199], v[176:179]
    s_waitcnt vmcnt(5)
    s_barrier
    s_lshl_b32 s64, s56, 2
    s_add_u32 s64, s64, s49
    s_lshl_b32 s64, s64, 9
    s_add_u32 s68, s64, 872448
    v_lshlrev_b32 v182, 3, v255
    v_mov_b32 v180, 0
    v_mov_b32 v181, 0
    buffer_atomic_add_x2 v[180:181], v182, s[44:47], s68 offen sc0
    s_add_u32 m0, s59, 0x00016200
    s_mov_b32 exec_hi, 0x0000ffff
    buffer_load_dwordx4 v227, s[8:11], s66 offen lds
    s_mov_b64 exec, -1
    ds_read_b128 v[128:131], v229 offset:43008
    ds_read_b128 v[132:135], v229 offset:44032
    ds_read_b128 v[136:139], v229 offset:51200
    ds_read_b128 v[140:143], v229 offset:52224
    s_add_u32 s66, s94, 2
    s_cmp_ge_u32 s66, 9
    s_cselect_b32 s95, 9, 0
    s_sub_u32 s66, s66, s95
    s_mul_i32 s66, s66, 221184
    s_add_u32 m0, s59, 0x00018000
    s_mov_b32 exec_hi, 0x0000ffff
    buffer_load_dwordx4 v225, s[8:11], s66 offen lds
    s_mov_b64 exec, -1
    ds_read_b64_tr_b16 v[144:145], v234 offset:34816
    ds_read_b64_tr_b16 v[146:147], v234 offset:37120
    ds_read_b64_tr_b16 v[148:149], v234 offset:44032
    ds_read_b64_tr_b16 v[150:151], v234 offset:46336
    s_add_u32 m0, s59, 0x00018300
    s_mov_b32 exec_hi, 0x0000ffff
    buffer_load_dwordx4 v226, s[8:11], s66 offen lds
    s_mov_b64 exec, -1
    ds_read_b64_tr_b16 v[152:153], v235 offset:34816
    ds_read_b64_tr_b16 v[154:155], v235 offset:37120
    ds_read_b64_tr_b16 v[156:157], v234 offset:39424
    ds_read_b64_tr_b16 v[158:159], v234 offset:41728
    s_add_u32 m0, s59, 0x00018600
    s_mov_b32 exec_hi, 0x0000ffff
    buffer_load_dwordx4 v227, s[8:11], s66 offen lds
    s_mov_b64 exec, -1
    ds_read_b64_tr_b16 v[160:161], v234 offset:48640
    ds_read_b64_tr_b16 v[162:163], v234 offset:50944
    ds_read_b64_tr_b16 v[164:165], v235 offset:39424
    ds_read_b64_tr_b16 v[166:167], v235 offset:41728
    s_add_u32 s66, s94, 3
    s_cmp_ge_u32 s66, 9
    s_cselect_b32 s95, 9, 0
    s_sub_u32 s66, s66, s95
    s_mul_i32 s66, s66, 221184
    s_add_u32 m0, s59, 0x0001a400
    s_mov_b32 exec_hi, 0x0000ffff
    buffer_load_dwordx4 v225, s[8:11], s66 offen lds
    s_mov_b64 exec, -1
    s_waitcnt lgkmcnt(10)
    v_mfma_f32_16x16x32_bf16 v[168:171], v[144:147], v[196:199], v[168:171]
    s_waitcnt lgkmcnt(8)
    v_mfma_f32_16x16x32_bf16 v[172:175], v[148:151], v[196:199], v[172:175]
    s_waitcnt lgkmcnt(6)
    v_mfma_f32_16x16x32_bf16 v[176:179], v[152:155], v[196:199], v[176:179]
    s_add_u32 m0, s59, 0x0001a700
    s_mov_b32 exec_hi, 0x0000ffff
    buffer_load_dwordx4 v226, s[8:11], s66 offen lds
    s_mov_b64 exec, -1
    s_waitcnt lgkmcnt(4)
    v_mfma_f32_16x16x32_bf16 v[168:171], v[156:159], v[196:199], v[168:171]
    s_waitcnt lgkmcnt(2)
    v_mfma_f32_16x16x32_bf16 v[172:175], v[160:163], v[196:199], v[172:175]
    s_waitcnt lgkmcnt(0)
    v_mfma_f32_16x16x32_bf16 v[176:179], v[164:167], v[196:199], v[176:179]
    v_readfirstlane_b32 s55, v233
    s_nop 1
    s_cmp_eq_u32 s55, 0
    s_cbranch_scc1 L_nslow_69
L_nback_70:
    s_lshl_b32 s64, s49, 8
    s_add_u32 s64, s64, 75776
    v_lshl_add_u32 v204, v255, 2, s64
    s_mov_b32 s62, 0
    s_waitcnt vmcnt(6)
L_xs_72:
    v_cmp_ne_u32 vcc, s55, v181
    s_nop 0
    s_cbranch_vccnz L_xsre_74
L_xsok_73:
    ds_write_b32 v204, v180
    s_lshl_b32 s64, s49, 6
    v_add_u32 v230, s64, v237
    s_and_b32 s64, s49, 1
    s_mul_i32 s64, s64, 320
    v_add_u32 v231, s64, v237
    s_mov_b32 exec_lo, 0x00010001
    s_mov_b32 exec_hi, 0x00010001
    ds_write_b128 v230, v[168:171]
    ds_write_b128 v230, v[172:175] offset:320
    ds_write_b128 v231, v[176:179] offset:256
    s_mov_b64 exec, -1
    s_setprio 0
    s_waitcnt lgkmcnt(0)
    s_barrier
    ds_read_b64 v[238:239], v242
    ds_read_b64 v[240:241], v242 offset:128
    s_add_u32 m0, s59, 0x0001aa00
    s_mov_b32 exec_hi, 0x0000ffff
    buffer_load_dwordx4 v227, s[8:11], s66 offen lds
    s_mov_b64 exec, -1
    s_add_u32 s66, s94, 4
    s_cmp_ge_u32 s66, 9
    s_cselect_b32 s95, 9, 0
    s_sub_u32 s66, s66, s95
    s_mul_i32 s66, s66, 221184
    s_add_u32 m0, s59, 0x0001c800
    s_mov_b32 exec_hi, 0x0000ffff
    buffer_load_dwordx4 v225, s[8:11], s66 offen lds
    s_mov_b64 exec, -1
    s_add_u32 m0, s59, 0x0001cb00
    s_mov_b32 exec_hi, 0x0000ffff
    buffer_load_dwordx4 v226, s[8:11], s66 offen lds
    s_mov_b64 exec, -1
    s_add_u32 m0, s59, 0x0001ce00
    s_mov_b32 exec_hi, 0x0000ffff
    buffer_load_dwordx4 v227, s[8:11], s66 offen lds
    s_mov_b64 exec, -1
    s_add_u32 s66, s94, 5
    s_cmp_ge_u32 s66, 9
    s_cselect_b32 s95, 9, 0
    s_sub_u32 s66, s66, s95
    s_mul_i32 s66, s66, 221184
    s_add_u32 m0, s59, 0x0001ec00
    s_mov_b32 exec_hi, 0x0000ffff
    buffer_load_dwordx4 v225, s[8:11], s66 offen lds
    s_mov_b64 exec, -1
    s_add_u32 m0, s59, 0x0001ef00
    s_mov_b32 exec_hi, 0x0000ffff
    buffer_load_dwordx4 v226, s[8:11], s66 offen lds
    s_mov_b64 exec, -1
    s_add_u32 m0, s59, 0x0001f200
    s_mov_b32 exec_hi, 0x0000ffff
    buffer_load_dwordx4 v227, s[8:11], s66 offen lds
    s_mov_b64 exec, -1
    s_add_u32 s66, s94, 6
    s_cmp_ge_u32 s66, 9
    s_cselect_b32 s95, 9, 0
    s_sub_u32 s66, s66, s95
    s_mul_i32 s66, s66, 221184
    s_add_u32 m0, s59, 0x00021000
    s_mov_b32 exec_hi, 0x0000ffff
    buffer_load_dwordx4 v225, s[8:11], s66 offen lds
    s_mov_b64 exec, -1
    s_add_u32 m0, s59, 0x00021300
    s_mov_b32 exec_hi, 0x0000ffff
    buffer_load_dwordx4 v226, s[8:11], s66 offen lds
    s_mov_b64 exec, -1
    s_add_u32 m0, s59, 0x00021600
    s_mov_b32 exec_hi, 0x0000ffff
    buffer_load_dwordx4 v227, s[8:11], s66 offen lds
    s_mov_b64 exec, -1
    s_add_u32 s66, s94, 7
    s_cmp_ge_u32 s66, 9
    s_cselect_b32 s95, 9, 0
    s_sub_u32 s66, s66, s95
    s_mul_i32 s66, s66, 221184
    s_add_u32 m0, s59, 0x00023400
    s_mov_b32 exec_hi, 0x0000ffff
    buffer_load_dwordx4 v225, s[8:11], s66 offen lds
    s_mov_b64 exec, -1
    s_add_u32 m0, s59, 0x00023700
    s_mov_b32 exec_hi, 0x0000ffff
    buffer_load_dwordx4 v226, s[8:11], s66 offen lds
    s_mov_b64 exec, -1
    s_add_u32 m0, s59, 0x00023a00
    s_mov_b32 exec_hi, 0x0000ffff
    buffer_load_dwordx4 v227, s[8:11], s66 offen lds
    s_mov_b64 exec, -1
    s_add_u32 s66, s94, 8
    s_cmp_ge_u32 s66, 9
    s_cselect_b32 s95, 9, 0
    s_sub_u32 s66, s66, s95
    s_mul_i32 s66, s66, 221184
    s_add_u32 m0, s59, 0x00025800
    s_mov_b32 exec_hi, 0x0000ffff
    buffer_load_dwordx4 v225, s[8:11], s66 offen lds
    s_mov_b64 exec, -1
    s_add_u32 m0, s59, 0x00025b00
    s_mov_b32 exec_hi, 0x0000ffff
    buffer_load_dwordx4 v226, s[8:11], s66 offen lds
    s_mov_b64 exec, -1
    s_add_u32 m0, s59, 0x00025e00
    s_mov_b32 exec_hi, 0x0000ffff
    buffer_load_dwordx4 v227, s[8:11], s66 offen lds
    s_mov_b64 exec, -1
    s_waitcnt lgkmcnt(1)
    v_mul_f32 v239, 0x3fb8aa3b, v239
    s_waitcnt lgkmcnt(0)
    v_mul_f32 v241, 0x3fb8aa3b, v241
    v_mul_u32_u24 v230, 7282, v255
    v_lshrrev_b32 v230, 16, v230
    v_mul_u32_u24 v230, 63, v230
    v_add_u32 v230, v230, v255
    v_lshlrev_b32 v230, 7, v230
    s_and_b32 s64, s51, 15
    s_lshl_b32 s64, s64, 2
    s_add_u32 s64, s64, s49
    s_mul_i32 s64, s64, 36864
    s_mul_i32 s65, s50, 1152
    s_add_u32 s64, s64, s65
    s_add_u32 s64, s64, 2949120
    s_mov_b32 exec_hi, 0x0000000f
    buffer_load_dword v224, v230, s[28:31], s64 offen
    s_mov_b64 exec, -1
    s_and_b32 s64, s51, 15
    s_lshl_b32 s64, s64, 2
    s_add_u32 s64, s64, s49
    s_mul_i32 s65, s64, 10368
    s_mul_i32 s67, s50, 663552
    s_add_u32 s65, s65, s67
    v_lshlrev_b32 v230, 7, v255
    s_mul_i32 s64, s64, 1408
    s_mul_i32 s67, s50, 82944
    s_add_u32 s64, s64, s67
    buffer_load_dword v243, v230, s[32:35], s65 offen
    s_add_u32 s65, s65, 8192
    s_mov_b64 exec, 0x0001ffff
    buffer_load_dword v244, v230, s[32:35], s65 offen
    s_mov_b64 exec, 0x000007ff
    buffer_load_dword v245, v230, s[16:19], s64 offen
    s_mov_b64 exec, -1
    v_bfe_u32 v230, v255, 4, 2
    v_and_b32 v229, 3, v255
    v_cmp_eq_u32 vcc, v230, v229
    s_nop 1
    v_cndmask_b32 v230, 4, v230, vcc
    v_mul_u32_u24 v230, 800, v230
    v_bfe_u32 v229, v255, 2, 2
    v_mul_u32_u24 v229, 40, v229
    v_add_u32 v229, v229, v230
    v_add_u32 v229, 71680, v229
    s_lshl_b32 s64, s52, 3
    s_add_u32 s64, s64, s48
    s_lshl_b32 s61, s64, 10
    s_add_u32 s61, s61, 151552
    s_mul_i32 s60, s64, 36864
    s_add_u32 s60, s60, 6553600
    s_add_u32 s64, s3, 0
    s_and_b32 s64, s64, 7
    s_lshl_b32 s64, s64, 11
    s_add_u32 s92, s64, s60
    s_add_u32 s64, s3, 1
    s_and_b32 s64, s64, 7
    s_lshl_b32 s64, s64, 11
    s_add_u32 s93, s64, s60
    s_add_u32 s64, s3, 2
    s_and_b32 s64, s64, 7
    s_lshl_b32 s64, s64, 11
    s_add_u32 s94, s64, s60
    s_add_u32 s64, s3, 3
    s_and_b32 s64, s64, 7
    s_lshl_b32 s64, s64, 11
    s_add_u32 s95, s64, s60
    s_add_u32 s64, s3, 4
    s_and_b32 s64, s64, 7
    s_lshl_b32 s64, s64, 11
    s_add_u32 s96, s64, s60
    s_add_u32 s64, s3, 5
    s_and_b32 s64, s64, 7
    s_lshl_b32 s64, s64, 11
    s_add_u32 s97, s64, s60
    s_add_u32 s64, s3, 6
    s_and_b32 s64, s64, 7
    s_lshl_b32 s64, s64, 11
    s_add_u32 s98, s64, s60
    s_add_u32 s64, s3, 7
    s_and_b32 s64, s64, 7
    s_lshl_b32 s64, s64, 11
    s_add_u32 s99, s64, s60
    s_add_u32 s60, s60, 16384
    v_add_u32 v251, 18432, v254
    v_lshlrev_b32 v252, 3, v255
    v_add_u32 v253, 18432, v252
    v_lshrrev_b32 v247, 2, v255
    v_lshlrev_b32 v232, 6, v247
    v_and_b32 v247, 3, v255
    v_lshl_add_u32 v232, v247, 3, v232
    v_and_b32 v247, 16, v255
    v_lshl_add_u32 v232, v247, 1, v232
    v_xor_b32 v233, 32, v232
    v_lshlrev_b32 v234, 3, v255
    v_lshrrev_b32 v247, 2, v255
    v_mul_u32_u24 v247, 1152, v247
    v_lshrrev_b32 v236, 3, v255
    v_and_b32 v236, 2, v236
    v_xor_b32 v236, v236, v255
    v_and_b32 v236, 3, v236
    v_lshl_add_u32 v235, v236, 4, v247
    v_bfe_u32 v247, v255, 1, 4
    v_mul_u32_u24 v247, 1152, v247
    v_and_b32 v236, 1, v255
    v_lshl_add_u32 v236, v236, 4, v247
    s_mul_i32 s64, s49, 18432
    s_mul_i32 s65, s53, 663552
    s_add_u32 s64, s64, s65
    s_lshl_b32 s65, s54, 8
    s_add_u32 s65, s65, s64
    v_add_u32 v235, s65, v235
    s_lshl_b32 s65, s54, 5
    s_add_u32 s65, s65, s64
    s_add_u32 s65, s65, 1024
    v_add_u32 v236, s65, v236
    s_lshl_b32 s64, s52, 2
    s_lshr_b32 s65, s48, 1
    s_add_u32 s64, s64, s65
    s_lshl_b32 s64, s64, 3
    s_add_u32 s64, s64, s53
    s_lshl_b32 s64, s64, 2
    s_add_u32 s64, s64, s54
    s_lshl_b32 s64, s64, 7
    s_add_u32 s100, s64, 20480
    s_getpc_b64 s[70:71]
L_pc_75:
    s_lshl_b32 s64, s51, 3
    s_add_u32 s64, s64, s48
    s_mul_i32 s64, s64, 192
    s_sub_u32 s70, s70, L_pc_75-parallel_sum__linear_kernel_hedgehog__mixer_s_mlp__prompt_kernel
    s_subb_u32 s71, s71, 0
    s_add_u32 s64, s64, L_S34-parallel_sum__linear_kernel_hedgehog__mixer_s_mlp__prompt_kernel
    s_min_u32 s64, s64, L_code_end-parallel_sum__linear_kernel_hedgehog__mixer_s_mlp__prompt_kernel-192
    s_load_dword s62, s[70:71], s64 offset:0
    s_load_dword s62, s[70:71], s64 offset:64
    s_load_dword s62, s[70:71], s64 offset:128
    s_waitcnt lgkmcnt(0)
    v_and_b32 v231, 48, v255
    v_add_u32 v231, 162816, v231
    s_waitcnt vmcnt(4)
    s_waitcnt lgkmcnt(0)
    s_setprio 1
    s_barrier
    v_add_u32 v228, 0x00011800, v228
    ds_read_b64_tr_b16 v[164:165], v228 offset:8192
    ds_read_b64_tr_b16 v[166:167], v228 offset:10496
    ds_read_b64_tr_b16 v[168:169], v228 offset:8200
    ds_read_b64_tr_b16 v[170:171], v228 offset:10504
    ds_read_b64_tr_b16 v[172:173], v228 offset:8208
    ds_read_b64_tr_b16 v[174:175], v228 offset:10512
    ds_read_b64_tr_b16 v[176:177], v228 offset:8216
    ds_read_b64_tr_b16 v[178:179], v228 offset:10520
    ds_read_b64_tr_b16 v[180:181], v228 offset:8224
    ds_read_b64_tr_b16 v[182:183], v228 offset:10528
    s_setprio 0
    s_waitcnt lgkmcnt(8)
    v_mfma_f32_16x16x32_bf16 v[184:187], v[164:167], v[0:3], 0
    ds_read_b64_tr_b16 v[144:145], v228 offset:12800
    v_mfma_f32_16x16x32_bf16 v[204:207], v[164:167], v[4:7], 0
    ds_read_b64_tr_b16 v[146:147], v228 offset:15104
    s_waitcnt lgkmcnt(8)
    v_mfma_f32_16x16x32_bf16 v[188:191], v[168:171], v[0:3], 0
    ds_read_b64_tr_b16 v[148:149], v228 offset:12808
    v_mfma_f32_16x16x32_bf16 v[208:211], v[168:171], v[4:7], 0
    ds_read_b64_tr_b16 v[150:151], v228 offset:15112
    s_waitcnt lgkmcnt(8)
    v_mfma_f32_16x16x32_bf16 v[192:195], v[172:175], v[0:3], 0
    ds_read_b64_tr_b16 v[152:153], v228 offset:12816
    v_mfma_f32_16x16x32_bf16 v[212:215], v[172:175], v[4:7], 0
    ds_read_b64_tr_b16 v[154:155], v228 offset:15120
    s_waitcnt lgkmcnt(8)
    v_mfma_f32_16x16x32_bf16 v[196:199], v[176:179], v[0:3], 0
    ds_read_b64_tr_b16 v[156:157], v228 offset:12824
    v_mfma_f32_16x16x32_bf16 v[216:219], v[176:179], v[4:7], 0
    ds_read_b64_tr_b16 v[158:159], v228 offset:15128
    s_waitcnt lgkmcnt(8)
    v_mfma_f32_16x16x32_bf16 v[200:203], v[180:183], v[0:3], 0
    ds_read_b64_tr_b16 v[160:161], v228 offset:12832
    v_mfma_f32_16x16x32_bf16 v[220:223], v[180:183], v[4:7], 0
    ds_read_b64_tr_b16 v[162:163], v228 offset:15136
    s_waitcnt lgkmcnt(8)
    v_mfma_f32_16x16x32_bf16 v[184:187], v[144:147], v[8:11], v[184:187]
    ds_read_b64_tr_b16 v[164:165], v228 offset:17408
    v_mfma_f32_16x16x32_bf16 v[204:207], v[144:147], v[12:15], v[204:207]
    ds_read_b64_tr_b16 v[166:167], v228 offset:19712
    s_waitcnt lgkmcnt(8)
    v_mfma_f32_16x16x32_bf16 v[188:191], v[148:151], v[8:11], v[188:191]
    ds_read_b64_tr_b16 v[168:169], v228 offset:17416
    v_mfma_f32_16x16x32_bf16 v[208:211], v[148:151], v[12:15], v[208:211]
    ds_read_b64_tr_b16 v[170:171], v228 offset:19720
    s_waitcnt lgkmcnt(8)
    v_mfma_f32_16x16x32_bf16 v[192:195], v[152:155], v[8:11], v[192:195]
    ds_read_b64_tr_b16 v[172:173], v228 offset:17424
    v_mfma_f32_16x16x32_bf16 v[212:215], v[152:155], v[12:15], v[212:215]
    ds_read_b64_tr_b16 v[174:175], v228 offset:19728
    s_waitcnt lgkmcnt(8)
    v_mfma_f32_16x16x32_bf16 v[196:199], v[156:159], v[8:11], v[196:199]
    ds_read_b64_tr_b16 v[176:177], v228 offset:17432
    v_mfma_f32_16x16x32_bf16 v[216:219], v[156:159], v[12:15], v[216:219]
    ds_read_b64_tr_b16 v[178:179], v228 offset:19736
    s_waitcnt lgkmcnt(8)
    v_mfma_f32_16x16x32_bf16 v[200:203], v[160:163], v[8:11], v[200:203]
    ds_read_b64_tr_b16 v[180:181], v228 offset:17440
    v_mfma_f32_16x16x32_bf16 v[220:223], v[160:163], v[12:15], v[220:223]
    ds_read_b64_tr_b16 v[182:183], v228 offset:19744
    s_waitcnt lgkmcnt(8)
    v_mfma_f32_16x16x32_bf16 v[184:187], v[164:167], v[16:19], v[184:187]
    ds_read_b64_tr_b16 v[144:145], v228 offset:22016
    v_mfma_f32_16x16x32_bf16 v[204:207], v[164:167], v[20:23], v[204:207]
    ds_read_b64_tr_b16 v[146:147], v228 offset:24320
    s_waitcnt lgkmcnt(8)
    v_mfma_f32_16x16x32_bf16 v[188:191], v[168:171], v[16:19], v[188:191]
    ds_read_b64_tr_b16 v[148:149], v228 offset:22024
    v_mfma_f32_16x16x32_bf16 v[208:211], v[168:171], v[20:23], v[208:211]
    ds_read_b64_tr_b16 v[150:151], v228 offset:24328
    s_waitcnt lgkmcnt(8)
    v_mfma_f32_16x16x32_bf16 v[192:195], v[172:175], v[16:19], v[192:195]
    ds_read_b64_tr_b16 v[152:153], v228 offset:22032
    v_mfma_f32_16x16x32_bf16 v[212:215], v[172:175], v[20:23], v[212:215]
    ds_read_b64_tr_b16 v[154:155], v228 offset:24336
    s_waitcnt lgkmcnt(8)
    v_mfma_f32_16x16x32_bf16 v[196:199], v[176:179], v[16:19], v[196:199]
    ds_read_b64_tr_b16 v[156:157], v228 offset:22040
    v_mfma_f32_16x16x32_bf16 v[216:219], v[176:179], v[20:23], v[216:219]
    ds_read_b64_tr_b16 v[158:159], v228 offset:24344
    s_waitcnt lgkmcnt(8)
    v_mfma_f32_16x16x32_bf16 v[200:203], v[180:183], v[16:19], v[200:203]
    ds_read_b64_tr_b16 v[160:161], v228 offset:22048
    v_mfma_f32_16x16x32_bf16 v[220:223], v[180:183], v[20:23], v[220:223]
    ds_read_b64_tr_b16 v[162:163], v228 offset:24352
    s_waitcnt lgkmcnt(8)
    v_mfma_f32_16x16x32_bf16 v[184:187], v[144:147], v[24:27], v[184:187]
    ds_read_b64_tr_b16 v[164:165], v228 offset:26624
    v_mfma_f32_16x16x32_bf16 v[204:207], v[144:147], v[28:31], v[204:207]
    ds_read_b64_tr_b16 v[166:167], v228 offset:28928
    s_waitcnt lgkmcnt(8)
    v_mfma_f32_16x16x32_bf16 v[188:191], v[148:151], v[24:27], v[188:191]
    ds_read_b64_tr_b16 v[168:169], v228 offset:26632
    v_mfma_f32_16x16x32_bf16 v[208:211], v[148:151], v[28:31], v[208:211]
    ds_read_b64_tr_b16 v[170:171], v228 offset:28936
    s_waitcnt lgkmcnt(8)
    v_mfma_f32_16x16x32_bf16 v[192:195], v[152:155], v[24:27], v[192:195]
    ds_read_b64_tr_b16 v[172:173], v228 offset:26640
    v_mfma_f32_16x16x32_bf16 v[212:215], v[152:155], v[28:31], v[212:215]
    ds_read_b64_tr_b16 v[174:175], v228 offset:28944
    s_waitcnt lgkmcnt(8)
    v_mfma_f32_16x16x32_bf16 v[196:199], v[156:159], v[24:27], v[196:199]
    ds_read_b64_tr_b16 v[176:177], v228 offset:26648
    v_mfma_f32_16x16x32_bf16 v[216:219], v[156:159], v[28:31], v[216:219]
    ds_read_b64_tr_b16 v[178:179], v228 offset:28952
    s_waitcnt lgkmcnt(8)
    v_mfma_f32_16x16x32_bf16 v[200:203], v[160:163], v[24:27], v[200:203]
    ds_read_b64_tr_b16 v[180:181], v228 offset:26656
    v_mfma_f32_16x16x32_bf16 v[220:223], v[160:163], v[28:31], v[220:223]
    ds_read_b64_tr_b16 v[182:183], v228 offset:28960
    s_waitcnt lgkmcnt(8)
    v_mfma_f32_16x16x32_bf16 v[184:187], v[164:167], v[32:35], v[184:187]
    ds_read_b64_tr_b16 v[144:145], v228 offset:31232
    v_mfma_f32_16x16x32_bf16 v[204:207], v[164:167], v[36:39], v[204:207]
    ds_read_b64_tr_b16 v[146:147], v228 offset:33536
    s_waitcnt lgkmcnt(8)
    v_mfma_f32_16x16x32_bf16 v[188:191], v[168:171], v[32:35], v[188:191]
    ds_read_b64_tr_b16 v[148:149], v228 offset:31240
    v_mfma_f32_16x16x32_bf16 v[208:211], v[168:171], v[36:39], v[208:211]
    ds_read_b64_tr_b16 v[150:151], v228 offset:33544
    s_waitcnt lgkmcnt(8)
    v_mfma_f32_16x16x32_bf16 v[192:195], v[172:175], v[32:35], v[192:195]
    ds_read_b64_tr_b16 v[152:153], v228 offset:31248
    v_mfma_f32_16x16x32_bf16 v[212:215], v[172:175], v[36:39], v[212:215]
    ds_read_b64_tr_b16 v[154:155], v228 offset:33552
    s_waitcnt lgkmcnt(8)
    v_mfma_f32_16x16x32_bf16 v[196:199], v[176:179], v[32:35], v[196:199]
    ds_read_b64_tr_b16 v[156:157], v228 offset:31256
    v_mfma_f32_16x16x32_bf16 v[216:219], v[176:179], v[36:39], v[216:219]
    ds_read_b64_tr_b16 v[158:159], v228 offset:33560
    s_waitcnt lgkmcnt(8)
    v_mfma_f32_16x16x32_bf16 v[200:203], v[180:183], v[32:35], v[200:203]
    ds_read_b64_tr_b16 v[160:161], v228 offset:31264
    v_mfma_f32_16x16x32_bf16 v[220:223], v[180:183], v[36:39], v[220:223]
    ds_read_b64_tr_b16 v[162:163], v228 offset:33568
    s_barrier
    s_waitcnt lgkmcnt(8)
    v_mfma_f32_16x16x32_bf16 v[184:187], v[144:147], v[40:43], v[184:187]
    ds_read_b64_tr_b16 v[164:165], v228 offset:35840
    v_mfma_f32_16x16x32_bf16 v[204:207], v[144:147], v[44:47], v[204:207]
    ds_read_b64_tr_b16 v[166:167], v228 offset:38144
    s_waitcnt lgkmcnt(8)
    v_mfma_f32_16x16x32_bf16 v[188:191], v[148:151], v[40:43], v[188:191]
    ds_read_b64_tr_b16 v[168:169], v228 offset:35848
    v_mfma_f32_16x16x32_bf16 v[208:211], v[148:151], v[44:47], v[208:211]
    ds_read_b64_tr_b16 v[170:171], v228 offset:38152
    s_waitcnt lgkmcnt(8)
    v_mfma_f32_16x16x32_bf16 v[192:195], v[152:155], v[40:43], v[192:195]
    ds_read_b64_tr_b16 v[172:173], v228 offset:35856
    v_mfma_f32_16x16x32_bf16 v[212:215], v[152:155], v[44:47], v[212:215]
    ds_read_b64_tr_b16 v[174:175], v228 offset:38160
    s_waitcnt lgkmcnt(8)
    v_mfma_f32_16x16x32_bf16 v[196:199], v[156:159], v[40:43], v[196:199]
    ds_read_b64_tr_b16 v[176:177], v228 offset:35864
    v_mfma_f32_16x16x32_bf16 v[216:219], v[156:159], v[44:47], v[216:219]
    ds_read_b64_tr_b16 v[178:179], v228 offset:38168
    s_waitcnt lgkmcnt(8)
    v_mfma_f32_16x16x32_bf16 v[200:203], v[160:163], v[40:43], v[200:203]
    ds_read_b64_tr_b16 v[180:181], v228 offset:35872
    v_mfma_f32_16x16x32_bf16 v[220:223], v[160:163], v[44:47], v[220:223]
    ds_read_b64_tr_b16 v[182:183], v228 offset:38176
    s_waitcnt lgkmcnt(8)
    v_mfma_f32_16x16x32_bf16 v[184:187], v[164:167], v[48:51], v[184:187]
    ds_read_b64_tr_b16 v[144:145], v228 offset:40448
    v_mfma_f32_16x16x32_bf16 v[204:207], v[164:167], v[52:55], v[204:207]
    ds_read_b64_tr_b16 v[146:147], v228 offset:42752
    s_waitcnt lgkmcnt(8)
    v_mfma_f32_16x16x32_bf16 v[188:191], v[168:171], v[48:51], v[188:191]
    ds_read_b64_tr_b16 v[148:149], v228 offset:40456
    v_mfma_f32_16x16x32_bf16 v[208:211], v[168:171], v[52:55], v[208:211]
    ds_read_b64_tr_b16 v[150:151], v228 offset:42760
    s_waitcnt lgkmcnt(8)
    v_mfma_f32_16x16x32_bf16 v[192:195], v[172:175], v[48:51], v[192:195]
    ds_read_b64_tr_b16 v[152:153], v228 offset:40464
    v_mfma_f32_16x16x32_bf16 v[212:215], v[172:175], v[52:55], v[212:215]
    ds_read_b64_tr_b16 v[154:155], v228 offset:42768
    s_waitcnt lgkmcnt(8)
    v_mfma_f32_16x16x32_bf16 v[196:199], v[176:179], v[48:51], v[196:199]
    ds_read_b64_tr_b16 v[156:157], v228 offset:40472
    v_mfma_f32_16x16x32_bf16 v[216:219], v[176:179], v[52:55], v[216:219]
    ds_read_b64_tr_b16 v[158:159], v228 offset:42776
    s_waitcnt lgkmcnt(8)
    v_mfma_f32_16x16x32_bf16 v[200:203], v[180:183], v[48:51], v[200:203]
    ds_read_b64_tr_b16 v[160:161], v228 offset:40480
    v_mfma_f32_16x16x32_bf16 v[220:223], v[180:183], v[52:55], v[220:223]
    ds_read_b64_tr_b16 v[162:163], v228 offset:42784
    s_waitcnt lgkmcnt(8)
    v_mfma_f32_16x16x32_bf16 v[184:187], v[144:147], v[56:59], v[184:187]
    ds_read_b64_tr_b16 v[164:165], v228 offset:45056
    v_mfma_f32_16x16x32_bf16 v[204:207], v[144:147], v[60:63], v[204:207]
    ds_read_b64_tr_b16 v[166:167], v228 offset:47360
    s_waitcnt lgkmcnt(8)
    v_mfma_f32_16x16x32_bf16 v[188:191], v[148:151], v[56:59], v[188:191]
    ds_read_b64_tr_b16 v[168:169], v228 offset:45064
    v_mfma_f32_16x16x32_bf16 v[208:211], v[148:151], v[60:63], v[208:211]
    ds_read_b64_tr_b16 v[170:171], v228 offset:47368
    s_waitcnt lgkmcnt(8)
    v_mfma_f32_16x16x32_bf16 v[192:195], v[152:155], v[56:59], v[192:195]
    ds_read_b64_tr_b16 v[172:173], v228 offset:45072
    v_mfma_f32_16x16x32_bf16 v[212:215], v[152:155], v[60:63], v[212:215]
    ds_read_b64_tr_b16 v[174:175], v228 offset:47376
    s_waitcnt lgkmcnt(8)
    v_mfma_f32_16x16x32_bf16 v[196:199], v[156:159], v[56:59], v[196:199]
    ds_read_b64_tr_b16 v[176:177], v228 offset:45080
    v_mfma_f32_16x16x32_bf16 v[216:219], v[156:159], v[60:63], v[216:219]
    ds_read_b64_tr_b16 v[178:179], v228 offset:47384
    s_waitcnt lgkmcnt(8)
    v_mfma_f32_16x16x32_bf16 v[200:203], v[160:163], v[56:59], v[200:203]
    ds_read_b64_tr_b16 v[180:181], v228 offset:45088
    v_mfma_f32_16x16x32_bf16 v[220:223], v[160:163], v[60:63], v[220:223]
    ds_read_b64_tr_b16 v[182:183], v228 offset:47392
    s_waitcnt lgkmcnt(8)
    v_mfma_f32_16x16x32_bf16 v[184:187], v[164:167], v[64:67], v[184:187]
    ds_read_b64_tr_b16 v[144:145], v228 offset:49664
    v_mfma_f32_16x16x32_bf16 v[204:207], v[164:167], v[68:71], v[204:207]
    ds_read_b64_tr_b16 v[146:147], v228 offset:51968
    s_waitcnt lgkmcnt(8)
    v_mfma_f32_16x16x32_bf16 v[188:191], v[168:171], v[64:67], v[188:191]
    ds_read_b64_tr_b16 v[148:149], v228 offset:49672
    v_mfma_f32_16x16x32_bf16 v[208:211], v[168:171], v[68:71], v[208:211]
    ds_read_b64_tr_b16 v[150:151], v228 offset:51976
    s_waitcnt lgkmcnt(8)
    v_mfma_f32_16x16x32_bf16 v[192:195], v[172:175], v[64:67], v[192:195]
    ds_read_b64_tr_b16 v[152:153], v228 offset:49680
    v_mfma_f32_16x16x32_bf16 v[212:215], v[172:175], v[68:71], v[212:215]
    ds_read_b64_tr_b16 v[154:155], v228 offset:51984
    s_waitcnt lgkmcnt(8)
    v_mfma_f32_16x16x32_bf16 v[196:199], v[176:179], v[64:67], v[196:199]
    ds_read_b64_tr_b16 v[156:157], v228 offset:49688
    v_mfma_f32_16x16x32_bf16 v[216:219], v[176:179], v[68:71], v[216:219]
    ds_read_b64_tr_b16 v[158:159], v228 offset:51992
    s_waitcnt lgkmcnt(8)
    v_mfma_f32_16x16x32_bf16 v[200:203], v[180:183], v[64:67], v[200:203]
    ds_read_b64_tr_b16 v[160:161], v228 offset:49696
    v_mfma_f32_16x16x32_bf16 v[220:223], v[180:183], v[68:71], v[220:223]
    ds_read_b64_tr_b16 v[162:163], v228 offset:52000
    s_waitcnt lgkmcnt(8)
    v_mfma_f32_16x16x32_bf16 v[184:187], v[144:147], v[72:75], v[184:187]
    ds_read_b64_tr_b16 v[164:165], v228 offset:54272
    v_mfma_f32_16x16x32_bf16 v[204:207], v[144:147], v[76:79], v[204:207]
    ds_read_b64_tr_b16 v[166:167], v228 offset:56576
    s_waitcnt lgkmcnt(8)
    v_mfma_f32_16x16x32_bf16 v[188:191], v[148:151], v[72:75], v[188:191]
    ds_read_b64_tr_b16 v[168:169], v228 offset:54280
    v_mfma_f32_16x16x32_bf16 v[208:211], v[148:151], v[76:79], v[208:211]
    ds_read_b64_tr_b16 v[170:171], v228 offset:56584
    s_waitcnt lgkmcnt(8)
    v_mfma_f32_16x16x32_bf16 v[192:195], v[152:155], v[72:75], v[192:195]
    ds_read_b64_tr_b16 v[172:173], v228 offset:54288
    v_mfma_f32_16x16x32_bf16 v[212:215], v[152:155], v[76:79], v[212:215]
    ds_read_b64_tr_b16 v[174:175], v228 offset:56592
    s_waitcnt lgkmcnt(8)
    v_mfma_f32_16x16x32_bf16 v[196:199], v[156:159], v[72:75], v[196:199]
    ds_read_b64_tr_b16 v[176:177], v228 offset:54296
    v_mfma_f32_16x16x32_bf16 v[216:219], v[156:159], v[76:79], v[216:219]
    ds_read_b64_tr_b16 v[178:179], v228 offset:56600
    s_waitcnt lgkmcnt(8)
    v_mfma_f32_16x16x32_bf16 v[200:203], v[160:163], v[72:75], v[200:203]
    ds_read_b64_tr_b16 v[180:181], v228 offset:54304
    v_mfma_f32_16x16x32_bf16 v[220:223], v[160:163], v[76:79], v[220:223]
    ds_read_b64_tr_b16 v[182:183], v228 offset:56608
    s_waitcnt lgkmcnt(8)
    v_mfma_f32_16x16x32_bf16 v[184:187], v[164:167], v[80:83], v[184:187]
    ds_read_b64_tr_b16 v[144:145], v228 offset:58880
    v_mfma_f32_16x16x32_bf16 v[204:207], v[164:167], v[84:87], v[204:207]
    ds_read_b64_tr_b16 v[146:147], v228 offset:61184
    s_waitcnt lgkmcnt(8)
    v_mfma_f32_16x16x32_bf16 v[188:191], v[168:171], v[80:83], v[188:191]
    ds_read_b64_tr_b16 v[148:149], v228 offset:58888
    v_mfma_f32_16x16x32_bf16 v[208:211], v[168:171], v[84:87], v[208:211]
    ds_read_b64_tr_b16 v[150:151], v228 offset:61192
    s_waitcnt lgkmcnt(8)
    v_mfma_f32_16x16x32_bf16 v[192:195], v[172:175], v[80:83], v[192:195]
    ds_read_b64_tr_b16 v[152:153], v228 offset:58896
    v_mfma_f32_16x16x32_bf16 v[212:215], v[172:175], v[84:87], v[212:215]
    ds_read_b64_tr_b16 v[154:155], v228 offset:61200
    s_waitcnt lgkmcnt(8)
    v_mfma_f32_16x16x32_bf16 v[196:199], v[176:179], v[80:83], v[196:199]
    ds_read_b64_tr_b16 v[156:157], v228 offset:58904
    v_mfma_f32_16x16x32_bf16 v[216:219], v[176:179], v[84:87], v[216:219]
    ds_read_b64_tr_b16 v[158:159], v228 offset:61208
    s_waitcnt lgkmcnt(8)
    v_mfma_f32_16x16x32_bf16 v[200:203], v[180:183], v[80:83], v[200:203]
    ds_read_b64_tr_b16 v[160:161], v228 offset:58912
    v_mfma_f32_16x16x32_bf16 v[220:223], v[180:183], v[84:87], v[220:223]
    ds_read_b64_tr_b16 v[162:163], v228 offset:61216
    s_waitcnt lgkmcnt(8)
    v_mfma_f32_16x16x32_bf16 v[184:187], v[144:147], v[88:91], v[184:187]
    ds_read_b64_tr_b16 v[164:165], v228 offset:63488
    v_mfma_f32_16x16x32_bf16 v[204:207], v[144:147], v[92:95], v[204:207]
    v_add_u32 v228, 0x0000e000, v228
    ds_read_b64_tr_b16 v[166:167], v228 offset:8448
    s_waitcnt lgkmcnt(8)
    v_mfma_f32_16x16x32_bf16 v[188:191], v[148:151], v[88:91], v[188:191]
    ds_read_b64_tr_b16 v[168:169], v228 offset:6152
    v_mfma_f32_16x16x32_bf16 v[208:211], v[148:151], v[92:95], v[208:211]
    ds_read_b64_tr_b16 v[170:171], v228 offset:8456
    s_waitcnt lgkmcnt(8)
    v_mfma_f32_16x16x32_bf16 v[192:195], v[152:155], v[88:91], v[192:195]
    ds_read_b64_tr_b16 v[172:173], v228 offset:6160
    v_mfma_f32_16x16x32_bf16 v[212:215], v[152:155], v[92:95], v[212:215]
    ds_read_b64_tr_b16 v[174:175], v228 offset:8464
    s_waitcnt lgkmcnt(8)
    v_mfma_f32_16x16x32_bf16 v[196:199], v[156:159], v[88:91], v[196:199]
    ds_read_b64_tr_b16 v[176:177], v228 offset:6168
    v_mfma_f32_16x16x32_bf16 v[216:219], v[156:159], v[92:95], v[216:219]
    ds_read_b64_tr_b16 v[178:179], v228 offset:8472
    s_waitcnt lgkmcnt(8)
    v_mfma_f32_16x16x32_bf16 v[200:203], v[160:163], v[88:91], v[200:203]
    ds_read_b64_tr_b16 v[180:181], v228 offset:6176
    v_mfma_f32_16x16x32_bf16 v[220:223], v[160:163], v[92:95], v[220:223]
    ds_read_b64_tr_b16 v[182:183], v228 offset:8480
    s_waitcnt lgkmcnt(8)
    v_mfma_f32_16x16x32_bf16 v[184:187], v[164:167], v[96:99], v[184:187]
    ds_read_b64_tr_b16 v[144:145], v228 offset:10752
    v_mfma_f32_16x16x32_bf16 v[204:207], v[164:167], v[100:103], v[204:207]
    ds_read_b64_tr_b16 v[146:147], v228 offset:13056
    s_waitcnt lgkmcnt(8)
    v_mfma_f32_16x16x32_bf16 v[188:191], v[168:171], v[96:99], v[188:191]
    ds_read_b64_tr_b16 v[148:149], v228 offset:10760
    ds_read_b64_tr_b16 v[0:1], v229 offset:0
    v_mfma_f32_16x16x32_bf16 v[208:211], v[168:171], v[100:103], v[208:211]
    ds_read_b64_tr_b16 v[150:151], v228 offset:13064
    s_waitcnt lgkmcnt(9)
    v_mfma_f32_16x16x32_bf16 v[192:195], v[172:175], v[96:99], v[192:195]
    ds_read_b64_tr_b16 v[152:153], v228 offset:10768
    v_mfma_f32_16x16x32_bf16 v[212:215], v[172:175], v[100:103], v[212:215]
    ds_read_b64_tr_b16 v[154:155], v228 offset:13072
    ds_read_b64_tr_b16 v[2:3], v229 offset:160
    s_waitcnt lgkmcnt(10)
    v_mfma_f32_16x16x32_bf16 v[196:199], v[176:179], v[96:99], v[196:199]
    ds_read_b64_tr_b16 v[156:157], v228 offset:10776
    v_mfma_f32_16x16x32_bf16 v[216:219], v[176:179], v[100:103], v[216:219]
    ds_read_b64_tr_b16 v[158:159], v228 offset:13080
    s_waitcnt lgkmcnt(10)
    v_mfma_f32_16x16x32_bf16 v[200:203], v[180:183], v[96:99], v[200:203]
    ds_read_b64_tr_b16 v[160:161], v228 offset:10784
    ds_read_b64_tr_b16 v[4:5], v229 offset:320
    v_mfma_f32_16x16x32_bf16 v[220:223], v[180:183], v[100:103], v[220:223]
    ds_read_b64_tr_b16 v[162:163], v228 offset:13088
    s_waitcnt lgkmcnt(11)
    v_mfma_f32_16x16x32_bf16 v[184:187], v[144:147], v[104:107], v[184:187]
    ds_read_b64_tr_b16 v[164:165], v228 offset:15360
    v_mfma_f32_16x16x32_bf16 v[204:207], v[144:147], v[108:111], v[204:207]
    ds_read_b64_tr_b16 v[166:167], v228 offset:17664
    s_waitcnt lgkmcnt(10)
    v_mfma_f32_16x16x32_bf16 v[188:191], v[148:151], v[104:107], v[188:191]
    ds_read_b64_tr_b16 v[168:169], v228 offset:15368
    ds_read_b64_tr_b16 v[6:7], v229 offset:480
    v_mfma_f32_16x16x32_bf16 v[208:211], v[148:151], v[108:111], v[208:211]
    ds_read_b64_tr_b16 v[170:171], v228 offset:17672
    s_waitcnt lgkmcnt(11)
    v_mfma_f32_16x16x32_bf16 v[192:195], v[152:155], v[104:107], v[192:195]
    ds_read_b64_tr_b16 v[172:173], v228 offset:15376
    v_mfma_f32_16x16x32_bf16 v[212:215], v[152:155], v[108:111], v[212:215]
    ds_read_b64_tr_b16 v[174:175], v228 offset:17680
    ds_read_b64_tr_b16 v[8:9], v229 offset:640
    s_waitcnt lgkmcnt(11)
    v_mfma_f32_16x16x32_bf16 v[196:199], v[156:159], v[104:107], v[196:199]
    ds_read_b64_tr_b16 v[176:177], v228 offset:15384
    v_mfma_f32_16x16x32_bf16 v[216:219], v[156:159], v[108:111], v[216:219]
    ds_read_b64_tr_b16 v[178:179], v228 offset:17688
    s_waitcnt lgkmcnt(10)
    v_mfma_f32_16x16x32_bf16 v[200:203], v[160:163], v[104:107], v[200:203]
    ds_read_b64_tr_b16 v[180:181], v228 offset:15392
    ds_read_b64_tr_b16 v[10:11], v229 offset:8
    v_mfma_f32_16x16x32_bf16 v[220:223], v[160:163], v[108:111], v[220:223]
    ds_read_b64_tr_b16 v[182:183], v228 offset:17696
    s_waitcnt lgkmcnt(11)
    v_mfma_f32_16x16x32_bf16 v[184:187], v[164:167], v[112:115], v[184:187]
    ds_read_b64_tr_b16 v[144:145], v228 offset:19968
    v_mfma_f32_16x16x32_bf16 v[204:207], v[164:167], v[116:119], v[204:207]
    ds_read_b64_tr_b16 v[146:147], v228 offset:22272
    s_waitcnt lgkmcnt(10)
    v_mfma_f32_16x16x32_bf16 v[188:191], v[168:171], v[112:115], v[188:191]
    ds_read_b64_tr_b16 v[148:149], v228 offset:19976
    ds_read_b64_tr_b16 v[12:13], v229 offset:168
    v_mfma_f32_16x16x32_bf16 v[208:211], v[168:171], v[116:119], v[208:211]
    ds_read_b64_tr_b16 v[150:151], v228 offset:22280
    s_waitcnt lgkmcnt(11)
    v_mfma_f32_16x16x32_bf16 v[192:195], v[172:175], v[112:115], v[192:195]
    ds_read_b64_tr_b16 v[152:153], v228 offset:19984
    v_mfma_f32_16x16x32_bf16 v[212:215], v[172:175], v[116:119], v[212:215]
    ds_read_b64_tr_b16 v[154:155], v228 offset:22288
    ds_read_b64_tr_b16 v[14:15], v229 offset:328
    s_waitcnt lgkmcnt(11)
    v_mfma_f32_16x16x32_bf16 v[196:199], v[176:179], v[112:115], v[196:199]
    ds_read_b64_tr_b16 v[156:157], v228 offset:19992
    v_mfma_f32_16x16x32_bf16 v[216:219], v[176:179], v[116:119], v[216:219]
    ds_read_b64_tr_b16 v[158:159], v228 offset:22296
    s_waitcnt lgkmcnt(10)
    v_mfma_f32_16x16x32_bf16 v[200:203], v[180:183], v[112:115], v[200:203]
    ds_read_b64_tr_b16 v[160:161], v228 offset:20000
    ds_read_b64_tr_b16 v[16:17], v229 offset:488
    v_mfma_f32_16x16x32_bf16 v[220:223], v[180:183], v[116:119], v[220:223]
    ds_read_b64_tr_b16 v[162:163], v228 offset:22304
    s_waitcnt lgkmcnt(11)
    v_mfma_f32_16x16x32_bf16 v[184:187], v[144:147], v[120:123], v[184:187]
    ds_read_b64_tr_b16 v[164:165], v228 offset:24576
    v_mfma_f32_16x16x32_bf16 v[204:207], v[144:147], v[124:127], v[204:207]
    ds_read_b64_tr_b16 v[166:167], v228 offset:26880
    s_waitcnt lgkmcnt(10)
    v_mfma_f32_16x16x32_bf16 v[188:191], v[148:151], v[120:123], v[188:191]
    ds_read_b64_tr_b16 v[168:169], v228 offset:24584
    ds_read_b64_tr_b16 v[18:19], v229 offset:648
    v_mfma_f32_16x16x32_bf16 v[208:211], v[148:151], v[124:127], v[208:211]
    ds_read_b64_tr_b16 v[170:171], v228 offset:26888
    s_waitcnt lgkmcnt(11)
    v_mfma_f32_16x16x32_bf16 v[192:195], v[152:155], v[120:123], v[192:195]
    ds_read_b64_tr_b16 v[172:173], v228 offset:24592
    v_mfma_f32_16x16x32_bf16 v[212:215], v[152:155], v[124:127], v[212:215]
    ds_read_b64_tr_b16 v[174:175], v228 offset:26896
    ds_read_b64_tr_b16 v[20:21], v229 offset:16
    s_waitcnt lgkmcnt(11)
    v_mfma_f32_16x16x32_bf16 v[196:199], v[156:159], v[120:123], v[196:199]
    ds_read_b64_tr_b16 v[176:177], v228 offset:24600
    v_mfma_f32_16x16x32_bf16 v[216:219], v[156:159], v[124:127], v[216:219]
    ds_read_b64_tr_b16 v[178:179], v228 offset:26904
    s_waitcnt lgkmcnt(10)
    v_mfma_f32_16x16x32_bf16 v[200:203], v[160:163], v[120:123], v[200:203]
    ds_read_b64_tr_b16 v[180:181], v228 offset:24608
    ds_read_b64_tr_b16 v[22:23], v229 offset:176
    v_mfma_f32_16x16x32_bf16 v[220:223], v[160:163], v[124:127], v[220:223]
    ds_read_b64_tr_b16 v[182:183], v228 offset:26912
    s_waitcnt lgkmcnt(11)
    v_mfma_f32_16x16x32_bf16 v[184:187], v[164:167], v[128:131], v[184:187]
    ds_read_b64_tr_b16 v[144:145], v228 offset:29184
    v_mfma_f32_16x16x32_bf16 v[204:207], v[164:167], v[132:135], v[204:207]
    ds_read_b64_tr_b16 v[146:147], v228 offset:31488
    s_waitcnt lgkmcnt(10)
    v_mfma_f32_16x16x32_bf16 v[188:191], v[168:171], v[128:131], v[188:191]
    ds_read_b64_tr_b16 v[148:149], v228 offset:29192
    ds_read_b64_tr_b16 v[24:25], v229 offset:336
    v_mfma_f32_16x16x32_bf16 v[208:211], v[168:171], v[132:135], v[208:211]
    ds_read_b64_tr_b16 v[150:151], v228 offset:31496
    s_waitcnt lgkmcnt(11)
    v_mfma_f32_16x16x32_bf16 v[192:195], v[172:175], v[128:131], v[192:195]
    ds_read_b64_tr_b16 v[152:153], v228 offset:29200
    v_mfma_f32_16x16x32_bf16 v[212:215], v[172:175], v[132:135], v[212:215]
    ds_read_b64_tr_b16 v[154:155], v228 offset:31504
    ds_read_b64_tr_b16 v[26:27], v229 offset:496
    s_waitcnt lgkmcnt(11)
    v_mfma_f32_16x16x32_bf16 v[196:199], v[176:179], v[128:131], v[196:199]
    ds_read_b64_tr_b16 v[156:157], v228 offset:29208
    v_mfma_f32_16x16x32_bf16 v[216:219], v[176:179], v[132:135], v[216:219]
    ds_read_b64_tr_b16 v[158:159], v228 offset:31512
    s_waitcnt lgkmcnt(10)
    v_mfma_f32_16x16x32_bf16 v[200:203], v[180:183], v[128:131], v[200:203]
    ds_read_b64_tr_b16 v[160:161], v228 offset:29216
    ds_read_b64_tr_b16 v[28:29], v229 offset:656
    v_mfma_f32_16x16x32_bf16 v[220:223], v[180:183], v[132:135], v[220:223]
    ds_read_b64_tr_b16 v[162:163], v228 offset:31520
    s_waitcnt lgkmcnt(11)
    v_mfma_f32_16x16x32_bf16 v[184:187], v[144:147], v[136:139], v[184:187]
    ds_read_b64_tr_b16 v[30:31], v229 offset:24
    v_mfma_f32_16x16x32_bf16 v[204:207], v[144:147], v[140:143], v[204:207]
    ds_read_b64_tr_b16 v[32:33], v229 offset:184
    s_waitcnt lgkmcnt(10)
    v_mfma_f32_16x16x32_bf16 v[188:191], v[148:151], v[136:139], v[188:191]
    ds_read_b64_tr_b16 v[34:35], v229 offset:344
    v_mfma_f32_16x16x32_bf16 v[208:211], v[148:151], v[140:143], v[208:211]
    ds_read_b64_tr_b16 v[36:37], v229 offset:504
    s_waitcnt lgkmcnt(10)
    v_mfma_f32_16x16x32_bf16 v[192:195], v[152:155], v[136:139], v[192:195]
    ds_read_b64_tr_b16 v[38:39], v229 offset:664
    v_mfma_f32_16x16x32_bf16 v[212:215], v[152:155], v[140:143], v[212:215]
    ds_read_b64_tr_b16 v[40:41], v229 offset:32
    s_waitcnt lgkmcnt(9)
    v_mfma_f32_16x16x32_bf16 v[196:199], v[156:159], v[136:139], v[196:199]
    ds_read_b64_tr_b16 v[42:43], v229 offset:192
    v_mfma_f32_16x16x32_bf16 v[216:219], v[156:159], v[140:143], v[216:219]
    ds_read_b64_tr_b16 v[44:45], v229 offset:352
    s_waitcnt lgkmcnt(8)
    v_mfma_f32_16x16x32_bf16 v[200:203], v[160:163], v[136:139], v[200:203]
    ds_read_b64_tr_b16 v[46:47], v229 offset:512
    v_mfma_f32_16x16x32_bf16 v[220:223], v[160:163], v[140:143], v[220:223]
    ds_read_b64_tr_b16 v[48:49], v229 offset:672
    s_waitcnt lgkmcnt(0)
    s_barrier
    ds_read_b128 v[92:95], v231 offset:320
    ds_read_b128 v[96:99], v231 offset:384
    ds_read_b128 v[100:103], v231 offset:448
    ds_read_b128 v[128:131], v231 offset:256
    ds_read_b128 v[112:115], v231 offset:0
    ds_read_b128 v[116:119], v231 offset:64
    ds_read_b128 v[120:123], v231 offset:128
    ds_read_b128 v[124:127], v231 offset:192
    s_waitcnt lgkmcnt(6)
    v_pk_add_f32 v[92:93], v[92:93], v[96:97]
    v_pk_add_f32 v[94:95], v[94:95], v[98:99]
    s_waitcnt lgkmcnt(4)
    v_pk_add_f32 v[128:129], v[128:129], v[100:101]
    v_pk_add_f32 v[130:131], v[130:131], v[102:103]
    v_pk_add_f32 v[128:129], v[128:129], v[92:93]
    v_pk_add_f32 v[130:131], v[130:131], v[94:95]
    s_mov_b32 s70, 0xffff
    s_mov_b32 s71, 0xffff
    s_waitcnt lgkmcnt(3)
    v_pk_fma_f32 v[184:185], v[112:113], v[238:239], v[184:185] op_sel_hi:[1,0,1]
    v_pk_fma_f32 v[186:187], v[114:115], v[238:239], v[186:187] op_sel_hi:[1,0,1]
    s_waitcnt lgkmcnt(2)
    v_pk_fma_f32 v[188:189], v[116:117], v[238:239], v[188:189] op_sel_hi:[1,0,1]
    v_pk_fma_f32 v[190:191], v[118:119], v[238:239], v[190:191] op_sel_hi:[1,0,1]
    s_waitcnt lgkmcnt(1)
    v_pk_fma_f32 v[192:193], v[120:121], v[238:239], v[192:193] op_sel_hi:[1,0,1]
    v_pk_fma_f32 v[194:195], v[122:123], v[238:239], v[194:195] op_sel_hi:[1,0,1]
    s_waitcnt lgkmcnt(0)
    v_pk_fma_f32 v[196:197], v[124:125], v[238:239], v[196:197] op_sel_hi:[1,0,1]
    v_pk_fma_f32 v[198:199], v[126:127], v[238:239], v[198:199] op_sel_hi:[1,0,1]
    v_pk_fma_f32 v[200:201], v[128:129], v[238:239], v[200:201] op_sel_hi:[1,0,1]
    v_pk_fma_f32 v[202:203], v[130:131], v[238:239], v[202:203] op_sel_hi:[1,0,1]
    v_cndmask_b32 v202, v202, v184, s[70:71]
    v_cndmask_b32 v203, v203, v185, s[70:71]
    v_cvt_pk_bf16_f32 v132, v186, v187
    v_cvt_pk_bf16_f32 v133, v188, v189
    v_cvt_pk_bf16_f32 v134, v190, v191
    v_cvt_pk_bf16_f32 v135, v192, v193
    v_cvt_pk_bf16_f32 v136, v194, v195
    v_cvt_pk_bf16_f32 v137, v196, v197
    v_cvt_pk_bf16_f32 v138, v198, v199
    v_cvt_pk_bf16_f32 v139, v200, v201
    v_cvt_pk_bf16_f32 v140, v202, v203
    v_mov_b32 v141, 0
    s_mov_b32 s70, 0xffff
    s_mov_b32 s71, 0xffff
    v_pk_fma_f32 v[204:205], v[112:113], v[240:241], v[204:205] op_sel_hi:[1,0,1]
    v_pk_fma_f32 v[206:207], v[114:115], v[240:241], v[206:207] op_sel_hi:[1,0,1]
    v_pk_fma_f32 v[208:209], v[116:117], v[240:241], v[208:209] op_sel_hi:[1,0,1]
    v_pk_fma_f32 v[210:211], v[118:119], v[240:241], v[210:211] op_sel_hi:[1,0,1]
    v_pk_fma_f32 v[212:213], v[120:121], v[240:241], v[212:213] op_sel_hi:[1,0,1]
    v_pk_fma_f32 v[214:215], v[122:123], v[240:241], v[214:215] op_sel_hi:[1,0,1]
    v_pk_fma_f32 v[216:217], v[124:125], v[240:241], v[216:217] op_sel_hi:[1,0,1]
    v_pk_fma_f32 v[218:219], v[126:127], v[240:241], v[218:219] op_sel_hi:[1,0,1]
    v_pk_fma_f32 v[220:221], v[128:129], v[240:241], v[220:221] op_sel_hi:[1,0,1]
    v_pk_fma_f32 v[222:223], v[130:131], v[240:241], v[222:223] op_sel_hi:[1,0,1]
    v_cndmask_b32 v222, v222, v204, s[70:71]
    v_cndmask_b32 v223, v223, v205, s[70:71]
    v_cvt_pk_bf16_f32 v142, v206, v207
    v_cvt_pk_bf16_f32 v143, v208, v209
    v_cvt_pk_bf16_f32 v144, v210, v211
    v_cvt_pk_bf16_f32 v145, v212, v213
    v_cvt_pk_bf16_f32 v146, v214, v215
    v_cvt_pk_bf16_f32 v147, v216, v217
    v_cvt_pk_bf16_f32 v148, v218, v219
    v_cvt_pk_bf16_f32 v149, v220, v221
    v_cvt_pk_bf16_f32 v150, v222, v223
    v_mov_b32 v151, 0
    v_mfma_f32_16x16x32_bf16 v[52:55], v[0:3], v[132:135], 0
    v_mfma_f32_16x16x32_bf16 v[56:59], v[10:13], v[132:135], 0
    v_mfma_f32_16x16x32_bf16 v[60:63], v[20:23], v[132:135], 0
    v_mfma_f32_16x16x32_bf16 v[64:67], v[30:33], v[132:135], 0
    v_mfma_f32_16x16x32_bf16 v[68:71], v[40:43], v[132:135], 0
    v_mfma_f32_16x16x32_bf16 v[52:55], v[4:7], v[136:139], v[52:55]
    v_mfma_f32_16x16x32_bf16 v[56:59], v[14:17], v[136:139], v[56:59]
    v_mfma_f32_16x16x32_bf16 v[60:63], v[24:27], v[136:139], v[60:63]
    v_mfma_f32_16x16x32_bf16 v[64:67], v[34:37], v[136:139], v[64:67]
    v_mfma_f32_16x16x32_bf16 v[68:71], v[44:47], v[136:139], v[68:71]
    v_mfma_f32_16x16x16_bf16 v[52:55], v[8:9], v[140:141], v[52:55]
    v_mfma_f32_16x16x16_bf16 v[56:59], v[18:19], v[140:141], v[56:59]
    v_mfma_f32_16x16x16_bf16 v[60:63], v[28:29], v[140:141], v[60:63]
    v_mfma_f32_16x16x16_bf16 v[64:67], v[38:39], v[140:141], v[64:67]
    v_mfma_f32_16x16x16_bf16 v[68:71], v[48:49], v[140:141], v[68:71]
    v_mfma_f32_16x16x32_bf16 v[72:75], v[0:3], v[142:145], 0
    v_mfma_f32_16x16x32_bf16 v[76:79], v[10:13], v[142:145], 0
    v_mfma_f32_16x16x32_bf16 v[80:83], v[20:23], v[142:145], 0
    v_mfma_f32_16x16x32_bf16 v[84:87], v[30:33], v[142:145], 0
    v_mfma_f32_16x16x32_bf16 v[88:91], v[40:43], v[142:145], 0
    v_mfma_f32_16x16x32_bf16 v[72:75], v[4:7], v[146:149], v[72:75]
    v_mfma_f32_16x16x32_bf16 v[76:79], v[14:17], v[146:149], v[76:79]
    v_mfma_f32_16x16x32_bf16 v[80:83], v[24:27], v[146:149], v[80:83]
    v_mfma_f32_16x16x32_bf16 v[84:87], v[34:37], v[146:149], v[84:87]
    v_mfma_f32_16x16x32_bf16 v[88:91], v[44:47], v[146:149], v[88:91]
    v_mfma_f32_16x16x16_bf16 v[72:75], v[8:9], v[150:151], v[72:75]
    v_mfma_f32_16x16x16_bf16 v[76:79], v[18:19], v[150:151], v[76:79]
    v_mfma_f32_16x16x16_bf16 v[80:83], v[28:29], v[150:151], v[80:83]
    v_mfma_f32_16x16x16_bf16 v[84:87], v[38:39], v[150:151], v[84:87]
    v_mfma_f32_16x16x16_bf16 v[88:91], v[48:49], v[150:151], v[88:91]
    v_lshrrev_b32 v231, 4, v255
    v_lshrrev_b32 v229, 2, v255
    v_sub_u32 v229, v229, v231
    v_and_b32 v229, 3, v229
    v_lshlrev_b32 v230, 8, v229
    v_lshl_add_u32 v230, v231, 6, v230
    v_and_b32 v231, 3, v255
    v_lshl_add_u32 v230, v231, 4, v230
    v_cmp_eq_u32 vcc, 0, v229
    s_nop 1
    v_cndmask_b32 v231, 0, -1, vcc
    s_lshl_b32 s64, s57, 4
    s_add_u32 s64, s64, s56
    s_lshl_b32 s64, s64, 8
    s_add_u32 s69, s64, 217088
    s_lshl_b32 s68, s57, 13
    s_add_u32 s68, s68, 544768
    s_lshr_b32 s64, s56, 1
    s_lshl_b32 s64, s64, 3
    s_add_u32 s64, s64, s57
    s_lshl_b32 s64, s64, 1
    s_and_b32 s65, s56, 1
    s_add_u32 s64, s64, s65
    s_lshl_b32 s64, s64, 2
    s_add_u32 s64, s64, s49
    s_mul_i32 s58, s64, 5120
    s_add_u32 s58, s58, 8912896
    s_add_u32 s59, s58, 4096
    s_lshl_b32 s101, s64, 9
    s_add_u32 s101, s101, 249872
    v_max3_f32 v152, v52, v53, v54
    v_min3_f32 v153, v52, v53, v54
    v_max3_f32 v152, v152, v55, v56
    v_min3_f32 v153, v153, v55, v56
    v_max3_f32 v152, v152, v57, v58
    v_min3_f32 v153, v153, v57, v58
    v_max3_f32 v152, v152, v59, v60
    v_min3_f32 v153, v153, v59, v60
    v_max3_f32 v152, v152, v61, v62
    v_min3_f32 v153, v153, v61, v62
    v_max3_f32 v152, v152, v63, v64
    v_min3_f32 v153, v153, v63, v64
    v_max3_f32 v152, v152, v65, v66
    v_min3_f32 v153, v153, v65, v66
    v_max3_f32 v152, v152, v67, v68
    v_min3_f32 v153, v153, v67, v68
    v_max_f32 v152, v152, v69
    v_min_f32 v153, v153, v69
    v_pk_mul_f32 v[152:153], v[152:153], v[238:239] op_sel:[0,1] op_sel_hi:[1,1]
    v_pk_fma_f32 v[92:93], v[52:53], v[238:239], v[152:153] op_sel:[0,1,0] op_sel_hi:[1,1,0] neg_lo:[0,0,1] neg_hi:[0,0,1]
    v_pk_fma_f32 v[94:95], v[54:55], v[238:239], v[152:153] op_sel:[0,1,0] op_sel_hi:[1,1,0] neg_lo:[0,0,1] neg_hi:[0,0,1]
    v_pk_fma_f32 v[96:97], v[56:57], v[238:239], v[152:153] op_sel:[0,1,0] op_sel_hi:[1,1,0] neg_lo:[0,0,1] neg_hi:[0,0,1]
    v_pk_fma_f32 v[98:99], v[58:59], v[238:239], v[152:153] op_sel:[0,1,0] op_sel_hi:[1,1,0] neg_lo:[0,0,1] neg_hi:[0,0,1]
    v_pk_fma_f32 v[100:101], v[60:61], v[238:239], v[152:153] op_sel:[0,1,0] op_sel_hi:[1,1,0] neg_lo:[0,0,1] neg_hi:[0,0,1]
    v_pk_fma_f32 v[102:103], v[62:63], v[238:239], v[152:153] op_sel:[0,1,0] op_sel_hi:[1,1,0] neg_lo:[0,0,1] neg_hi:[0,0,1]
    v_pk_fma_f32 v[104:105], v[64:65], v[238:239], v[152:153] op_sel:[0,1,0] op_sel_hi:[1,1,0] neg_lo:[0,0,1] neg_hi:[0,0,1]
    v_pk_fma_f32 v[106:107], v[66:67], v[238:239], v[152:153] op_sel:[0,1,0] op_sel_hi:[1,1,0] neg_lo:[0,0,1] neg_hi:[0,0,1]
    v_pk_fma_f32 v[108:109], v[68:69], v[238:239], v[152:153] op_sel:[0,1,0] op_sel_hi:[1,1,0] neg_lo:[0,0,1] neg_hi:[0,0,1]
    v_pk_fma_f32 v[52:53], v[52:53], v[238:239], v[152:153] op_sel:[0,1,1] op_sel_hi:[1,1,1] neg_lo:[1,0,0] neg_hi:[1,0,0]
    v_pk_fma_f32 v[54:55], v[54:55], v[238:239], v[152:153] op_sel:[0,1,1] op_sel_hi:[1,1,1] neg_lo:[1,0,0] neg_hi:[1,0,0]
    v_pk_fma_f32 v[56:57], v[56:57], v[238:239], v[152:153] op_sel:[0,1,1] op_sel_hi:[1,1,1] neg_lo:[1,0,0] neg_hi:[1,0,0]
    v_pk_fma_f32 v[58:59], v[58:59], v[238:239], v[152:153] op_sel:[0,1,1] op_sel_hi:[1,1,1] neg_lo:[1,0,0] neg_hi:[1,0,0]
    v_pk_fma_f32 v[60:61], v[60:61], v[238:239], v[152:153] op_sel:[0,1,1] op_sel_hi:[1,1,1] neg_lo:[1,0,0] neg_hi:[1,0,0]
    v_pk_fma_f32 v[62:63], v[62:63], v[238:239], v[152:153] op_sel:[0,1,1] op_sel_hi:[1,1,1] neg_lo:[1,0,0] neg_hi:[1,0,0]
    v_pk_fma_f32 v[64:65], v[64:65], v[238:239], v[152:153] op_sel:[0,1,1] op_sel_hi:[1,1,1] neg_lo:[1,0,0] neg_hi:[1,0,0]
    v_pk_fma_f32 v[66:67], v[66:67], v[238:239], v[152:153] op_sel:[0,1,1] op_sel_hi:[1,1,1] neg_lo:[1,0,0] neg_hi:[1,0,0]
    v_pk_fma_f32 v[68:69], v[68:69], v[238:239], v[152:153] op_sel:[0,1,1] op_sel_hi:[1,1,1] neg_lo:[1,0,0] neg_hi:[1,0,0]
    v_exp_f32 v92, v92
    v_exp_f32 v93, v93
    v_exp_f32 v94, v94
    v_exp_f32 v95, v95
    v_exp_f32 v96, v96
    v_exp_f32 v97, v97
    v_exp_f32 v98, v98
    v_exp_f32 v99, v99
    v_exp_f32 v100, v100
    v_exp_f32 v101, v101
    v_exp_f32 v102, v102
    v_exp_f32 v103, v103
    v_exp_f32 v104, v104
    v_exp_f32 v105, v105
    v_exp_f32 v106, v106
    v_exp_f32 v107, v107
    v_exp_f32 v108, v108
    v_exp_f32 v109, v109
    v_exp_f32 v52, v52
    v_exp_f32 v53, v53
    v_exp_f32 v54, v54
    v_exp_f32 v55, v55
    v_exp_f32 v56, v56
    v_exp_f32 v57, v57
    v_exp_f32 v58, v58
    v_exp_f32 v59, v59
    v_exp_f32 v60, v60
    v_exp_f32 v61, v61
    v_exp_f32 v62, v62
    v_exp_f32 v63, v63
    v_exp_f32 v64, v64
    v_exp_f32 v65, v65
    v_exp_f32 v66, v66
    v_exp_f32 v67, v67
    v_exp_f32 v68, v68
    v_exp_f32 v69, v69
    v_pk_add_f32 v[154:155], v[92:93], v[94:95]
    v_pk_add_f32 v[156:157], v[52:53], v[54:55]
    v_pk_add_f32 v[154:155], v[154:155], v[96:97]
    v_pk_add_f32 v[156:157], v[156:157], v[56:57]
    v_pk_add_f32 v[154:155], v[154:155], v[98:99]
    v_pk_add_f32 v[156:157], v[156:157], v[58:59]
    v_pk_add_f32 v[154:155], v[154:155], v[100:101]
    v_pk_add_f32 v[156:157], v[156:157], v[60:61]
    v_pk_add_f32 v[154:155], v[154:155], v[102:103]
    v_pk_add_f32 v[156:157], v[156:157], v[62:63]
    v_pk_add_f32 v[154:155], v[154:155], v[104:105]
    v_pk_add_f32 v[156:157], v[156:157], v[64:65]
    v_pk_add_f32 v[154:155], v[154:155], v[106:107]
    v_pk_add_f32 v[156:157], v[156:157], v[66:67]
    v_pk_add_f32 v[154:155], v[154:155], v[108:109]
    v_pk_add_f32 v[156:157], v[156:157], v[68:69]
    v_add_f32 v154, v154, v155
    v_add_f32 v156, v156, v157
    v_rcp_f32 v156, v156
    v_mul_f32 v238, 0x358637bd, v154
    v_mul_f32 v156, v156, v154
    v_cvt_pk_bf16_f32 v184, v92, v93
    v_cvt_pk_bf16_f32 v185, v94, v95
    v_cvt_pk_bf16_f32 v186, v96, v97
    v_cvt_pk_bf16_f32 v187, v98, v99
    v_cvt_pk_bf16_f32 v188, v100, v101
    v_cvt_pk_bf16_f32 v189, v102, v103
    v_cvt_pk_bf16_f32 v190, v104, v105
    v_cvt_pk_bf16_f32 v191, v106, v107
    v_cvt_pk_bf16_f32 v192, v108, v109
    v_pk_mul_f32 v[52:53], v[52:53], v[156:157] op_sel_hi:[1,0]
    v_pk_mul_f32 v[54:55], v[54:55], v[156:157] op_sel_hi:[1,0]
    v_pk_mul_f32 v[56:57], v[56:57], v[156:157] op_sel_hi:[1,0]
    v_pk_mul_f32 v[58:59], v[58:59], v[156:157] op_sel_hi:[1,0]
    v_pk_mul_f32 v[60:61], v[60:61], v[156:157] op_sel_hi:[1,0]
    v_pk_mul_f32 v[62:63], v[62:63], v[156:157] op_sel_hi:[1,0]
    v_pk_mul_f32 v[64:65], v[64:65], v[156:157] op_sel_hi:[1,0]
    v_pk_mul_f32 v[66:67], v[66:67], v[156:157] op_sel_hi:[1,0]
    v_pk_mul_f32 v[68:69], v[68:69], v[156:157] op_sel_hi:[1,0]
    v_cvt_pk_bf16_f32 v193, v52, v53
    v_cvt_pk_bf16_f32 v194, v54, v55
    v_cvt_pk_bf16_f32 v195, v56, v57
    v_cvt_pk_bf16_f32 v196, v58, v59
    v_cvt_pk_bf16_f32 v197, v60, v61
    v_cvt_pk_bf16_f32 v198, v62, v63
    v_cvt_pk_bf16_f32 v199, v64, v65
    v_cvt_pk_bf16_f32 v200, v66, v67
    v_cvt_pk_bf16_f32 v201, v68, v69
    v_max3_f32 v152, v72, v73, v74
    v_min3_f32 v153, v72, v73, v74
    v_max3_f32 v152, v152, v75, v76
    v_min3_f32 v153, v153, v75, v76
    v_max3_f32 v152, v152, v77, v78
    v_min3_f32 v153, v153, v77, v78
    v_max3_f32 v152, v152, v79, v80
    v_min3_f32 v153, v153, v79, v80
    v_max3_f32 v152, v152, v81, v82
    v_min3_f32 v153, v153, v81, v82
    v_max3_f32 v152, v152, v83, v84
    v_min3_f32 v153, v153, v83, v84
    v_max3_f32 v152, v152, v85, v86
    v_min3_f32 v153, v153, v85, v86
    v_max3_f32 v152, v152, v87, v88
    v_min3_f32 v153, v153, v87, v88
    v_max_f32 v152, v152, v89
    v_min_f32 v153, v153, v89
    v_pk_mul_f32 v[152:153], v[152:153], v[240:241] op_sel:[0,1] op_sel_hi:[1,1]
    v_pk_fma_f32 v[92:93], v[72:73], v[240:241], v[152:153] op_sel:[0,1,0] op_sel_hi:[1,1,0] neg_lo:[0,0,1] neg_hi:[0,0,1]
    v_pk_fma_f32 v[94:95], v[74:75], v[240:241], v[152:153] op_sel:[0,1,0] op_sel_hi:[1,1,0] neg_lo:[0,0,1] neg_hi:[0,0,1]
    v_pk_fma_f32 v[96:97], v[76:77], v[240:241], v[152:153] op_sel:[0,1,0] op_sel_hi:[1,1,0] neg_lo:[0,0,1] neg_hi:[0,0,1]
    v_pk_fma_f32 v[98:99], v[78:79], v[240:241], v[152:153] op_sel:[0,1,0] op_sel_hi:[1,1,0] neg_lo:[0,0,1] neg_hi:[0,0,1]
    v_pk_fma_f32 v[100:101], v[80:81], v[240:241], v[152:153] op_sel:[0,1,0] op_sel_hi:[1,1,0] neg_lo:[0,0,1] neg_hi:[0,0,1]
    v_pk_fma_f32 v[102:103], v[82:83], v[240:241], v[152:153] op_sel:[0,1,0] op_sel_hi:[1,1,0] neg_lo:[0,0,1] neg_hi:[0,0,1]
    v_pk_fma_f32 v[104:105], v[84:85], v[240:241], v[152:153] op_sel:[0,1,0] op_sel_hi:[1,1,0] neg_lo:[0,0,1] neg_hi:[0,0,1]
    v_pk_fma_f32 v[106:107], v[86:87], v[240:241], v[152:153] op_sel:[0,1,0] op_sel_hi:[1,1,0] neg_lo:[0,0,1] neg_hi:[0,0,1]
    v_pk_fma_f32 v[108:109], v[88:89], v[240:241], v[152:153] op_sel:[0,1,0] op_sel_hi:[1,1,0] neg_lo:[0,0,1] neg_hi:[0,0,1]
    v_pk_fma_f32 v[72:73], v[72:73], v[240:241], v[152:153] op_sel:[0,1,1] op_sel_hi:[1,1,1] neg_lo:[1,0,0] neg_hi:[1,0,0]
    v_pk_fma_f32 v[74:75], v[74:75], v[240:241], v[152:153] op_sel:[0,1,1] op_sel_hi:[1,1,1] neg_lo:[1,0,0] neg_hi:[1,0,0]
    v_pk_fma_f32 v[76:77], v[76:77], v[240:241], v[152:153] op_sel:[0,1,1] op_sel_hi:[1,1,1] neg_lo:[1,0,0] neg_hi:[1,0,0]
    v_pk_fma_f32 v[78:79], v[78:79], v[240:241], v[152:153] op_sel:[0,1,1] op_sel_hi:[1,1,1] neg_lo:[1,0,0] neg_hi:[1,0,0]
    v_pk_fma_f32 v[80:81], v[80:81], v[240:241], v[152:153] op_sel:[0,1,1] op_sel_hi:[1,1,1] neg_lo:[1,0,0] neg_hi:[1,0,0]
    v_pk_fma_f32 v[82:83], v[82:83], v[240:241], v[152:153] op_sel:[0,1,1] op_sel_hi:[1,1,1] neg_lo:[1,0,0] neg_hi:[1,0,0]
    v_pk_fma_f32 v[84:85], v[84:85], v[240:241], v[152:153] op_sel:[0,1,1] op_sel_hi:[1,1,1] neg_lo:[1,0,0] neg_hi:[1,0,0]
    v_pk_fma_f32 v[86:87], v[86:87], v[240:241], v[152:153] op_sel:[0,1,1] op_sel_hi:[1,1,1] neg_lo:[1,0,0] neg_hi:[1,0,0]
    v_pk_fma_f32 v[88:89], v[88:89], v[240:241], v[152:153] op_sel:[0,1,1] op_sel_hi:[1,1,1] neg_lo:[1,0,0] neg_hi:[1,0,0]
    v_exp_f32 v92, v92
    v_exp_f32 v93, v93
    v_exp_f32 v94, v94
    v_exp_f32 v95, v95
    v_exp_f32 v96, v96
    v_exp_f32 v97, v97
    v_exp_f32 v98, v98
    v_exp_f32 v99, v99
    v_exp_f32 v100, v100
    v_exp_f32 v101, v101
    v_exp_f32 v102, v102
    v_exp_f32 v103, v103
    v_exp_f32 v104, v104
    v_exp_f32 v105, v105
    v_exp_f32 v106, v106
    v_exp_f32 v107, v107
    v_exp_f32 v108, v108
    v_exp_f32 v109, v109
    v_exp_f32 v72, v72
    v_exp_f32 v73, v73
    v_exp_f32 v74, v74
    v_exp_f32 v75, v75
    v_exp_f32 v76, v76
    v_exp_f32 v77, v77
    v_exp_f32 v78, v78
    v_exp_f32 v79, v79
    v_exp_f32 v80, v80
    v_exp_f32 v81, v81
    v_exp_f32 v82, v82
    v_exp_f32 v83, v83
    v_exp_f32 v84, v84
    v_exp_f32 v85, v85
    v_exp_f32 v86, v86
    v_exp_f32 v87, v87
    v_exp_f32 v88, v88
    v_exp_f32 v89, v89
    v_pk_add_f32 v[154:155], v[92:93], v[94:95]
    v_pk_add_f32 v[156:157], v[72:73], v[74:75]
    v_pk_add_f32 v[154:155], v[154:155], v[96:97]
    v_pk_add_f32 v[156:157], v[156:157], v[76:77]
    v_pk_add_f32 v[154:155], v[154:155], v[98:99]
    v_pk_add_f32 v[156:157], v[156:157], v[78:79]
    v_pk_add_f32 v[154:155], v[154:155], v[100:101]
    v_pk_add_f32 v[156:157], v[156:157], v[80:81]
    v_pk_add_f32 v[154:155], v[154:155], v[102:103]
    v_pk_add_f32 v[156:157], v[156:157], v[82:83]
    v_pk_add_f32 v[154:155], v[154:155], v[104:105]
    v_pk_add_f32 v[156:157], v[156:157], v[84:85]
    v_pk_add_f32 v[154:155], v[154:155], v[106:107]
    v_pk_add_f32 v[156:157], v[156:157], v[86:87]
    v_pk_add_f32 v[154:155], v[154:155], v[108:109]
    v_pk_add_f32 v[156:157], v[156:157], v[88:89]
    v_add_f32 v154, v154, v155
    v_add_f32 v156, v156, v157
    v_rcp_f32 v156, v156
    v_mul_f32 v240, 0x358637bd, v154
    v_mul_f32 v156, v156, v154
    v_cvt_pk_bf16_f32 v202, v92, v93
    v_cvt_pk_bf16_f32 v203, v94, v95
    v_cvt_pk_bf16_f32 v204, v96, v97
    v_cvt_pk_bf16_f32 v205, v98, v99
    v_cvt_pk_bf16_f32 v206, v100, v101
    v_cvt_pk_bf16_f32 v207, v102, v103
    v_cvt_pk_bf16_f32 v208, v104, v105
    v_cvt_pk_bf16_f32 v209, v106, v107
    v_cvt_pk_bf16_f32 v210, v108, v109
    v_pk_mul_f32 v[72:73], v[72:73], v[156:157] op_sel_hi:[1,0]
    v_pk_mul_f32 v[74:75], v[74:75], v[156:157] op_sel_hi:[1,0]
    v_pk_mul_f32 v[76:77], v[76:77], v[156:157] op_sel_hi:[1,0]
    v_pk_mul_f32 v[78:79], v[78:79], v[156:157] op_sel_hi:[1,0]
    v_pk_mul_f32 v[80:81], v[80:81], v[156:157] op_sel_hi:[1,0]
    v_pk_mul_f32 v[82:83], v[82:83], v[156:157] op_sel_hi:[1,0]
    v_pk_mul_f32 v[84:85], v[84:85], v[156:157] op_sel_hi:[1,0]
    v_pk_mul_f32 v[86:87], v[86:87], v[156:157] op_sel_hi:[1,0]
    v_pk_mul_f32 v[88:89], v[88:89], v[156:157] op_sel_hi:[1,0]
    v_cvt_pk_bf16_f32 v211, v72, v73
    v_cvt_pk_bf16_f32 v212, v74, v75
    v_cvt_pk_bf16_f32 v213, v76, v77
    v_cvt_pk_bf16_f32 v214, v78, v79
    v_cvt_pk_bf16_f32 v215, v80, v81
    v_cvt_pk_bf16_f32 v216, v82, v83
    v_cvt_pk_bf16_f32 v217, v84, v85
    v_cvt_pk_bf16_f32 v218, v86, v87
    v_cvt_pk_bf16_f32 v219, v88, v89
    s_barrier
    s_buffer_load_dwordx8 s[8:15], s[44:47], s69 glc
    s_buffer_load_dwordx8 s[20:27], s[44:47], s69 offset:32 glc
    s_waitcnt lgkmcnt(0)
    s_xor_b32 s8, s8, s55
    s_xor_b32 s9, s9, s55
    s_xor_b32 s10, s10, s55
    s_xor_b32 s11, s11, s55
    s_xor_b32 s12, s12, s55
    s_xor_b32 s13, s13, s55
    s_xor_b32 s14, s14, s55
    s_xor_b32 s15, s15, s55
    s_or_b64 s[8:9], s[8:9], s[14:15]
    s_or_b64 s[8:9], s[8:9], s[12:13]
    s_or_b64 s[8:9], s[8:9], s[10:11]
    s_cbranch_scc1 L_pslow_76
L_pback_77:
    s_waitcnt lgkmcnt(0)
    s_xor_b32 s20, s20, s55
    s_xor_b32 s21, s21, s55
    s_xor_b32 s22, s22, s55
    s_xor_b32 s23, s23, s55
    s_xor_b32 s24, s24, s55
    s_xor_b32 s25, s25, s55
    s_xor_b32 s26, s26, s55
    s_or_b32 s20, s20, s26
    s_or_b64 s[20:21], s[20:21], s[24:25]
    s_or_b64 s[20:21], s[20:21], s[22:23]
    s_cbranch_scc1 L_pslow_80
L_pback_81:
    s_add_u32 s69, s68, 4096
    buffer_load_dwordx4 v[132:135], v230, s[44:47], s69 offen offset:1024 sc1
    buffer_load_dwordx4 v[136:139], v230, s[44:47], s69 offen offset:2048 sc1
    buffer_load_dwordx4 v[112:115], v230, s[44:47], s68 offen offset:0 sc1
    buffer_load_dwordx4 v[116:119], v230, s[44:47], s68 offen offset:1024 sc1
    buffer_load_dwordx4 v[120:123], v230, s[44:47], s68 offen offset:2048 sc1
    buffer_load_dwordx4 v[124:127], v230, s[44:47], s68 offen offset:3072 sc1
    buffer_load_dwordx4 v[128:131], v230, s[44:47], s69 offen offset:0 sc1
    s_lshl_b32 s64, s52, 3
    s_add_u32 s64, s64, s53
    s_lshl_b32 s65, s64, 3
    s_add_u32 s65, s65, s48
    s_mul_i32 s0, s65, 36864
    s_add_u32 s0, s0, 14680064
    s_lshl_b32 s1, s65, 9
    s_add_u32 s1, s1, 249856
    s_lshl_b32 s64, s52, 2
    s_add_u32 s64, s64, s54
    s_lshl_b32 s64, s64, 3
    s_add_u32 s64, s64, s48
    s_mul_i32 s63, s64, 73728
    s_lshl_b32 s65, s53, 10
    s_add_u32 s63, s63, s65
    s_add_u32 s63, s63, 33554432
    s_lshl_b32 s65, s53, 3
    s_add_u32 s65, s65, s53
    s_bfe_u32 s65, s65, 0x30001
    s_cmp_eq_u32 s48, s65
    s_cselect_b32 s63, 0x40000000, s63
    s_lshl_b32 s20, s54, 13
    s_add_u32 s20, s20, s0
    s_add_u32 s21, s20, 4096
    s_lshl_b32 s22, s54, 10
    s_add_u32 s22, s22, s0
    s_add_u32 s22, s22, 32768
    s_mul_i32 s23, s49, 2560
    s_lshl_b32 s24, s49, 11
    s_mul_i32 s8, s54, 147456
    s_add_u32 s9, s8, 73728
    s_and_b32 s64, s52, 3
    s_lshl_b32 s64, s64, 1
    s_lshr_b32 s64, 0xe79, s64
    s_add_u32 s65, s64, s54
    s_and_b32 s65, s65, 3
    s_mul_i32 s10, s65, 147456
    s_add_u32 s13, s10, 73728
    s_lshl_b32 s65, s65, 13
    s_add_u32 s25, s65, s0
    s_lshr_b32 s64, s64, 2
    s_add_u32 s65, s64, s54
    s_and_b32 s65, s65, 3
    s_mul_i32 s11, s65, 147456
    s_add_u32 s14, s11, 73728
    s_lshl_b32 s65, s65, 13
    s_add_u32 s26, s65, s0
    s_lshr_b32 s64, s64, 2
    s_add_u32 s65, s64, s54
    s_and_b32 s65, s65, 3
    s_mul_i32 s12, s65, 147456
    s_add_u32 s15, s12, 73728
    s_lshl_b32 s65, s65, 13
    s_add_u32 s27, s65, s0
    s_lshl_b32 s64, s52, 2
    s_add_u32 s64, s64, s54
    s_lshl_b32 s64, s64, 3
    s_add_u32 s64, s64, s48
    s_lshl_b32 s42, s64, 5
    s_add_u32 s42, s42, s53
    s_lshl_b32 s42, s42, 2
    s_add_u32 s42, s42, 512000
    s_lshl_b32 s40, s54, 7
    s_add_u32 s40, s40, s1
    s_lshl_b32 s41, s54, 2
    s_add_u32 s41, s41, s1
    s_mov_b32 s43, 0
    s_buffer_load_dwordx4 s[64:67], s[44:47], s100 glc
    s_setprio 1
    s_waitcnt vmcnt(6)
    v_and_b32 v48, v132, v231
    v_and_b32 v49, v133, v231
    v_and_b32 v50, v134, v231
    v_and_b32 v51, v135, v231
    v_and_b32_dpp v52, v132, v231 row_ror:12 row_mask:0xf bank_mask:0xf
    v_and_b32_dpp v53, v133, v231 row_ror:12 row_mask:0xf bank_mask:0xf
    v_and_b32_dpp v54, v134, v231 row_ror:12 row_mask:0xf bank_mask:0xf
    v_and_b32_dpp v55, v135, v231 row_ror:12 row_mask:0xf bank_mask:0xf
    v_mfma_f32_16x16x32_bf16 v[88:91], v[48:51], v[184:187], 0
    v_and_b32_dpp v56, v132, v231 row_ror:8 row_mask:0xf bank_mask:0xf
    v_and_b32_dpp v57, v133, v231 row_ror:8 row_mask:0xf bank_mask:0xf
    v_mfma_f32_16x16x32_bf16 v[108:111], v[48:51], v[202:205], 0
    v_and_b32_dpp v58, v134, v231 row_ror:8 row_mask:0xf bank_mask:0xf
    v_and_b32_dpp v59, v135, v231 row_ror:8 row_mask:0xf bank_mask:0xf
    v_mfma_f32_16x16x32_bf16 v[88:91], v[52:55], v[188:191], v[88:91]
    v_and_b32_dpp v48, v132, v231 row_ror:4 row_mask:0xf bank_mask:0xf
    v_and_b32_dpp v49, v133, v231 row_ror:4 row_mask:0xf bank_mask:0xf
    v_mfma_f32_16x16x32_bf16 v[108:111], v[52:55], v[206:209], v[108:111]
    v_and_b32_dpp v50, v134, v231 row_ror:4 row_mask:0xf bank_mask:0xf
    v_and_b32_dpp v51, v135, v231 row_ror:4 row_mask:0xf bank_mask:0xf
    v_mfma_f32_16x16x32_bf16 v[88:91], v[56:59], v[192:195], v[88:91]
    s_waitcnt vmcnt(5)
    v_and_b32 v52, v136, v231
    v_and_b32 v53, v137, v231
    v_mfma_f32_16x16x32_bf16 v[108:111], v[56:59], v[210:213], v[108:111]
    v_mfma_f32_16x16x32_bf16 v[88:91], v[48:51], v[196:199], v[88:91]
    s_waitcnt vmcnt(4)
    v_and_b32 v56, v112, v231
    v_and_b32 v57, v113, v231
    v_mfma_f32_16x16x32_bf16 v[108:111], v[48:51], v[214:217], v[108:111]
    v_and_b32 v58, v114, v231
    v_and_b32 v59, v115, v231
    v_mfma_f32_16x16x16_bf16 v[88:91], v[52:53], v[200:201], v[88:91]
    v_and_b32_dpp v48, v112, v231 row_ror:12 row_mask:0xf bank_mask:0xf
    v_and_b32_dpp v49, v113, v231 row_ror:12 row_mask:0xf bank_mask:0xf
    v_mfma_f32_16x16x16_bf16 v[108:111], v[52:53], v[218:219], v[108:111]
    v_and_b32_dpp v50, v114, v231 row_ror:12 row_mask:0xf bank_mask:0xf
    v_and_b32_dpp v51, v115, v231 row_ror:12 row_mask:0xf bank_mask:0xf
    v_mfma_f32_16x16x32_bf16 v[72:75], v[56:59], v[184:187], 0
    v_and_b32_dpp v52, v112, v231 row_ror:8 row_mask:0xf bank_mask:0xf
    v_and_b32_dpp v53, v113, v231 row_ror:8 row_mask:0xf bank_mask:0xf
    v_mfma_f32_16x16x32_bf16 v[92:95], v[56:59], v[202:205], 0
    v_and_b32_dpp v54, v114, v231 row_ror:8 row_mask:0xf bank_mask:0xf
    v_and_b32_dpp v55, v115, v231 row_ror:8 row_mask:0xf bank_mask:0xf
    v_mfma_f32_16x16x32_bf16 v[72:75], v[48:51], v[188:191], v[72:75]
    v_and_b32_dpp v56, v112, v231 row_ror:4 row_mask:0xf bank_mask:0xf
    v_and_b32_dpp v57, v113, v231 row_ror:4 row_mask:0xf bank_mask:0xf
    v_mfma_f32_16x16x32_bf16 v[92:95], v[48:51], v[206:209], v[92:95]
    v_and_b32_dpp v58, v114, v231 row_ror:4 row_mask:0xf bank_mask:0xf
    v_and_b32_dpp v59, v115, v231 row_ror:4 row_mask:0xf bank_mask:0xf
    v_mfma_f32_16x16x32_bf16 v[72:75], v[52:55], v[192:195], v[72:75]
    s_waitcnt vmcnt(3)
    v_and_b32 v48, v116, v231
    v_and_b32 v49, v117, v231
    v_mfma_f32_16x16x32_bf16 v[92:95], v[52:55], v[210:213], v[92:95]
    v_mfma_f32_16x16x32_bf16 v[72:75], v[56:59], v[196:199], v[72:75]
    v_and_b32_dpp v52, v116, v231 row_ror:12 row_mask:0xf bank_mask:0xf
    v_and_b32_dpp v53, v117, v231 row_ror:12 row_mask:0xf bank_mask:0xf
    v_mfma_f32_16x16x32_bf16 v[92:95], v[56:59], v[214:217], v[92:95]
    v_and_b32_dpp v54, v118, v231 row_ror:12 row_mask:0xf bank_mask:0xf
    v_and_b32_dpp v55, v119, v231 row_ror:12 row_mask:0xf bank_mask:0xf
    v_mfma_f32_16x16x16_bf16 v[72:75], v[48:49], v[200:201], v[72:75]
    v_and_b32_dpp v56, v116, v231 row_ror:8 row_mask:0xf bank_mask:0xf
    v_and_b32_dpp v57, v117, v231 row_ror:8 row_mask:0xf bank_mask:0xf
    v_mfma_f32_16x16x16_bf16 v[92:95], v[48:49], v[218:219], v[92:95]
    v_and_b32_dpp v58, v118, v231 row_ror:8 row_mask:0xf bank_mask:0xf
    v_and_b32_dpp v59, v119, v231 row_ror:8 row_mask:0xf bank_mask:0xf
    v_mfma_f32_16x16x32_bf16 v[76:79], v[52:55], v[184:187], 0
    v_and_b32_dpp v48, v116, v231 row_ror:4 row_mask:0xf bank_mask:0xf
    v_and_b32_dpp v49, v117, v231 row_ror:4 row_mask:0xf bank_mask:0xf
    v_mfma_f32_16x16x32_bf16 v[96:99], v[52:55], v[202:205], 0
    v_and_b32_dpp v50, v118, v231 row_ror:4 row_mask:0xf bank_mask:0xf
    v_and_b32_dpp v51, v119, v231 row_ror:4 row_mask:0xf bank_mask:0xf
    v_mfma_f32_16x16x32_bf16 v[76:79], v[56:59], v[188:191], v[76:79]
    s_waitcnt vmcnt(2)
    v_and_b32 v52, v120, v231
    v_and_b32 v53, v121, v231
    v_mfma_f32_16x16x32_bf16 v[96:99], v[56:59], v[206:209], v[96:99]
    v_and_b32 v54, v122, v231
    v_and_b32 v55, v123, v231
    v_mfma_f32_16x16x32_bf16 v[76:79], v[48:51], v[192:195], v[76:79]
    v_and_b32_dpp v56, v120, v231 row_ror:12 row_mask:0xf bank_mask:0xf
    v_and_b32_dpp v57, v121, v231 row_ror:12 row_mask:0xf bank_mask:0xf
    v_mfma_f32_16x16x32_bf16 v[96:99], v[48:51], v[210:213], v[96:99]
    v_mfma_f32_16x16x32_bf16 v[76:79], v[52:55], v[196:199], v[76:79]
    v_and_b32_dpp v48, v120, v231 row_ror:8 row_mask:0xf bank_mask:0xf
    v_and_b32_dpp v49, v121, v231 row_ror:8 row_mask:0xf bank_mask:0xf
    v_mfma_f32_16x16x32_bf16 v[96:99], v[52:55], v[214:217], v[96:99]
    v_and_b32_dpp v50, v122, v231 row_ror:8 row_mask:0xf bank_mask:0xf
    v_and_b32_dpp v51, v123, v231 row_ror:8 row_mask:0xf bank_mask:0xf
    v_mfma_f32_16x16x16_bf16 v[76:79], v[56:57], v[200:201], v[76:79]
    v_and_b32_dpp v52, v120, v231 row_ror:4 row_mask:0xf bank_mask:0xf
    v_and_b32_dpp v53, v121, v231 row_ror:4 row_mask:0xf bank_mask:0xf
    v_mfma_f32_16x16x16_bf16 v[96:99], v[56:57], v[218:219], v[96:99]
    v_and_b32_dpp v54, v122, v231 row_ror:4 row_mask:0xf bank_mask:0xf
    v_and_b32_dpp v55, v123, v231 row_ror:4 row_mask:0xf bank_mask:0xf
    v_mfma_f32_16x16x32_bf16 v[80:83], v[48:51], v[184:187], 0
    s_waitcnt vmcnt(1)
    v_and_b32 v56, v124, v231
    v_and_b32 v57, v125, v231
    v_mfma_f32_16x16x32_bf16 v[100:103], v[48:51], v[202:205], 0
    v_and_b32 v58, v126, v231
    v_and_b32 v59, v127, v231
    v_mfma_f32_16x16x32_bf16 v[80:83], v[52:55], v[188:191], v[80:83]
    v_and_b32_dpp v48, v124, v231 row_ror:12 row_mask:0xf bank_mask:0xf
    v_and_b32_dpp v49, v125, v231 row_ror:12 row_mask:0xf bank_mask:0xf
    v_mfma_f32_16x16x32_bf16 v[100:103], v[52:55], v[206:209], v[100:103]
    v_and_b32_dpp v50, v126, v231 row_ror:12 row_mask:0xf bank_mask:0xf
    v_and_b32_dpp v51, v127, v231 row_ror:12 row_mask:0xf bank_mask:0xf
    v_mfma_f32_16x16x32_bf16 v[80:83], v[56:59], v[192:195], v[80:83]
    v_and_b32_dpp v52, v124, v231 row_ror:8 row_mask:0xf bank_mask:0xf
    v_and_b32_dpp v53, v125, v231 row_ror:8 row_mask:0xf bank_mask:0xf
    v_mfma_f32_16x16x32_bf16 v[100:103], v[56:59], v[210:213], v[100:103]
    v_mfma_f32_16x16x32_bf16 v[80:83], v[48:51], v[196:199], v[80:83]
    v_and_b32_dpp v56, v124, v231 row_ror:4 row_mask:0xf bank_mask:0xf
    v_and_b32_dpp v57, v125, v231 row_ror:4 row_mask:0xf bank_mask:0xf
    v_mfma_f32_16x16x32_bf16 v[100:103], v[48:51], v[214:217], v[100:103]
    v_and_b32_dpp v58, v126, v231 row_ror:4 row_mask:0xf bank_mask:0xf
    v_and_b32_dpp v59, v127, v231 row_ror:4 row_mask:0xf bank_mask:0xf
    v_mfma_f32_16x16x16_bf16 v[80:83], v[52:53], v[200:201], v[80:83]
    s_waitcnt vmcnt(0)
    v_and_b32 v48, v128, v231
    v_and_b32 v49, v129, v231
    v_mfma_f32_16x16x16_bf16 v[100:103], v[52:53], v[218:219], v[100:103]
    v_and_b32 v50, v130, v231
    v_and_b32 v51, v131, v231
    v_mfma_f32_16x16x32_bf16 v[84:87], v[56:59], v[184:187], 0
    v_and_b32_dpp v52, v128, v231 row_ror:12 row_mask:0xf bank_mask:0xf
    v_and_b32_dpp v53, v129, v231 row_ror:12 row_mask:0xf bank_mask:0xf
    v_mfma_f32_16x16x32_bf16 v[104:107], v[56:59], v[202:205], 0
    v_and_b32_dpp v54, v130, v231 row_ror:12 row_mask:0xf bank_mask:0xf
    v_and_b32_dpp v55, v131, v231 row_ror:12 row_mask:0xf bank_mask:0xf
    v_mfma_f32_16x16x32_bf16 v[84:87], v[48:51], v[188:191], v[84:87]
    v_and_b32_dpp v56, v128, v231 row_ror:8 row_mask:0xf bank_mask:0xf
    v_and_b32_dpp v57, v129, v231 row_ror:8 row_mask:0xf bank_mask:0xf
    v_mfma_f32_16x16x32_bf16 v[104:107], v[48:51], v[206:209], v[104:107]
    v_and_b32_dpp v58, v130, v231 row_ror:8 row_mask:0xf bank_mask:0xf
    v_and_b32_dpp v59, v131, v231 row_ror:8 row_mask:0xf bank_mask:0xf
    v_mfma_f32_16x16x32_bf16 v[84:87], v[52:55], v[192:195], v[84:87]
    v_and_b32_dpp v48, v128, v231 row_ror:4 row_mask:0xf bank_mask:0xf
    v_and_b32_dpp v49, v129, v231 row_ror:4 row_mask:0xf bank_mask:0xf
    v_mfma_f32_16x16x32_bf16 v[104:107], v[52:55], v[210:213], v[104:107]
    v_mfma_f32_16x16x32_bf16 v[84:87], v[56:59], v[196:199], v[84:87]
    v_mfma_f32_16x16x32_bf16 v[104:107], v[56:59], v[214:217], v[104:107]
    v_mfma_f32_16x16x16_bf16 v[84:87], v[48:49], v[200:201], v[84:87]
    v_mfma_f32_16x16x16_bf16 v[104:107], v[48:49], v[218:219], v[104:107]
    v_add_f32 v90, v238, v90
    v_rcp_f32 v90, v90
    v_mov_b32 v181, 0
    v_add_f32 v110, v240, v110
    v_rcp_f32 v110, v110
    v_mov_b32 v183, 0
    s_waitcnt lgkmcnt(0)
    s_xor_b32 s64, s64, s55
    s_xor_b32 s65, s65, s55
    s_xor_b32 s66, s66, s55
    s_xor_b32 s67, s67, s55
    s_or_b64 s[64:65], s[64:65], s[66:67]
    s_cbranch_scc1 L_pslow_84
L_pback_85:
    buffer_load_dwordx4 v[144:147], v254, s[44:47], s61 offen sc1
    buffer_load_dwordx4 v[0:3], v254, s[44:47], s92 offen offset:0 sc1
    buffer_load_dwordx4 v[4:7], v251, s[44:47], s92 offen offset:0 sc1
    buffer_load_dwordx4 v[8:11], v254, s[44:47], s92 offen offset:1024 sc1
    buffer_load_dwordx4 v[12:15], v251, s[44:47], s92 offen offset:1024 sc1
    buffer_load_dwordx4 v[16:19], v254, s[44:47], s93 offen offset:0 sc1
    buffer_load_dwordx4 v[20:23], v251, s[44:47], s93 offen offset:0 sc1
    buffer_load_dwordx4 v[24:27], v254, s[44:47], s93 offen offset:1024 sc1
    buffer_load_dwordx4 v[28:31], v251, s[44:47], s93 offen offset:1024 sc1
    buffer_load_dwordx4 v[32:35], v254, s[44:47], s94 offen offset:0 sc1
    buffer_load_dwordx4 v[36:39], v251, s[44:47], s94 offen offset:0 sc1
    buffer_load_dwordx4 v[40:43], v254, s[44:47], s94 offen offset:1024 sc1
    buffer_load_dwordx4 v[44:47], v251, s[44:47], s94 offen offset:1024 sc1
    v_mul_f32 v88, v88, v90
    v_mul_f32 v89, v89, v90
    v_cvt_pk_bf16_f32 v180, v88, v89
    v_mul_f32 v108, v108, v110
    v_mul_f32 v109, v109, v110
    v_cvt_pk_bf16_f32 v182, v108, v109
    buffer_store_dwordx4 v[180:183], v254, s[44:47], s59 offen offset:0 sc1
    v_mul_f32 v72, v72, v90
    v_mul_f32 v73, v73, v90
    v_mul_f32 v74, v74, v90
    v_mul_f32 v75, v75, v90
    v_mul_f32 v76, v76, v90
    v_mul_f32 v77, v77, v90
    v_mul_f32 v78, v78, v90
    v_mul_f32 v79, v79, v90
    v_cvt_pk_bf16_f32 v164, v72, v73
    v_cvt_pk_bf16_f32 v165, v74, v75
    v_cvt_pk_bf16_f32 v166, v76, v77
    v_cvt_pk_bf16_f32 v167, v78, v79
    buffer_store_dwordx4 v[164:167], v254, s[44:47], s58 offen offset:0 sc1
    v_mul_f32 v92, v92, v110
    v_mul_f32 v93, v93, v110
    v_mul_f32 v94, v94, v110
    v_mul_f32 v95, v95, v110
    v_mul_f32 v96, v96, v110
    v_mul_f32 v97, v97, v110
    v_mul_f32 v98, v98, v110
    v_mul_f32 v99, v99, v110
    v_cvt_pk_bf16_f32 v168, v92, v93
    v_cvt_pk_bf16_f32 v169, v94, v95
    v_cvt_pk_bf16_f32 v170, v96, v97
    v_cvt_pk_bf16_f32 v171, v98, v99
    buffer_store_dwordx4 v[168:171], v254, s[44:47], s58 offen offset:1024 sc1
    v_mul_f32 v80, v80, v90
    v_mul_f32 v81, v81, v90
    v_mul_f32 v82, v82, v90
    v_mul_f32 v83, v83, v90
    v_mul_f32 v84, v84, v90
    v_mul_f32 v85, v85, v90
    v_mul_f32 v86, v86, v90
    v_mul_f32 v87, v87, v90
    v_cvt_pk_bf16_f32 v172, v80, v81
    v_cvt_pk_bf16_f32 v173, v82, v83
    v_cvt_pk_bf16_f32 v174, v84, v85
    v_cvt_pk_bf16_f32 v175, v86, v87
    buffer_store_dwordx4 v[172:175], v254, s[44:47], s58 offen offset:2048 sc1
    v_mul_f32 v100, v100, v110
    v_mul_f32 v101, v101, v110
    v_mul_f32 v102, v102, v110
    v_mul_f32 v103, v103, v110
    v_mul_f32 v104, v104, v110
    v_mul_f32 v105, v105, v110
    v_mul_f32 v106, v106, v110
    v_mul_f32 v107, v107, v110
    v_cvt_pk_bf16_f32 v176, v100, v101
    v_cvt_pk_bf16_f32 v177, v102, v103
    v_cvt_pk_bf16_f32 v178, v104, v105
    v_cvt_pk_bf16_f32 v179, v106, v107
    buffer_store_dwordx4 v[176:179], v254, s[44:47], s58 offen offset:3072 sc1
    s_setprio 0
    s_branch L_SY
L_resx_2:
    v_add_u32 v218, s96, v216
    ds_read_b64 v[236:237], v218
    v_xor_b32 v218, 32, v218
    ds_read_b64 v[238:239], v218
    v_add_u32 v218, s97, v216
    ds_read_b64 v[240:241], v218
    v_xor_b32 v218, 32, v218
    ds_read_b64 v[242:243], v218
    v_add_u32 v218, s98, v216
    ds_read_b64 v[244:245], v218
    v_xor_b32 v218, 32, v218
    ds_read_b64 v[246:247], v218
    v_add_u32 v218, s99, v216
    ds_read_b64 v[248:249], v218
    v_xor_b32 v218, 32, v218
    ds_read_b64 v[250:251], v218
    s_setpc_b64 s[70:71]
L_res_4:
    s_call_b64 s[70:71], L_resx_2
    s_branch L_resb_5
L_res_6:
    s_call_b64 s[70:71], L_resx_2
    s_branch L_resb_7
L_res_8:
    ds_read_b64 v[252:253], v217
    s_branch L_resb_9
L_res_10:
    s_call_b64 s[70:71], L_resx_2
    s_branch L_resb_11
L_res_12:
    ds_read_b64 v[252:253], v217
    s_branch L_resb_13
L_res_14:
    s_call_b64 s[70:71], L_resx_2
    s_branch L_resb_15
L_res_16:
    ds_read_b64 v[252:253], v217
    s_branch L_resb_17
L_res_18:
    s_call_b64 s[70:71], L_resx_2
    s_branch L_resb_19
L_res_20:
    ds_read_b64 v[252:253], v217
    s_branch L_resb_21
L_res_22:
    s_call_b64 s[70:71], L_resx_2
    s_branch L_resb_23
L_res_24:
    ds_read_b64 v[252:253], v217
    s_branch L_resb_25
L_res_26:
    s_call_b64 s[70:71], L_resx_2
    s_branch L_resb_27
L_res_28:
    ds_read_b64 v[252:253], v217
    s_branch L_resb_29
L_res_30:
    s_call_b64 s[70:71], L_resx_2
    s_branch L_resb_31
L_res_32:
    ds_read_b64 v[252:253], v217
    s_branch L_resb_33
L_res_34:
    s_call_b64 s[70:71], L_resx_2
    s_branch L_resb_35
L_res_36:
    ds_read_b64 v[252:253], v217
    s_branch L_resb_37
L_nslow_38:
    s_mov_b32 s62, 0
L_nloop_40:
    v_mov_b32 v221, 0
    buffer_load_dword v221, v221, s[40:43], 0 offen sc1
    s_add_u32 s62, s62, 1
    s_waitcnt vmcnt(0)
    v_readfirstlane_b32 s55, v221
    s_cmp_ge_u32 s62, 40000
    s_cbranch_scc1 L_nback_39
    s_cmp_eq_u32 s55, 0
    s_cbranch_scc1 L_nloop_40
    s_branch L_nback_39
L_wbre_43:
    s_add_u32 s62, s62, 1
    s_cmp_ge_u32 s62, 40000
    s_cbranch_scc1 L_wbok_42
    buffer_load_dwordx4 v[0:3], v254, s[44:47], s68 offen offset:0 sc1
    buffer_load_dwordx4 v[4:7], v254, s[44:47], s68 offen offset:576 sc1
    s_waitcnt vmcnt(0)
    s_branch L_wb_41
L_nslow_46:
    s_mov_b32 s62, 0
L_nloop_48:
    v_mov_b32 v207, 0
    buffer_load_dword v207, v207, s[40:43], 0 offen sc1
    s_add_u32 s62, s62, 1
    s_waitcnt vmcnt(0)
    v_readfirstlane_b32 s55, v207
    s_cmp_ge_u32 s62, 40000
    s_cbranch_scc1 L_nback_47
    s_cmp_eq_u32 s55, 0
    s_cbranch_scc1 L_nloop_48
    s_branch L_nback_47
L_pslow_51:
    s_mov_b32 s62, 0
L_ploop_53:
    s_buffer_load_dwordx8 s[64:71], s[44:47], s60 glc
    s_add_u32 s62, s62, 1
    s_cmp_ge_u32 s62, 40000
    s_cbranch_scc1 L_pgive_54
    s_waitcnt lgkmcnt(0)
    s_xor_b32 s64, s64, s55
    s_xor_b32 s65, s65, s55
    s_xor_b32 s66, s66, s55
    s_xor_b32 s67, s67, s55
    s_xor_b32 s68, s68, s55
    s_xor_b32 s69, s69, s55
    s_xor_b32 s70, s70, s55
    s_xor_b32 s71, s71, s55
    s_or_b64 s[64:65], s[64:65], s[70:71]
    s_or_b64 s[64:65], s[64:65], s[68:69]
    s_or_b64 s[64:65], s[64:65], s[66:67]
    s_cbranch_scc1 L_ploop_53
L_pgive_54:
    s_waitcnt lgkmcnt(0)
    s_branch L_pback_52
L_pslow_55:
    s_mov_b32 s62, 0
L_ploop_57:
    s_buffer_load_dwordx4 s[64:67], s[44:47], s100 glc
    s_add_u32 s62, s62, 1
    s_cmp_ge_u32 s62, 40000
    s_cbranch_scc1 L_pgive_58
    s_waitcnt lgkmcnt(0)
    s_xor_b32 s64, s64, s55
    s_xor_b32 s65, s65, s55
    s_xor_b32 s66, s66, s55
    s_xor_b32 s67, s67, s55
    s_or_b64 s[64:65], s[64:65], s[66:67]
    s_cbranch_scc1 L_ploop_57
L_pgive_58:
    s_waitcnt lgkmcnt(0)
    s_branch L_pback_56
L_nslow_59:
    s_mov_b32 s62, 0
L_nloop_61:
    v_mov_b32 v233, 0
    buffer_load_dword v233, v233, s[40:43], 0 offen sc1
    s_add_u32 s62, s62, 1
    s_waitcnt vmcnt(0)
    v_readfirstlane_b32 s55, v233
    s_cmp_ge_u32 s62, 40000
    s_cbranch_scc1 L_nback_60
    s_cmp_eq_u32 s55, 0
    s_cbranch_scc1 L_nloop_61
    s_branch L_nback_60
L_redo_65:
    s_add_u32 s62, s62, 1
    s_cmp_ge_u32 s62, 10000
    s_cbranch_scc1 L_redok_64
    s_mul_i32 s68, s58, 49152
    s_add_u32 s68, s68, 1572864
    v_mov_b32 v64, 0
    v_mov_b32 v65, 0
    v_mov_b32 v66, 0
    v_mov_b32 v67, 0
    v_mov_b32 v68, 0
    v_mov_b32 v69, 0
    v_mov_b32 v70, 0
    v_mov_b32 v71, 0
    v_mov_b32 v72, 0
    v_mov_b32 v73, 0
    v_mov_b32 v74, 0
    v_mov_b32 v75, 0
    v_mov_b32 v76, 0
    v_mov_b32 v77, 0
    v_mov_b32 v78, 0
    v_mov_b32 v79, 0
    s_mov_b32 exec_lo, 0x00ffffff
    s_mov_b32 exec_hi, 0x00ffffff
    buffer_atomic_add_x2 v[64:65], v226, s[44:47], s68 offen offset:0 sc0
    buffer_atomic_add_x2 v[66:67], v226, s[44:47], s68 offen offset:3072 sc0
    s_add_u32 s68, s68, 6144
    buffer_atomic_add_x2 v[68:69], v226, s[44:47], s68 offen offset:0 sc0
    buffer_atomic_add_x2 v[70:71], v226, s[44:47], s68 offen offset:3072 sc0
    s_add_u32 s68, s68, 6144
    buffer_atomic_add_x2 v[72:73], v226, s[44:47], s68 offen offset:0 sc0
    buffer_atomic_add_x2 v[74:75], v226, s[44:47], s68 offen offset:3072 sc0
    s_add_u32 s68, s68, 6144
    buffer_atomic_add_x2 v[76:77], v226, s[44:47], s68 offen offset:0 sc0
    buffer_atomic_add_x2 v[78:79], v226, s[44:47], s68 offen offset:3072 sc0
    s_waitcnt vmcnt(0)
    s_branch L_red_63
L_nslow_69:
    s_mov_b32 s62, 0
L_nloop_71:
    v_mov_b32 v233, 0
    buffer_load_dword v233, v233, s[40:43], 0 offen sc1
    s_add_u32 s62, s62, 1
    s_waitcnt vmcnt(0)
    v_readfirstlane_b32 s55, v233
    s_cmp_ge_u32 s62, 40000
    s_cbranch_scc1 L_nback_70
    s_cmp_eq_u32 s55, 0
    s_cbranch_scc1 L_nloop_71
    s_branch L_nback_70
L_xsre_74:
    s_add_u32 s62, s62, 1
    s_cmp_ge_u32 s62, 40000
    s_cbranch_scc1 L_xsok_73
    v_mov_b32 v180, 0
    v_mov_b32 v181, 0
    buffer_atomic_add_x2 v[180:181], v182, s[44:47], s68 offen sc0
    s_waitcnt vmcnt(0)
    s_branch L_xs_72
L_pslow_76:
    s_mov_b32 s62, 0
L_ploop_78:
    s_buffer_load_dwordx8 s[8:15], s[44:47], s69 glc
    s_add_u32 s62, s62, 1
    s_cmp_ge_u32 s62, 40000
    s_cbranch_scc1 L_pgive_79
    s_waitcnt lgkmcnt(0)
    s_xor_b32 s8, s8, s55
    s_xor_b32 s9, s9, s55
    s_xor_b32 s10, s10, s55
    s_xor_b32 s11, s11, s55
    s_xor_b32 s12, s12, s55
    s_xor_b32 s13, s13, s55
    s_xor_b32 s14, s14, s55
    s_xor_b32 s15, s15, s55
    s_or_b64 s[8:9], s[8:9], s[14:15]
    s_or_b64 s[8:9], s[8:9], s[12:13]
    s_or_b64 s[8:9], s[8:9], s[10:11]
    s_cbranch_scc1 L_ploop_78
L_pgive_79:
    s_waitcnt lgkmcnt(0)
    s_branch L_pback_77
L_pslow_80:
    s_mov_b32 s62, 0
L_ploop_82:
    s_buffer_load_dwordx8 s[20:27], s[44:47], s69 offset:32 glc
    s_add_u32 s62, s62, 1
    s_cmp_ge_u32 s62, 40000
    s_cbranch_scc1 L_pgive_83
    s_waitcnt lgkmcnt(0)
    s_xor_b32 s20, s20, s55
    s_xor_b32 s21, s21, s55
    s_xor_b32 s22, s22, s55
    s_xor_b32 s23, s23, s55
    s_xor_b32 s24, s24, s55
    s_xor_b32 s25, s25, s55
    s_xor_b32 s26, s26, s55
    s_or_b32 s20, s20, s26
    s_or_b64 s[20:21], s[20:21], s[24:25]
    s_or_b64 s[20:21], s[20:21], s[22:23]
    s_cbranch_scc1 L_ploop_82
L_pgive_83:
    s_waitcnt lgkmcnt(0)
    s_branch L_pback_81
L_pslow_84:
    s_mov_b32 s62, 0
L_ploop_86:
    s_buffer_load_dwordx4 s[64:67], s[44:47], s100 glc
    s_add_u32 s62, s62, 1
    s_cmp_ge_u32 s62, 40000
    s_cbranch_scc1 L_pgive_87
    s_waitcnt lgkmcnt(0)
    s_xor_b32 s64, s64, s55
    s_xor_b32 s65, s65, s55
    s_xor_b32 s66, s66, s55
    s_xor_b32 s67, s67, s55
    s_or_b64 s[64:65], s[64:65], s[66:67]
    s_cbranch_scc1 L_ploop_86
L_pgive_87:
    s_waitcnt lgkmcnt(0)
    s_branch L_pback_85
L_S34:
L_SO:
    s_buffer_load_dwordx4 s[64:67], s[44:47], s100 glc
    s_waitcnt lgkmcnt(0)
    s_xor_b32 s64, s64, s55
    s_xor_b32 s65, s65, s55
    s_xor_b32 s66, s66, s55
    s_xor_b32 s67, s67, s55
    s_or_b64 s[64:65], s[64:65], s[66:67]
    s_cbranch_scc1 L_pslow_88
L_pback_89:
    buffer_load_dwordx4 v[144:147], v254, s[44:47], s61 offen sc1
    buffer_load_dwordx4 v[0:3], v254, s[44:47], s92 offen offset:0 sc1
    buffer_load_dwordx4 v[4:7], v251, s[44:47], s92 offen offset:0 sc1
    buffer_load_dwordx4 v[8:11], v254, s[44:47], s92 offen offset:1024 sc1
    buffer_load_dwordx4 v[12:15], v251, s[44:47], s92 offen offset:1024 sc1
    buffer_load_dwordx4 v[16:19], v254, s[44:47], s93 offen offset:0 sc1
    buffer_load_dwordx4 v[20:23], v251, s[44:47], s93 offen offset:0 sc1
    buffer_load_dwordx4 v[24:27], v254, s[44:47], s93 offen offset:1024 sc1
    buffer_load_dwordx4 v[28:31], v251, s[44:47], s93 offen offset:1024 sc1
    v_bfe_u32 v247, v255, 4, 2
    v_mul_u32_u24 v236, 18, v247
    v_and_b32 v247, 1, v247
    v_xor_b32 v247, 1, v247
    v_lshl_add_u32 v236, v247, 1, v236
    v_bfe_u32 v247, v255, 2, 2
    v_add_u32 v236, v236, v247
    v_mul_u32_u24 v236, 1152, v236
    v_lshrrev_b32 v247, 3, v255
    v_and_b32 v247, 2, v247
    v_xor_b32 v247, v247, v255
    v_and_b32 v247, 3, v247
    v_lshl_add_u32 v236, v247, 4, v236
    v_bfe_u32 v247, v255, 3, 2
    v_mul_u32_u24 v237, 18, v247
    v_and_b32 v247, 1, v247
    v_xor_b32 v247, 1, v247
    v_lshl_add_u32 v237, v247, 1, v237
    v_bfe_u32 v247, v255, 1, 2
    v_add_u32 v237, v237, v247
    v_mul_u32_u24 v237, 1152, v237
    v_and_b32 v247, 1, v255
    v_lshl_add_u32 v237, v247, 4, v237
    s_mul_i32 s64, s53, 82944
    s_mul_i32 s65, s49, 4608
    s_add_u32 s64, s64, s65
    s_lshl_b32 s65, s54, 8
    s_add_u32 s65, s65, s64
    v_add_u32 v236, s65, v236
    s_lshl_b32 s65, s54, 5
    s_add_u32 s65, s65, s64
    s_add_u32 s65, s65, 1024
    v_add_u32 v237, s65, v237
    v_bfe_u32 v247, v255, 4, 2
    v_mul_u32_u24 v241, 18, v247
    v_and_b32 v247, 1, v247
    v_lshl_add_u32 v241, v247, 4, v241
    v_bfe_u32 v247, v255, 2, 2
    v_add_u32 v241, v241, v247
    v_mul_u32_u24 v241, 1152, v241
    v_lshrrev_b32 v247, 3, v255
    v_and_b32 v247, 2, v247
    v_xor_b32 v247, v247, v255
    v_and_b32 v247, 3, v247
    v_lshl_add_u32 v241, v247, 4, v241
    v_bfe_u32 v247, v255, 3, 2
    v_mul_u32_u24 v245, 18, v247
    v_and_b32 v247, 1, v247
    v_lshl_add_u32 v245, v247, 4, v245
    v_bfe_u32 v247, v255, 1, 2
    v_add_u32 v245, v245, v247
    v_mul_u32_u24 v245, 1152, v245
    v_and_b32 v247, 1, v255
    v_lshl_add_u32 v245, v247, 4, v245
    s_mul_i32 s64, s53, 82944
    s_lshl_b32 s65, s54, 8
    s_add_u32 s65, s65, s64
    v_add_u32 v241, s65, v241
    s_lshl_b32 s65, s54, 5
    s_add_u32 s65, s65, s64
    s_add_u32 s65, s65, 1024
    v_add_u32 v245, s65, v245
    s_waitcnt vmcnt(9)
    s_cmp_lt_u32 s51, 16
    s_cbranch_scc1 L_rol_92
L_rolb_93:
    s_barrier
    ds_read_b64_tr_b16 v[208:209], v234 offset:2048
    ds_read_b64_tr_b16 v[210:211], v234 offset:4608
    ds_read_b64_tr_b16 v[212:213], v234 offset:7168
    ds_read_b64_tr_b16 v[214:215], v234 offset:9728
    ds_read_b64_tr_b16 v[216:217], v232 offset:0
    ds_read_b64_tr_b16 v[218:219], v232 offset:2560
    ds_read_b64_tr_b16 v[220:221], v232 offset:5120
    ds_read_b64_tr_b16 v[222:223], v232 offset:7680
    ds_read_b64_tr_b16 v[224:225], v233 offset:0
    ds_read_b64_tr_b16 v[226:227], v233 offset:2560
    ds_read_b64_tr_b16 v[228:229], v233 offset:5120
    ds_read_b64_tr_b16 v[230:231], v233 offset:7680
    s_waitcnt vmcnt(8)
    v_add_f32 v144, v144, v145
    v_add_f32 v146, v146, v147
    v_add_f32 v152, v144, v146
    v_add_f32 v144, v144, v146
    s_nop 1
    v_permlane32_swap_b32 v144, v152
    v_mov_b32 v148, v144
    v_mov_b32 v156, v152
    s_nop 0
    v_permlane16_swap_b32 v144, v148
    v_permlane16_swap_b32 v152, v156
    v_mul_f32 v147, 0xbae38e39, v144
    v_mul_f32 v145, 0x3ae38e39, v148
    v_fma_f32 v145, -v147, v147, v145
    v_max_f32 v145, 0, v145
    v_add_f32 v145, 0x3727c5ac, v145
    v_rsq_f32 v146, v145
    v_mul_f32 v155, 0xbae38e39, v152
    v_mul_f32 v153, 0x3ae38e39, v156
    v_fma_f32 v153, -v155, v155, v153
    v_max_f32 v153, 0, v153
    v_add_f32 v153, 0x3727c5ac, v153
    v_rsq_f32 v154, v153
    v_rcp_f32 v240, v146
    v_mul_f32 v239, v146, v146
    v_mul_f32 v238, 0xc0135761, v146
    v_mul_f32 v239, 0x3d372713, v239
    v_mul_f32 v239, v239, v238
    v_rcp_f32 v244, v154
    v_mul_f32 v243, v154, v154
    v_mul_f32 v242, 0xc0135761, v154
    v_mul_f32 v243, 0x3d372713, v243
    v_mul_f32 v243, v243, v242
    s_waitcnt lgkmcnt(8)
    s_waitcnt vmcnt(7)
    v_mfma_f32_16x16x32_bf16 v[168:171], v[208:211], v[0:3], 0
    ds_read_b64_tr_b16 v[160:161], v232 offset:1024
    s_waitcnt vmcnt(5)
    v_mfma_f32_16x16x32_bf16 v[168:171], v[212:215], v[8:11], v[168:171]
    ds_read_b64_tr_b16 v[162:163], v232 offset:3584
    s_waitcnt vmcnt(4)
    v_mfma_f32_16x16x32_bf16 v[172:175], v[212:215], v[12:15], 0
    ds_read_b64_tr_b16 v[164:165], v232 offset:6144
    v_mfma_f32_16x16x32_bf16 v[172:175], v[208:211], v[4:7], v[172:175]
    ds_read_b64_tr_b16 v[166:167], v232 offset:8704
    buffer_load_dwordx4 v[32:35], v254, s[44:47], s94 offen offset:0 sc1
    s_waitcnt lgkmcnt(8)
    v_mfma_f32_16x16x32_bf16 v[176:179], v[216:219], v[0:3], 0
    ds_read_b64_tr_b16 v[208:209], v233 offset:1024
    v_mfma_f32_16x16x32_bf16 v[176:179], v[220:223], v[8:11], v[176:179]
    ds_read_b64_tr_b16 v[210:211], v233 offset:3584
    v_mfma_f32_16x16x32_bf16 v[184:187], v[220:223], v[12:15], 0
    ds_read_b64_tr_b16 v[212:213], v233 offset:6144
    v_mfma_f32_16x16x32_bf16 v[184:187], v[216:219], v[4:7], v[184:187]
    ds_read_b64_tr_b16 v[214:215], v233 offset:8704
    buffer_load_dwordx4 v[36:39], v251, s[44:47], s94 offen offset:0 sc1
    s_waitcnt lgkmcnt(8)
    v_mfma_f32_16x16x32_bf16 v[180:183], v[224:227], v[0:3], 0
    ds_read_b64_tr_b16 v[216:217], v234 offset:12288
    v_mfma_f32_16x16x32_bf16 v[180:183], v[228:231], v[8:11], v[180:183]
    ds_read_b64_tr_b16 v[218:219], v234 offset:14848
    v_mfma_f32_16x16x32_bf16 v[188:191], v[228:231], v[12:15], 0
    ds_read_b64_tr_b16 v[220:221], v234 offset:17408
    v_mfma_f32_16x16x32_bf16 v[188:191], v[224:227], v[4:7], v[188:191]
    ds_read_b64_tr_b16 v[222:223], v234 offset:19968
    s_waitcnt lgkmcnt(8)
    v_mfma_f32_16x16x32_bf16 v[192:195], v[160:163], v[0:3], 0
    ds_read_b64_tr_b16 v[224:225], v232 offset:10240
    v_mfma_f32_16x16x32_bf16 v[192:195], v[164:167], v[8:11], v[192:195]
    ds_read_b64_tr_b16 v[226:227], v232 offset:12800
    v_mfma_f32_16x16x32_bf16 v[200:203], v[164:167], v[12:15], 0
    ds_read_b64_tr_b16 v[228:229], v232 offset:15360
    v_mfma_f32_16x16x32_bf16 v[200:203], v[160:163], v[4:7], v[200:203]
    ds_read_b64_tr_b16 v[230:231], v232 offset:17920
    buffer_load_dwordx4 v[40:43], v254, s[44:47], s94 offen offset:1024 sc1
    s_waitcnt lgkmcnt(8)
    v_mfma_f32_16x16x32_bf16 v[196:199], v[208:211], v[0:3], 0
    ds_read_b64_tr_b16 v[160:161], v233 offset:10240
    v_mfma_f32_16x16x32_bf16 v[196:199], v[212:215], v[8:11], v[196:199]
    ds_read_b64_tr_b16 v[162:163], v233 offset:12800
    v_mfma_f32_16x16x32_bf16 v[204:207], v[212:215], v[12:15], 0
    ds_read_b64_tr_b16 v[164:165], v233 offset:15360
    v_mfma_f32_16x16x32_bf16 v[204:207], v[208:211], v[4:7], v[204:207]
    ds_read_b64_tr_b16 v[166:167], v233 offset:17920
    buffer_load_dwordx4 v[44:47], v251, s[44:47], s94 offen offset:1024 sc1
    s_waitcnt lgkmcnt(8)
    s_waitcnt vmcnt(7)
    v_mfma_f32_16x16x32_bf16 v[168:171], v[216:219], v[16:19], v[168:171]
    ds_read_b64_tr_b16 v[208:209], v232 offset:11264
    s_waitcnt vmcnt(5)
    v_mfma_f32_16x16x32_bf16 v[168:171], v[220:223], v[24:27], v[168:171]
    ds_read_b64_tr_b16 v[210:211], v232 offset:13824
    s_waitcnt vmcnt(4)
    v_mfma_f32_16x16x32_bf16 v[172:175], v[220:223], v[28:31], v[172:175]
    ds_read_b64_tr_b16 v[212:213], v232 offset:16384
    v_mfma_f32_16x16x32_bf16 v[172:175], v[216:219], v[20:23], v[172:175]
    ds_read_b64_tr_b16 v[214:215], v232 offset:18944
    buffer_load_dwordx4 v[48:51], v254, s[44:47], s95 offen offset:0 sc1
    s_waitcnt lgkmcnt(8)
    v_mfma_f32_16x16x32_bf16 v[176:179], v[224:227], v[16:19], v[176:179]
    ds_read_b64_tr_b16 v[216:217], v233 offset:11264
    v_mfma_f32_16x16x32_bf16 v[176:179], v[228:231], v[24:27], v[176:179]
    ds_read_b64_tr_b16 v[218:219], v233 offset:13824
    v_mfma_f32_16x16x32_bf16 v[184:187], v[228:231], v[28:31], v[184:187]
    ds_read_b64_tr_b16 v[220:221], v233 offset:16384
    v_mfma_f32_16x16x32_bf16 v[184:187], v[224:227], v[20:23], v[184:187]
    ds_read_b64_tr_b16 v[222:223], v233 offset:18944
    buffer_load_dwordx4 v[52:55], v251, s[44:47], s95 offen offset:0 sc1
    s_waitcnt lgkmcnt(8)
    v_mfma_f32_16x16x32_bf16 v[180:183], v[160:163], v[16:19], v[180:183]
    ds_read_b64_tr_b16 v[224:225], v234 offset:22528
    v_mfma_f32_16x16x32_bf16 v[180:183], v[164:167], v[24:27], v[180:183]
    ds_read_b64_tr_b16 v[226:227], v234 offset:25088
    v_mfma_f32_16x16x32_bf16 v[188:191], v[164:167], v[28:31], v[188:191]
    ds_read_b64_tr_b16 v[228:229], v234 offset:27648
    v_mfma_f32_16x16x32_bf16 v[188:191], v[160:163], v[20:23], v[188:191]
    ds_read_b64_tr_b16 v[230:231], v234 offset:30208
    s_waitcnt lgkmcnt(8)
    v_mfma_f32_16x16x32_bf16 v[192:195], v[208:211], v[16:19], v[192:195]
    ds_read_b64_tr_b16 v[160:161], v232 offset:20480
    v_mfma_f32_16x16x32_bf16 v[192:195], v[212:215], v[24:27], v[192:195]
    ds_read_b64_tr_b16 v[162:163], v232 offset:23040
    v_mfma_f32_16x16x32_bf16 v[200:203], v[212:215], v[28:31], v[200:203]
    ds_read_b64_tr_b16 v[164:165], v232 offset:25600
    v_mfma_f32_16x16x32_bf16 v[200:203], v[208:211], v[20:23], v[200:203]
    ds_read_b64_tr_b16 v[166:167], v232 offset:28160
    buffer_load_dwordx4 v[56:59], v254, s[44:47], s95 offen offset:1024 sc1
    s_waitcnt lgkmcnt(8)
    v_mfma_f32_16x16x32_bf16 v[196:199], v[216:219], v[16:19], v[196:199]
    ds_read_b64_tr_b16 v[208:209], v233 offset:20480
    v_mfma_f32_16x16x32_bf16 v[196:199], v[220:223], v[24:27], v[196:199]
    ds_read_b64_tr_b16 v[210:211], v233 offset:23040
    v_mfma_f32_16x16x32_bf16 v[204:207], v[220:223], v[28:31], v[204:207]
    ds_read_b64_tr_b16 v[212:213], v233 offset:25600
    v_mfma_f32_16x16x32_bf16 v[204:207], v[216:219], v[20:23], v[204:207]
    ds_read_b64_tr_b16 v[214:215], v233 offset:28160
    buffer_load_dwordx4 v[60:63], v251, s[44:47], s95 offen offset:1024 sc1
    s_waitcnt lgkmcnt(8)
    s_waitcnt vmcnt(7)
    v_mfma_f32_16x16x32_bf16 v[168:171], v[224:227], v[32:35], v[168:171]
    ds_read_b64_tr_b16 v[216:217], v232 offset:21504
    s_waitcnt vmcnt(5)
    v_mfma_f32_16x16x32_bf16 v[168:171], v[228:231], v[40:43], v[168:171]
    ds_read_b64_tr_b16 v[218:219], v232 offset:24064
    s_waitcnt vmcnt(4)
    v_mfma_f32_16x16x32_bf16 v[172:175], v[228:231], v[44:47], v[172:175]
    ds_read_b64_tr_b16 v[220:221], v232 offset:26624
    v_mfma_f32_16x16x32_bf16 v[172:175], v[224:227], v[36:39], v[172:175]
    ds_read_b64_tr_b16 v[222:223], v232 offset:29184
    buffer_load_dwordx4 v[64:67], v254, s[44:47], s96 offen offset:0 sc1
    s_waitcnt lgkmcnt(8)
    v_mfma_f32_16x16x32_bf16 v[176:179], v[160:163], v[32:35], v[176:179]
    ds_read_b64_tr_b16 v[224:225], v233 offset:21504
    v_mfma_f32_16x16x32_bf16 v[176:179], v[164:167], v[40:43], v[176:179]
    ds_read_b64_tr_b16 v[226:227], v233 offset:24064
    v_mfma_f32_16x16x32_bf16 v[184:187], v[164:167], v[44:47], v[184:187]
    ds_read_b64_tr_b16 v[228:229], v233 offset:26624
    v_mfma_f32_16x16x32_bf16 v[184:187], v[160:163], v[36:39], v[184:187]
    ds_read_b64_tr_b16 v[230:231], v233 offset:29184
    buffer_load_dwordx4 v[68:71], v251, s[44:47], s96 offen offset:0 sc1
    s_waitcnt lgkmcnt(8)
    v_mfma_f32_16x16x32_bf16 v[180:183], v[208:211], v[32:35], v[180:183]
    ds_read_b64_tr_b16 v[160:161], v234 offset:32768
    v_mfma_f32_16x16x32_bf16 v[180:183], v[212:215], v[40:43], v[180:183]
    ds_read_b64_tr_b16 v[162:163], v234 offset:35328
    v_mfma_f32_16x16x32_bf16 v[188:191], v[212:215], v[44:47], v[188:191]
    ds_read_b64_tr_b16 v[164:165], v234 offset:37888
    v_mfma_f32_16x16x32_bf16 v[188:191], v[208:211], v[36:39], v[188:191]
    ds_read_b64_tr_b16 v[166:167], v234 offset:40448
    s_waitcnt lgkmcnt(8)
    v_mfma_f32_16x16x32_bf16 v[192:195], v[216:219], v[32:35], v[192:195]
    ds_read_b64_tr_b16 v[208:209], v232 offset:30720
    v_mfma_f32_16x16x32_bf16 v[192:195], v[220:223], v[40:43], v[192:195]
    ds_read_b64_tr_b16 v[210:211], v232 offset:33280
    v_mfma_f32_16x16x32_bf16 v[200:203], v[220:223], v[44:47], v[200:203]
    ds_read_b64_tr_b16 v[212:213], v232 offset:35840
    v_mfma_f32_16x16x32_bf16 v[200:203], v[216:219], v[36:39], v[200:203]
    ds_read_b64_tr_b16 v[214:215], v232 offset:38400
    buffer_load_dwordx4 v[72:75], v254, s[44:47], s96 offen offset:1024 sc1
    s_waitcnt lgkmcnt(8)
    v_mfma_f32_16x16x32_bf16 v[196:199], v[224:227], v[32:35], v[196:199]
    ds_read_b64_tr_b16 v[216:217], v233 offset:30720
    v_mfma_f32_16x16x32_bf16 v[196:199], v[228:231], v[40:43], v[196:199]
    ds_read_b64_tr_b16 v[218:219], v233 offset:33280
    v_mfma_f32_16x16x32_bf16 v[204:207], v[228:231], v[44:47], v[204:207]
    ds_read_b64_tr_b16 v[220:221], v233 offset:35840
    v_mfma_f32_16x16x32_bf16 v[204:207], v[224:227], v[36:39], v[204:207]
    ds_read_b64_tr_b16 v[222:223], v233 offset:38400
    buffer_load_dwordx4 v[76:79], v251, s[44:47], s96 offen offset:1024 sc1
    s_waitcnt lgkmcnt(8)
    s_waitcnt vmcnt(7)
    v_mfma_f32_16x16x32_bf16 v[168:171], v[160:163], v[48:51], v[168:171]
    ds_read_b64_tr_b16 v[224:225], v232 offset:31744
    s_waitcnt vmcnt(5)
    v_mfma_f32_16x16x32_bf16 v[168:171], v[164:167], v[56:59], v[168:171]
    ds_read_b64_tr_b16 v[226:227], v232 offset:34304
    s_waitcnt vmcnt(4)
    v_mfma_f32_16x16x32_bf16 v[172:175], v[164:167], v[60:63], v[172:175]
    ds_read_b64_tr_b16 v[228:229], v232 offset:36864
    v_mfma_f32_16x16x32_bf16 v[172:175], v[160:163], v[52:55], v[172:175]
    ds_read_b64_tr_b16 v[230:231], v232 offset:39424
    buffer_load_dwordx4 v[80:83], v254, s[44:47], s97 offen offset:0 sc1
    s_waitcnt lgkmcnt(8)
    v_mfma_f32_16x16x32_bf16 v[176:179], v[208:211], v[48:51], v[176:179]
    ds_read_b64_tr_b16 v[160:161], v233 offset:31744
    v_mfma_f32_16x16x32_bf16 v[176:179], v[212:215], v[56:59], v[176:179]
    ds_read_b64_tr_b16 v[162:163], v233 offset:34304
    v_mfma_f32_16x16x32_bf16 v[184:187], v[212:215], v[60:63], v[184:187]
    ds_read_b64_tr_b16 v[164:165], v233 offset:36864
    v_mfma_f32_16x16x32_bf16 v[184:187], v[208:211], v[52:55], v[184:187]
    ds_read_b64_tr_b16 v[166:167], v233 offset:39424
    buffer_load_dwordx4 v[84:87], v251, s[44:47], s97 offen offset:0 sc1
    s_waitcnt lgkmcnt(8)
    v_mfma_f32_16x16x32_bf16 v[180:183], v[216:219], v[48:51], v[180:183]
    ds_read_b64_tr_b16 v[208:209], v234 offset:43008
    v_mfma_f32_16x16x32_bf16 v[180:183], v[220:223], v[56:59], v[180:183]
    ds_read_b64_tr_b16 v[210:211], v234 offset:45568
    v_mfma_f32_16x16x32_bf16 v[188:191], v[220:223], v[60:63], v[188:191]
    ds_read_b64_tr_b16 v[212:213], v234 offset:48128
    v_mfma_f32_16x16x32_bf16 v[188:191], v[216:219], v[52:55], v[188:191]
    ds_read_b64_tr_b16 v[214:215], v234 offset:50688
    s_waitcnt lgkmcnt(8)
    v_mfma_f32_16x16x32_bf16 v[192:195], v[224:227], v[48:51], v[192:195]
    ds_read_b64_tr_b16 v[216:217], v232 offset:40960
    v_mfma_f32_16x16x32_bf16 v[192:195], v[228:231], v[56:59], v[192:195]
    ds_read_b64_tr_b16 v[218:219], v232 offset:43520
    v_mfma_f32_16x16x32_bf16 v[200:203], v[228:231], v[60:63], v[200:203]
    ds_read_b64_tr_b16 v[220:221], v232 offset:46080
    v_mfma_f32_16x16x32_bf16 v[200:203], v[224:227], v[52:55], v[200:203]
    ds_read_b64_tr_b16 v[222:223], v232 offset:48640
    buffer_load_dwordx4 v[88:91], v254, s[44:47], s97 offen offset:1024 sc1
    s_waitcnt lgkmcnt(8)
    v_mfma_f32_16x16x32_bf16 v[196:199], v[160:163], v[48:51], v[196:199]
    ds_read_b64_tr_b16 v[224:225], v233 offset:40960
    v_mfma_f32_16x16x32_bf16 v[196:199], v[164:167], v[56:59], v[196:199]
    ds_read_b64_tr_b16 v[226:227], v233 offset:43520
    v_mfma_f32_16x16x32_bf16 v[204:207], v[164:167], v[60:63], v[204:207]
    ds_read_b64_tr_b16 v[228:229], v233 offset:46080
    v_mfma_f32_16x16x32_bf16 v[204:207], v[160:163], v[52:55], v[204:207]
    ds_read_b64_tr_b16 v[230:231], v233 offset:48640
    buffer_load_dwordx4 v[92:95], v251, s[44:47], s97 offen offset:1024 sc1
    s_waitcnt lgkmcnt(8)
    s_waitcnt vmcnt(7)
    v_mfma_f32_16x16x32_bf16 v[168:171], v[208:211], v[64:67], v[168:171]
    ds_read_b64_tr_b16 v[160:161], v232 offset:41984
    s_waitcnt vmcnt(5)
    v_mfma_f32_16x16x32_bf16 v[168:171], v[212:215], v[72:75], v[168:171]
    ds_read_b64_tr_b16 v[162:163], v232 offset:44544
    s_waitcnt vmcnt(4)
    v_mfma_f32_16x16x32_bf16 v[172:175], v[212:215], v[76:79], v[172:175]
    ds_read_b64_tr_b16 v[164:165], v232 offset:47104
    v_mfma_f32_16x16x32_bf16 v[172:175], v[208:211], v[68:71], v[172:175]
    ds_read_b64_tr_b16 v[166:167], v232 offset:49664
    buffer_load_dwordx4 v[96:99], v254, s[44:47], s98 offen offset:0 sc1
    s_waitcnt lgkmcnt(8)
    v_mfma_f32_16x16x32_bf16 v[176:179], v[216:219], v[64:67], v[176:179]
    ds_read_b64_tr_b16 v[208:209], v233 offset:41984
    v_mfma_f32_16x16x32_bf16 v[176:179], v[220:223], v[72:75], v[176:179]
    ds_read_b64_tr_b16 v[210:211], v233 offset:44544
    v_mfma_f32_16x16x32_bf16 v[184:187], v[220:223], v[76:79], v[184:187]
    ds_read_b64_tr_b16 v[212:213], v233 offset:47104
    v_mfma_f32_16x16x32_bf16 v[184:187], v[216:219], v[68:71], v[184:187]
    ds_read_b64_tr_b16 v[214:215], v233 offset:49664
    buffer_load_dwordx4 v[100:103], v251, s[44:47], s98 offen offset:0 sc1
    s_waitcnt lgkmcnt(8)
    v_mfma_f32_16x16x32_bf16 v[180:183], v[224:227], v[64:67], v[180:183]
    ds_read_b64_tr_b16 v[216:217], v234 offset:53248
    v_mfma_f32_16x16x32_bf16 v[180:183], v[228:231], v[72:75], v[180:183]
    ds_read_b64_tr_b16 v[218:219], v234 offset:55808
    v_mfma_f32_16x16x32_bf16 v[188:191], v[228:231], v[76:79], v[188:191]
    ds_read_b64_tr_b16 v[220:221], v234 offset:58368
    v_mfma_f32_16x16x32_bf16 v[188:191], v[224:227], v[68:71], v[188:191]
    ds_read_b64_tr_b16 v[222:223], v234 offset:60928
    s_waitcnt lgkmcnt(8)
    v_mfma_f32_16x16x32_bf16 v[192:195], v[160:163], v[64:67], v[192:195]
    ds_read_b64_tr_b16 v[224:225], v232 offset:51200
    v_mfma_f32_16x16x32_bf16 v[192:195], v[164:167], v[72:75], v[192:195]
    ds_read_b64_tr_b16 v[226:227], v232 offset:53760
    v_mfma_f32_16x16x32_bf16 v[200:203], v[164:167], v[76:79], v[200:203]
    ds_read_b64_tr_b16 v[228:229], v232 offset:56320
    v_mfma_f32_16x16x32_bf16 v[200:203], v[160:163], v[68:71], v[200:203]
    ds_read_b64_tr_b16 v[230:231], v232 offset:58880
    buffer_load_dwordx4 v[104:107], v254, s[44:47], s98 offen offset:1024 sc1
    s_waitcnt lgkmcnt(8)
    v_mfma_f32_16x16x32_bf16 v[196:199], v[208:211], v[64:67], v[196:199]
    ds_read_b64_tr_b16 v[160:161], v233 offset:51200
    v_mfma_f32_16x16x32_bf16 v[196:199], v[212:215], v[72:75], v[196:199]
    ds_read_b64_tr_b16 v[162:163], v233 offset:53760
    v_mfma_f32_16x16x32_bf16 v[204:207], v[212:215], v[76:79], v[204:207]
    ds_read_b64_tr_b16 v[164:165], v233 offset:56320
    v_mfma_f32_16x16x32_bf16 v[204:207], v[208:211], v[68:71], v[204:207]
    ds_read_b64_tr_b16 v[166:167], v233 offset:58880
    buffer_load_dwordx4 v[108:111], v251, s[44:47], s98 offen offset:1024 sc1
    s_waitcnt lgkmcnt(8)
    s_waitcnt vmcnt(7)
    v_mfma_f32_16x16x32_bf16 v[168:171], v[216:219], v[80:83], v[168:171]
    ds_read_b64_tr_b16 v[208:209], v232 offset:52224
    s_waitcnt vmcnt(5)
    v_mfma_f32_16x16x32_bf16 v[168:171], v[220:223], v[88:91], v[168:171]
    ds_read_b64_tr_b16 v[210:211], v232 offset:54784
    s_waitcnt vmcnt(4)
    v_mfma_f32_16x16x32_bf16 v[172:175], v[220:223], v[92:95], v[172:175]
    ds_read_b64_tr_b16 v[212:213], v232 offset:57344
    v_mfma_f32_16x16x32_bf16 v[172:175], v[216:219], v[84:87], v[172:175]
    ds_read_b64_tr_b16 v[214:215], v232 offset:59904
    buffer_load_dwordx4 v[112:115], v254, s[44:47], s99 offen offset:0 sc1
    s_waitcnt lgkmcnt(8)
    v_mfma_f32_16x16x32_bf16 v[176:179], v[224:227], v[80:83], v[176:179]
    ds_read_b64_tr_b16 v[216:217], v233 offset:52224
    v_mfma_f32_16x16x32_bf16 v[176:179], v[228:231], v[88:91], v[176:179]
    ds_read_b64_tr_b16 v[218:219], v233 offset:54784
    v_mfma_f32_16x16x32_bf16 v[184:187], v[228:231], v[92:95], v[184:187]
    ds_read_b64_tr_b16 v[220:221], v233 offset:57344
    v_mfma_f32_16x16x32_bf16 v[184:187], v[224:227], v[84:87], v[184:187]
    ds_read_b64_tr_b16 v[222:223], v233 offset:59904
    buffer_load_dwordx4 v[116:119], v251, s[44:47], s99 offen offset:0 sc1
    s_waitcnt lgkmcnt(8)
    v_mfma_f32_16x16x32_bf16 v[180:183], v[160:163], v[80:83], v[180:183]
    ds_read_b64_tr_b16 v[224:225], v234 offset:63488
    v_mfma_f32_16x16x32_bf16 v[180:183], v[164:167], v[88:91], v[180:183]
    v_add_u32 v234, 0x0000e000, v234
    ds_read_b64_tr_b16 v[226:227], v234 offset:8704
    v_mfma_f32_16x16x32_bf16 v[188:191], v[164:167], v[92:95], v[188:191]
    ds_read_b64_tr_b16 v[228:229], v234 offset:11264
    v_mfma_f32_16x16x32_bf16 v[188:191], v[160:163], v[84:87], v[188:191]
    ds_read_b64_tr_b16 v[230:231], v234 offset:13824
    s_waitcnt lgkmcnt(8)
    v_mfma_f32_16x16x32_bf16 v[192:195], v[208:211], v[80:83], v[192:195]
    ds_read_b64_tr_b16 v[160:161], v232 offset:61440
    v_mfma_f32_16x16x32_bf16 v[192:195], v[212:215], v[88:91], v[192:195]
    ds_read_b64_tr_b16 v[162:163], v232 offset:64000
    v_mfma_f32_16x16x32_bf16 v[200:203], v[212:215], v[92:95], v[200:203]
    v_add_u32 v232, 0x0000e400, v232
    ds_read_b64_tr_b16 v[164:165], v232 offset:8192
    v_mfma_f32_16x16x32_bf16 v[200:203], v[208:211], v[84:87], v[200:203]
    ds_read_b64_tr_b16 v[166:167], v232 offset:10752
    buffer_load_dwordx4 v[120:123], v254, s[44:47], s99 offen offset:1024 sc1
    s_waitcnt lgkmcnt(8)
    v_mfma_f32_16x16x32_bf16 v[196:199], v[216:219], v[80:83], v[196:199]
    ds_read_b64_tr_b16 v[208:209], v233 offset:61440
    v_mfma_f32_16x16x32_bf16 v[196:199], v[220:223], v[88:91], v[196:199]
    ds_read_b64_tr_b16 v[210:211], v233 offset:64000
    v_mfma_f32_16x16x32_bf16 v[204:207], v[220:223], v[92:95], v[204:207]
    v_add_u32 v233, 0x0000e400, v233
    ds_read_b64_tr_b16 v[212:213], v233 offset:8192
    v_mfma_f32_16x16x32_bf16 v[204:207], v[216:219], v[84:87], v[204:207]
    ds_read_b64_tr_b16 v[214:215], v233 offset:10752
    buffer_load_dwordx4 v[124:127], v251, s[44:47], s99 offen offset:1024 sc1
    s_waitcnt lgkmcnt(8)
    s_waitcnt vmcnt(7)
    v_mfma_f32_16x16x32_bf16 v[168:171], v[224:227], v[96:99], v[168:171]
    ds_read_b64_tr_b16 v[216:217], v232 offset:4096
    s_waitcnt vmcnt(5)
    v_mfma_f32_16x16x32_bf16 v[168:171], v[228:231], v[104:107], v[168:171]
    ds_read_b64_tr_b16 v[218:219], v232 offset:6656
    s_waitcnt vmcnt(4)
    v_mfma_f32_16x16x32_bf16 v[172:175], v[228:231], v[108:111], v[172:175]
    ds_read_b64_tr_b16 v[220:221], v232 offset:9216
    v_mfma_f32_16x16x32_bf16 v[172:175], v[224:227], v[100:103], v[172:175]
    ds_read_b64_tr_b16 v[222:223], v232 offset:11776
    buffer_load_dwordx2 v[128:129], v252, s[44:47], s60 offen offset:0 sc1
    buffer_load_dwordx2 v[130:131], v252, s[44:47], s60 offen offset:512 sc1
    s_waitcnt lgkmcnt(8)
    v_mfma_f32_16x16x32_bf16 v[176:179], v[160:163], v[96:99], v[176:179]
    ds_read_b64_tr_b16 v[224:225], v233 offset:4096
    v_mfma_f32_16x16x32_bf16 v[176:179], v[164:167], v[104:107], v[176:179]
    ds_read_b64_tr_b16 v[226:227], v233 offset:6656
    v_mfma_f32_16x16x32_bf16 v[184:187], v[164:167], v[108:111], v[184:187]
    ds_read_b64_tr_b16 v[228:229], v233 offset:9216
    v_mfma_f32_16x16x32_bf16 v[184:187], v[160:163], v[100:103], v[184:187]
    ds_read_b64_tr_b16 v[230:231], v233 offset:11776
    buffer_load_dwordx2 v[132:133], v253, s[44:47], s60 offen offset:0 sc1
    buffer_load_dwordx2 v[134:135], v253, s[44:47], s60 offen offset:512 sc1
    s_waitcnt lgkmcnt(8)
    v_mfma_f32_16x16x32_bf16 v[180:183], v[208:211], v[96:99], v[180:183]
    ds_read_b64_tr_b16 v[160:161], v234 offset:16384
    v_mfma_f32_16x16x32_bf16 v[180:183], v[212:215], v[104:107], v[180:183]
    ds_read_b64_tr_b16 v[162:163], v234 offset:18944
    v_mfma_f32_16x16x32_bf16 v[188:191], v[212:215], v[108:111], v[188:191]
    ds_read_b64_tr_b16 v[164:165], v234 offset:21504
    v_mfma_f32_16x16x32_bf16 v[188:191], v[208:211], v[100:103], v[188:191]
    ds_read_b64_tr_b16 v[166:167], v234 offset:24064
    s_waitcnt lgkmcnt(8)
    v_mfma_f32_16x16x32_bf16 v[192:195], v[216:219], v[96:99], v[192:195]
    ds_read_b64_tr_b16 v[208:209], v232 offset:13312
    v_mfma_f32_16x16x32_bf16 v[192:195], v[220:223], v[104:107], v[192:195]
    ds_read_b64_tr_b16 v[210:211], v232 offset:15872
    v_mfma_f32_16x16x32_bf16 v[200:203], v[220:223], v[108:111], v[200:203]
    ds_read_b64_tr_b16 v[212:213], v232 offset:18432
    v_mfma_f32_16x16x32_bf16 v[200:203], v[216:219], v[100:103], v[200:203]
    ds_read_b64_tr_b16 v[214:215], v232 offset:20992
    buffer_load_dwordx2 v[136:137], v252, s[44:47], s60 offen offset:1024 sc1
    buffer_load_dwordx2 v[138:139], v252, s[44:47], s60 offen offset:1536 sc1
    s_waitcnt lgkmcnt(8)
    v_mfma_f32_16x16x32_bf16 v[196:199], v[224:227], v[96:99], v[196:199]
    ds_read_b64_tr_b16 v[216:217], v233 offset:13312
    v_mfma_f32_16x16x32_bf16 v[196:199], v[228:231], v[104:107], v[196:199]
    ds_read_b64_tr_b16 v[218:219], v233 offset:15872
    v_mfma_f32_16x16x32_bf16 v[204:207], v[228:231], v[108:111], v[204:207]
    ds_read_b64_tr_b16 v[220:221], v233 offset:18432
    v_mfma_f32_16x16x32_bf16 v[204:207], v[224:227], v[100:103], v[204:207]
    ds_read_b64_tr_b16 v[222:223], v233 offset:20992
    buffer_load_dwordx2 v[140:141], v253, s[44:47], s60 offen offset:1024 sc1
    buffer_load_dwordx2 v[142:143], v253, s[44:47], s60 offen offset:1536 sc1
    s_waitcnt lgkmcnt(8)
    s_waitcnt vmcnt(11)
    v_mfma_f32_16x16x32_bf16 v[168:171], v[160:163], v[112:115], v[168:171]
    ds_read_b64_tr_b16 v[224:225], v232 offset:14336
    s_waitcnt vmcnt(9)
    v_mfma_f32_16x16x32_bf16 v[168:171], v[164:167], v[120:123], v[168:171]
    ds_read_b64_tr_b16 v[226:227], v232 offset:16896
    s_waitcnt vmcnt(8)
    v_mfma_f32_16x16x32_bf16 v[172:175], v[164:167], v[124:127], v[172:175]
    ds_read_b64_tr_b16 v[228:229], v232 offset:19456
    v_mfma_f32_16x16x32_bf16 v[172:175], v[160:163], v[116:119], v[172:175]
    ds_read_b64_tr_b16 v[230:231], v232 offset:22016
    s_waitcnt lgkmcnt(8)
    v_mfma_f32_16x16x32_bf16 v[176:179], v[208:211], v[112:115], v[176:179]
    ds_read_b64_tr_b16 v[160:161], v233 offset:14336
    v_mfma_f32_16x16x32_bf16 v[176:179], v[212:215], v[120:123], v[176:179]
    ds_read_b64_tr_b16 v[162:163], v233 offset:16896
    v_mfma_f32_16x16x32_bf16 v[184:187], v[212:215], v[124:127], v[184:187]
    ds_read_b64_tr_b16 v[164:165], v233 offset:19456
    v_mfma_f32_16x16x32_bf16 v[184:187], v[208:211], v[116:119], v[184:187]
    ds_read_b64_tr_b16 v[166:167], v233 offset:22016
    s_waitcnt lgkmcnt(8)
    v_mfma_f32_16x16x32_bf16 v[180:183], v[216:219], v[112:115], v[180:183]
    ds_read_b64_tr_b16 v[208:209], v234 offset:26624
    v_mfma_f32_16x16x32_bf16 v[180:183], v[220:223], v[120:123], v[180:183]
    ds_read_b64_tr_b16 v[210:211], v234 offset:29184
    v_mfma_f32_16x16x32_bf16 v[188:191], v[220:223], v[124:127], v[188:191]
    ds_read_b64_tr_b16 v[212:213], v234 offset:31744
    v_mfma_f32_16x16x32_bf16 v[188:191], v[216:219], v[116:119], v[188:191]
    ds_read_b64_tr_b16 v[214:215], v234 offset:34304
    s_waitcnt lgkmcnt(8)
    v_mfma_f32_16x16x32_bf16 v[192:195], v[224:227], v[112:115], v[192:195]
    ds_read_b64_tr_b16 v[216:217], v232 offset:23552
    v_mfma_f32_16x16x32_bf16 v[192:195], v[228:231], v[120:123], v[192:195]
    ds_read_b64_tr_b16 v[218:219], v232 offset:26112
    v_mfma_f32_16x16x32_bf16 v[200:203], v[228:231], v[124:127], v[200:203]
    ds_read_b64_tr_b16 v[220:221], v232 offset:28672
    v_mfma_f32_16x16x32_bf16 v[200:203], v[224:227], v[116:119], v[200:203]
    ds_read_b64_tr_b16 v[222:223], v232 offset:31232
    s_waitcnt lgkmcnt(8)
    v_mfma_f32_16x16x32_bf16 v[196:199], v[160:163], v[112:115], v[196:199]
    ds_read_b64_tr_b16 v[224:225], v233 offset:23552
    v_mfma_f32_16x16x32_bf16 v[196:199], v[164:167], v[120:123], v[196:199]
    ds_read_b64_tr_b16 v[226:227], v233 offset:26112
    v_mfma_f32_16x16x32_bf16 v[204:207], v[164:167], v[124:127], v[204:207]
    ds_read_b64_tr_b16 v[228:229], v233 offset:28672
    v_mfma_f32_16x16x32_bf16 v[204:207], v[160:163], v[116:119], v[204:207]
    ds_read_b64_tr_b16 v[230:231], v233 offset:31232
    s_waitcnt lgkmcnt(8)
    s_waitcnt vmcnt(6)
    v_mfma_f32_16x16x32_bf16 v[168:171], v[208:211], v[128:131], v[168:171]
    ds_read_b64_tr_b16 v[160:161], v232 offset:24576
    s_waitcnt vmcnt(2)
    v_mfma_f32_16x16x32_bf16 v[168:171], v[212:215], v[136:139], v[168:171]
    ds_read_b64_tr_b16 v[162:163], v232 offset:27136
    s_waitcnt vmcnt(0)
    v_mfma_f32_16x16x32_bf16 v[172:175], v[212:215], v[140:143], v[172:175]
    ds_read_b64_tr_b16 v[164:165], v232 offset:29696
    v_mfma_f32_16x16x32_bf16 v[172:175], v[208:211], v[132:135], v[172:175]
    ds_read_b64_tr_b16 v[166:167], v232 offset:32256
    s_waitcnt lgkmcnt(8)
    v_mfma_f32_16x16x32_bf16 v[176:179], v[216:219], v[128:131], v[176:179]
    ds_read_b64_tr_b16 v[208:209], v233 offset:24576
    v_mfma_f32_16x16x32_bf16 v[176:179], v[220:223], v[136:139], v[176:179]
    ds_read_b64_tr_b16 v[210:211], v233 offset:27136
    v_mfma_f32_16x16x32_bf16 v[184:187], v[220:223], v[140:143], v[184:187]
    ds_read_b64_tr_b16 v[212:213], v233 offset:29696
    v_mfma_f32_16x16x32_bf16 v[184:187], v[216:219], v[132:135], v[184:187]
    ds_read_b64_tr_b16 v[214:215], v233 offset:32256
    s_waitcnt lgkmcnt(8)
    v_mfma_f32_16x16x32_bf16 v[180:183], v[224:227], v[128:131], v[180:183]
    v_mfma_f32_16x16x32_bf16 v[180:183], v[228:231], v[136:139], v[180:183]
    v_mfma_f32_16x16x32_bf16 v[188:191], v[228:231], v[140:143], v[188:191]
    v_mfma_f32_16x16x32_bf16 v[188:191], v[224:227], v[132:135], v[188:191]
    s_waitcnt lgkmcnt(4)
    v_mfma_f32_16x16x32_bf16 v[192:195], v[160:163], v[128:131], v[192:195]
    v_mfma_f32_16x16x32_bf16 v[192:195], v[164:167], v[136:139], v[192:195]
    v_mfma_f32_16x16x32_bf16 v[200:203], v[164:167], v[140:143], v[200:203]
    v_mfma_f32_16x16x32_bf16 v[200:203], v[160:163], v[132:135], v[200:203]
    s_waitcnt lgkmcnt(0)
    v_mfma_f32_16x16x32_bf16 v[196:199], v[208:211], v[128:131], v[196:199]
    v_mfma_f32_16x16x32_bf16 v[196:199], v[212:215], v[136:139], v[196:199]
    v_mfma_f32_16x16x32_bf16 v[204:207], v[212:215], v[140:143], v[204:207]
    v_mfma_f32_16x16x32_bf16 v[204:207], v[208:211], v[132:135], v[204:207]
    s_cmp_lt_u32 s51, 16
    s_cbranch_scc1 L_rol_94
L_rolb_95:
    ds_read_b64_tr_b16 v[208:209], v232 offset:33792
    ds_read_b64_tr_b16 v[210:211], v232 offset:34816
    ds_read_b64_tr_b16 v[212:213], v232 offset:35840
    ds_read_b64_tr_b16 v[214:215], v232 offset:36864
    ds_read_b64_tr_b16 v[216:217], v233 offset:33792
    ds_read_b64_tr_b16 v[218:219], v233 offset:34816
    ds_read_b64_tr_b16 v[220:221], v233 offset:35840
    ds_read_b64_tr_b16 v[222:223], v233 offset:36864
    ds_read_b64_tr_b16 v[224:225], v232 offset:37888
    ds_read_b64_tr_b16 v[226:227], v232 offset:38912
    ds_read_b64_tr_b16 v[228:229], v232 offset:39936
    ds_read_b64_tr_b16 v[230:231], v232 offset:40960
    s_setprio 1
    v_mul_f32 v246, v168, v168
    v_mul_f32 v247, v169, v169
    v_mul_f32 v248, v170, v170
    v_mul_f32 v249, v171, v171
    v_mul_f32 v250, v172, v172
    v_mul_f32 v251, v173, v173
    v_mul_f32 v252, v174, v174
    v_mul_f32 v253, v175, v175
    v_fma_f32 v246, v246, v239, v238
    v_fma_f32 v247, v247, v239, v238
    v_fma_f32 v248, v248, v239, v238
    v_fma_f32 v249, v249, v239, v238
    v_fma_f32 v250, v250, v243, v242
    v_fma_f32 v251, v251, v243, v242
    v_fma_f32 v252, v252, v243, v242
    v_fma_f32 v253, v253, v243, v242
    v_mul_f32 v246, v246, v168
    v_mul_f32 v247, v247, v169
    v_mul_f32 v248, v248, v170
    v_mul_f32 v249, v249, v171
    v_mul_f32 v250, v250, v172
    v_mul_f32 v251, v251, v173
    v_mul_f32 v252, v252, v174
    v_mul_f32 v253, v253, v175
    v_exp_f32 v246, v246
    v_exp_f32 v247, v247
    v_exp_f32 v248, v248
    v_exp_f32 v249, v249
    v_exp_f32 v250, v250
    v_exp_f32 v251, v251
    v_exp_f32 v252, v252
    v_exp_f32 v253, v253
    v_fma_f32 v246, v246, v240, v240
    v_fma_f32 v247, v247, v240, v240
    v_fma_f32 v248, v248, v240, v240
    v_fma_f32 v249, v249, v240, v240
    v_fma_f32 v250, v250, v244, v244
    v_fma_f32 v251, v251, v244, v244
    v_fma_f32 v252, v252, v244, v244
    v_fma_f32 v253, v253, v244, v244
    v_rcp_f32 v246, v246
    v_rcp_f32 v247, v247
    v_rcp_f32 v248, v248
    v_rcp_f32 v249, v249
    v_rcp_f32 v250, v250
    v_rcp_f32 v251, v251
    v_rcp_f32 v252, v252
    v_rcp_f32 v253, v253
    v_mul_f32 v246, v246, v168
    v_mul_f32 v247, v247, v169
    v_mul_f32 v248, v248, v170
    v_mul_f32 v249, v249, v171
    v_mul_f32 v250, v250, v172
    v_mul_f32 v251, v251, v173
    v_mul_f32 v252, v252, v174
    v_mul_f32 v253, v253, v175
    v_cvt_pk_bf16_f32 v160, v246, v247
    v_cvt_pk_bf16_f32 v161, v248, v249
    v_cvt_pk_bf16_f32 v162, v250, v251
    v_cvt_pk_bf16_f32 v163, v252, v253
    v_mul_f32 v246, v176, v176
    v_mul_f32 v247, v177, v177
    v_mul_f32 v248, v178, v178
    v_mul_f32 v249, v179, v179
    v_mul_f32 v250, v180, v180
    v_mul_f32 v251, v181, v181
    v_mul_f32 v252, v182, v182
    v_mul_f32 v253, v183, v183
    v_fma_f32 v246, v246, v239, v238
    v_fma_f32 v247, v247, v239, v238
    v_fma_f32 v248, v248, v239, v238
    v_fma_f32 v249, v249, v239, v238
    v_fma_f32 v250, v250, v239, v238
    v_fma_f32 v251, v251, v239, v238
    v_fma_f32 v252, v252, v239, v238
    v_fma_f32 v253, v253, v239, v238
    v_mul_f32 v246, v246, v176
    v_mul_f32 v247, v247, v177
    v_mul_f32 v248, v248, v178
    v_mul_f32 v249, v249, v179
    v_mul_f32 v250, v250, v180
    v_mul_f32 v251, v251, v181
    v_mul_f32 v252, v252, v182
    v_mul_f32 v253, v253, v183
    v_exp_f32 v246, v246
    v_exp_f32 v247, v247
    v_exp_f32 v248, v248
    v_exp_f32 v249, v249
    v_exp_f32 v250, v250
    v_exp_f32 v251, v251
    v_exp_f32 v252, v252
    v_exp_f32 v253, v253
    v_fma_f32 v246, v246, v240, v240
    v_fma_f32 v247, v247, v240, v240
    v_fma_f32 v248, v248, v240, v240
    v_fma_f32 v249, v249, v240, v240
    v_fma_f32 v250, v250, v240, v240
    v_fma_f32 v251, v251, v240, v240
    v_fma_f32 v252, v252, v240, v240
    v_fma_f32 v253, v253, v240, v240
    v_rcp_f32 v246, v246
    v_rcp_f32 v247, v247
    v_rcp_f32 v248, v248
    v_rcp_f32 v249, v249
    v_rcp_f32 v250, v250
    v_rcp_f32 v251, v251
    v_rcp_f32 v252, v252
    v_rcp_f32 v253, v253
    v_mul_f32 v246, v246, v176
    v_mul_f32 v247, v247, v177
    v_mul_f32 v248, v248, v178
    v_mul_f32 v249, v249, v179
    v_mul_f32 v250, v250, v180
    v_mul_f32 v251, v251, v181
    v_mul_f32 v252, v252, v182
    v_mul_f32 v253, v253, v183
    v_cvt_pk_bf16_f32 v144, v246, v247
    v_cvt_pk_bf16_f32 v145, v248, v249
    v_cvt_pk_bf16_f32 v146, v250, v251
    v_cvt_pk_bf16_f32 v147, v252, v253
    v_mul_f32 v246, v184, v184
    v_mul_f32 v247, v185, v185
    v_mul_f32 v248, v186, v186
    v_mul_f32 v249, v187, v187
    v_mul_f32 v250, v188, v188
    v_mul_f32 v251, v189, v189
    v_mul_f32 v252, v190, v190
    v_mul_f32 v253, v191, v191
    v_fma_f32 v246, v246, v243, v242
    v_fma_f32 v247, v247, v243, v242
    v_fma_f32 v248, v248, v243, v242
    v_fma_f32 v249, v249, v243, v242
    v_fma_f32 v250, v250, v243, v242
    v_fma_f32 v251, v251, v243, v242
    v_fma_f32 v252, v252, v243, v242
    v_fma_f32 v253, v253, v243, v242
    v_mul_f32 v246, v246, v184
    v_mul_f32 v247, v247, v185
    v_mul_f32 v248, v248, v186
    v_mul_f32 v249, v249, v187
    v_mul_f32 v250, v250, v188
    v_mul_f32 v251, v251, v189
    v_mul_f32 v252, v252, v190
    v_mul_f32 v253, v253, v191
    v_exp_f32 v246, v246
    v_exp_f32 v247, v247
    v_exp_f32 v248, v248
    v_exp_f32 v249, v249
    v_exp_f32 v250, v250
    v_exp_f32 v251, v251
    v_exp_f32 v252, v252
    v_exp_f32 v253, v253
    v_fma_f32 v246, v246, v244, v244
    v_fma_f32 v247, v247, v244, v244
    v_fma_f32 v248, v248, v244, v244
    v_fma_f32 v249, v249, v244, v244
    v_fma_f32 v250, v250, v244, v244
    v_fma_f32 v251, v251, v244, v244
    v_fma_f32 v252, v252, v244, v244
    v_fma_f32 v253, v253, v244, v244
    v_rcp_f32 v246, v246
    v_rcp_f32 v247, v247
    v_rcp_f32 v248, v248
    v_rcp_f32 v249, v249
    v_rcp_f32 v250, v250
    v_rcp_f32 v251, v251
    v_rcp_f32 v252, v252
    v_rcp_f32 v253, v253
    v_mul_f32 v246, v246, v184
    v_mul_f32 v247, v247, v185
    v_mul_f32 v248, v248, v186
    v_mul_f32 v249, v249, v187
    v_mul_f32 v250, v250, v188
    v_mul_f32 v251, v251, v189
    v_mul_f32 v252, v252, v190
    v_mul_f32 v253, v253, v191
    v_cvt_pk_bf16_f32 v148, v246, v247
    v_cvt_pk_bf16_f32 v149, v248, v249
    v_cvt_pk_bf16_f32 v150, v250, v251
    v_cvt_pk_bf16_f32 v151, v252, v253
    v_mul_f32 v246, v192, v192
    v_mul_f32 v247, v193, v193
    v_mul_f32 v248, v194, v194
    v_mul_f32 v249, v195, v195
    v_mul_f32 v250, v196, v196
    v_mul_f32 v251, v197, v197
    v_mul_f32 v252, v198, v198
    v_mul_f32 v253, v199, v199
    v_fma_f32 v246, v246, v239, v238
    v_fma_f32 v247, v247, v239, v238
    v_fma_f32 v248, v248, v239, v238
    v_fma_f32 v249, v249, v239, v238
    v_fma_f32 v250, v250, v239, v238
    v_fma_f32 v251, v251, v239, v238
    v_fma_f32 v252, v252, v239, v238
    buffer_store_dwordx4 v[160:163], v254, s[44:47], s22 offen offset:0 sc1
    v_fma_f32 v253, v253, v239, v238
    v_mul_f32 v246, v246, v192
    v_mul_f32 v247, v247, v193
    v_mul_f32 v248, v248, v194
    v_mul_f32 v249, v249, v195
    v_mul_f32 v250, v250, v196
    v_mul_f32 v251, v251, v197
    v_mul_f32 v252, v252, v198
    v_mul_f32 v253, v253, v199
    v_exp_f32 v246, v246
    v_exp_f32 v247, v247
    v_exp_f32 v248, v248
    v_exp_f32 v249, v249
    v_exp_f32 v250, v250
    v_exp_f32 v251, v251
    v_exp_f32 v252, v252
    v_exp_f32 v253, v253
    v_fma_f32 v246, v246, v240, v240
    v_fma_f32 v247, v247, v240, v240
    v_fma_f32 v248, v248, v240, v240
    v_fma_f32 v249, v249, v240, v240
    v_fma_f32 v250, v250, v240, v240
    v_fma_f32 v251, v251, v240, v240
    v_fma_f32 v252, v252, v240, v240
    v_fma_f32 v253, v253, v240, v240
    v_rcp_f32 v246, v246
    v_rcp_f32 v247, v247
    v_rcp_f32 v248, v248
    v_rcp_f32 v249, v249
    v_rcp_f32 v250, v250
    v_rcp_f32 v251, v251
    v_rcp_f32 v252, v252
    v_rcp_f32 v253, v253
    v_mul_f32 v246, v246, v192
    v_mul_f32 v247, v247, v193
    v_mul_f32 v248, v248, v194
    v_mul_f32 v249, v249, v195
    v_mul_f32 v250, v250, v196
    v_mul_f32 v251, v251, v197
    v_mul_f32 v252, v252, v198
    v_mul_f32 v253, v253, v199
    v_cvt_pk_bf16_f32 v152, v246, v247
    v_cvt_pk_bf16_f32 v153, v248, v249
    v_cvt_pk_bf16_f32 v154, v250, v251
    v_cvt_pk_bf16_f32 v155, v252, v253
    buffer_store_dwordx4 v[144:147], v254, s[44:47], s20 offen offset:0 sc1
    v_mul_f32 v246, v200, v200
    v_mul_f32 v247, v201, v201
    v_mul_f32 v248, v202, v202
    v_mul_f32 v249, v203, v203
    v_mul_f32 v250, v204, v204
    v_mul_f32 v251, v205, v205
    v_mul_f32 v252, v206, v206
    v_mul_f32 v253, v207, v207
    v_fma_f32 v246, v246, v243, v242
    v_fma_f32 v247, v247, v243, v242
    v_fma_f32 v248, v248, v243, v242
    v_fma_f32 v249, v249, v243, v242
    v_fma_f32 v250, v250, v243, v242
    v_fma_f32 v251, v251, v243, v242
    v_fma_f32 v252, v252, v243, v242
    v_fma_f32 v253, v253, v243, v242
    v_mul_f32 v246, v246, v200
    v_mul_f32 v247, v247, v201
    v_mul_f32 v248, v248, v202
    v_mul_f32 v249, v249, v203
    v_mul_f32 v250, v250, v204
    v_mul_f32 v251, v251, v205
    v_mul_f32 v252, v252, v206
    v_mul_f32 v253, v253, v207
    v_exp_f32 v246, v246
    v_exp_f32 v247, v247
    v_exp_f32 v248, v248
    v_exp_f32 v249, v249
    v_exp_f32 v250, v250
    v_exp_f32 v251, v251
    v_exp_f32 v252, v252
    v_exp_f32 v253, v253
    v_fma_f32 v246, v246, v244, v244
    v_fma_f32 v247, v247, v244, v244
    v_fma_f32 v248, v248, v244, v244
    v_fma_f32 v249, v249, v244, v244
    v_fma_f32 v250, v250, v244, v244
    v_fma_f32 v251, v251, v244, v244
    v_fma_f32 v252, v252, v244, v244
    v_fma_f32 v253, v253, v244, v244
    v_rcp_f32 v246, v246
    v_rcp_f32 v247, v247
    v_rcp_f32 v248, v248
    v_rcp_f32 v249, v249
    v_rcp_f32 v250, v250
    buffer_store_dwordx4 v[148:151], v254, s[44:47], s20 offen offset:1024 sc1
    v_rcp_f32 v251, v251
    v_rcp_f32 v252, v252
    v_rcp_f32 v253, v253
    v_mul_f32 v246, v246, v200
    v_mul_f32 v247, v247, v201
    v_mul_f32 v248, v248, v202
    v_mul_f32 v249, v249, v203
    v_mul_f32 v250, v250, v204
    v_mul_f32 v251, v251, v205
    v_mul_f32 v252, v252, v206
    v_mul_f32 v253, v253, v207
    v_cvt_pk_bf16_f32 v156, v246, v247
    v_cvt_pk_bf16_f32 v157, v248, v249
    v_cvt_pk_bf16_f32 v158, v250, v251
    v_cvt_pk_bf16_f32 v159, v252, v253
    s_setprio 0
    s_barrier
    s_waitcnt lgkmcnt(8)
    v_mfma_f32_16x16x32_bf16 v[192:195], v[208:211], v[0:3], 0
    ds_read_b64_tr_b16 v[176:177], v233 offset:37888
    v_mfma_f32_16x16x32_bf16 v[192:195], v[212:215], v[8:11], v[192:195]
    ds_read_b64_tr_b16 v[178:179], v233 offset:38912
    v_mfma_f32_16x16x32_bf16 v[200:203], v[212:215], v[12:15], 0
    ds_read_b64_tr_b16 v[180:181], v233 offset:39936
    v_mfma_f32_16x16x32_bf16 v[200:203], v[208:211], v[4:7], v[200:203]
    ds_read_b64_tr_b16 v[182:183], v233 offset:40960
    buffer_store_dwordx4 v[152:155], v254, s[44:47], s20 offen offset:2048 sc1
    s_waitcnt lgkmcnt(8)
    v_mfma_f32_16x16x32_bf16 v[196:199], v[216:219], v[0:3], 0
    ds_read_b64_tr_b16 v[208:209], v232 offset:41984
    v_mfma_f32_16x16x32_bf16 v[196:199], v[220:223], v[8:11], v[196:199]
    ds_read_b64_tr_b16 v[210:211], v232 offset:43008
    v_mfma_f32_16x16x32_bf16 v[204:207], v[220:223], v[12:15], 0
    ds_read_b64_tr_b16 v[212:213], v232 offset:44032
    v_mfma_f32_16x16x32_bf16 v[204:207], v[216:219], v[4:7], v[204:207]
    ds_read_b64_tr_b16 v[214:215], v232 offset:45056
    s_waitcnt lgkmcnt(8)
    v_mfma_f32_16x16x32_bf16 v[192:195], v[224:227], v[16:19], v[192:195]
    ds_read_b64_tr_b16 v[216:217], v233 offset:41984
    v_mfma_f32_16x16x32_bf16 v[192:195], v[228:231], v[24:27], v[192:195]
    ds_read_b64_tr_b16 v[218:219], v233 offset:43008
    v_mfma_f32_16x16x32_bf16 v[200:203], v[228:231], v[28:31], v[200:203]
    ds_read_b64_tr_b16 v[220:221], v233 offset:44032
    v_mfma_f32_16x16x32_bf16 v[200:203], v[224:227], v[20:23], v[200:203]
    ds_read_b64_tr_b16 v[222:223], v233 offset:45056
    buffer_store_dwordx4 v[156:159], v254, s[44:47], s20 offen offset:3072 sc1
    s_waitcnt lgkmcnt(8)
    v_mfma_f32_16x16x32_bf16 v[196:199], v[176:179], v[16:19], v[196:199]
    ds_read_b64_tr_b16 v[224:225], v232 offset:46080
    v_mfma_f32_16x16x32_bf16 v[196:199], v[180:183], v[24:27], v[196:199]
    ds_read_b64_tr_b16 v[226:227], v232 offset:47104
    v_mfma_f32_16x16x32_bf16 v[204:207], v[180:183], v[28:31], v[204:207]
    ds_read_b64_tr_b16 v[228:229], v232 offset:48128
    v_mfma_f32_16x16x32_bf16 v[204:207], v[176:179], v[20:23], v[204:207]
    ds_read_b64_tr_b16 v[230:231], v232 offset:49152
    s_waitcnt lgkmcnt(8)
    v_mfma_f32_16x16x32_bf16 v[192:195], v[208:211], v[32:35], v[192:195]
    ds_read_b64_tr_b16 v[176:177], v233 offset:46080
    v_mfma_f32_16x16x32_bf16 v[192:195], v[212:215], v[40:43], v[192:195]
    ds_read_b64_tr_b16 v[178:179], v233 offset:47104
    v_mfma_f32_16x16x32_bf16 v[200:203], v[212:215], v[44:47], v[200:203]
    ds_read_b64_tr_b16 v[180:181], v233 offset:48128
    v_mfma_f32_16x16x32_bf16 v[200:203], v[208:211], v[36:39], v[200:203]
    ds_read_b64_tr_b16 v[182:183], v233 offset:49152
    s_mov_b32 s66, 0
    s_add_u32 m0, s43, 0x00015740
    s_nop 0
    buffer_load_dwordx4 v235, s[28:31], s66 offen offset:192 lds
    s_waitcnt lgkmcnt(8)
    v_mfma_f32_16x16x32_bf16 v[196:199], v[216:219], v[32:35], v[196:199]
    ds_read_b64_tr_b16 v[208:209], v232 offset:50176
    v_mfma_f32_16x16x32_bf16 v[196:199], v[220:223], v[40:43], v[196:199]
    ds_read_b64_tr_b16 v[210:211], v232 offset:51200
    v_mfma_f32_16x16x32_bf16 v[204:207], v[220:223], v[44:47], v[204:207]
    ds_read_b64_tr_b16 v[212:213], v232 offset:52224
    v_mfma_f32_16x16x32_bf16 v[204:207], v[216:219], v[36:39], v[204:207]
    ds_read_b64_tr_b16 v[214:215], v232 offset:53248
    s_waitcnt lgkmcnt(8)
    v_mfma_f32_16x16x32_bf16 v[192:195], v[224:227], v[48:51], v[192:195]
    ds_read_b64_tr_b16 v[216:217], v233 offset:50176
    v_mfma_f32_16x16x32_bf16 v[192:195], v[228:231], v[56:59], v[192:195]
    ds_read_b64_tr_b16 v[218:219], v233 offset:51200
    v_mfma_f32_16x16x32_bf16 v[200:203], v[228:231], v[60:63], v[200:203]
    ds_read_b64_tr_b16 v[220:221], v233 offset:52224
    v_mfma_f32_16x16x32_bf16 v[200:203], v[224:227], v[52:55], v[200:203]
    ds_read_b64_tr_b16 v[222:223], v233 offset:53248
    s_mov_b32 s66, 147456
    s_add_u32 m0, s43, 0x00015b40
    s_nop 0
    buffer_load_dwordx4 v235, s[28:31], s66 offen offset:192 lds
    s_waitcnt lgkmcnt(8)
    v_mfma_f32_16x16x32_bf16 v[196:199], v[176:179], v[48:51], v[196:199]
    ds_read_b64_tr_b16 v[224:225], v232 offset:54272
    v_mfma_f32_16x16x32_bf16 v[196:199], v[180:183], v[56:59], v[196:199]
    ds_read_b64_tr_b16 v[226:227], v232 offset:55296
    v_mfma_f32_16x16x32_bf16 v[204:207], v[180:183], v[60:63], v[204:207]
    ds_read_b64_tr_b16 v[228:229], v232 offset:56320
    v_mfma_f32_16x16x32_bf16 v[204:207], v[176:179], v[52:55], v[204:207]
    ds_read_b64_tr_b16 v[230:231], v232 offset:57344
    s_waitcnt lgkmcnt(8)
    v_mfma_f32_16x16x32_bf16 v[192:195], v[208:211], v[64:67], v[192:195]
    ds_read_b64_tr_b16 v[176:177], v233 offset:54272
    v_mfma_f32_16x16x32_bf16 v[192:195], v[212:215], v[72:75], v[192:195]
    ds_read_b64_tr_b16 v[178:179], v233 offset:55296
    v_mfma_f32_16x16x32_bf16 v[200:203], v[212:215], v[76:79], v[200:203]
    ds_read_b64_tr_b16 v[180:181], v233 offset:56320
    v_mfma_f32_16x16x32_bf16 v[200:203], v[208:211], v[68:71], v[200:203]
    ds_read_b64_tr_b16 v[182:183], v233 offset:57344
    s_mov_b32 s66, 294912
    s_add_u32 m0, s43, 0x00015f40
    s_nop 0
    buffer_load_dwordx4 v235, s[28:31], s66 offen offset:192 lds
    s_waitcnt lgkmcnt(8)
    v_mfma_f32_16x16x32_bf16 v[196:199], v[216:219], v[64:67], v[196:199]
    ds_read_b64_tr_b16 v[208:209], v232 offset:58368
    v_mfma_f32_16x16x32_bf16 v[196:199], v[220:223], v[72:75], v[196:199]
    ds_read_b64_tr_b16 v[210:211], v232 offset:59392
    v_mfma_f32_16x16x32_bf16 v[204:207], v[220:223], v[76:79], v[204:207]
    ds_read_b64_tr_b16 v[212:213], v232 offset:60416
    v_mfma_f32_16x16x32_bf16 v[204:207], v[216:219], v[68:71], v[204:207]
    ds_read_b64_tr_b16 v[214:215], v232 offset:61440
    s_waitcnt lgkmcnt(8)
    v_mfma_f32_16x16x32_bf16 v[192:195], v[224:227], v[80:83], v[192:195]
    ds_read_b64_tr_b16 v[216:217], v233 offset:58368
    v_mfma_f32_16x16x32_bf16 v[192:195], v[228:231], v[88:91], v[192:195]
    ds_read_b64_tr_b16 v[218:219], v233 offset:59392
    v_mfma_f32_16x16x32_bf16 v[200:203], v[228:231], v[92:95], v[200:203]
    ds_read_b64_tr_b16 v[220:221], v233 offset:60416
    v_mfma_f32_16x16x32_bf16 v[200:203], v[224:227], v[84:87], v[200:203]
    ds_read_b64_tr_b16 v[222:223], v233 offset:61440
    s_mov_b32 s66, 442368
    s_add_u32 m0, s43, 0x00016340
    s_nop 0
    buffer_load_dwordx4 v235, s[28:31], s66 offen offset:192 lds
    s_waitcnt lgkmcnt(8)
    v_mfma_f32_16x16x32_bf16 v[196:199], v[176:179], v[80:83], v[196:199]
    ds_read_b64_tr_b16 v[224:225], v232 offset:62464
    v_mfma_f32_16x16x32_bf16 v[196:199], v[180:183], v[88:91], v[196:199]
    ds_read_b64_tr_b16 v[226:227], v232 offset:63488
    v_mfma_f32_16x16x32_bf16 v[204:207], v[180:183], v[92:95], v[204:207]
    ds_read_b64_tr_b16 v[228:229], v232 offset:64512
    v_mfma_f32_16x16x32_bf16 v[204:207], v[176:179], v[84:87], v[204:207]
    v_add_u32 v232, 0x0000e000, v232
    ds_read_b64_tr_b16 v[230:231], v232 offset:8192
    s_waitcnt lgkmcnt(8)
    v_mfma_f32_16x16x32_bf16 v[192:195], v[208:211], v[96:99], v[192:195]
    ds_read_b64_tr_b16 v[176:177], v233 offset:62464
    v_mfma_f32_16x16x32_bf16 v[192:195], v[212:215], v[104:107], v[192:195]
    ds_read_b64_tr_b16 v[178:179], v233 offset:63488
    v_mfma_f32_16x16x32_bf16 v[200:203], v[212:215], v[108:111], v[200:203]
    ds_read_b64_tr_b16 v[180:181], v233 offset:64512
    v_mfma_f32_16x16x32_bf16 v[200:203], v[208:211], v[100:103], v[200:203]
    v_add_u32 v233, 0x0000e000, v233
    ds_read_b64_tr_b16 v[182:183], v233 offset:8192
    s_waitcnt lgkmcnt(8)
    v_mfma_f32_16x16x32_bf16 v[196:199], v[216:219], v[96:99], v[196:199]
    ds_read_b64_tr_b16 v[208:209], v232 offset:9216
    v_mfma_f32_16x16x32_bf16 v[196:199], v[220:223], v[104:107], v[196:199]
    ds_read_b64_tr_b16 v[210:211], v232 offset:10240
    v_mfma_f32_16x16x32_bf16 v[204:207], v[220:223], v[108:111], v[204:207]
    ds_read_b64_tr_b16 v[212:213], v232 offset:11264
    v_mfma_f32_16x16x32_bf16 v[204:207], v[216:219], v[100:103], v[204:207]
    ds_read_b64_tr_b16 v[214:215], v232 offset:12288
    s_waitcnt lgkmcnt(8)
    v_mfma_f32_16x16x32_bf16 v[192:195], v[224:227], v[112:115], v[192:195]
    ds_read_b64_tr_b16 v[216:217], v233 offset:9216
    v_mfma_f32_16x16x32_bf16 v[192:195], v[228:231], v[120:123], v[192:195]
    ds_read_b64_tr_b16 v[218:219], v233 offset:10240
    v_mfma_f32_16x16x32_bf16 v[200:203], v[228:231], v[124:127], v[200:203]
    ds_read_b64_tr_b16 v[220:221], v233 offset:11264
    v_mfma_f32_16x16x32_bf16 v[200:203], v[224:227], v[116:119], v[200:203]
    ds_read_b64_tr_b16 v[222:223], v233 offset:12288
    s_waitcnt lgkmcnt(8)
    v_mfma_f32_16x16x32_bf16 v[196:199], v[176:179], v[112:115], v[196:199]
    v_mfma_f32_16x16x32_bf16 v[196:199], v[180:183], v[120:123], v[196:199]
    v_mfma_f32_16x16x32_bf16 v[204:207], v[180:183], v[124:127], v[204:207]
    v_mfma_f32_16x16x32_bf16 v[204:207], v[176:179], v[116:119], v[204:207]
    s_waitcnt lgkmcnt(4)
    v_mfma_f32_16x16x32_bf16 v[192:195], v[208:211], v[128:131], v[192:195]
    v_mfma_f32_16x16x32_bf16 v[192:195], v[212:215], v[136:139], v[192:195]
    v_mfma_f32_16x16x32_bf16 v[200:203], v[212:215], v[140:143], v[200:203]
    v_mfma_f32_16x16x32_bf16 v[200:203], v[208:211], v[132:135], v[200:203]
    s_waitcnt lgkmcnt(0)
    v_mfma_f32_16x16x32_bf16 v[196:199], v[216:219], v[128:131], v[196:199]
    v_mfma_f32_16x16x32_bf16 v[196:199], v[220:223], v[136:139], v[196:199]
    v_mfma_f32_16x16x32_bf16 v[204:207], v[220:223], v[140:143], v[204:207]
    v_mfma_f32_16x16x32_bf16 v[204:207], v[216:219], v[132:135], v[204:207]
    ds_read_b64_tr_b16 v[208:209], v232 offset:13312
    ds_read_b64_tr_b16 v[210:211], v232 offset:14336
    ds_read_b64_tr_b16 v[212:213], v232 offset:15360
    ds_read_b64_tr_b16 v[214:215], v232 offset:16384
    ds_read_b64_tr_b16 v[216:217], v233 offset:13312
    ds_read_b64_tr_b16 v[218:219], v233 offset:14336
    ds_read_b64_tr_b16 v[220:221], v233 offset:15360
    ds_read_b64_tr_b16 v[222:223], v233 offset:16384
    ds_read_b64_tr_b16 v[224:225], v232 offset:17408
    ds_read_b64_tr_b16 v[226:227], v232 offset:18432
    ds_read_b64_tr_b16 v[228:229], v232 offset:19456
    ds_read_b64_tr_b16 v[230:231], v232 offset:20480
    s_waitcnt vmcnt(4)
    s_buffer_atomic_swap s55, s[44:47], s41 offset:0
    s_buffer_atomic_swap s55, s[44:47], s41 offset:128
    s_buffer_atomic_swap s55, s[44:47], s41 offset:256
    s_buffer_atomic_swap s55, s[44:47], s41 offset:384
    s_setprio 1
    v_mul_f32 v246, v192, v192
    v_mul_f32 v247, v193, v193
    v_mul_f32 v248, v194, v194
    v_mul_f32 v249, v195, v195
    v_mul_f32 v250, v196, v196
    v_mul_f32 v251, v197, v197
    v_mul_f32 v252, v198, v198
    v_mul_f32 v253, v199, v199
    v_fma_f32 v246, v246, v239, v238
    v_fma_f32 v247, v247, v239, v238
    v_fma_f32 v248, v248, v239, v238
    v_fma_f32 v249, v249, v239, v238
    v_fma_f32 v250, v250, v239, v238
    v_fma_f32 v251, v251, v239, v238
    v_fma_f32 v252, v252, v239, v238
    v_fma_f32 v253, v253, v239, v238
    v_mul_f32 v246, v246, v192
    v_mul_f32 v247, v247, v193
    v_mul_f32 v248, v248, v194
    v_mul_f32 v249, v249, v195
    v_mul_f32 v250, v250, v196
    v_mul_f32 v251, v251, v197
    v_mul_f32 v252, v252, v198
    v_mul_f32 v253, v253, v199
    v_exp_f32 v246, v246
    v_exp_f32 v247, v247
    v_exp_f32 v248, v248
    v_exp_f32 v249, v249
    v_exp_f32 v250, v250
    v_exp_f32 v251, v251
    v_exp_f32 v252, v252
    v_exp_f32 v253, v253
    v_fma_f32 v246, v246, v240, v240
    v_fma_f32 v247, v247, v240, v240
    v_fma_f32 v248, v248, v240, v240
    v_fma_f32 v249, v249, v240, v240
    v_fma_f32 v250, v250, v240, v240
    v_fma_f32 v251, v251, v240, v240
    v_fma_f32 v252, v252, v240, v240
    v_fma_f32 v253, v253, v240, v240
    v_rcp_f32 v246, v246
    v_rcp_f32 v247, v247
    v_rcp_f32 v248, v248
    v_rcp_f32 v249, v249
    v_rcp_f32 v250, v250
    v_rcp_f32 v251, v251
    v_rcp_f32 v252, v252
    v_rcp_f32 v253, v253
    v_mul_f32 v246, v246, v192
    v_mul_f32 v247, v247, v193
    v_mul_f32 v248, v248, v194
    v_mul_f32 v249, v249, v195
    v_mul_f32 v250, v250, v196
    v_mul_f32 v251, v251, v197
    v_mul_f32 v252, v252, v198
    v_mul_f32 v253, v253, v199
    v_cvt_pk_bf16_f32 v160, v246, v247
    v_cvt_pk_bf16_f32 v161, v248, v249
    v_cvt_pk_bf16_f32 v162, v250, v251
    v_cvt_pk_bf16_f32 v163, v252, v253
    buffer_store_dwordx4 v[160:163], v254, s[44:47], s21 offen offset:0 sc1
    v_mul_f32 v246, v200, v200
    v_mul_f32 v247, v201, v201
    v_mul_f32 v248, v202, v202
    v_mul_f32 v249, v203, v203
    v_mul_f32 v250, v204, v204
    v_mul_f32 v251, v205, v205
    v_mul_f32 v252, v206, v206
    v_mul_f32 v253, v207, v207
    v_fma_f32 v246, v246, v243, v242
    v_fma_f32 v247, v247, v243, v242
    v_fma_f32 v248, v248, v243, v242
    v_fma_f32 v249, v249, v243, v242
    v_fma_f32 v250, v250, v243, v242
    v_fma_f32 v251, v251, v243, v242
    v_fma_f32 v252, v252, v243, v242
    v_fma_f32 v253, v253, v243, v242
    v_mul_f32 v246, v246, v200
    v_mul_f32 v247, v247, v201
    v_mul_f32 v248, v248, v202
    v_mul_f32 v249, v249, v203
    v_mul_f32 v250, v250, v204
    v_mul_f32 v251, v251, v205
    v_mul_f32 v252, v252, v206
    v_mul_f32 v253, v253, v207
    v_exp_f32 v246, v246
    v_exp_f32 v247, v247
    v_exp_f32 v248, v248
    v_exp_f32 v249, v249
    v_exp_f32 v250, v250
    v_exp_f32 v251, v251
    v_exp_f32 v252, v252
    v_exp_f32 v253, v253
    v_fma_f32 v246, v246, v244, v244
    v_fma_f32 v247, v247, v244, v244
    v_fma_f32 v248, v248, v244, v244
    v_fma_f32 v249, v249, v244, v244
    v_fma_f32 v250, v250, v244, v244
    v_fma_f32 v251, v251, v244, v244
    v_fma_f32 v252, v252, v244, v244
    v_fma_f32 v253, v253, v244, v244
    v_rcp_f32 v246, v246
    v_rcp_f32 v247, v247
    v_rcp_f32 v248, v248
    v_rcp_f32 v249, v249
    v_rcp_f32 v250, v250
    v_rcp_f32 v251, v251
    v_rcp_f32 v252, v252
    v_rcp_f32 v253, v253
    v_mul_f32 v246, v246, v200
    v_mul_f32 v247, v247, v201
    v_mul_f32 v248, v248, v202
    v_mul_f32 v249, v249, v203
    v_mul_f32 v250, v250, v204
    v_mul_f32 v251, v251, v205
    v_mul_f32 v252, v252, v206
    v_mul_f32 v253, v253, v207
    v_cvt_pk_bf16_f32 v164, v246, v247
    v_cvt_pk_bf16_f32 v165, v248, v249
    v_cvt_pk_bf16_f32 v166, v250, v251
    v_cvt_pk_bf16_f32 v167, v252, v253
    buffer_store_dwordx4 v[164:167], v254, s[44:47], s21 offen offset:1024 sc1
    s_setprio 0
    s_waitcnt lgkmcnt(8)
    v_mfma_f32_16x16x32_bf16 v[192:195], v[208:211], v[0:3], 0
    ds_read_b64_tr_b16 v[176:177], v233 offset:17408
    v_mfma_f32_16x16x32_bf16 v[192:195], v[212:215], v[8:11], v[192:195]
    ds_read_b64_tr_b16 v[178:179], v233 offset:18432
    v_mfma_f32_16x16x32_bf16 v[200:203], v[212:215], v[12:15], 0
    ds_read_b64_tr_b16 v[180:181], v233 offset:19456
    v_mfma_f32_16x16x32_bf16 v[200:203], v[208:211], v[4:7], v[200:203]
    ds_read_b64_tr_b16 v[182:183], v233 offset:20480
    s_waitcnt lgkmcnt(8)
    v_mfma_f32_16x16x32_bf16 v[196:199], v[216:219], v[0:3], 0
    ds_read_b64_tr_b16 v[208:209], v232 offset:21504
    v_mfma_f32_16x16x32_bf16 v[196:199], v[220:223], v[8:11], v[196:199]
    ds_read_b64_tr_b16 v[210:211], v232 offset:22528
    v_mfma_f32_16x16x32_bf16 v[204:207], v[220:223], v[12:15], 0
    ds_read_b64_tr_b16 v[212:213], v232 offset:23552
    v_mfma_f32_16x16x32_bf16 v[204:207], v[216:219], v[4:7], v[204:207]
    ds_read_b64_tr_b16 v[214:215], v232 offset:24576
    s_waitcnt lgkmcnt(8)
    v_mfma_f32_16x16x32_bf16 v[192:195], v[224:227], v[16:19], v[192:195]
    ds_read_b64_tr_b16 v[216:217], v233 offset:21504
    v_mfma_f32_16x16x32_bf16 v[192:195], v[228:231], v[24:27], v[192:195]
    ds_read_b64_tr_b16 v[218:219], v233 offset:22528
    v_mfma_f32_16x16x32_bf16 v[200:203], v[228:231], v[28:31], v[200:203]
    ds_read_b64_tr_b16 v[220:221], v233 offset:23552
    v_mfma_f32_16x16x32_bf16 v[200:203], v[224:227], v[20:23], v[200:203]
    ds_read_b64_tr_b16 v[222:223], v233 offset:24576
    s_buffer_load_dwordx8 s[92:99], s[44:47], s40 glc
    s_waitcnt lgkmcnt(8)
    v_mfma_f32_16x16x32_bf16 v[196:199], v[176:179], v[16:19], v[196:199]
    ds_read_b64_tr_b16 v[224:225], v232 offset:25600
    v_mfma_f32_16x16x32_bf16 v[196:199], v[180:183], v[24:27], v[196:199]
    ds_read_b64_tr_b16 v[226:227], v232 offset:26624
    v_mfma_f32_16x16x32_bf16 v[204:207], v[180:183], v[28:31], v[204:207]
    ds_read_b64_tr_b16 v[228:229], v232 offset:27648
    v_mfma_f32_16x16x32_bf16 v[204:207], v[176:179], v[20:23], v[204:207]
    ds_read_b64_tr_b16 v[230:231], v232 offset:28672
    s_waitcnt lgkmcnt(8)
    v_mfma_f32_16x16x32_bf16 v[192:195], v[208:211], v[32:35], v[192:195]
    ds_read_b64_tr_b16 v[176:177], v233 offset:25600
    v_mfma_f32_16x16x32_bf16 v[192:195], v[212:215], v[40:43], v[192:195]
    ds_read_b64_tr_b16 v[178:179], v233 offset:26624
    v_mfma_f32_16x16x32_bf16 v[200:203], v[212:215], v[44:47], v[200:203]
    ds_read_b64_tr_b16 v[180:181], v233 offset:27648
    v_mfma_f32_16x16x32_bf16 v[200:203], v[208:211], v[36:39], v[200:203]
    ds_read_b64_tr_b16 v[182:183], v233 offset:28672
    s_waitcnt lgkmcnt(8)
    v_mfma_f32_16x16x32_bf16 v[196:199], v[216:219], v[32:35], v[196:199]
    ds_read_b64_tr_b16 v[208:209], v232 offset:29696
    v_mfma_f32_16x16x32_bf16 v[196:199], v[220:223], v[40:43], v[196:199]
    ds_read_b64_tr_b16 v[210:211], v232 offset:30720
    v_mfma_f32_16x16x32_bf16 v[204:207], v[220:223], v[44:47], v[204:207]
    ds_read_b64_tr_b16 v[212:213], v232 offset:31744
    v_mfma_f32_16x16x32_bf16 v[204:207], v[216:219], v[36:39], v[204:207]
    ds_read_b64_tr_b16 v[214:215], v232 offset:32768
    s_waitcnt lgkmcnt(8)
    v_mfma_f32_16x16x32_bf16 v[192:195], v[224:227], v[48:51], v[192:195]
    ds_read_b64_tr_b16 v[216:217], v233 offset:29696
    v_mfma_f32_16x16x32_bf16 v[192:195], v[228:231], v[56:59], v[192:195]
    ds_read_b64_tr_b16 v[218:219], v233 offset:30720
    v_mfma_f32_16x16x32_bf16 v[200:203], v[228:231], v[60:63], v[200:203]
    ds_read_b64_tr_b16 v[220:221], v233 offset:31744
    v_mfma_f32_16x16x32_bf16 v[200:203], v[224:227], v[52:55], v[200:203]
    ds_read_b64_tr_b16 v[222:223], v233 offset:32768
    s_waitcnt lgkmcnt(8)
    v_mfma_f32_16x16x32_bf16 v[196:199], v[176:179], v[48:51], v[196:199]
    ds_read_b64_tr_b16 v[224:225], v232 offset:33792
    v_mfma_f32_16x16x32_bf16 v[196:199], v[180:183], v[56:59], v[196:199]
    ds_read_b64_tr_b16 v[226:227], v232 offset:34816
    v_mfma_f32_16x16x32_bf16 v[204:207], v[180:183], v[60:63], v[204:207]
    ds_read_b64_tr_b16 v[228:229], v232 offset:35840
    v_mfma_f32_16x16x32_bf16 v[204:207], v[176:179], v[52:55], v[204:207]
    ds_read_b64_tr_b16 v[230:231], v232 offset:36864
    s_waitcnt lgkmcnt(8)
    v_mfma_f32_16x16x32_bf16 v[192:195], v[208:211], v[64:67], v[192:195]
    ds_read_b64_tr_b16 v[176:177], v233 offset:33792
    v_mfma_f32_16x16x32_bf16 v[192:195], v[212:215], v[72:75], v[192:195]
    ds_read_b64_tr_b16 v[178:179], v233 offset:34816
    v_mfma_f32_16x16x32_bf16 v[200:203], v[212:215], v[76:79], v[200:203]
    ds_read_b64_tr_b16 v[180:181], v233 offset:35840
    v_mfma_f32_16x16x32_bf16 v[200:203], v[208:211], v[68:71], v[200:203]
    ds_read_b64_tr_b16 v[182:183], v233 offset:36864
    s_waitcnt lgkmcnt(8)
    v_mfma_f32_16x16x32_bf16 v[196:199], v[216:219], v[64:67], v[196:199]
    ds_read_b64_tr_b16 v[208:209], v232 offset:37888
    v_mfma_f32_16x16x32_bf16 v[196:199], v[220:223], v[72:75], v[196:199]
    ds_read_b64_tr_b16 v[210:211], v232 offset:38912
    v_mfma_f32_16x16x32_bf16 v[204:207], v[220:223], v[76:79], v[204:207]
    ds_read_b64_tr_b16 v[212:213], v232 offset:39936
    v_mfma_f32_16x16x32_bf16 v[204:207], v[216:219], v[68:71], v[204:207]
    ds_read_b64_tr_b16 v[214:215], v232 offset:40960
    s_waitcnt lgkmcnt(8)
    v_mfma_f32_16x16x32_bf16 v[192:195], v[224:227], v[80:83], v[192:195]
    ds_read_b64_tr_b16 v[216:217], v233 offset:37888
    v_mfma_f32_16x16x32_bf16 v[192:195], v[228:231], v[88:91], v[192:195]
    ds_read_b64_tr_b16 v[218:219], v233 offset:38912
    v_mfma_f32_16x16x32_bf16 v[200:203], v[228:231], v[92:95], v[200:203]
    ds_read_b64_tr_b16 v[220:221], v233 offset:39936
    v_mfma_f32_16x16x32_bf16 v[200:203], v[224:227], v[84:87], v[200:203]
    ds_read_b64_tr_b16 v[222:223], v233 offset:40960
    s_waitcnt lgkmcnt(8)
    v_mfma_f32_16x16x32_bf16 v[196:199], v[176:179], v[80:83], v[196:199]
    ds_read_b64_tr_b16 v[224:225], v232 offset:41984
    v_mfma_f32_16x16x32_bf16 v[196:199], v[180:183], v[88:91], v[196:199]
    ds_read_b64_tr_b16 v[226:227], v232 offset:43008
    v_mfma_f32_16x16x32_bf16 v[204:207], v[180:183], v[92:95], v[204:207]
    ds_read_b64_tr_b16 v[228:229], v232 offset:44032
    v_mfma_f32_16x16x32_bf16 v[204:207], v[176:179], v[84:87], v[204:207]
    ds_read_b64_tr_b16 v[230:231], v232 offset:45056
    s_waitcnt lgkmcnt(8)
    v_mfma_f32_16x16x32_bf16 v[192:195], v[208:211], v[96:99], v[192:195]
    ds_read_b64_tr_b16 v[176:177], v233 offset:41984
    v_mfma_f32_16x16x32_bf16 v[192:195], v[212:215], v[104:107], v[192:195]
    ds_read_b64_tr_b16 v[178:179], v233 offset:43008
    v_mfma_f32_16x16x32_bf16 v[200:203], v[212:215], v[108:111], v[200:203]
    ds_read_b64_tr_b16 v[180:181], v233 offset:44032
    v_mfma_f32_16x16x32_bf16 v[200:203], v[208:211], v[100:103], v[200:203]
    ds_read_b64_tr_b16 v[182:183], v233 offset:45056
    s_waitcnt lgkmcnt(8)
    v_mfma_f32_16x16x32_bf16 v[196:199], v[216:219], v[96:99], v[196:199]
    s_waitcnt vmcnt(2)
    v_mfma_f32_16x16x32_bf16 v[196:199], v[220:223], v[104:107], v[196:199]
    v_add_u32 v232, 0xffff7400, v232
    ds_read_b64_tr_b16 v[208:209], v232 offset:8192
    v_mfma_f32_16x16x32_bf16 v[204:207], v[220:223], v[108:111], v[204:207]
    ds_read_b64_tr_b16 v[210:211], v232 offset:9216
    v_mfma_f32_16x16x32_bf16 v[204:207], v[216:219], v[100:103], v[204:207]
    ds_read_b64_tr_b16 v[212:213], v232 offset:10240
    ds_read_b64_tr_b16 v[214:215], v232 offset:11264
    s_waitcnt lgkmcnt(8)
    v_mfma_f32_16x16x32_bf16 v[192:195], v[224:227], v[112:115], v[192:195]
    v_add_u32 v233, 0xffff7400, v233
    ds_read_b64_tr_b16 v[216:217], v233 offset:8192
    v_mfma_f32_16x16x32_bf16 v[192:195], v[228:231], v[120:123], v[192:195]
    ds_read_b64_tr_b16 v[218:219], v233 offset:9216
    v_mfma_f32_16x16x32_bf16 v[200:203], v[228:231], v[124:127], v[200:203]
    ds_read_b64_tr_b16 v[220:221], v233 offset:10240
    v_mfma_f32_16x16x32_bf16 v[200:203], v[224:227], v[116:119], v[200:203]
    ds_read_b64_tr_b16 v[222:223], v233 offset:11264
    s_waitcnt lgkmcnt(8)
    v_mfma_f32_16x16x32_bf16 v[196:199], v[176:179], v[112:115], v[196:199]
    v_mfma_f32_16x16x32_bf16 v[196:199], v[180:183], v[120:123], v[196:199]
    v_mfma_f32_16x16x32_bf16 v[204:207], v[180:183], v[124:127], v[204:207]
    v_mfma_f32_16x16x32_bf16 v[204:207], v[176:179], v[116:119], v[204:207]
    s_waitcnt lgkmcnt(4)
    v_mfma_f32_16x16x32_bf16 v[192:195], v[208:211], v[128:131], v[192:195]
    v_mfma_f32_16x16x32_bf16 v[192:195], v[212:215], v[136:139], v[192:195]
    v_mfma_f32_16x16x32_bf16 v[200:203], v[212:215], v[140:143], v[200:203]
    v_mfma_f32_16x16x32_bf16 v[200:203], v[208:211], v[132:135], v[200:203]
    s_waitcnt lgkmcnt(0)
    v_mfma_f32_16x16x32_bf16 v[196:199], v[216:219], v[128:131], v[196:199]
    v_mfma_f32_16x16x32_bf16 v[196:199], v[220:223], v[136:139], v[196:199]
    v_mfma_f32_16x16x32_bf16 v[204:207], v[220:223], v[140:143], v[204:207]
    v_mfma_f32_16x16x32_bf16 v[204:207], v[216:219], v[132:135], v[204:207]
    s_waitcnt lgkmcnt(0)
    s_xor_b32 s92, s92, s55
    s_xor_b32 s93, s93, s55
    s_xor_b32 s94, s94, s55
    s_xor_b32 s95, s95, s55
    s_xor_b32 s96, s96, s55
    s_or_b32 s92, s92, s96
    s_or_b64 s[92:93], s[92:93], s[94:95]
    s_cbranch_scc1 L_pslow_96
L_pback_97:
    v_mul_f32 v246, v192, v192
    v_mul_f32 v247, v193, v193
    v_mul_f32 v248, v194, v194
    v_mul_f32 v249, v195, v195
    v_mul_f32 v250, v196, v196
    v_mul_f32 v251, v197, v197
    v_mul_f32 v252, v198, v198
    v_mul_f32 v253, v199, v199
    v_fma_f32 v246, v246, v239, v238
    buffer_load_dwordx4 v[0:3], v254, s[44:47], s25 offen offset:0 sc1
    v_fma_f32 v247, v247, v239, v238
    v_fma_f32 v248, v248, v239, v238
    v_fma_f32 v249, v249, v239, v238
    v_fma_f32 v250, v250, v239, v238
    v_fma_f32 v251, v251, v239, v238
    v_fma_f32 v252, v252, v239, v238
    v_fma_f32 v253, v253, v239, v238
    v_mul_f32 v246, v246, v192
    v_mul_f32 v247, v247, v193
    buffer_load_dwordx4 v[4:7], v254, s[44:47], s25 offen offset:1024 sc1
    v_mul_f32 v248, v248, v194
    v_mul_f32 v249, v249, v195
    v_mul_f32 v250, v250, v196
    v_mul_f32 v251, v251, v197
    v_mul_f32 v252, v252, v198
    v_mul_f32 v253, v253, v199
    v_exp_f32 v246, v246
    v_exp_f32 v247, v247
    v_exp_f32 v248, v248
    buffer_load_dwordx4 v[8:11], v254, s[44:47], s25 offen offset:2048 sc1
    v_exp_f32 v249, v249
    v_exp_f32 v250, v250
    v_exp_f32 v251, v251
    v_exp_f32 v252, v252
    v_exp_f32 v253, v253
    v_fma_f32 v246, v246, v240, v240
    v_fma_f32 v247, v247, v240, v240
    v_fma_f32 v248, v248, v240, v240
    v_fma_f32 v249, v249, v240, v240
    buffer_load_dwordx4 v[12:15], v254, s[44:47], s25 offen offset:3072 sc1
    v_fma_f32 v250, v250, v240, v240
    v_fma_f32 v251, v251, v240, v240
    v_fma_f32 v252, v252, v240, v240
    v_fma_f32 v253, v253, v240, v240
    v_rcp_f32 v246, v246
    v_rcp_f32 v247, v247
    v_rcp_f32 v248, v248
    v_rcp_f32 v249, v249
    v_rcp_f32 v250, v250
    buffer_load_dwordx4 v[16:19], v254, s[44:47], s26 offen offset:0 sc1
    v_rcp_f32 v251, v251
    v_rcp_f32 v252, v252
    v_rcp_f32 v253, v253
    v_mul_f32 v246, v246, v192
    v_mul_f32 v247, v247, v193
    v_mul_f32 v248, v248, v194
    v_mul_f32 v249, v249, v195
    v_mul_f32 v250, v250, v196
    v_mul_f32 v251, v251, v197
    buffer_load_dwordx4 v[20:23], v254, s[44:47], s26 offen offset:1024 sc1
    v_mul_f32 v252, v252, v198
    v_mul_f32 v253, v253, v199
    v_cvt_pk_bf16_f32 v168, v246, v247
    v_cvt_pk_bf16_f32 v169, v248, v249
    v_cvt_pk_bf16_f32 v170, v250, v251
    v_cvt_pk_bf16_f32 v171, v252, v253
    buffer_store_dwordx4 v[168:171], v254, s[44:47], s21 offen offset:2048 sc1
    v_mul_f32 v246, v200, v200
    v_mul_f32 v247, v201, v201
    buffer_load_dwordx4 v[24:27], v254, s[44:47], s26 offen offset:2048 sc1
    v_mul_f32 v248, v202, v202
    v_mul_f32 v249, v203, v203
    v_mul_f32 v250, v204, v204
    v_mul_f32 v251, v205, v205
    v_mul_f32 v252, v206, v206
    v_mul_f32 v253, v207, v207
    v_fma_f32 v246, v246, v243, v242
    v_fma_f32 v247, v247, v243, v242
    v_fma_f32 v248, v248, v243, v242
    buffer_load_dwordx4 v[28:31], v254, s[44:47], s26 offen offset:3072 sc1
    v_fma_f32 v249, v249, v243, v242
    v_fma_f32 v250, v250, v243, v242
    v_fma_f32 v251, v251, v243, v242
    v_fma_f32 v252, v252, v243, v242
    v_fma_f32 v253, v253, v243, v242
    v_mul_f32 v246, v246, v200
    v_mul_f32 v247, v247, v201
    v_mul_f32 v248, v248, v202
    v_mul_f32 v249, v249, v203
    buffer_load_dwordx4 v[32:35], v254, s[44:47], s27 offen offset:0 sc1
    v_mul_f32 v250, v250, v204
    v_mul_f32 v251, v251, v205
    v_mul_f32 v252, v252, v206
    v_mul_f32 v253, v253, v207
    v_exp_f32 v246, v246
    v_exp_f32 v247, v247
    v_exp_f32 v248, v248
    v_exp_f32 v249, v249
    v_exp_f32 v250, v250
    buffer_load_dwordx4 v[36:39], v254, s[44:47], s27 offen offset:1024 sc1
    v_exp_f32 v251, v251
    v_exp_f32 v252, v252
    v_exp_f32 v253, v253
    v_fma_f32 v246, v246, v244, v244
    v_fma_f32 v247, v247, v244, v244
    v_fma_f32 v248, v248, v244, v244
    v_fma_f32 v249, v249, v244, v244
    v_fma_f32 v250, v250, v244, v244
    v_fma_f32 v251, v251, v244, v244
    buffer_load_dwordx4 v[40:43], v254, s[44:47], s27 offen offset:2048 sc1
    v_fma_f32 v252, v252, v244, v244
    v_fma_f32 v253, v253, v244, v244
    v_rcp_f32 v246, v246
    v_rcp_f32 v247, v247
    v_rcp_f32 v248, v248
    v_rcp_f32 v249, v249
    v_rcp_f32 v250, v250
    v_rcp_f32 v251, v251
    v_rcp_f32 v252, v252
    buffer_load_dwordx4 v[44:47], v254, s[44:47], s27 offen offset:3072 sc1
    v_rcp_f32 v253, v253
    v_mul_f32 v246, v246, v200
    v_mul_f32 v247, v247, v201
    v_mul_f32 v248, v248, v202
    v_mul_f32 v249, v249, v203
    v_mul_f32 v250, v250, v204
    v_mul_f32 v251, v251, v205
    v_mul_f32 v252, v252, v206
    v_mul_f32 v253, v253, v207
    v_cvt_pk_bf16_f32 v172, v246, v247
    v_cvt_pk_bf16_f32 v173, v248, v249
    v_cvt_pk_bf16_f32 v174, v250, v251
    v_cvt_pk_bf16_f32 v175, v252, v253
    buffer_store_dwordx4 v[172:175], v254, s[44:47], s21 offen offset:3072 sc1
    s_barrier
    v_add_u32 v234, 0xffff2000, v234
    ds_read_b64_tr_b16 v[208:209], v234 offset:2048
    ds_read_b64_tr_b16 v[210:211], v234 offset:4608
    ds_read_b64_tr_b16 v[212:213], v234 offset:7168
    ds_read_b64_tr_b16 v[214:215], v234 offset:9728
    v_add_u32 v232, 0xfffec800, v232
    ds_read_b64_tr_b16 v[216:217], v232 offset:0
    ds_read_b64_tr_b16 v[218:219], v232 offset:2560
    ds_read_b64_tr_b16 v[220:221], v232 offset:5120
    ds_read_b64_tr_b16 v[222:223], v232 offset:7680
    s_waitcnt lgkmcnt(4)
    v_mfma_f32_16x16x32_bf16 v[132:135], v[208:211], v[144:147], 0
    v_add_u32 v233, 0xfffec800, v233
    ds_read_b64_tr_b16 v[224:225], v233 offset:0
    v_mfma_f32_16x16x32_bf16 v[132:135], v[212:215], v[152:155], v[132:135]
    ds_read_b64_tr_b16 v[226:227], v233 offset:2560
    v_mfma_f32_16x16x32_bf16 v[136:139], v[212:215], v[156:159], 0
    ds_read_b64_tr_b16 v[228:229], v233 offset:5120
    v_mfma_f32_16x16x32_bf16 v[136:139], v[208:211], v[148:151], v[136:139]
    ds_read_b64_tr_b16 v[230:231], v233 offset:7680
    s_add_u32 s61, s0, 32768
    buffer_load_dwordx4 v[48:51], v254, s[44:47], s61 offen offset:0 sc1
    s_waitcnt lgkmcnt(4)
    v_mfma_f32_16x16x32_bf16 v[176:179], v[216:219], v[144:147], 0
    ds_read_b64_tr_b16 v[208:209], v232 offset:1024
    v_mfma_f32_16x16x32_bf16 v[176:179], v[220:223], v[152:155], v[176:179]
    ds_read_b64_tr_b16 v[210:211], v232 offset:3584
    v_mfma_f32_16x16x32_bf16 v[184:187], v[220:223], v[156:159], 0
    ds_read_b64_tr_b16 v[212:213], v232 offset:6144
    v_mfma_f32_16x16x32_bf16 v[184:187], v[216:219], v[148:151], v[184:187]
    ds_read_b64_tr_b16 v[214:215], v232 offset:8704
    buffer_load_dwordx4 v[52:55], v254, s[44:47], s61 offen offset:1024 sc1
    s_waitcnt lgkmcnt(4)
    v_mfma_f32_16x16x32_bf16 v[180:183], v[224:227], v[144:147], 0
    ds_read_b64_tr_b16 v[216:217], v233 offset:1024
    v_mfma_f32_16x16x32_bf16 v[180:183], v[228:231], v[152:155], v[180:183]
    ds_read_b64_tr_b16 v[218:219], v233 offset:3584
    v_mfma_f32_16x16x32_bf16 v[188:191], v[228:231], v[156:159], 0
    ds_read_b64_tr_b16 v[220:221], v233 offset:6144
    v_mfma_f32_16x16x32_bf16 v[188:191], v[224:227], v[148:151], v[188:191]
    ds_read_b64_tr_b16 v[222:223], v233 offset:8704
    s_waitcnt lgkmcnt(4)
    v_mfma_f32_16x16x32_bf16 v[192:195], v[208:211], v[144:147], 0
    ds_read_b64_tr_b16 v[224:225], v234 offset:12288
    v_mfma_f32_16x16x32_bf16 v[192:195], v[212:215], v[152:155], v[192:195]
    ds_read_b64_tr_b16 v[226:227], v234 offset:14848
    v_mfma_f32_16x16x32_bf16 v[200:203], v[212:215], v[156:159], 0
    ds_read_b64_tr_b16 v[228:229], v234 offset:17408
    v_mfma_f32_16x16x32_bf16 v[200:203], v[208:211], v[148:151], v[200:203]
    ds_read_b64_tr_b16 v[230:231], v234 offset:19968
    buffer_load_dwordx4 v[56:59], v254, s[44:47], s61 offen offset:2048 sc1
    s_waitcnt lgkmcnt(4)
    v_mfma_f32_16x16x32_bf16 v[196:199], v[216:219], v[144:147], 0
    ds_read_b64_tr_b16 v[208:209], v232 offset:10240
    v_mfma_f32_16x16x32_bf16 v[196:199], v[220:223], v[152:155], v[196:199]
    ds_read_b64_tr_b16 v[210:211], v232 offset:12800
    v_mfma_f32_16x16x32_bf16 v[204:207], v[220:223], v[156:159], 0
    ds_read_b64_tr_b16 v[212:213], v232 offset:15360
    v_mfma_f32_16x16x32_bf16 v[204:207], v[216:219], v[148:151], v[204:207]
    ds_read_b64_tr_b16 v[214:215], v232 offset:17920
    buffer_load_dwordx4 v[60:63], v254, s[44:47], s61 offen offset:3072 sc1
    s_waitcnt lgkmcnt(4)
    v_mfma_f32_16x16x32_bf16 v[132:135], v[224:227], v[160:163], v[132:135]
    ds_read_b64_tr_b16 v[216:217], v233 offset:10240
    v_mfma_f32_16x16x32_bf16 v[132:135], v[228:231], v[168:171], v[132:135]
    ds_read_b64_tr_b16 v[218:219], v233 offset:12800
    v_mfma_f32_16x16x32_bf16 v[136:139], v[228:231], v[172:175], v[136:139]
    ds_read_b64_tr_b16 v[220:221], v233 offset:15360
    v_mfma_f32_16x16x32_bf16 v[136:139], v[224:227], v[164:167], v[136:139]
    ds_read_b64_tr_b16 v[222:223], v233 offset:17920
    s_waitcnt lgkmcnt(4)
    v_mfma_f32_16x16x32_bf16 v[176:179], v[208:211], v[160:163], v[176:179]
    ds_read_b64_tr_b16 v[224:225], v232 offset:11264
    v_mfma_f32_16x16x32_bf16 v[176:179], v[212:215], v[168:171], v[176:179]
    ds_read_b64_tr_b16 v[226:227], v232 offset:13824
    v_mfma_f32_16x16x32_bf16 v[184:187], v[212:215], v[172:175], v[184:187]
    ds_read_b64_tr_b16 v[228:229], v232 offset:16384
    v_mfma_f32_16x16x32_bf16 v[184:187], v[208:211], v[164:167], v[184:187]
    ds_read_b64_tr_b16 v[230:231], v232 offset:18944
    s_sub_u32 s61, s1, 249856
    s_mul_i32 s61, s61, 10
    s_add_u32 s61, s61, 8912896
    buffer_load_dwordx4 v[64:67], v254, s[44:47], s61 offen offset:0 sc1
    s_waitcnt lgkmcnt(4)
    v_mfma_f32_16x16x32_bf16 v[180:183], v[216:219], v[160:163], v[180:183]
    ds_read_b64_tr_b16 v[208:209], v233 offset:11264
    v_mfma_f32_16x16x32_bf16 v[180:183], v[220:223], v[168:171], v[180:183]
    ds_read_b64_tr_b16 v[210:211], v233 offset:13824
    v_mfma_f32_16x16x32_bf16 v[188:191], v[220:223], v[172:175], v[188:191]
    ds_read_b64_tr_b16 v[212:213], v233 offset:16384
    v_mfma_f32_16x16x32_bf16 v[188:191], v[216:219], v[164:167], v[188:191]
    ds_read_b64_tr_b16 v[214:215], v233 offset:18944
    buffer_load_dwordx4 v[68:71], v254, s[44:47], s61 offen offset:1024 sc1
    s_waitcnt lgkmcnt(4)
    v_mfma_f32_16x16x32_bf16 v[192:195], v[224:227], v[160:163], v[192:195]
    ds_read_b64_tr_b16 v[216:217], v234 offset:22528
    v_mfma_f32_16x16x32_bf16 v[192:195], v[228:231], v[168:171], v[192:195]
    ds_read_b64_tr_b16 v[218:219], v234 offset:25088
    v_mfma_f32_16x16x32_bf16 v[200:203], v[228:231], v[172:175], v[200:203]
    ds_read_b64_tr_b16 v[220:221], v234 offset:27648
    v_mfma_f32_16x16x32_bf16 v[200:203], v[224:227], v[164:167], v[200:203]
    ds_read_b64_tr_b16 v[222:223], v234 offset:30208
    s_waitcnt lgkmcnt(4)
    v_mfma_f32_16x16x32_bf16 v[196:199], v[208:211], v[160:163], v[196:199]
    ds_read_b64_tr_b16 v[224:225], v232 offset:20480
    v_mfma_f32_16x16x32_bf16 v[196:199], v[212:215], v[168:171], v[196:199]
    ds_read_b64_tr_b16 v[226:227], v232 offset:23040
    v_mfma_f32_16x16x32_bf16 v[204:207], v[212:215], v[172:175], v[204:207]
    ds_read_b64_tr_b16 v[228:229], v232 offset:25600
    v_mfma_f32_16x16x32_bf16 v[204:207], v[208:211], v[164:167], v[204:207]
    ds_read_b64_tr_b16 v[230:231], v232 offset:28160
    buffer_load_dwordx4 v[72:75], v254, s[44:47], s61 offen offset:2048 sc1
    s_waitcnt lgkmcnt(4)
    s_waitcnt vmcnt(20)
    v_mfma_f32_16x16x32_bf16 v[132:135], v[216:219], v[0:3], v[132:135]
    ds_read_b64_tr_b16 v[208:209], v233 offset:20480
    s_waitcnt vmcnt(18)
    v_mfma_f32_16x16x32_bf16 v[132:135], v[220:223], v[8:11], v[132:135]
    ds_read_b64_tr_b16 v[210:211], v233 offset:23040
    s_waitcnt vmcnt(17)
    v_mfma_f32_16x16x32_bf16 v[136:139], v[220:223], v[12:15], v[136:139]
    ds_read_b64_tr_b16 v[212:213], v233 offset:25600
    v_mfma_f32_16x16x32_bf16 v[136:139], v[216:219], v[4:7], v[136:139]
    ds_read_b64_tr_b16 v[214:215], v233 offset:28160
    buffer_load_dwordx4 v[76:79], v254, s[44:47], s61 offen offset:3072 sc1
    s_waitcnt lgkmcnt(4)
    v_mfma_f32_16x16x32_bf16 v[176:179], v[224:227], v[0:3], v[176:179]
    ds_read_b64_tr_b16 v[216:217], v232 offset:21504
    v_mfma_f32_16x16x32_bf16 v[176:179], v[228:231], v[8:11], v[176:179]
    ds_read_b64_tr_b16 v[218:219], v232 offset:24064
    v_mfma_f32_16x16x32_bf16 v[184:187], v[228:231], v[12:15], v[184:187]
    ds_read_b64_tr_b16 v[220:221], v232 offset:26624
    v_mfma_f32_16x16x32_bf16 v[184:187], v[224:227], v[4:7], v[184:187]
    ds_read_b64_tr_b16 v[222:223], v232 offset:29184
    s_waitcnt lgkmcnt(4)
    v_mfma_f32_16x16x32_bf16 v[180:183], v[208:211], v[0:3], v[180:183]
    ds_read_b64_tr_b16 v[224:225], v233 offset:21504
    v_mfma_f32_16x16x32_bf16 v[180:183], v[212:215], v[8:11], v[180:183]
    ds_read_b64_tr_b16 v[226:227], v233 offset:24064
    v_mfma_f32_16x16x32_bf16 v[188:191], v[212:215], v[12:15], v[188:191]
    ds_read_b64_tr_b16 v[228:229], v233 offset:26624
    v_mfma_f32_16x16x32_bf16 v[188:191], v[208:211], v[4:7], v[188:191]
    ds_read_b64_tr_b16 v[230:231], v233 offset:29184
    s_add_u32 s61, s61, 4096
    buffer_load_dwordx4 v[80:83], v254, s[44:47], s61 offen offset:0 sc1
    s_waitcnt vmcnt(9)
    s_buffer_atomic_swap s55, s[44:47], s41 offset:32
    s_buffer_atomic_swap s55, s[44:47], s41 offset:160
    s_buffer_atomic_swap s55, s[44:47], s41 offset:288
    s_buffer_atomic_swap s55, s[44:47], s41 offset:416
    s_waitcnt lgkmcnt(4)
    v_mfma_f32_16x16x32_bf16 v[192:195], v[216:219], v[0:3], v[192:195]
    ds_read_b64_tr_b16 v[208:209], v234 offset:32768
    v_mfma_f32_16x16x32_bf16 v[192:195], v[220:223], v[8:11], v[192:195]
    ds_read_b64_tr_b16 v[210:211], v234 offset:35328
    v_mfma_f32_16x16x32_bf16 v[200:203], v[220:223], v[12:15], v[200:203]
    ds_read_b64_tr_b16 v[212:213], v234 offset:37888
    v_mfma_f32_16x16x32_bf16 v[200:203], v[216:219], v[4:7], v[200:203]
    ds_read_b64_tr_b16 v[214:215], v234 offset:40448
    s_waitcnt lgkmcnt(4)
    v_mfma_f32_16x16x32_bf16 v[196:199], v[224:227], v[0:3], v[196:199]
    ds_read_b64_tr_b16 v[216:217], v232 offset:30720
    v_mfma_f32_16x16x32_bf16 v[196:199], v[228:231], v[8:11], v[196:199]
    ds_read_b64_tr_b16 v[218:219], v232 offset:33280
    v_mfma_f32_16x16x32_bf16 v[204:207], v[228:231], v[12:15], v[204:207]
    ds_read_b64_tr_b16 v[220:221], v232 offset:35840
    v_mfma_f32_16x16x32_bf16 v[204:207], v[224:227], v[4:7], v[204:207]
    ds_read_b64_tr_b16 v[222:223], v232 offset:38400
    s_waitcnt lgkmcnt(4)
    v_mfma_f32_16x16x32_bf16 v[132:135], v[208:211], v[16:19], v[132:135]
    ds_read_b64_tr_b16 v[224:225], v233 offset:30720
    v_mfma_f32_16x16x32_bf16 v[132:135], v[212:215], v[24:27], v[132:135]
    ds_read_b64_tr_b16 v[226:227], v233 offset:33280
    v_mfma_f32_16x16x32_bf16 v[136:139], v[212:215], v[28:31], v[136:139]
    ds_read_b64_tr_b16 v[228:229], v233 offset:35840
    v_mfma_f32_16x16x32_bf16 v[136:139], v[208:211], v[20:23], v[136:139]
    ds_read_b64_tr_b16 v[230:231], v233 offset:38400
    s_waitcnt lgkmcnt(4)
    v_mfma_f32_16x16x32_bf16 v[176:179], v[216:219], v[16:19], v[176:179]
    ds_read_b64_tr_b16 v[208:209], v232 offset:31744
    v_mfma_f32_16x16x32_bf16 v[176:179], v[220:223], v[24:27], v[176:179]
    ds_read_b64_tr_b16 v[210:211], v232 offset:34304
    v_mfma_f32_16x16x32_bf16 v[184:187], v[220:223], v[28:31], v[184:187]
    ds_read_b64_tr_b16 v[212:213], v232 offset:36864
    v_mfma_f32_16x16x32_bf16 v[184:187], v[216:219], v[20:23], v[184:187]
    ds_read_b64_tr_b16 v[214:215], v232 offset:39424
    s_waitcnt lgkmcnt(4)
    v_mfma_f32_16x16x32_bf16 v[180:183], v[224:227], v[16:19], v[180:183]
    ds_read_b64_tr_b16 v[216:217], v233 offset:31744
    v_mfma_f32_16x16x32_bf16 v[180:183], v[228:231], v[24:27], v[180:183]
    ds_read_b64_tr_b16 v[218:219], v233 offset:34304
    v_mfma_f32_16x16x32_bf16 v[188:191], v[228:231], v[28:31], v[188:191]
    ds_read_b64_tr_b16 v[220:221], v233 offset:36864
    v_mfma_f32_16x16x32_bf16 v[188:191], v[224:227], v[20:23], v[188:191]
    ds_read_b64_tr_b16 v[222:223], v233 offset:39424
    s_waitcnt lgkmcnt(4)
    v_mfma_f32_16x16x32_bf16 v[192:195], v[208:211], v[16:19], v[192:195]
    v_mfma_f32_16x16x32_bf16 v[192:195], v[212:215], v[24:27], v[192:195]
    v_mfma_f32_16x16x32_bf16 v[200:203], v[212:215], v[28:31], v[200:203]
    v_mfma_f32_16x16x32_bf16 v[200:203], v[208:211], v[20:23], v[200:203]
    s_waitcnt lgkmcnt(0)
    v_mfma_f32_16x16x32_bf16 v[196:199], v[216:219], v[16:19], v[196:199]
    v_mfma_f32_16x16x32_bf16 v[196:199], v[220:223], v[24:27], v[196:199]
    v_mfma_f32_16x16x32_bf16 v[204:207], v[220:223], v[28:31], v[204:207]
    v_mfma_f32_16x16x32_bf16 v[204:207], v[216:219], v[20:23], v[204:207]
    ds_read_b64_tr_b16 v[208:209], v234 offset:43008
    ds_read_b64_tr_b16 v[210:211], v234 offset:45568
    ds_read_b64_tr_b16 v[212:213], v234 offset:48128
    ds_read_b64_tr_b16 v[214:215], v234 offset:50688
    ds_read_b64_tr_b16 v[216:217], v232 offset:40960
    ds_read_b64_tr_b16 v[218:219], v232 offset:43520
    ds_read_b64_tr_b16 v[220:221], v232 offset:46080
    ds_read_b64_tr_b16 v[222:223], v232 offset:48640
    s_add_u32 m0, s23, 0x0000f000
    s_nop 0
    buffer_load_dwordx4 v236, s[16:19], s43 offen lds
    s_add_u32 m0, s23, 0x0000f3c0
    s_nop 0
    buffer_load_dwordx4 v236, s[16:19], s43 offen offset:64 lds
    s_mov_b32 exec_hi, 0x00000000
    s_add_u32 m0, s23, 0x0000f800
    s_nop 0
    buffer_load_dwordx4 v237, s[16:19], s43 offen lds
    s_mov_b64 exec, -1
    s_lshl_b32 s64, s49, 4
    s_lshl_b64 exec, 0xffff, s64
    s_add_u32 m0, s43, 0x00014000
    s_nop 0
    buffer_load_dwordx4 v241, s[16:19], s43 offen lds
    s_add_u32 m0, s43, 0x000143c0
    s_nop 0
    buffer_load_dwordx4 v241, s[16:19], s43 offen offset:64 lds
    s_mov_b64 exec, -1
    s_lshl_b32 s64, s49, 3
    s_lshl_b64 exec, 0xff, s64
    s_add_u32 m0, s43, 0x00014800
    s_nop 0
    buffer_load_dwordx4 v245, s[16:19], s43 offen lds
    s_mov_b64 exec, -1
    s_buffer_load_dwordx4 s[92:95], s[44:47], s40 offset:32 glc
    s_waitcnt vmcnt(13)
    v_swap_b32 v50, v52
    v_swap_b32 v51, v53
    s_waitcnt vmcnt(11)
    v_swap_b32 v58, v60
    v_swap_b32 v59, v61
    s_waitcnt lgkmcnt(0)
    s_xor_b32 s92, s92, s55
    s_xor_b32 s93, s93, s55
    s_xor_b32 s94, s94, s55
    s_xor_b32 s95, s95, s55
    s_or_b64 s[92:93], s[92:93], s[94:95]
    s_cbranch_scc1 L_pslow_100
L_pback_101:
    s_add_u32 s25, s25, 4096
    buffer_load_dwordx4 v[84:87], v254, s[44:47], s25 offen offset:0 sc1
    buffer_load_dwordx4 v[88:91], v254, s[44:47], s25 offen offset:1024 sc1
    buffer_load_dwordx4 v[92:95], v254, s[44:47], s25 offen offset:2048 sc1
    buffer_load_dwordx4 v[96:99], v254, s[44:47], s25 offen offset:3072 sc1
    s_waitcnt vmcnt(4)
    s_barrier
    v_mfma_f32_16x16x32_bf16 v[132:135], v[208:211], v[32:35], v[132:135]
    ds_read_b64_tr_b16 v[224:225], v233 offset:40960
    v_mfma_f32_16x16x32_bf16 v[132:135], v[212:215], v[40:43], v[132:135]
    ds_read_b64_tr_b16 v[226:227], v233 offset:43520
    v_mfma_f32_16x16x32_bf16 v[136:139], v[212:215], v[44:47], v[136:139]
    ds_read_b64_tr_b16 v[228:229], v233 offset:46080
    v_mfma_f32_16x16x32_bf16 v[136:139], v[208:211], v[36:39], v[136:139]
    ds_read_b64_tr_b16 v[230:231], v233 offset:48640
    s_add_u32 s26, s26, 4096
    buffer_load_dwordx4 v[100:103], v254, s[44:47], s26 offen offset:0 sc1
    v_mfma_f32_16x16x32_bf16 v[176:179], v[216:219], v[32:35], v[176:179]
    ds_read_b64_tr_b16 v[208:209], v232 offset:41984
    v_mfma_f32_16x16x32_bf16 v[176:179], v[220:223], v[40:43], v[176:179]
    ds_read_b64_tr_b16 v[210:211], v232 offset:44544
    v_mfma_f32_16x16x32_bf16 v[184:187], v[220:223], v[44:47], v[184:187]
    ds_read_b64_tr_b16 v[212:213], v232 offset:47104
    v_mfma_f32_16x16x32_bf16 v[184:187], v[216:219], v[36:39], v[184:187]
    ds_read_b64_tr_b16 v[214:215], v232 offset:49664
    buffer_load_dwordx4 v[104:107], v254, s[44:47], s26 offen offset:1024 sc1
    s_waitcnt lgkmcnt(4)
    v_mfma_f32_16x16x32_bf16 v[180:183], v[224:227], v[32:35], v[180:183]
    ds_read_b64_tr_b16 v[216:217], v233 offset:41984
    v_mfma_f32_16x16x32_bf16 v[180:183], v[228:231], v[40:43], v[180:183]
    ds_read_b64_tr_b16 v[218:219], v233 offset:44544
    v_mfma_f32_16x16x32_bf16 v[188:191], v[228:231], v[44:47], v[188:191]
    ds_read_b64_tr_b16 v[220:221], v233 offset:47104
    v_mfma_f32_16x16x32_bf16 v[188:191], v[224:227], v[36:39], v[188:191]
    ds_read_b64_tr_b16 v[222:223], v233 offset:49664
    s_waitcnt lgkmcnt(4)
    v_mfma_f32_16x16x32_bf16 v[192:195], v[208:211], v[32:35], v[192:195]
    ds_read_b64_tr_b16 v[224:225], v234 offset:53248
    v_mfma_f32_16x16x32_bf16 v[192:195], v[212:215], v[40:43], v[192:195]
    ds_read_b64_tr_b16 v[226:227], v234 offset:55808
    v_mfma_f32_16x16x32_bf16 v[200:203], v[212:215], v[44:47], v[200:203]
    ds_read_b64_tr_b16 v[228:229], v234 offset:58368
    v_mfma_f32_16x16x32_bf16 v[200:203], v[208:211], v[36:39], v[200:203]
    ds_read_b64_tr_b16 v[230:231], v234 offset:60928
    buffer_load_dwordx4 v[108:111], v254, s[44:47], s26 offen offset:2048 sc1
    s_waitcnt lgkmcnt(4)
    v_mfma_f32_16x16x32_bf16 v[196:199], v[216:219], v[32:35], v[196:199]
    ds_read_b64_tr_b16 v[208:209], v232 offset:51200
    v_mfma_f32_16x16x32_bf16 v[196:199], v[220:223], v[40:43], v[196:199]
    ds_read_b64_tr_b16 v[210:211], v232 offset:53760
    v_mfma_f32_16x16x32_bf16 v[204:207], v[220:223], v[44:47], v[204:207]
    ds_read_b64_tr_b16 v[212:213], v232 offset:56320
    v_mfma_f32_16x16x32_bf16 v[204:207], v[216:219], v[36:39], v[204:207]
    ds_read_b64_tr_b16 v[214:215], v232 offset:58880
    buffer_load_dwordx4 v[112:115], v254, s[44:47], s26 offen offset:3072 sc1
    s_waitcnt lgkmcnt(4)
    v_mfma_f32_16x16x32_bf16 v[132:135], v[224:227], v[48:51], v[132:135]
    ds_read_b64_tr_b16 v[216:217], v233 offset:51200
    v_mfma_f32_16x16x32_bf16 v[132:135], v[228:231], v[56:59], v[132:135]
    ds_read_b64_tr_b16 v[218:219], v233 offset:53760
    v_mfma_f32_16x16x32_bf16 v[136:139], v[228:231], v[60:63], v[136:139]
    ds_read_b64_tr_b16 v[220:221], v233 offset:56320
    v_mfma_f32_16x16x32_bf16 v[136:139], v[224:227], v[52:55], v[136:139]
    ds_read_b64_tr_b16 v[222:223], v233 offset:58880
    s_waitcnt lgkmcnt(4)
    v_mfma_f32_16x16x32_bf16 v[176:179], v[208:211], v[48:51], v[176:179]
    ds_read_b64_tr_b16 v[224:225], v232 offset:52224
    v_mfma_f32_16x16x32_bf16 v[176:179], v[212:215], v[56:59], v[176:179]
    ds_read_b64_tr_b16 v[226:227], v232 offset:54784
    v_mfma_f32_16x16x32_bf16 v[184:187], v[212:215], v[60:63], v[184:187]
    ds_read_b64_tr_b16 v[228:229], v232 offset:57344
    v_mfma_f32_16x16x32_bf16 v[184:187], v[208:211], v[52:55], v[184:187]
    ds_read_b64_tr_b16 v[230:231], v232 offset:59904
    s_add_u32 s27, s27, 4096
    buffer_load_dwordx4 v[116:119], v254, s[44:47], s27 offen offset:0 sc1
    s_waitcnt lgkmcnt(4)
    v_mfma_f32_16x16x32_bf16 v[180:183], v[216:219], v[48:51], v[180:183]
    ds_read_b64_tr_b16 v[208:209], v233 offset:52224
    v_mfma_f32_16x16x32_bf16 v[180:183], v[220:223], v[56:59], v[180:183]
    ds_read_b64_tr_b16 v[210:211], v233 offset:54784
    v_mfma_f32_16x16x32_bf16 v[188:191], v[220:223], v[60:63], v[188:191]
    ds_read_b64_tr_b16 v[212:213], v233 offset:57344
    v_mfma_f32_16x16x32_bf16 v[188:191], v[216:219], v[52:55], v[188:191]
    ds_read_b64_tr_b16 v[214:215], v233 offset:59904
    buffer_load_dwordx4 v[120:123], v254, s[44:47], s27 offen offset:1024 sc1
    s_waitcnt lgkmcnt(4)
    v_mfma_f32_16x16x32_bf16 v[192:195], v[224:227], v[48:51], v[192:195]
    ds_read_b64_tr_b16 v[216:217], v234 offset:63488
    v_mfma_f32_16x16x32_bf16 v[192:195], v[228:231], v[56:59], v[192:195]
    v_add_u32 v234, 0x0000e000, v234
    ds_read_b64_tr_b16 v[218:219], v234 offset:8704
    v_mfma_f32_16x16x32_bf16 v[200:203], v[228:231], v[60:63], v[200:203]
    ds_read_b64_tr_b16 v[220:221], v234 offset:11264
    v_mfma_f32_16x16x32_bf16 v[200:203], v[224:227], v[52:55], v[200:203]
    ds_read_b64_tr_b16 v[222:223], v234 offset:13824
    s_waitcnt lgkmcnt(4)
    v_mfma_f32_16x16x32_bf16 v[196:199], v[208:211], v[48:51], v[196:199]
    ds_read_b64_tr_b16 v[224:225], v232 offset:61440
    v_mfma_f32_16x16x32_bf16 v[196:199], v[212:215], v[56:59], v[196:199]
    ds_read_b64_tr_b16 v[226:227], v232 offset:64000
    v_mfma_f32_16x16x32_bf16 v[204:207], v[212:215], v[60:63], v[204:207]
    v_add_u32 v232, 0x0000e400, v232
    ds_read_b64_tr_b16 v[228:229], v232 offset:8192
    v_mfma_f32_16x16x32_bf16 v[204:207], v[208:211], v[52:55], v[204:207]
    ds_read_b64_tr_b16 v[230:231], v232 offset:10752
    buffer_load_dwordx4 v[124:127], v254, s[44:47], s27 offen offset:2048 sc1
    s_waitcnt lgkmcnt(4)
    v_mfma_f32_16x16x32_bf16 v[132:135], v[216:219], v[64:67], v[132:135]
    ds_read_b64_tr_b16 v[208:209], v233 offset:61440
    v_mfma_f32_16x16x32_bf16 v[132:135], v[220:223], v[72:75], v[132:135]
    ds_read_b64_tr_b16 v[210:211], v233 offset:64000
    v_mfma_f32_16x16x32_bf16 v[136:139], v[220:223], v[76:79], v[136:139]
    v_add_u32 v233, 0x0000e400, v233
    ds_read_b64_tr_b16 v[212:213], v233 offset:8192
    v_mfma_f32_16x16x32_bf16 v[136:139], v[216:219], v[68:71], v[136:139]
    ds_read_b64_tr_b16 v[214:215], v233 offset:10752
    buffer_load_dwordx4 v[128:131], v254, s[44:47], s27 offen offset:3072 sc1
    s_waitcnt lgkmcnt(4)
    v_mfma_f32_16x16x32_bf16 v[176:179], v[224:227], v[64:67], v[176:179]
    ds_read_b64_tr_b16 v[216:217], v232 offset:4096
    v_mfma_f32_16x16x32_bf16 v[176:179], v[228:231], v[72:75], v[176:179]
    ds_read_b64_tr_b16 v[218:219], v232 offset:6656
    v_mfma_f32_16x16x32_bf16 v[184:187], v[228:231], v[76:79], v[184:187]
    ds_read_b64_tr_b16 v[220:221], v232 offset:9216
    v_mfma_f32_16x16x32_bf16 v[184:187], v[224:227], v[68:71], v[184:187]
    ds_read_b64_tr_b16 v[222:223], v232 offset:11776
    s_waitcnt lgkmcnt(4)
    v_mfma_f32_16x16x32_bf16 v[180:183], v[208:211], v[64:67], v[180:183]
    ds_read_b64_tr_b16 v[224:225], v233 offset:4096
    v_mfma_f32_16x16x32_bf16 v[180:183], v[212:215], v[72:75], v[180:183]
    ds_read_b64_tr_b16 v[226:227], v233 offset:6656
    v_mfma_f32_16x16x32_bf16 v[188:191], v[212:215], v[76:79], v[188:191]
    ds_read_b64_tr_b16 v[228:229], v233 offset:9216
    v_mfma_f32_16x16x32_bf16 v[188:191], v[208:211], v[68:71], v[188:191]
    ds_read_b64_tr_b16 v[230:231], v233 offset:11776
    s_waitcnt lgkmcnt(4)
    v_mfma_f32_16x16x32_bf16 v[192:195], v[216:219], v[64:67], v[192:195]
    ds_read_b64_tr_b16 v[208:209], v234 offset:26624
    v_mfma_f32_16x16x32_bf16 v[192:195], v[220:223], v[72:75], v[192:195]
    ds_read_b64_tr_b16 v[212:213], v232 offset:23552
    v_mfma_f32_16x16x32_bf16 v[200:203], v[220:223], v[76:79], v[200:203]
    v_mfma_f32_16x16x32_bf16 v[200:203], v[216:219], v[68:71], v[200:203]
    s_waitcnt lgkmcnt(2)
    v_mfma_f32_16x16x32_bf16 v[196:199], v[224:227], v[64:67], v[196:199]
    ds_read_b64_tr_b16 v[216:217], v233 offset:23552
    v_mfma_f32_16x16x32_bf16 v[196:199], v[228:231], v[72:75], v[196:199]
    ds_read_b64_tr_b16 v[220:221], v232 offset:24576
    v_mfma_f32_16x16x32_bf16 v[204:207], v[228:231], v[76:79], v[204:207]
    v_mfma_f32_16x16x32_bf16 v[204:207], v[224:227], v[68:71], v[204:207]
    s_waitcnt lgkmcnt(3)
    v_mfma_f32_16x16x16_bf16 v[132:135], v[208:209], v[80:81], v[132:135]
    ds_read_b64_tr_b16 v[224:225], v233 offset:24576
    v_mfma_f32_16x16x16_bf16 v[136:139], v[208:209], v[82:83], v[136:139]
    ds_read_b64_tr_b16 v[228:229], v234 offset:16384
    ds_read_b64_tr_b16 v[230:231], v234 offset:18944
    s_waitcnt lgkmcnt(5)
    v_mfma_f32_16x16x16_bf16 v[176:179], v[212:213], v[80:81], v[176:179]
    ds_read_b64_tr_b16 v[208:209], v234 offset:21504
    v_mfma_f32_16x16x16_bf16 v[184:187], v[212:213], v[82:83], v[184:187]
    ds_read_b64_tr_b16 v[210:211], v234 offset:24064
    s_waitcnt lgkmcnt(6)
    v_mfma_f32_16x16x16_bf16 v[180:183], v[216:217], v[80:81], v[180:183]
    ds_read_b64_tr_b16 v[212:213], v232 offset:13312
    v_mfma_f32_16x16x16_bf16 v[188:191], v[216:217], v[82:83], v[188:191]
    ds_read_b64_tr_b16 v[214:215], v232 offset:15872
    s_waitcnt lgkmcnt(7)
    v_mfma_f32_16x16x16_bf16 v[192:195], v[220:221], v[80:81], v[192:195]
    ds_read_b64_tr_b16 v[216:217], v232 offset:18432
    v_mfma_f32_16x16x16_bf16 v[200:203], v[220:221], v[82:83], v[200:203]
    ds_read_b64_tr_b16 v[218:219], v232 offset:20992
    s_waitcnt lgkmcnt(8)
    v_mfma_f32_16x16x16_bf16 v[196:199], v[224:225], v[80:81], v[196:199]
    ds_read_b64_tr_b16 v[220:221], v233 offset:13312
    v_mfma_f32_16x16x16_bf16 v[204:207], v[224:225], v[82:83], v[204:207]
    ds_read_b64_tr_b16 v[222:223], v233 offset:15872
    s_waitcnt lgkmcnt(6)
    s_waitcnt vmcnt(11)
    v_mfma_f32_16x16x32_bf16 v[132:135], v[228:231], v[84:87], v[132:135]
    ds_read_b64_tr_b16 v[224:225], v233 offset:18432
    s_waitcnt vmcnt(9)
    v_mfma_f32_16x16x32_bf16 v[132:135], v[208:211], v[92:95], v[132:135]
    ds_read_b64_tr_b16 v[226:227], v233 offset:20992
    s_waitcnt vmcnt(8)
    v_mfma_f32_16x16x32_bf16 v[136:139], v[208:211], v[96:99], v[136:139]
    v_mfma_f32_16x16x32_bf16 v[136:139], v[228:231], v[88:91], v[136:139]
    s_waitcnt lgkmcnt(4)
    v_mfma_f32_16x16x32_bf16 v[176:179], v[212:215], v[84:87], v[176:179]
    ds_read_b64_tr_b16 v[228:229], v232 offset:14336
    v_mfma_f32_16x16x32_bf16 v[176:179], v[216:219], v[92:95], v[176:179]
    ds_read_b64_tr_b16 v[230:231], v232 offset:16896
    v_mfma_f32_16x16x32_bf16 v[184:187], v[216:219], v[96:99], v[184:187]
    ds_read_b64_tr_b16 v[208:209], v232 offset:19456
    v_mfma_f32_16x16x32_bf16 v[184:187], v[212:215], v[88:91], v[184:187]
    ds_read_b64_tr_b16 v[210:211], v232 offset:22016
    s_waitcnt lgkmcnt(4)
    v_mfma_f32_16x16x32_bf16 v[180:183], v[220:223], v[84:87], v[180:183]
    ds_read_b64_tr_b16 v[212:213], v233 offset:14336
    v_mfma_f32_16x16x32_bf16 v[180:183], v[224:227], v[92:95], v[180:183]
    ds_read_b64_tr_b16 v[214:215], v233 offset:16896
    v_mfma_f32_16x16x32_bf16 v[188:191], v[224:227], v[96:99], v[188:191]
    ds_read_b64_tr_b16 v[216:217], v233 offset:19456
    v_mfma_f32_16x16x32_bf16 v[188:191], v[220:223], v[88:91], v[188:191]
    ds_read_b64_tr_b16 v[218:219], v233 offset:22016
    s_waitcnt lgkmcnt(4)
    v_mfma_f32_16x16x32_bf16 v[192:195], v[228:231], v[84:87], v[192:195]
    ds_read_b64_tr_b16 v[220:221], v234 offset:36864
    v_mfma_f32_16x16x32_bf16 v[192:195], v[208:211], v[92:95], v[192:195]
    ds_read_b64_tr_b16 v[222:223], v234 offset:39424
    v_mfma_f32_16x16x32_bf16 v[200:203], v[208:211], v[96:99], v[200:203]
    ds_read_b64_tr_b16 v[224:225], v234 offset:41984
    v_mfma_f32_16x16x32_bf16 v[200:203], v[228:231], v[88:91], v[200:203]
    ds_read_b64_tr_b16 v[226:227], v234 offset:44544
    s_waitcnt lgkmcnt(4)
    v_mfma_f32_16x16x32_bf16 v[196:199], v[212:215], v[84:87], v[196:199]
    ds_read_b64_tr_b16 v[228:229], v232 offset:33792
    v_mfma_f32_16x16x32_bf16 v[196:199], v[216:219], v[92:95], v[196:199]
    ds_read_b64_tr_b16 v[230:231], v232 offset:36352
    v_mfma_f32_16x16x32_bf16 v[204:207], v[216:219], v[96:99], v[204:207]
    ds_read_b64_tr_b16 v[208:209], v232 offset:38912
    v_mfma_f32_16x16x32_bf16 v[204:207], v[212:215], v[88:91], v[204:207]
    ds_read_b64_tr_b16 v[210:211], v232 offset:41472
    s_waitcnt lgkmcnt(4)
    s_waitcnt vmcnt(7)
    v_mfma_f32_16x16x32_bf16 v[132:135], v[220:223], v[100:103], v[132:135]
    ds_read_b64_tr_b16 v[212:213], v233 offset:33792
    s_waitcnt vmcnt(5)
    v_mfma_f32_16x16x32_bf16 v[132:135], v[224:227], v[108:111], v[132:135]
    ds_read_b64_tr_b16 v[214:215], v233 offset:36352
    s_waitcnt vmcnt(4)
    v_mfma_f32_16x16x32_bf16 v[136:139], v[224:227], v[112:115], v[136:139]
    ds_read_b64_tr_b16 v[216:217], v233 offset:38912
    v_mfma_f32_16x16x32_bf16 v[136:139], v[220:223], v[104:107], v[136:139]
    ds_read_b64_tr_b16 v[218:219], v233 offset:41472
    s_waitcnt lgkmcnt(4)
    v_mfma_f32_16x16x32_bf16 v[176:179], v[228:231], v[100:103], v[176:179]
    ds_read_b64_tr_b16 v[220:221], v232 offset:34816
    v_mfma_f32_16x16x32_bf16 v[176:179], v[208:211], v[108:111], v[176:179]
    ds_read_b64_tr_b16 v[222:223], v232 offset:37376
    v_mfma_f32_16x16x32_bf16 v[184:187], v[208:211], v[112:115], v[184:187]
    ds_read_b64_tr_b16 v[224:225], v232 offset:39936
    v_mfma_f32_16x16x32_bf16 v[184:187], v[228:231], v[104:107], v[184:187]
    ds_read_b64_tr_b16 v[226:227], v232 offset:42496
    s_waitcnt lgkmcnt(4)
    v_mfma_f32_16x16x32_bf16 v[180:183], v[212:215], v[100:103], v[180:183]
    ds_read_b64_tr_b16 v[228:229], v233 offset:34816
    v_mfma_f32_16x16x32_bf16 v[180:183], v[216:219], v[108:111], v[180:183]
    ds_read_b64_tr_b16 v[230:231], v233 offset:37376
    v_mfma_f32_16x16x32_bf16 v[188:191], v[216:219], v[112:115], v[188:191]
    ds_read_b64_tr_b16 v[208:209], v233 offset:39936
    v_mfma_f32_16x16x32_bf16 v[188:191], v[212:215], v[104:107], v[188:191]
    ds_read_b64_tr_b16 v[210:211], v233 offset:42496
    s_waitcnt lgkmcnt(4)
    v_mfma_f32_16x16x32_bf16 v[192:195], v[220:223], v[100:103], v[192:195]
    ds_read_b64_tr_b16 v[212:213], v234 offset:47104
    v_mfma_f32_16x16x32_bf16 v[192:195], v[224:227], v[108:111], v[192:195]
    ds_read_b64_tr_b16 v[214:215], v234 offset:49664
    v_mfma_f32_16x16x32_bf16 v[200:203], v[224:227], v[112:115], v[200:203]
    ds_read_b64_tr_b16 v[216:217], v234 offset:52224
    v_mfma_f32_16x16x32_bf16 v[200:203], v[220:223], v[104:107], v[200:203]
    ds_read_b64_tr_b16 v[218:219], v234 offset:54784
    s_waitcnt lgkmcnt(4)
    v_mfma_f32_16x16x32_bf16 v[196:199], v[228:231], v[100:103], v[196:199]
    ds_read_b64_tr_b16 v[220:221], v232 offset:44032
    v_mfma_f32_16x16x32_bf16 v[196:199], v[208:211], v[108:111], v[196:199]
    ds_read_b64_tr_b16 v[222:223], v232 offset:46592
    v_mfma_f32_16x16x32_bf16 v[204:207], v[208:211], v[112:115], v[204:207]
    ds_read_b64_tr_b16 v[224:225], v232 offset:49152
    v_mfma_f32_16x16x32_bf16 v[204:207], v[228:231], v[104:107], v[204:207]
    ds_read_b64_tr_b16 v[226:227], v232 offset:51712
    s_waitcnt lgkmcnt(4)
    s_waitcnt vmcnt(3)
    v_mfma_f32_16x16x32_bf16 v[132:135], v[212:215], v[116:119], v[132:135]
    ds_read_b64_tr_b16 v[228:229], v233 offset:44032
    s_waitcnt vmcnt(1)
    v_mfma_f32_16x16x32_bf16 v[132:135], v[216:219], v[124:127], v[132:135]
    ds_read_b64_tr_b16 v[230:231], v233 offset:46592
    s_waitcnt vmcnt(0)
    v_mfma_f32_16x16x32_bf16 v[136:139], v[216:219], v[128:131], v[136:139]
    ds_read_b64_tr_b16 v[208:209], v233 offset:49152
    v_mfma_f32_16x16x32_bf16 v[136:139], v[212:215], v[120:123], v[136:139]
    ds_read_b64_tr_b16 v[210:211], v233 offset:51712
    s_waitcnt lgkmcnt(4)
    v_mfma_f32_16x16x32_bf16 v[176:179], v[220:223], v[116:119], v[176:179]
    ds_read_b64_tr_b16 v[212:213], v232 offset:45056
    v_mfma_f32_16x16x32_bf16 v[176:179], v[224:227], v[124:127], v[176:179]
    ds_read_b64_tr_b16 v[214:215], v232 offset:47616
    v_mfma_f32_16x16x32_bf16 v[184:187], v[224:227], v[128:131], v[184:187]
    ds_read_b64_tr_b16 v[216:217], v232 offset:50176
    v_mfma_f32_16x16x32_bf16 v[184:187], v[220:223], v[120:123], v[184:187]
    ds_read_b64_tr_b16 v[218:219], v232 offset:52736
    s_waitcnt lgkmcnt(4)
    v_mfma_f32_16x16x32_bf16 v[180:183], v[228:231], v[116:119], v[180:183]
    ds_read_b64_tr_b16 v[220:221], v233 offset:45056
    v_mfma_f32_16x16x32_bf16 v[180:183], v[208:211], v[124:127], v[180:183]
    ds_read_b64_tr_b16 v[222:223], v233 offset:47616
    v_mfma_f32_16x16x32_bf16 v[188:191], v[208:211], v[128:131], v[188:191]
    ds_read_b64_tr_b16 v[224:225], v233 offset:50176
    v_mfma_f32_16x16x32_bf16 v[188:191], v[228:231], v[120:123], v[188:191]
    ds_read_b64_tr_b16 v[226:227], v233 offset:52736
    s_waitcnt lgkmcnt(4)
    v_mfma_f32_16x16x32_bf16 v[192:195], v[212:215], v[116:119], v[192:195]
    v_mfma_f32_16x16x32_bf16 v[192:195], v[216:219], v[124:127], v[192:195]
    v_mfma_f32_16x16x32_bf16 v[200:203], v[216:219], v[128:131], v[200:203]
    v_mfma_f32_16x16x32_bf16 v[200:203], v[212:215], v[120:123], v[200:203]
    s_waitcnt lgkmcnt(0)
    v_mfma_f32_16x16x32_bf16 v[196:199], v[220:223], v[116:119], v[196:199]
    v_mfma_f32_16x16x32_bf16 v[196:199], v[224:227], v[124:127], v[196:199]
    v_mfma_f32_16x16x32_bf16 v[204:207], v[224:227], v[128:131], v[204:207]
    v_mfma_f32_16x16x32_bf16 v[204:207], v[220:223], v[120:123], v[204:207]
    s_lshl_b32 s64, s49, 4
    s_lshl_b64 exec, 0xffff, s64
    s_add_u32 m0, s43, 0x00014980
    s_nop 0
    buffer_load_dwordx4 v241, s[16:19], s43 offen offset:128 lds
    s_add_u32 m0, s43, 0x00014d40
    s_nop 0
    buffer_load_dwordx4 v241, s[16:19], s43 offen offset:192 lds
    s_mov_b64 exec, -1
    v_lshrrev_b32 v245, 2, v255
    v_mul_u32_u24 v245, 1152, v245
    v_lshrrev_b32 v236, 3, v255
    v_and_b32 v236, 2, v236
    v_xor_b32 v236, v236, v255
    v_and_b32 v236, 3, v236
    v_lshl_add_u32 v235, v236, 4, v245
    v_bfe_u32 v245, v255, 1, 4
    v_mul_u32_u24 v245, 1152, v245
    v_and_b32 v236, 1, v255
    v_lshl_add_u32 v236, v236, 4, v245
    s_mul_i32 s64, s49, 18432
    s_mul_i32 s65, s53, 663552
    s_add_u32 s64, s64, s65
    s_lshl_b32 s65, s54, 8
    s_add_u32 s65, s65, s64
    v_add_u32 v235, s65, v235
    s_lshl_b32 s65, s54, 5
    s_add_u32 s65, s65, s64
    s_add_u32 s65, s65, 1024
    v_add_u32 v236, s65, v236
    s_add_u32 m0, s24, 0x0001f780
    s_nop 0
    buffer_load_dwordx4 v235, s[32:35], s10 offen offset:128 lds
    s_add_u32 m0, s24, 0x0001fb40
    s_nop 0
    buffer_load_dwordx4 v235, s[32:35], s10 offen offset:192 lds
    s_add_u32 m0, s24, 0x00021780
    s_nop 0
    buffer_load_dwordx4 v235, s[32:35], s11 offen offset:128 lds
    s_add_u32 m0, s24, 0x00021b40
    s_nop 0
    buffer_load_dwordx4 v235, s[32:35], s11 offen offset:192 lds
    s_add_u32 m0, s24, 0x00023780
    s_nop 0
    buffer_load_dwordx4 v235, s[32:35], s12 offen offset:128 lds
    s_add_u32 m0, s24, 0x00023b40
    s_nop 0
    buffer_load_dwordx4 v235, s[32:35], s12 offen offset:192 lds
    s_mov_b32 s66, 589824
    s_add_u32 m0, s24, 0x00025780
    s_nop 0
    buffer_load_dwordx4 v235, s[32:35], s66 offen offset:128 lds
    s_add_u32 m0, s24, 0x00025b40
    s_nop 0
    buffer_load_dwordx4 v235, s[32:35], s66 offen offset:192 lds
    s_lshl_b32 s3, s53, 3
    s_add_u32 s3, s3, s53
    s_bfe_u32 s3, s3, 0x30001
    v_cvt_pk_bf16_f32 v132, v132, v133
    v_cvt_pk_bf16_f32 v133, v134, v135
    v_cvt_pk_bf16_f32 v134, v136, v137
    v_cvt_pk_bf16_f32 v135, v138, v139
    v_cvt_pk_bf16_f32 v136, v176, v177
    v_cvt_pk_bf16_f32 v137, v178, v179
    v_cvt_pk_bf16_f32 v138, v180, v181
    v_cvt_pk_bf16_f32 v139, v182, v183
    v_cvt_pk_bf16_f32 v140, v184, v185
    v_cvt_pk_bf16_f32 v141, v186, v187
    v_cvt_pk_bf16_f32 v142, v188, v189
    v_cvt_pk_bf16_f32 v143, v190, v191
    v_cvt_pk_bf16_f32 v246, v192, v193
    v_cvt_pk_bf16_f32 v247, v194, v195
    v_cvt_pk_bf16_f32 v248, v196, v197
    v_cvt_pk_bf16_f32 v249, v198, v199
    v_cvt_pk_bf16_f32 v250, v200, v201
    v_cvt_pk_bf16_f32 v251, v202, v203
    v_cvt_pk_bf16_f32 v252, v204, v205
    v_cvt_pk_bf16_f32 v253, v206, v207
    s_lshl_b32 s64, s52, 2
    s_add_u32 s64, s64, s54
    s_lshl_b32 s64, s64, 3
    s_add_u32 s64, s64, s3
    s_lshl_b32 s64, s64, 7
    s_add_u32 s69, s64, 512096
    s_buffer_load_dwordx4 s[92:95], s[44:47], s69 glc
    s_waitcnt lgkmcnt(0)
    s_xor_b32 s92, s92, s55
    s_xor_b32 s93, s93, s55
    s_xor_b32 s94, s94, s55
    s_xor_b32 s95, s95, s55
    s_or_b64 s[92:93], s[92:93], s[94:95]
    s_cbranch_scc1 L_pslow_104
L_pback_105:
    ds_read_b64_tr_b16 v[208:209], v232 offset:54272
    ds_read_b64_tr_b16 v[210:211], v232 offset:56320
    ds_read_b64_tr_b16 v[212:213], v232 offset:58368
    ds_read_b64_tr_b16 v[214:215], v232 offset:60416
    ds_read_b64_tr_b16 v[216:217], v233 offset:54272
    ds_read_b64_tr_b16 v[218:219], v233 offset:56320
    ds_read_b64_tr_b16 v[220:221], v233 offset:58368
    ds_read_b64_tr_b16 v[222:223], v233 offset:60416
    s_waitcnt vmcnt(0)
    s_barrier
    s_add_u32 s68, s63, 0
    buffer_store_dwordx4 v[136:139], v254, s[44:47], s68 offen sc1
    s_add_u32 s68, s63, 8192
    buffer_store_dwordx4 v[140:143], v254, s[44:47], s68 offen sc1
    s_add_u32 s68, s63, 16384
    buffer_store_dwordx4 v[246:249], v254, s[44:47], s68 offen sc1
    s_add_u32 s68, s63, 24576
    buffer_store_dwordx4 v[250:253], v254, s[44:47], s68 offen sc1
    s_add_u32 s68, s63, 65536
    buffer_store_dwordx4 v[132:135], v254, s[44:47], s68 offen sc1
    s_barrier
    s_waitcnt lgkmcnt(4)
    v_mfma_f32_16x16x32_bf16 v[176:179], v[208:211], v[144:147], 0
    ds_read_b64_tr_b16 v[224:225], v232 offset:55296
    v_mfma_f32_16x16x32_bf16 v[176:179], v[212:215], v[152:155], v[176:179]
    ds_read_b64_tr_b16 v[226:227], v232 offset:57344
    v_mfma_f32_16x16x32_bf16 v[184:187], v[212:215], v[156:159], 0
    ds_read_b64_tr_b16 v[228:229], v232 offset:59392
    v_mfma_f32_16x16x32_bf16 v[184:187], v[208:211], v[148:151], v[184:187]
    ds_read_b64_tr_b16 v[230:231], v232 offset:61440
    s_waitcnt lgkmcnt(4)
    v_mfma_f32_16x16x32_bf16 v[180:183], v[216:219], v[144:147], 0
    ds_read_b64_tr_b16 v[208:209], v233 offset:55296
    v_mfma_f32_16x16x32_bf16 v[180:183], v[220:223], v[152:155], v[180:183]
    ds_read_b64_tr_b16 v[210:211], v233 offset:57344
    v_mfma_f32_16x16x32_bf16 v[188:191], v[220:223], v[156:159], 0
    ds_read_b64_tr_b16 v[212:213], v233 offset:59392
    v_mfma_f32_16x16x32_bf16 v[188:191], v[216:219], v[148:151], v[188:191]
    ds_read_b64_tr_b16 v[214:215], v233 offset:61440
    s_waitcnt lgkmcnt(4)
    v_mfma_f32_16x16x32_bf16 v[192:195], v[224:227], v[144:147], 0
    ds_read_b64_tr_b16 v[216:217], v232 offset:62464
    v_mfma_f32_16x16x32_bf16 v[192:195], v[228:231], v[152:155], v[192:195]
    ds_read_b64_tr_b16 v[218:219], v232 offset:64512
    v_mfma_f32_16x16x32_bf16 v[200:203], v[228:231], v[156:159], 0
    v_add_u32 v232, 0x0000e400, v232
    ds_read_b64_tr_b16 v[220:221], v232 offset:8192
    v_mfma_f32_16x16x32_bf16 v[200:203], v[224:227], v[148:151], v[200:203]
    ds_read_b64_tr_b16 v[222:223], v232 offset:10240
    s_waitcnt lgkmcnt(4)
    v_mfma_f32_16x16x32_bf16 v[196:199], v[208:211], v[144:147], 0
    ds_read_b64_tr_b16 v[224:225], v233 offset:62464
    v_mfma_f32_16x16x32_bf16 v[196:199], v[212:215], v[152:155], v[196:199]
    ds_read_b64_tr_b16 v[226:227], v233 offset:64512
    v_mfma_f32_16x16x32_bf16 v[204:207], v[212:215], v[156:159], 0
    v_add_u32 v233, 0x0000e400, v233
    ds_read_b64_tr_b16 v[228:229], v233 offset:8192
    v_mfma_f32_16x16x32_bf16 v[204:207], v[208:211], v[148:151], v[204:207]
    ds_read_b64_tr_b16 v[230:231], v233 offset:10240
    s_waitcnt lgkmcnt(4)
    v_mfma_f32_16x16x32_bf16 v[176:179], v[216:219], v[160:163], v[176:179]
    ds_read_b64_tr_b16 v[208:209], v232 offset:5120
    v_mfma_f32_16x16x32_bf16 v[176:179], v[220:223], v[168:171], v[176:179]
    ds_read_b64_tr_b16 v[210:211], v232 offset:7168
    v_mfma_f32_16x16x32_bf16 v[184:187], v[220:223], v[172:175], v[184:187]
    ds_read_b64_tr_b16 v[212:213], v232 offset:9216
    v_mfma_f32_16x16x32_bf16 v[184:187], v[216:219], v[164:167], v[184:187]
    ds_read_b64_tr_b16 v[214:215], v232 offset:11264
    s_waitcnt lgkmcnt(4)
    v_mfma_f32_16x16x32_bf16 v[180:183], v[224:227], v[160:163], v[180:183]
    ds_read_b64_tr_b16 v[216:217], v233 offset:5120
    v_mfma_f32_16x16x32_bf16 v[180:183], v[228:231], v[168:171], v[180:183]
    ds_read_b64_tr_b16 v[218:219], v233 offset:7168
    v_mfma_f32_16x16x32_bf16 v[188:191], v[228:231], v[172:175], v[188:191]
    ds_read_b64_tr_b16 v[220:221], v233 offset:9216
    v_mfma_f32_16x16x32_bf16 v[188:191], v[224:227], v[164:167], v[188:191]
    ds_read_b64_tr_b16 v[222:223], v233 offset:11264
    s_waitcnt lgkmcnt(4)
    v_mfma_f32_16x16x32_bf16 v[192:195], v[208:211], v[160:163], v[192:195]
    ds_read_b64_tr_b16 v[224:225], v232 offset:12288
    v_mfma_f32_16x16x32_bf16 v[192:195], v[212:215], v[168:171], v[192:195]
    ds_read_b64_tr_b16 v[226:227], v232 offset:14336
    v_mfma_f32_16x16x32_bf16 v[200:203], v[212:215], v[172:175], v[200:203]
    ds_read_b64_tr_b16 v[228:229], v232 offset:16384
    v_mfma_f32_16x16x32_bf16 v[200:203], v[208:211], v[164:167], v[200:203]
    ds_read_b64_tr_b16 v[230:231], v232 offset:18432
    s_waitcnt lgkmcnt(4)
    v_mfma_f32_16x16x32_bf16 v[196:199], v[216:219], v[160:163], v[196:199]
    ds_read_b64_tr_b16 v[208:209], v233 offset:12288
    v_mfma_f32_16x16x32_bf16 v[196:199], v[220:223], v[168:171], v[196:199]
    ds_read_b64_tr_b16 v[210:211], v233 offset:14336
    v_mfma_f32_16x16x32_bf16 v[204:207], v[220:223], v[172:175], v[204:207]
    ds_read_b64_tr_b16 v[212:213], v233 offset:16384
    v_mfma_f32_16x16x32_bf16 v[204:207], v[216:219], v[164:167], v[204:207]
    ds_read_b64_tr_b16 v[214:215], v233 offset:18432
    s_waitcnt lgkmcnt(4)
    v_mfma_f32_16x16x32_bf16 v[176:179], v[224:227], v[0:3], v[176:179]
    ds_read_b64_tr_b16 v[216:217], v232 offset:13312
    v_mfma_f32_16x16x32_bf16 v[176:179], v[228:231], v[8:11], v[176:179]
    ds_read_b64_tr_b16 v[218:219], v232 offset:15360
    v_mfma_f32_16x16x32_bf16 v[184:187], v[228:231], v[12:15], v[184:187]
    ds_read_b64_tr_b16 v[220:221], v232 offset:17408
    v_mfma_f32_16x16x32_bf16 v[184:187], v[224:227], v[4:7], v[184:187]
    ds_read_b64_tr_b16 v[222:223], v232 offset:19456
    s_waitcnt lgkmcnt(4)
    v_mfma_f32_16x16x32_bf16 v[180:183], v[208:211], v[0:3], v[180:183]
    ds_read_b64_tr_b16 v[224:225], v233 offset:13312
    v_mfma_f32_16x16x32_bf16 v[180:183], v[212:215], v[8:11], v[180:183]
    ds_read_b64_tr_b16 v[226:227], v233 offset:15360
    v_mfma_f32_16x16x32_bf16 v[188:191], v[212:215], v[12:15], v[188:191]
    ds_read_b64_tr_b16 v[228:229], v233 offset:17408
    v_mfma_f32_16x16x32_bf16 v[188:191], v[208:211], v[4:7], v[188:191]
    ds_read_b64_tr_b16 v[230:231], v233 offset:19456
    s_waitcnt lgkmcnt(4)
    v_mfma_f32_16x16x32_bf16 v[192:195], v[216:219], v[0:3], v[192:195]
    ds_read_b64_tr_b16 v[208:209], v232 offset:20480
    v_mfma_f32_16x16x32_bf16 v[192:195], v[220:223], v[8:11], v[192:195]
    ds_read_b64_tr_b16 v[210:211], v232 offset:22528
    v_mfma_f32_16x16x32_bf16 v[200:203], v[220:223], v[12:15], v[200:203]
    ds_read_b64_tr_b16 v[212:213], v232 offset:24576
    v_mfma_f32_16x16x32_bf16 v[200:203], v[216:219], v[4:7], v[200:203]
    ds_read_b64_tr_b16 v[214:215], v232 offset:26624
    s_cmp_eq_u32 s48, s3
    s_cbranch_scc1 L_own_108
L_ownb_109:
    s_waitcnt lgkmcnt(4)
    v_mfma_f32_16x16x32_bf16 v[196:199], v[224:227], v[0:3], v[196:199]
    ds_read_b64_tr_b16 v[216:217], v233 offset:20480
    v_mfma_f32_16x16x32_bf16 v[196:199], v[228:231], v[8:11], v[196:199]
    ds_read_b64_tr_b16 v[218:219], v233 offset:22528
    v_mfma_f32_16x16x32_bf16 v[204:207], v[228:231], v[12:15], v[204:207]
    ds_read_b64_tr_b16 v[220:221], v233 offset:24576
    v_mfma_f32_16x16x32_bf16 v[204:207], v[224:227], v[4:7], v[204:207]
    ds_read_b64_tr_b16 v[222:223], v233 offset:26624
    s_waitcnt lgkmcnt(4)
    v_mfma_f32_16x16x32_bf16 v[176:179], v[208:211], v[16:19], v[176:179]
    ds_read_b64_tr_b16 v[224:225], v232 offset:21504
    v_mfma_f32_16x16x32_bf16 v[176:179], v[212:215], v[24:27], v[176:179]
    ds_read_b64_tr_b16 v[226:227], v232 offset:23552
    v_mfma_f32_16x16x32_bf16 v[184:187], v[212:215], v[28:31], v[184:187]
    ds_read_b64_tr_b16 v[228:229], v232 offset:25600
    v_mfma_f32_16x16x32_bf16 v[184:187], v[208:211], v[20:23], v[184:187]
    ds_read_b64_tr_b16 v[230:231], v232 offset:27648
    s_cmp_eq_u32 s48, s3
    s_cbranch_scc1 L_own_110
L_ownb_111:
    s_waitcnt lgkmcnt(4)
    v_mfma_f32_16x16x32_bf16 v[180:183], v[216:219], v[16:19], v[180:183]
    ds_read_b64_tr_b16 v[208:209], v233 offset:21504
    v_mfma_f32_16x16x32_bf16 v[180:183], v[220:223], v[24:27], v[180:183]
    ds_read_b64_tr_b16 v[210:211], v233 offset:23552
    v_mfma_f32_16x16x32_bf16 v[188:191], v[220:223], v[28:31], v[188:191]
    ds_read_b64_tr_b16 v[212:213], v233 offset:25600
    v_mfma_f32_16x16x32_bf16 v[188:191], v[216:219], v[20:23], v[188:191]
    ds_read_b64_tr_b16 v[214:215], v233 offset:27648
    s_waitcnt lgkmcnt(4)
    v_mfma_f32_16x16x32_bf16 v[192:195], v[224:227], v[16:19], v[192:195]
    ds_read_b64_tr_b16 v[216:217], v232 offset:28672
    v_mfma_f32_16x16x32_bf16 v[192:195], v[228:231], v[24:27], v[192:195]
    ds_read_b64_tr_b16 v[218:219], v232 offset:30720
    v_mfma_f32_16x16x32_bf16 v[200:203], v[228:231], v[28:31], v[200:203]
    ds_read_b64_tr_b16 v[220:221], v232 offset:32768
    v_mfma_f32_16x16x32_bf16 v[200:203], v[224:227], v[20:23], v[200:203]
    ds_read_b64_tr_b16 v[222:223], v232 offset:34816
    s_cmp_eq_u32 s48, s3
    s_cbranch_scc1 L_own_112
L_ownb_113:
    s_waitcnt lgkmcnt(4)
    v_mfma_f32_16x16x32_bf16 v[196:199], v[208:211], v[16:19], v[196:199]
    ds_read_b64_tr_b16 v[224:225], v233 offset:28672
    v_mfma_f32_16x16x32_bf16 v[196:199], v[212:215], v[24:27], v[196:199]
    ds_read_b64_tr_b16 v[226:227], v233 offset:30720
    v_mfma_f32_16x16x32_bf16 v[204:207], v[212:215], v[28:31], v[204:207]
    ds_read_b64_tr_b16 v[228:229], v233 offset:32768
    v_mfma_f32_16x16x32_bf16 v[204:207], v[208:211], v[20:23], v[204:207]
    ds_read_b64_tr_b16 v[230:231], v233 offset:34816
    s_waitcnt lgkmcnt(4)
    v_mfma_f32_16x16x32_bf16 v[176:179], v[216:219], v[32:35], v[176:179]
    ds_read_b64_tr_b16 v[208:209], v232 offset:29696
    v_mfma_f32_16x16x32_bf16 v[176:179], v[220:223], v[40:43], v[176:179]
    ds_read_b64_tr_b16 v[210:211], v232 offset:31744
    v_mfma_f32_16x16x32_bf16 v[184:187], v[220:223], v[44:47], v[184:187]
    ds_read_b64_tr_b16 v[212:213], v232 offset:33792
    v_mfma_f32_16x16x32_bf16 v[184:187], v[216:219], v[36:39], v[184:187]
    ds_read_b64_tr_b16 v[214:215], v232 offset:35840
    s_cmp_eq_u32 s48, s3
    s_cbranch_scc1 L_own_114
L_ownb_115:
    s_waitcnt lgkmcnt(4)
    v_mfma_f32_16x16x32_bf16 v[180:183], v[224:227], v[32:35], v[180:183]
    ds_read_b64_tr_b16 v[216:217], v233 offset:29696
    v_mfma_f32_16x16x32_bf16 v[180:183], v[228:231], v[40:43], v[180:183]
    ds_read_b64_tr_b16 v[218:219], v233 offset:31744
    v_mfma_f32_16x16x32_bf16 v[188:191], v[228:231], v[44:47], v[188:191]
    ds_read_b64_tr_b16 v[220:221], v233 offset:33792
    v_mfma_f32_16x16x32_bf16 v[188:191], v[224:227], v[36:39], v[188:191]
    ds_read_b64_tr_b16 v[222:223], v233 offset:35840
    s_waitcnt lgkmcnt(4)
    v_mfma_f32_16x16x32_bf16 v[192:195], v[208:211], v[32:35], v[192:195]
    ds_read_b64_tr_b16 v[224:225], v232 offset:36864
    v_mfma_f32_16x16x32_bf16 v[192:195], v[212:215], v[40:43], v[192:195]
    ds_read_b64_tr_b16 v[226:227], v232 offset:38912
    v_mfma_f32_16x16x32_bf16 v[200:203], v[212:215], v[44:47], v[200:203]
    ds_read_b64_tr_b16 v[228:229], v232 offset:40960
    v_mfma_f32_16x16x32_bf16 v[200:203], v[208:211], v[36:39], v[200:203]
    ds_read_b64_tr_b16 v[230:231], v232 offset:43008
    s_cmp_eq_u32 s48, s3
    s_cbranch_scc1 L_own_116
L_ownb_117:
    s_waitcnt lgkmcnt(4)
    v_mfma_f32_16x16x32_bf16 v[196:199], v[216:219], v[32:35], v[196:199]
    ds_read_b64_tr_b16 v[208:209], v233 offset:36864
    v_mfma_f32_16x16x32_bf16 v[196:199], v[220:223], v[40:43], v[196:199]
    ds_read_b64_tr_b16 v[210:211], v233 offset:38912
    v_mfma_f32_16x16x32_bf16 v[204:207], v[220:223], v[44:47], v[204:207]
    ds_read_b64_tr_b16 v[212:213], v233 offset:40960
    v_mfma_f32_16x16x32_bf16 v[204:207], v[216:219], v[36:39], v[204:207]
    ds_read_b64_tr_b16 v[214:215], v233 offset:43008
    s_waitcnt lgkmcnt(4)
    v_mfma_f32_16x16x32_bf16 v[176:179], v[224:227], v[48:51], v[176:179]
    ds_read_b64_tr_b16 v[216:217], v232 offset:37888
    v_mfma_f32_16x16x32_bf16 v[176:179], v[228:231], v[56:59], v[176:179]
    ds_read_b64_tr_b16 v[218:219], v232 offset:39936
    v_mfma_f32_16x16x32_bf16 v[184:187], v[228:231], v[60:63], v[184:187]
    ds_read_b64_tr_b16 v[220:221], v232 offset:41984
    v_mfma_f32_16x16x32_bf16 v[184:187], v[224:227], v[52:55], v[184:187]
    ds_read_b64_tr_b16 v[222:223], v232 offset:44032
    s_waitcnt lgkmcnt(4)
    v_mfma_f32_16x16x32_bf16 v[180:183], v[208:211], v[48:51], v[180:183]
    ds_read_b64_tr_b16 v[224:225], v233 offset:37888
    v_mfma_f32_16x16x32_bf16 v[180:183], v[212:215], v[56:59], v[180:183]
    ds_read_b64_tr_b16 v[226:227], v233 offset:39936
    v_mfma_f32_16x16x32_bf16 v[188:191], v[212:215], v[60:63], v[188:191]
    ds_read_b64_tr_b16 v[228:229], v233 offset:41984
    v_mfma_f32_16x16x32_bf16 v[188:191], v[208:211], v[52:55], v[188:191]
    ds_read_b64_tr_b16 v[230:231], v233 offset:44032
    s_waitcnt lgkmcnt(4)
    v_mfma_f32_16x16x32_bf16 v[192:195], v[216:219], v[48:51], v[192:195]
    s_barrier
    v_mfma_f32_16x16x32_bf16 v[192:195], v[220:223], v[56:59], v[192:195]
    v_add_u32 v232, 0xfffe3800, v232
    ds_read_b64_tr_b16 v[208:209], v232 offset:1024
    v_mfma_f32_16x16x32_bf16 v[200:203], v[220:223], v[60:63], v[200:203]
    ds_read_b64_tr_b16 v[210:211], v232 offset:3072
    v_mfma_f32_16x16x32_bf16 v[200:203], v[216:219], v[52:55], v[200:203]
    ds_read_b64_tr_b16 v[212:213], v232 offset:5120
    ds_read_b64_tr_b16 v[214:215], v232 offset:7168
    s_waitcnt lgkmcnt(4)
    v_mfma_f32_16x16x32_bf16 v[196:199], v[224:227], v[48:51], v[196:199]
    v_add_u32 v233, 0xfffe3800, v233
    ds_read_b64_tr_b16 v[216:217], v233 offset:1024
    v_mfma_f32_16x16x32_bf16 v[196:199], v[228:231], v[56:59], v[196:199]
    ds_read_b64_tr_b16 v[218:219], v233 offset:3072
    v_mfma_f32_16x16x32_bf16 v[204:207], v[228:231], v[60:63], v[204:207]
    ds_read_b64_tr_b16 v[220:221], v233 offset:5120
    v_mfma_f32_16x16x32_bf16 v[204:207], v[224:227], v[52:55], v[204:207]
    ds_read_b64_tr_b16 v[222:223], v233 offset:7168
    s_waitcnt lgkmcnt(4)
    v_mfma_f32_16x16x32_bf16 v[176:179], v[208:211], v[64:67], v[176:179]
    ds_read_b64_tr_b16 v[224:225], v232 offset:2048
    v_mfma_f32_16x16x32_bf16 v[176:179], v[212:215], v[72:75], v[176:179]
    ds_read_b64_tr_b16 v[226:227], v232 offset:4096
    v_mfma_f32_16x16x32_bf16 v[184:187], v[212:215], v[76:79], v[184:187]
    ds_read_b64_tr_b16 v[228:229], v232 offset:6144
    v_mfma_f32_16x16x32_bf16 v[184:187], v[208:211], v[68:71], v[184:187]
    ds_read_b64_tr_b16 v[230:231], v232 offset:8192
    s_waitcnt lgkmcnt(4)
    v_mfma_f32_16x16x32_bf16 v[180:183], v[216:219], v[64:67], v[180:183]
    ds_read_b64_tr_b16 v[208:209], v233 offset:2048
    v_mfma_f32_16x16x32_bf16 v[180:183], v[220:223], v[72:75], v[180:183]
    ds_read_b64_tr_b16 v[210:211], v233 offset:4096
    v_mfma_f32_16x16x32_bf16 v[188:191], v[220:223], v[76:79], v[188:191]
    ds_read_b64_tr_b16 v[212:213], v233 offset:6144
    v_mfma_f32_16x16x32_bf16 v[188:191], v[216:219], v[68:71], v[188:191]
    ds_read_b64_tr_b16 v[214:215], v233 offset:8192
    s_waitcnt lgkmcnt(4)
    v_mfma_f32_16x16x32_bf16 v[192:195], v[224:227], v[64:67], v[192:195]
    v_add_u32 v232, 0x00012800, v232
    ds_read_b64_tr_b16 v[216:217], v232 offset:8704
    v_mfma_f32_16x16x32_bf16 v[192:195], v[228:231], v[72:75], v[192:195]
    v_add_u32 v233, 0x00012800, v233
    ds_read_b64_tr_b16 v[220:221], v233 offset:8704
    v_mfma_f32_16x16x32_bf16 v[200:203], v[228:231], v[76:79], v[200:203]
    v_mfma_f32_16x16x32_bf16 v[200:203], v[224:227], v[68:71], v[200:203]
    s_waitcnt lgkmcnt(2)
    v_mfma_f32_16x16x32_bf16 v[196:199], v[208:211], v[64:67], v[196:199]
    ds_read_b64_tr_b16 v[224:225], v232 offset:9728
    v_mfma_f32_16x16x32_bf16 v[196:199], v[212:215], v[72:75], v[196:199]
    ds_read_b64_tr_b16 v[228:229], v233 offset:9728
    v_mfma_f32_16x16x32_bf16 v[204:207], v[212:215], v[76:79], v[204:207]
    v_mfma_f32_16x16x32_bf16 v[204:207], v[208:211], v[68:71], v[204:207]
    s_waitcnt lgkmcnt(3)
    v_mfma_f32_16x16x16_bf16 v[176:179], v[216:217], v[80:81], v[176:179]
    v_add_u32 v232, 0xfffedc00, v232
    ds_read_b64_tr_b16 v[208:209], v232 offset:8192
    v_mfma_f32_16x16x16_bf16 v[184:187], v[216:217], v[82:83], v[184:187]
    ds_read_b64_tr_b16 v[210:211], v232 offset:10240
    ds_read_b64_tr_b16 v[212:213], v232 offset:12288
    ds_read_b64_tr_b16 v[214:215], v232 offset:14336
    s_waitcnt lgkmcnt(6)
    v_mfma_f32_16x16x16_bf16 v[180:183], v[220:221], v[80:81], v[180:183]
    v_add_u32 v233, 0xfffedc00, v233
    ds_read_b64_tr_b16 v[216:217], v233 offset:8192
    v_mfma_f32_16x16x16_bf16 v[188:191], v[220:221], v[82:83], v[188:191]
    ds_read_b64_tr_b16 v[218:219], v233 offset:10240
    s_waitcnt lgkmcnt(7)
    v_mfma_f32_16x16x16_bf16 v[192:195], v[224:225], v[80:81], v[192:195]
    ds_read_b64_tr_b16 v[220:221], v233 offset:12288
    v_mfma_f32_16x16x16_bf16 v[200:203], v[224:225], v[82:83], v[200:203]
    ds_read_b64_tr_b16 v[222:223], v233 offset:14336
    s_waitcnt lgkmcnt(8)
    v_mfma_f32_16x16x16_bf16 v[196:199], v[228:229], v[80:81], v[196:199]
    ds_read_b64_tr_b16 v[224:225], v232 offset:9216
    v_mfma_f32_16x16x16_bf16 v[204:207], v[228:229], v[82:83], v[204:207]
    ds_read_b64_tr_b16 v[226:227], v232 offset:11264
    s_waitcnt lgkmcnt(6)
    v_mfma_f32_16x16x32_bf16 v[176:179], v[208:211], v[84:87], v[176:179]
    ds_read_b64_tr_b16 v[228:229], v232 offset:13312
    v_mfma_f32_16x16x32_bf16 v[176:179], v[212:215], v[92:95], v[176:179]
    ds_read_b64_tr_b16 v[230:231], v232 offset:15360
    v_mfma_f32_16x16x32_bf16 v[184:187], v[212:215], v[96:99], v[184:187]
    v_mfma_f32_16x16x32_bf16 v[184:187], v[208:211], v[88:91], v[184:187]
    s_waitcnt lgkmcnt(4)
    v_mfma_f32_16x16x32_bf16 v[180:183], v[216:219], v[84:87], v[180:183]
    ds_read_b64_tr_b16 v[208:209], v233 offset:9216
    v_mfma_f32_16x16x32_bf16 v[180:183], v[220:223], v[92:95], v[180:183]
    ds_read_b64_tr_b16 v[210:211], v233 offset:11264
    v_mfma_f32_16x16x32_bf16 v[188:191], v[220:223], v[96:99], v[188:191]
    ds_read_b64_tr_b16 v[212:213], v233 offset:13312
    v_mfma_f32_16x16x32_bf16 v[188:191], v[216:219], v[88:91], v[188:191]
    ds_read_b64_tr_b16 v[214:215], v233 offset:15360
    s_waitcnt lgkmcnt(4)
    v_mfma_f32_16x16x32_bf16 v[192:195], v[224:227], v[84:87], v[192:195]
    ds_read_b64_tr_b16 v[216:217], v232 offset:16384
    v_mfma_f32_16x16x32_bf16 v[192:195], v[228:231], v[92:95], v[192:195]
    ds_read_b64_tr_b16 v[218:219], v232 offset:18432
    v_mfma_f32_16x16x32_bf16 v[200:203], v[228:231], v[96:99], v[200:203]
    ds_read_b64_tr_b16 v[220:221], v232 offset:20480
    v_mfma_f32_16x16x32_bf16 v[200:203], v[224:227], v[88:91], v[200:203]
    ds_read_b64_tr_b16 v[222:223], v232 offset:22528
    s_waitcnt lgkmcnt(4)
    v_mfma_f32_16x16x32_bf16 v[196:199], v[208:211], v[84:87], v[196:199]
    ds_read_b64_tr_b16 v[224:225], v233 offset:16384
    v_mfma_f32_16x16x32_bf16 v[196:199], v[212:215], v[92:95], v[196:199]
    ds_read_b64_tr_b16 v[226:227], v233 offset:18432
    v_mfma_f32_16x16x32_bf16 v[204:207], v[212:215], v[96:99], v[204:207]
    ds_read_b64_tr_b16 v[228:229], v233 offset:20480
    v_mfma_f32_16x16x32_bf16 v[204:207], v[208:211], v[88:91], v[204:207]
    ds_read_b64_tr_b16 v[230:231], v233 offset:22528
    s_waitcnt lgkmcnt(4)
    v_mfma_f32_16x16x32_bf16 v[176:179], v[216:219], v[100:103], v[176:179]
    ds_read_b64_tr_b16 v[208:209], v232 offset:17408
    v_mfma_f32_16x16x32_bf16 v[176:179], v[220:223], v[108:111], v[176:179]
    ds_read_b64_tr_b16 v[210:211], v232 offset:19456
    v_mfma_f32_16x16x32_bf16 v[184:187], v[220:223], v[112:115], v[184:187]
    ds_read_b64_tr_b16 v[212:213], v232 offset:21504
    v_mfma_f32_16x16x32_bf16 v[184:187], v[216:219], v[104:107], v[184:187]
    ds_read_b64_tr_b16 v[214:215], v232 offset:23552
    s_waitcnt lgkmcnt(4)
    v_mfma_f32_16x16x32_bf16 v[180:183], v[224:227], v[100:103], v[180:183]
    ds_read_b64_tr_b16 v[216:217], v233 offset:17408
    v_mfma_f32_16x16x32_bf16 v[180:183], v[228:231], v[108:111], v[180:183]
    ds_read_b64_tr_b16 v[218:219], v233 offset:19456
    v_mfma_f32_16x16x32_bf16 v[188:191], v[228:231], v[112:115], v[188:191]
    ds_read_b64_tr_b16 v[220:221], v233 offset:21504
    v_mfma_f32_16x16x32_bf16 v[188:191], v[224:227], v[104:107], v[188:191]
    ds_read_b64_tr_b16 v[222:223], v233 offset:23552
    s_waitcnt lgkmcnt(4)
    v_mfma_f32_16x16x32_bf16 v[192:195], v[208:211], v[100:103], v[192:195]
    ds_read_b64_tr_b16 v[224:225], v232 offset:24576
    v_mfma_f32_16x16x32_bf16 v[192:195], v[212:215], v[108:111], v[192:195]
    ds_read_b64_tr_b16 v[226:227], v232 offset:26624
    v_mfma_f32_16x16x32_bf16 v[200:203], v[212:215], v[112:115], v[200:203]
    ds_read_b64_tr_b16 v[228:229], v232 offset:28672
    v_mfma_f32_16x16x32_bf16 v[200:203], v[208:211], v[104:107], v[200:203]
    ds_read_b64_tr_b16 v[230:231], v232 offset:30720
    s_waitcnt lgkmcnt(4)
    v_mfma_f32_16x16x32_bf16 v[196:199], v[216:219], v[100:103], v[196:199]
    ds_read_b64_tr_b16 v[208:209], v233 offset:24576
    v_mfma_f32_16x16x32_bf16 v[196:199], v[220:223], v[108:111], v[196:199]
    ds_read_b64_tr_b16 v[210:211], v233 offset:26624
    v_mfma_f32_16x16x32_bf16 v[204:207], v[220:223], v[112:115], v[204:207]
    ds_read_b64_tr_b16 v[212:213], v233 offset:28672
    v_mfma_f32_16x16x32_bf16 v[204:207], v[216:219], v[104:107], v[204:207]
    ds_read_b64_tr_b16 v[214:215], v233 offset:30720
    s_waitcnt lgkmcnt(4)
    v_mfma_f32_16x16x32_bf16 v[176:179], v[224:227], v[116:119], v[176:179]
    ds_read_b64_tr_b16 v[216:217], v232 offset:25600
    v_mfma_f32_16x16x32_bf16 v[176:179], v[228:231], v[124:127], v[176:179]
    ds_read_b64_tr_b16 v[218:219], v232 offset:27648
    v_mfma_f32_16x16x32_bf16 v[184:187], v[228:231], v[128:131], v[184:187]
    ds_read_b64_tr_b16 v[220:221], v232 offset:29696
    v_mfma_f32_16x16x32_bf16 v[184:187], v[224:227], v[120:123], v[184:187]
    ds_read_b64_tr_b16 v[222:223], v232 offset:31744
    s_waitcnt lgkmcnt(4)
    v_mfma_f32_16x16x32_bf16 v[180:183], v[208:211], v[116:119], v[180:183]
    ds_read_b64_tr_b16 v[224:225], v233 offset:25600
    v_mfma_f32_16x16x32_bf16 v[180:183], v[212:215], v[124:127], v[180:183]
    ds_read_b64_tr_b16 v[226:227], v233 offset:27648
    v_mfma_f32_16x16x32_bf16 v[188:191], v[212:215], v[128:131], v[188:191]
    ds_read_b64_tr_b16 v[228:229], v233 offset:29696
    v_mfma_f32_16x16x32_bf16 v[188:191], v[208:211], v[120:123], v[188:191]
    ds_read_b64_tr_b16 v[230:231], v233 offset:31744
    s_waitcnt lgkmcnt(4)
    v_mfma_f32_16x16x32_bf16 v[192:195], v[216:219], v[116:119], v[192:195]
    v_mfma_f32_16x16x32_bf16 v[192:195], v[220:223], v[124:127], v[192:195]
    v_mfma_f32_16x16x32_bf16 v[200:203], v[220:223], v[128:131], v[200:203]
    v_mfma_f32_16x16x32_bf16 v[200:203], v[216:219], v[120:123], v[200:203]
    s_waitcnt lgkmcnt(0)
    v_mfma_f32_16x16x32_bf16 v[196:199], v[224:227], v[116:119], v[196:199]
    v_mfma_f32_16x16x32_bf16 v[196:199], v[228:231], v[124:127], v[196:199]
    v_mfma_f32_16x16x32_bf16 v[204:207], v[228:231], v[128:131], v[204:207]
    v_mfma_f32_16x16x32_bf16 v[204:207], v[224:227], v[120:123], v[204:207]
    s_waitcnt vmcnt(0)
    s_waitcnt lgkmcnt(0)
    s_buffer_atomic_swap s55, s[44:47], s42 offset:0
    v_cvt_pk_bf16_f32 v246, v176, v177
    v_cvt_pk_bf16_f32 v247, v178, v179
    v_cvt_pk_bf16_f32 v248, v180, v181
    v_cvt_pk_bf16_f32 v249, v182, v183
    s_add_u32 s68, s63, 32768
    buffer_store_dwordx4 v[246:249], v254, s[44:47], s68 offen sc1
    s_cmp_eq_u32 s48, s3
    s_cbranch_scc1 L_own_118
L_ownb_119:
    v_cvt_pk_bf16_f32 v250, v184, v185
    v_cvt_pk_bf16_f32 v251, v186, v187
    v_cvt_pk_bf16_f32 v252, v188, v189
    v_cvt_pk_bf16_f32 v253, v190, v191
    s_add_u32 s68, s63, 40960
    buffer_store_dwordx4 v[250:253], v254, s[44:47], s68 offen sc1
    s_cmp_eq_u32 s48, s3
    s_cbranch_scc1 L_own_120
L_ownb_121:
    v_cvt_pk_bf16_f32 v246, v192, v193
    v_cvt_pk_bf16_f32 v247, v194, v195
    v_cvt_pk_bf16_f32 v248, v196, v197
    v_cvt_pk_bf16_f32 v249, v198, v199
    s_add_u32 s68, s63, 49152
    buffer_store_dwordx4 v[246:249], v254, s[44:47], s68 offen sc1
    s_cmp_eq_u32 s48, s3
    s_cbranch_scc1 L_own_122
L_ownb_123:
    v_cvt_pk_bf16_f32 v250, v200, v201
    v_cvt_pk_bf16_f32 v251, v202, v203
    v_cvt_pk_bf16_f32 v252, v204, v205
    v_cvt_pk_bf16_f32 v253, v206, v207
    s_add_u32 s68, s63, 57344
    buffer_store_dwordx4 v[250:253], v254, s[44:47], s68 offen sc1
    s_cmp_eq_u32 s48, s3
    s_cbranch_scc1 L_own_124
L_ownb_125:
    s_lshl_b32 s59, s52, 2
    s_add_u32 s59, s59, s54
    s_lshl_b32 s59, s59, 3
    s_mov_b32 s56, s49
    s_lshl_b32 s64, s52, 3
    s_add_u32 s64, s64, s3
    s_lshl_b32 s64, s64, 1
    s_and_b32 s65, s56, 1
    s_add_u32 s64, s64, s65
    s_mul_i32 s64, s64, 18432
    s_lshr_b32 s65, s56, 1
    s_lshl_b32 s66, s54, 2
    s_add_u32 s65, s65, s66
    s_lshl_b32 s66, s65, 10
    s_add_u32 s66, s66, s64
    s_add_u32 s66, s66, 11534336
    buffer_load_dwordx4 v[32:35], v254, s[44:47], s66 offen sc1
    s_lshl_b32 s65, s65, 6
    s_add_u32 s57, s65, s64
    v_and_b32 v41, 15, v255
    v_mul_u32_u24 v40, 1152, v41
    v_lshrrev_b32 v41, 4, v255
    v_lshl_add_u32 v42, v41, 3, v40
    v_lshrrev_b32 v42, 1, v41
    v_lshl_add_u32 v40, v42, 4, v40
    v_and_b32 v41, 1, v41
    v_mul_u32_u24 v41, 32, v41
    v_add_u32 v40, v40, v41
    s_add_u32 s64, s59, s3
    s_lshl_b32 s69, s64, 7
    s_add_u32 s69, s69, 512000
    s_mul_i32 s68, s64, 73728
    s_lshl_b32 s65, s56, 13
    s_add_u32 s68, s68, s65
    s_add_u32 s68, s68, 33554432
    s_add_u32 s67, s68, 4096
    s_buffer_load_dwordx8 s[92:99], s[44:47], s69 glc
    s_add_u32 s64, s53, 1
    s_and_b32 s64, s64, 7
    s_lshl_b32 s64, s64, 10
    s_add_u32 s9, s64, s68
    s_add_u32 s64, s53, 2
    s_and_b32 s64, s64, 7
    s_lshl_b32 s64, s64, 10
    s_add_u32 s10, s64, s68
    s_add_u32 s64, s53, 3
    s_and_b32 s64, s64, 7
    s_lshl_b32 s64, s64, 10
    s_add_u32 s11, s64, s68
    s_add_u32 s64, s53, 4
    s_and_b32 s64, s64, 7
    s_lshl_b32 s64, s64, 10
    s_add_u32 s12, s64, s68
    s_add_u32 s64, s53, 5
    s_and_b32 s64, s64, 7
    s_lshl_b32 s64, s64, 10
    s_add_u32 s13, s64, s68
    s_add_u32 s64, s53, 6
    s_and_b32 s64, s64, 7
    s_lshl_b32 s64, s64, 10
    s_add_u32 s14, s64, s68
    s_add_u32 s64, s53, 7
    s_and_b32 s64, s64, 7
    s_lshl_b32 s64, s64, 10
    s_add_u32 s15, s64, s68
    s_cmp_ge_u32 s56, 7
    s_cselect_b32 s65, 0, 0
    s_lshl_b32 s64, s56, 10
    s_add_u32 s64, s64, 40960
    s_add_u32 s64, s64, s65
    v_add_u32 v43, s64, v254
    s_waitcnt lgkmcnt(0)
    s_xor_b32 s92, s92, s55
    s_xor_b32 s93, s93, s55
    s_xor_b32 s94, s94, s55
    s_xor_b32 s95, s95, s55
    s_xor_b32 s96, s96, s55
    s_xor_b32 s97, s97, s55
    s_xor_b32 s98, s98, s55
    s_xor_b32 s99, s99, s55
    s_or_b64 s[92:93], s[92:93], s[98:99]
    s_or_b64 s[92:93], s[92:93], s[96:97]
    s_or_b64 s[92:93], s[92:93], s[94:95]
    s_cbranch_scc1 L_pslow_126
L_pback_127:
    buffer_load_dwordx4 v[4:7], v254, s[44:47], s9 offen sc1
    buffer_load_dwordx4 v[8:11], v254, s[44:47], s10 offen sc1
    buffer_load_dwordx4 v[12:15], v254, s[44:47], s11 offen sc1
    buffer_load_dwordx4 v[16:19], v254, s[44:47], s12 offen sc1
    buffer_load_dwordx4 v[20:23], v254, s[44:47], s13 offen sc1
    buffer_load_dwordx4 v[24:27], v254, s[44:47], s14 offen sc1
    buffer_load_dwordx4 v[28:31], v254, s[44:47], s15 offen sc1
    ds_read_b128 v[0:3], v43
    s_waitcnt vmcnt(8)
    s_waitcnt lgkmcnt(0)
    s_buffer_atomic_swap s55, s[44:47], s42 offset:32
    s_buffer_atomic_swap s55, s[44:47], s42 offset:64
    s_waitcnt vmcnt(7)
    v_lshlrev_b32 v44, 16, v32
    v_and_b32 v45, 0xffff0000, v32
    v_lshlrev_b32 v46, 16, v33
    v_and_b32 v47, 0xffff0000, v33
    v_lshlrev_b32 v48, 16, v34
    v_and_b32 v49, 0xffff0000, v34
    v_lshlrev_b32 v50, 16, v35
    v_and_b32 v51, 0xffff0000, v35
    v_lshlrev_b32 v52, 16, v0
    v_and_b32 v0, 0xffff0000, v0
    v_lshlrev_b32 v53, 16, v1
    v_and_b32 v1, 0xffff0000, v1
    v_lshlrev_b32 v54, 16, v2
    v_and_b32 v2, 0xffff0000, v2
    v_lshlrev_b32 v55, 16, v3
    v_and_b32 v3, 0xffff0000, v3
    v_add_f32 v44, v44, v52
    v_add_f32 v45, v45, v0
    v_add_f32 v46, v46, v53
    v_add_f32 v47, v47, v1
    v_add_f32 v48, v48, v54
    v_add_f32 v49, v49, v2
    v_add_f32 v50, v50, v55
    v_add_f32 v51, v51, v3
    s_waitcnt vmcnt(6)
    v_lshlrev_b32 v52, 16, v4
    v_and_b32 v4, 0xffff0000, v4
    v_lshlrev_b32 v53, 16, v5
    v_and_b32 v5, 0xffff0000, v5
    v_lshlrev_b32 v54, 16, v6
    v_and_b32 v6, 0xffff0000, v6
    v_lshlrev_b32 v55, 16, v7
    v_and_b32 v7, 0xffff0000, v7
    v_add_f32 v44, v44, v52
    v_add_f32 v45, v45, v4
    v_add_f32 v46, v46, v53
    v_add_f32 v47, v47, v5
    v_add_f32 v48, v48, v54
    v_add_f32 v49, v49, v6
    v_add_f32 v50, v50, v55
    v_add_f32 v51, v51, v7
    s_waitcnt vmcnt(5)
    v_lshlrev_b32 v52, 16, v8
    v_and_b32 v8, 0xffff0000, v8
    v_lshlrev_b32 v53, 16, v9
    v_and_b32 v9, 0xffff0000, v9
    v_lshlrev_b32 v54, 16, v10
    v_and_b32 v10, 0xffff0000, v10
    v_lshlrev_b32 v55, 16, v11
    v_and_b32 v11, 0xffff0000, v11
    v_add_f32 v44, v44, v52
    v_add_f32 v45, v45, v8
    v_add_f32 v46, v46, v53
    v_add_f32 v47, v47, v9
    v_add_f32 v48, v48, v54
    v_add_f32 v49, v49, v10
    v_add_f32 v50, v50, v55
    v_add_f32 v51, v51, v11
    s_waitcnt vmcnt(4)
    v_lshlrev_b32 v52, 16, v12
    v_and_b32 v12, 0xffff0000, v12
    v_lshlrev_b32 v53, 16, v13
    v_and_b32 v13, 0xffff0000, v13
    v_lshlrev_b32 v54, 16, v14
    v_and_b32 v14, 0xffff0000, v14
    v_lshlrev_b32 v55, 16, v15
    v_and_b32 v15, 0xffff0000, v15
    v_add_f32 v44, v44, v52
    v_add_f32 v45, v45, v12
    v_add_f32 v46, v46, v53
    v_add_f32 v47, v47, v13
    v_add_f32 v48, v48, v54
    v_add_f32 v49, v49, v14
    v_add_f32 v50, v50, v55
    v_add_f32 v51, v51, v15
    s_waitcnt vmcnt(3)
    v_lshlrev_b32 v52, 16, v16
    v_and_b32 v16, 0xffff0000, v16
    v_lshlrev_b32 v53, 16, v17
    v_and_b32 v17, 0xffff0000, v17
    v_lshlrev_b32 v54, 16, v18
    v_and_b32 v18, 0xffff0000, v18
    v_lshlrev_b32 v55, 16, v19
    v_and_b32 v19, 0xffff0000, v19
    v_add_f32 v44, v44, v52
    v_add_f32 v45, v45, v16
    v_add_f32 v46, v46, v53
    v_add_f32 v47, v47, v17
    v_add_f32 v48, v48, v54
    v_add_f32 v49, v49, v18
    v_add_f32 v50, v50, v55
    v_add_f32 v51, v51, v19
    s_waitcnt vmcnt(2)
    v_lshlrev_b32 v52, 16, v20
    v_and_b32 v20, 0xffff0000, v20
    v_lshlrev_b32 v53, 16, v21
    v_and_b32 v21, 0xffff0000, v21
    v_lshlrev_b32 v54, 16, v22
    v_and_b32 v22, 0xffff0000, v22
    v_lshlrev_b32 v55, 16, v23
    v_and_b32 v23, 0xffff0000, v23
    v_add_f32 v44, v44, v52
    v_add_f32 v45, v45, v20
    v_add_f32 v46, v46, v53
    v_add_f32 v47, v47, v21
    v_add_f32 v48, v48, v54
    v_add_f32 v49, v49, v22
    v_add_f32 v50, v50, v55
    v_add_f32 v51, v51, v23
    s_waitcnt vmcnt(1)
    v_lshlrev_b32 v52, 16, v24
    v_and_b32 v24, 0xffff0000, v24
    v_lshlrev_b32 v53, 16, v25
    v_and_b32 v25, 0xffff0000, v25
    v_lshlrev_b32 v54, 16, v26
    v_and_b32 v26, 0xffff0000, v26
    v_lshlrev_b32 v55, 16, v27
    v_and_b32 v27, 0xffff0000, v27
    v_add_f32 v44, v44, v52
    v_add_f32 v45, v45, v24
    v_add_f32 v46, v46, v53
    v_add_f32 v47, v47, v25
    v_add_f32 v48, v48, v54
    v_add_f32 v49, v49, v26
    v_add_f32 v50, v50, v55
    v_add_f32 v51, v51, v27
    s_waitcnt vmcnt(0)
    v_lshlrev_b32 v52, 16, v28
    v_and_b32 v28, 0xffff0000, v28
    v_lshlrev_b32 v53, 16, v29
    v_and_b32 v29, 0xffff0000, v29
    v_lshlrev_b32 v54, 16, v30
    v_and_b32 v30, 0xffff0000, v30
    v_lshlrev_b32 v55, 16, v31
    v_and_b32 v31, 0xffff0000, v31
    v_add_f32 v44, v44, v52
    v_add_f32 v45, v45, v28
    v_add_f32 v46, v46, v53
    v_add_f32 v47, v47, v29
    v_add_f32 v48, v48, v54
    v_add_f32 v49, v49, v30
    v_add_f32 v50, v50, v55
    v_add_f32 v51, v51, v31
    v_cvt_pk_bf16_f32 v56, v44, v45
    v_cvt_pk_bf16_f32 v57, v46, v47
    v_cvt_pk_bf16_f32 v58, v48, v49
    v_cvt_pk_bf16_f32 v59, v50, v51
    s_nop 0
    v_permlane16_swap_b32 v56, v58
    v_permlane16_swap_b32 v57, v59
    buffer_store_dwordx4 v[56:59], v40, s[36:39], s57 offen sc1
    s_add_u32 s56, s49, 4
    s_cmp_lt_u32 s49, 2
    s_cselect_b32 s58, 32, 64
    s_lshl_b32 s64, s52, 3
    s_add_u32 s64, s64, s3
    s_lshl_b32 s64, s64, 1
    s_and_b32 s65, s56, 1
    s_add_u32 s64, s64, s65
    s_mul_i32 s64, s64, 18432
    s_lshr_b32 s65, s56, 1
    s_lshl_b32 s66, s54, 2
    s_add_u32 s65, s65, s66
    s_lshl_b32 s66, s65, 10
    s_add_u32 s66, s66, s64
    s_add_u32 s66, s66, 11534336
    buffer_load_dwordx4 v[32:35], v254, s[44:47], s66 offen sc1
    s_lshl_b32 s65, s65, 6
    s_add_u32 s57, s65, s64
    v_and_b32 v41, 15, v255
    v_mul_u32_u24 v40, 1152, v41
    v_lshrrev_b32 v41, 4, v255
    v_lshl_add_u32 v42, v41, 3, v40
    v_lshrrev_b32 v42, 1, v41
    v_lshl_add_u32 v40, v42, 4, v40
    v_and_b32 v41, 1, v41
    v_mul_u32_u24 v41, 32, v41
    v_add_u32 v40, v40, v41
    s_add_u32 s64, s59, s3
    s_lshl_b32 s69, s64, 7
    s_add_u32 s69, s69, 512000
    s_add_u32 s69, s69, s58
    s_mul_i32 s68, s64, 73728
    s_lshl_b32 s65, s56, 13
    s_add_u32 s68, s68, s65
    s_add_u32 s68, s68, 33554432
    s_add_u32 s67, s68, 4096
    s_buffer_load_dwordx8 s[92:99], s[44:47], s69 glc
    s_add_u32 s64, s53, 1
    s_and_b32 s64, s64, 7
    s_lshl_b32 s64, s64, 10
    s_add_u32 s9, s64, s68
    s_add_u32 s64, s53, 2
    s_and_b32 s64, s64, 7
    s_lshl_b32 s64, s64, 10
    s_add_u32 s10, s64, s68
    s_add_u32 s64, s53, 3
    s_and_b32 s64, s64, 7
    s_lshl_b32 s64, s64, 10
    s_add_u32 s11, s64, s68
    s_add_u32 s64, s53, 4
    s_and_b32 s64, s64, 7
    s_lshl_b32 s64, s64, 10
    s_add_u32 s12, s64, s68
    s_add_u32 s64, s53, 5
    s_and_b32 s64, s64, 7
    s_lshl_b32 s64, s64, 10
    s_add_u32 s13, s64, s68
    s_add_u32 s64, s53, 6
    s_and_b32 s64, s64, 7
    s_lshl_b32 s64, s64, 10
    s_add_u32 s14, s64, s68
    s_add_u32 s64, s53, 7
    s_and_b32 s64, s64, 7
    s_lshl_b32 s64, s64, 10
    s_add_u32 s15, s64, s68
    s_cmp_ge_u32 s56, 7
    s_cselect_b32 s65, 0, 0
    s_lshl_b32 s64, s56, 10
    s_add_u32 s64, s64, 40960
    s_add_u32 s64, s64, s65
    v_add_u32 v43, s64, v254
    s_waitcnt lgkmcnt(0)
    s_xor_b32 s92, s92, s55
    s_xor_b32 s93, s93, s55
    s_xor_b32 s94, s94, s55
    s_xor_b32 s95, s95, s55
    s_xor_b32 s96, s96, s55
    s_xor_b32 s97, s97, s55
    s_xor_b32 s98, s98, s55
    s_xor_b32 s99, s99, s55
    s_or_b64 s[92:93], s[92:93], s[98:99]
    s_or_b64 s[92:93], s[92:93], s[96:97]
    s_or_b64 s[92:93], s[92:93], s[94:95]
    s_cbranch_scc1 L_pslow_130
L_pback_131:
    buffer_load_dwordx4 v[4:7], v254, s[44:47], s9 offen sc1
    buffer_load_dwordx4 v[8:11], v254, s[44:47], s10 offen sc1
    buffer_load_dwordx4 v[12:15], v254, s[44:47], s11 offen sc1
    buffer_load_dwordx4 v[16:19], v254, s[44:47], s12 offen sc1
    buffer_load_dwordx4 v[20:23], v254, s[44:47], s13 offen sc1
    buffer_load_dwordx4 v[24:27], v254, s[44:47], s14 offen sc1
    buffer_load_dwordx4 v[28:31], v254, s[44:47], s15 offen sc1
    ds_read_b128 v[0:3], v43
    s_waitcnt vmcnt(7)
    v_lshlrev_b32 v44, 16, v32
    v_and_b32 v45, 0xffff0000, v32
    v_lshlrev_b32 v46, 16, v33
    v_and_b32 v47, 0xffff0000, v33
    v_lshlrev_b32 v48, 16, v34
    v_and_b32 v49, 0xffff0000, v34
    v_lshlrev_b32 v50, 16, v35
    v_and_b32 v51, 0xffff0000, v35
    s_waitcnt lgkmcnt(0)
    v_lshlrev_b32 v52, 16, v0
    v_and_b32 v0, 0xffff0000, v0
    v_lshlrev_b32 v53, 16, v1
    v_and_b32 v1, 0xffff0000, v1
    v_lshlrev_b32 v54, 16, v2
    v_and_b32 v2, 0xffff0000, v2
    v_lshlrev_b32 v55, 16, v3
    v_and_b32 v3, 0xffff0000, v3
    v_add_f32 v44, v44, v52
    v_add_f32 v45, v45, v0
    v_add_f32 v46, v46, v53
    v_add_f32 v47, v47, v1
    v_add_f32 v48, v48, v54
    v_add_f32 v49, v49, v2
    v_add_f32 v50, v50, v55
    v_add_f32 v51, v51, v3
    s_waitcnt vmcnt(6)
    v_lshlrev_b32 v52, 16, v4
    v_and_b32 v4, 0xffff0000, v4
    v_lshlrev_b32 v53, 16, v5
    v_and_b32 v5, 0xffff0000, v5
    v_lshlrev_b32 v54, 16, v6
    v_and_b32 v6, 0xffff0000, v6
    v_lshlrev_b32 v55, 16, v7
    v_and_b32 v7, 0xffff0000, v7
    v_add_f32 v44, v44, v52
    v_add_f32 v45, v45, v4
    v_add_f32 v46, v46, v53
    v_add_f32 v47, v47, v5
    v_add_f32 v48, v48, v54
    v_add_f32 v49, v49, v6
    v_add_f32 v50, v50, v55
    v_add_f32 v51, v51, v7
    s_waitcnt vmcnt(5)
    v_lshlrev_b32 v52, 16, v8
    v_and_b32 v8, 0xffff0000, v8
    v_lshlrev_b32 v53, 16, v9
    v_and_b32 v9, 0xffff0000, v9
    v_lshlrev_b32 v54, 16, v10
    v_and_b32 v10, 0xffff0000, v10
    v_lshlrev_b32 v55, 16, v11
    v_and_b32 v11, 0xffff0000, v11
    v_add_f32 v44, v44, v52
    v_add_f32 v45, v45, v8
    v_add_f32 v46, v46, v53
    v_add_f32 v47, v47, v9
    v_add_f32 v48, v48, v54
    v_add_f32 v49, v49, v10
    v_add_f32 v50, v50, v55
    v_add_f32 v51, v51, v11
    s_waitcnt vmcnt(4)
    v_lshlrev_b32 v52, 16, v12
    v_and_b32 v12, 0xffff0000, v12
    v_lshlrev_b32 v53, 16, v13
    v_and_b32 v13, 0xffff0000, v13
    v_lshlrev_b32 v54, 16, v14
    v_and_b32 v14, 0xffff0000, v14
    v_lshlrev_b32 v55, 16, v15
    v_and_b32 v15, 0xffff0000, v15
    v_add_f32 v44, v44, v52
    v_add_f32 v45, v45, v12
    v_add_f32 v46, v46, v53
    v_add_f32 v47, v47, v13
    v_add_f32 v48, v48, v54
    v_add_f32 v49, v49, v14
    v_add_f32 v50, v50, v55
    v_add_f32 v51, v51, v15
    s_waitcnt vmcnt(3)
    v_lshlrev_b32 v52, 16, v16
    v_and_b32 v16, 0xffff0000, v16
    v_lshlrev_b32 v53, 16, v17
    v_and_b32 v17, 0xffff0000, v17
    v_lshlrev_b32 v54, 16, v18
    v_and_b32 v18, 0xffff0000, v18
    v_lshlrev_b32 v55, 16, v19
    v_and_b32 v19, 0xffff0000, v19
    v_add_f32 v44, v44, v52
    v_add_f32 v45, v45, v16
    v_add_f32 v46, v46, v53
    v_add_f32 v47, v47, v17
    v_add_f32 v48, v48, v54
    v_add_f32 v49, v49, v18
    v_add_f32 v50, v50, v55
    v_add_f32 v51, v51, v19
    s_waitcnt vmcnt(2)
    v_lshlrev_b32 v52, 16, v20
    v_and_b32 v20, 0xffff0000, v20
    v_lshlrev_b32 v53, 16, v21
    v_and_b32 v21, 0xffff0000, v21
    v_lshlrev_b32 v54, 16, v22
    v_and_b32 v22, 0xffff0000, v22
    v_lshlrev_b32 v55, 16, v23
    v_and_b32 v23, 0xffff0000, v23
    v_add_f32 v44, v44, v52
    v_add_f32 v45, v45, v20
    v_add_f32 v46, v46, v53
    v_add_f32 v47, v47, v21
    v_add_f32 v48, v48, v54
    v_add_f32 v49, v49, v22
    v_add_f32 v50, v50, v55
    v_add_f32 v51, v51, v23
    s_waitcnt vmcnt(1)
    v_lshlrev_b32 v52, 16, v24
    v_and_b32 v24, 0xffff0000, v24
    v_lshlrev_b32 v53, 16, v25
    v_and_b32 v25, 0xffff0000, v25
    v_lshlrev_b32 v54, 16, v26
    v_and_b32 v26, 0xffff0000, v26
    v_lshlrev_b32 v55, 16, v27
    v_and_b32 v27, 0xffff0000, v27
    v_add_f32 v44, v44, v52
    v_add_f32 v45, v45, v24
    v_add_f32 v46, v46, v53
    v_add_f32 v47, v47, v25
    v_add_f32 v48, v48, v54
    v_add_f32 v49, v49, v26
    v_add_f32 v50, v50, v55
    v_add_f32 v51, v51, v27
    s_waitcnt vmcnt(0)
    v_lshlrev_b32 v52, 16, v28
    v_and_b32 v28, 0xffff0000, v28
    v_lshlrev_b32 v53, 16, v29
    v_and_b32 v29, 0xffff0000, v29
    v_lshlrev_b32 v54, 16, v30
    v_and_b32 v30, 0xffff0000, v30
    v_lshlrev_b32 v55, 16, v31
    v_and_b32 v31, 0xffff0000, v31
    v_add_f32 v44, v44, v52
    v_add_f32 v45, v45, v28
    v_add_f32 v46, v46, v53
    v_add_f32 v47, v47, v29
    v_add_f32 v48, v48, v54
    v_add_f32 v49, v49, v30
    v_add_f32 v50, v50, v55
    v_add_f32 v51, v51, v31
    v_cvt_pk_bf16_f32 v56, v44, v45
    v_cvt_pk_bf16_f32 v57, v46, v47
    v_cvt_pk_bf16_f32 v58, v48, v49
    v_cvt_pk_bf16_f32 v59, v50, v51
    s_nop 0
    v_permlane16_swap_b32 v56, v58
    v_permlane16_swap_b32 v57, v59
    buffer_store_dwordx4 v[56:59], v40, s[36:39], s57 offen sc1
    s_endpgm
L_SY:
    ds_read_b64_tr_b16 v[208:209], v234 offset:2048
    ds_read_b64_tr_b16 v[210:211], v234 offset:4608
    ds_read_b64_tr_b16 v[212:213], v234 offset:7168
    ds_read_b64_tr_b16 v[214:215], v234 offset:9728
    ds_read_b64_tr_b16 v[216:217], v232 offset:0
    ds_read_b64_tr_b16 v[218:219], v232 offset:2560
    ds_read_b64_tr_b16 v[220:221], v232 offset:5120
    ds_read_b64_tr_b16 v[222:223], v232 offset:7680
    ds_read_b64_tr_b16 v[224:225], v233 offset:0
    ds_read_b64_tr_b16 v[226:227], v233 offset:2560
    ds_read_b64_tr_b16 v[228:229], v233 offset:5120
    ds_read_b64_tr_b16 v[230:231], v233 offset:7680
    s_waitcnt vmcnt(12)
    v_add_f32 v144, v144, v145
    v_add_f32 v146, v146, v147
    v_add_f32 v152, v144, v146
    v_add_f32 v144, v144, v146
    s_nop 1
    v_permlane32_swap_b32 v144, v152
    v_mov_b32 v148, v144
    v_mov_b32 v156, v152
    s_nop 0
    v_permlane16_swap_b32 v144, v148
    v_permlane16_swap_b32 v152, v156
    v_mul_f32 v147, 0xbae38e39, v144
    v_mul_f32 v145, 0x3ae38e39, v148
    v_fma_f32 v145, -v147, v147, v145
    v_max_f32 v145, 0, v145
    v_add_f32 v145, 0x3727c5ac, v145
    v_rsq_f32 v146, v145
    v_mul_f32 v155, 0xbae38e39, v152
    v_mul_f32 v153, 0x3ae38e39, v156
    v_fma_f32 v153, -v155, v155, v153
    v_max_f32 v153, 0, v153
    v_add_f32 v153, 0x3727c5ac, v153
    v_rsq_f32 v154, v153
    v_rcp_f32 v240, v146
    v_mul_f32 v239, v146, v146
    v_mul_f32 v238, 0xc0135761, v146
    v_mul_f32 v239, 0x3d372713, v239
    v_mul_f32 v239, v239, v238
    v_rcp_f32 v244, v154
    v_mul_f32 v243, v154, v154
    v_mul_f32 v242, 0xc0135761, v154
    v_mul_f32 v243, 0x3d372713, v243
    v_mul_f32 v243, v243, v242
    s_cmp_lt_u32 s51, 16
    s_cbranch_scc1 L_rol_134
L_rolb_135:
    s_waitcnt lgkmcnt(8)
    s_waitcnt vmcnt(11)
    v_mfma_f32_16x16x32_bf16 v[168:171], v[208:211], v[0:3], 0
    ds_read_b64_tr_b16 v[160:161], v232 offset:1024
    s_waitcnt vmcnt(9)
    v_mfma_f32_16x16x32_bf16 v[168:171], v[212:215], v[8:11], v[168:171]
    ds_read_b64_tr_b16 v[162:163], v232 offset:3584
    s_waitcnt vmcnt(8)
    v_mfma_f32_16x16x32_bf16 v[172:175], v[212:215], v[12:15], 0
    ds_read_b64_tr_b16 v[164:165], v232 offset:6144
    v_mfma_f32_16x16x32_bf16 v[172:175], v[208:211], v[4:7], v[172:175]
    ds_read_b64_tr_b16 v[166:167], v232 offset:8704
    buffer_load_dwordx4 v[48:51], v254, s[44:47], s95 offen offset:0 sc1
    s_waitcnt lgkmcnt(8)
    v_mfma_f32_16x16x32_bf16 v[176:179], v[216:219], v[0:3], 0
    ds_read_b64_tr_b16 v[208:209], v233 offset:1024
    v_mfma_f32_16x16x32_bf16 v[176:179], v[220:223], v[8:11], v[176:179]
    ds_read_b64_tr_b16 v[210:211], v233 offset:3584
    v_mfma_f32_16x16x32_bf16 v[184:187], v[220:223], v[12:15], 0
    ds_read_b64_tr_b16 v[212:213], v233 offset:6144
    v_mfma_f32_16x16x32_bf16 v[184:187], v[216:219], v[4:7], v[184:187]
    ds_read_b64_tr_b16 v[214:215], v233 offset:8704
    buffer_load_dwordx4 v[52:55], v251, s[44:47], s95 offen offset:0 sc1
    s_waitcnt lgkmcnt(8)
    v_mfma_f32_16x16x32_bf16 v[180:183], v[224:227], v[0:3], 0
    ds_read_b64_tr_b16 v[216:217], v234 offset:12288
    v_mfma_f32_16x16x32_bf16 v[180:183], v[228:231], v[8:11], v[180:183]
    ds_read_b64_tr_b16 v[218:219], v234 offset:14848
    v_mfma_f32_16x16x32_bf16 v[188:191], v[228:231], v[12:15], 0
    ds_read_b64_tr_b16 v[220:221], v234 offset:17408
    v_mfma_f32_16x16x32_bf16 v[188:191], v[224:227], v[4:7], v[188:191]
    ds_read_b64_tr_b16 v[222:223], v234 offset:19968
    s_waitcnt lgkmcnt(8)
    v_mfma_f32_16x16x32_bf16 v[192:195], v[160:163], v[0:3], 0
    ds_read_b64_tr_b16 v[224:225], v232 offset:10240
    v_mfma_f32_16x16x32_bf16 v[192:195], v[164:167], v[8:11], v[192:195]
    ds_read_b64_tr_b16 v[226:227], v232 offset:12800
    v_mfma_f32_16x16x32_bf16 v[200:203], v[164:167], v[12:15], 0
    ds_read_b64_tr_b16 v[228:229], v232 offset:15360
    v_mfma_f32_16x16x32_bf16 v[200:203], v[160:163], v[4:7], v[200:203]
    ds_read_b64_tr_b16 v[230:231], v232 offset:17920
    buffer_load_dwordx4 v[56:59], v254, s[44:47], s95 offen offset:1024 sc1
    s_waitcnt lgkmcnt(8)
    v_mfma_f32_16x16x32_bf16 v[196:199], v[208:211], v[0:3], 0
    ds_read_b64_tr_b16 v[160:161], v233 offset:10240
    v_mfma_f32_16x16x32_bf16 v[196:199], v[212:215], v[8:11], v[196:199]
    ds_read_b64_tr_b16 v[162:163], v233 offset:12800
    v_mfma_f32_16x16x32_bf16 v[204:207], v[212:215], v[12:15], 0
    ds_read_b64_tr_b16 v[164:165], v233 offset:15360
    v_mfma_f32_16x16x32_bf16 v[204:207], v[208:211], v[4:7], v[204:207]
    ds_read_b64_tr_b16 v[166:167], v233 offset:17920
    buffer_load_dwordx4 v[60:63], v251, s[44:47], s95 offen offset:1024 sc1
    s_waitcnt lgkmcnt(8)
    s_waitcnt vmcnt(11)
    v_mfma_f32_16x16x32_bf16 v[168:171], v[216:219], v[16:19], v[168:171]
    ds_read_b64_tr_b16 v[208:209], v232 offset:11264
    s_waitcnt vmcnt(9)
    v_mfma_f32_16x16x32_bf16 v[168:171], v[220:223], v[24:27], v[168:171]
    ds_read_b64_tr_b16 v[210:211], v232 offset:13824
    s_waitcnt vmcnt(8)
    v_mfma_f32_16x16x32_bf16 v[172:175], v[220:223], v[28:31], v[172:175]
    ds_read_b64_tr_b16 v[212:213], v232 offset:16384
    v_mfma_f32_16x16x32_bf16 v[172:175], v[216:219], v[20:23], v[172:175]
    ds_read_b64_tr_b16 v[214:215], v232 offset:18944
    buffer_load_dwordx4 v[64:67], v254, s[44:47], s96 offen offset:0 sc1
    s_waitcnt lgkmcnt(8)
    v_mfma_f32_16x16x32_bf16 v[176:179], v[224:227], v[16:19], v[176:179]
    ds_read_b64_tr_b16 v[216:217], v233 offset:11264
    v_mfma_f32_16x16x32_bf16 v[176:179], v[228:231], v[24:27], v[176:179]
    ds_read_b64_tr_b16 v[218:219], v233 offset:13824
    v_mfma_f32_16x16x32_bf16 v[184:187], v[228:231], v[28:31], v[184:187]
    ds_read_b64_tr_b16 v[220:221], v233 offset:16384
    v_mfma_f32_16x16x32_bf16 v[184:187], v[224:227], v[20:23], v[184:187]
    ds_read_b64_tr_b16 v[222:223], v233 offset:18944
    buffer_load_dwordx4 v[68:71], v251, s[44:47], s96 offen offset:0 sc1
    s_waitcnt lgkmcnt(8)
    v_mfma_f32_16x16x32_bf16 v[180:183], v[160:163], v[16:19], v[180:183]
    ds_read_b64_tr_b16 v[224:225], v234 offset:22528
    v_mfma_f32_16x16x32_bf16 v[180:183], v[164:167], v[24:27], v[180:183]
    ds_read_b64_tr_b16 v[226:227], v234 offset:25088
    v_mfma_f32_16x16x32_bf16 v[188:191], v[164:167], v[28:31], v[188:191]
    ds_read_b64_tr_b16 v[228:229], v234 offset:27648
    v_mfma_f32_16x16x32_bf16 v[188:191], v[160:163], v[20:23], v[188:191]
    ds_read_b64_tr_b16 v[230:231], v234 offset:30208
    s_waitcnt lgkmcnt(8)
    v_mfma_f32_16x16x32_bf16 v[192:195], v[208:211], v[16:19], v[192:195]
    ds_read_b64_tr_b16 v[160:161], v232 offset:20480
    v_mfma_f32_16x16x32_bf16 v[192:195], v[212:215], v[24:27], v[192:195]
    ds_read_b64_tr_b16 v[162:163], v232 offset:23040
    v_mfma_f32_16x16x32_bf16 v[200:203], v[212:215], v[28:31], v[200:203]
    ds_read_b64_tr_b16 v[164:165], v232 offset:25600
    v_mfma_f32_16x16x32_bf16 v[200:203], v[208:211], v[20:23], v[200:203]
    ds_read_b64_tr_b16 v[166:167], v232 offset:28160
    buffer_load_dwordx4 v[72:75], v254, s[44:47], s96 offen offset:1024 sc1
    s_waitcnt lgkmcnt(8)
    v_mfma_f32_16x16x32_bf16 v[196:199], v[216:219], v[16:19], v[196:199]
    ds_read_b64_tr_b16 v[208:209], v233 offset:20480
    v_mfma_f32_16x16x32_bf16 v[196:199], v[220:223], v[24:27], v[196:199]
    ds_read_b64_tr_b16 v[210:211], v233 offset:23040
    v_mfma_f32_16x16x32_bf16 v[204:207], v[220:223], v[28:31], v[204:207]
    ds_read_b64_tr_b16 v[212:213], v233 offset:25600
    v_mfma_f32_16x16x32_bf16 v[204:207], v[216:219], v[20:23], v[204:207]
    ds_read_b64_tr_b16 v[214:215], v233 offset:28160
    buffer_load_dwordx4 v[76:79], v251, s[44:47], s96 offen offset:1024 sc1
    s_waitcnt lgkmcnt(8)
    s_waitcnt vmcnt(11)
    v_mfma_f32_16x16x32_bf16 v[168:171], v[224:227], v[32:35], v[168:171]
    ds_read_b64_tr_b16 v[216:217], v232 offset:21504
    s_waitcnt vmcnt(9)
    v_mfma_f32_16x16x32_bf16 v[168:171], v[228:231], v[40:43], v[168:171]
    ds_read_b64_tr_b16 v[218:219], v232 offset:24064
    s_waitcnt vmcnt(8)
    v_mfma_f32_16x16x32_bf16 v[172:175], v[228:231], v[44:47], v[172:175]
    ds_read_b64_tr_b16 v[220:221], v232 offset:26624
    v_mfma_f32_16x16x32_bf16 v[172:175], v[224:227], v[36:39], v[172:175]
    ds_read_b64_tr_b16 v[222:223], v232 offset:29184
    buffer_load_dwordx4 v[80:83], v254, s[44:47], s97 offen offset:0 sc1
    s_waitcnt lgkmcnt(8)
    v_mfma_f32_16x16x32_bf16 v[176:179], v[160:163], v[32:35], v[176:179]
    ds_read_b64_tr_b16 v[224:225], v233 offset:21504
    v_mfma_f32_16x16x32_bf16 v[176:179], v[164:167], v[40:43], v[176:179]
    ds_read_b64_tr_b16 v[226:227], v233 offset:24064
    v_mfma_f32_16x16x32_bf16 v[184:187], v[164:167], v[44:47], v[184:187]
    ds_read_b64_tr_b16 v[228:229], v233 offset:26624
    v_mfma_f32_16x16x32_bf16 v[184:187], v[160:163], v[36:39], v[184:187]
    ds_read_b64_tr_b16 v[230:231], v233 offset:29184
    buffer_load_dwordx4 v[84:87], v251, s[44:47], s97 offen offset:0 sc1
    s_waitcnt lgkmcnt(8)
    v_mfma_f32_16x16x32_bf16 v[180:183], v[208:211], v[32:35], v[180:183]
    ds_read_b64_tr_b16 v[160:161], v234 offset:32768
    v_mfma_f32_16x16x32_bf16 v[180:183], v[212:215], v[40:43], v[180:183]
    ds_read_b64_tr_b16 v[162:163], v234 offset:35328
    v_mfma_f32_16x16x32_bf16 v[188:191], v[212:215], v[44:47], v[188:191]
    ds_read_b64_tr_b16 v[164:165], v234 offset:37888
    v_mfma_f32_16x16x32_bf16 v[188:191], v[208:211], v[36:39], v[188:191]
    ds_read_b64_tr_b16 v[166:167], v234 offset:40448
    s_waitcnt lgkmcnt(8)
    v_mfma_f32_16x16x32_bf16 v[192:195], v[216:219], v[32:35], v[192:195]
    ds_read_b64_tr_b16 v[208:209], v232 offset:30720
    v_mfma_f32_16x16x32_bf16 v[192:195], v[220:223], v[40:43], v[192:195]
    ds_read_b64_tr_b16 v[210:211], v232 offset:33280
    v_mfma_f32_16x16x32_bf16 v[200:203], v[220:223], v[44:47], v[200:203]
    ds_read_b64_tr_b16 v[212:213], v232 offset:35840
    v_mfma_f32_16x16x32_bf16 v[200:203], v[216:219], v[36:39], v[200:203]
    ds_read_b64_tr_b16 v[214:215], v232 offset:38400
    buffer_load_dwordx4 v[88:91], v254, s[44:47], s97 offen offset:1024 sc1
    s_waitcnt lgkmcnt(8)
    v_mfma_f32_16x16x32_bf16 v[196:199], v[224:227], v[32:35], v[196:199]
    ds_read_b64_tr_b16 v[216:217], v233 offset:30720
    v_mfma_f32_16x16x32_bf16 v[196:199], v[228:231], v[40:43], v[196:199]
    ds_read_b64_tr_b16 v[218:219], v233 offset:33280
    v_mfma_f32_16x16x32_bf16 v[204:207], v[228:231], v[44:47], v[204:207]
    ds_read_b64_tr_b16 v[220:221], v233 offset:35840
    v_mfma_f32_16x16x32_bf16 v[204:207], v[224:227], v[36:39], v[204:207]
    ds_read_b64_tr_b16 v[222:223], v233 offset:38400
    buffer_load_dwordx4 v[92:95], v251, s[44:47], s97 offen offset:1024 sc1
    s_waitcnt lgkmcnt(8)
    s_waitcnt vmcnt(11)
    v_mfma_f32_16x16x32_bf16 v[168:171], v[160:163], v[48:51], v[168:171]
    ds_read_b64_tr_b16 v[224:225], v232 offset:31744
    s_waitcnt vmcnt(9)
    v_mfma_f32_16x16x32_bf16 v[168:171], v[164:167], v[56:59], v[168:171]
    ds_read_b64_tr_b16 v[226:227], v232 offset:34304
    s_waitcnt vmcnt(8)
    v_mfma_f32_16x16x32_bf16 v[172:175], v[164:167], v[60:63], v[172:175]
    ds_read_b64_tr_b16 v[228:229], v232 offset:36864
    v_mfma_f32_16x16x32_bf16 v[172:175], v[160:163], v[52:55], v[172:175]
    ds_read_b64_tr_b16 v[230:231], v232 offset:39424
    buffer_load_dwordx4 v[96:99], v254, s[44:47], s98 offen offset:0 sc1
    s_waitcnt lgkmcnt(8)
    v_mfma_f32_16x16x32_bf16 v[176:179], v[208:211], v[48:51], v[176:179]
    ds_read_b64_tr_b16 v[160:161], v233 offset:31744
    v_mfma_f32_16x16x32_bf16 v[176:179], v[212:215], v[56:59], v[176:179]
    ds_read_b64_tr_b16 v[162:163], v233 offset:34304
    v_mfma_f32_16x16x32_bf16 v[184:187], v[212:215], v[60:63], v[184:187]
    ds_read_b64_tr_b16 v[164:165], v233 offset:36864
    v_mfma_f32_16x16x32_bf16 v[184:187], v[208:211], v[52:55], v[184:187]
    ds_read_b64_tr_b16 v[166:167], v233 offset:39424
    buffer_load_dwordx4 v[100:103], v251, s[44:47], s98 offen offset:0 sc1
    s_waitcnt lgkmcnt(8)
    v_mfma_f32_16x16x32_bf16 v[180:183], v[216:219], v[48:51], v[180:183]
    ds_read_b64_tr_b16 v[208:209], v234 offset:43008
    v_mfma_f32_16x16x32_bf16 v[180:183], v[220:223], v[56:59], v[180:183]
    ds_read_b64_tr_b16 v[210:211], v234 offset:45568
    v_mfma_f32_16x16x32_bf16 v[188:191], v[220:223], v[60:63], v[188:191]
    ds_read_b64_tr_b16 v[212:213], v234 offset:48128
    v_mfma_f32_16x16x32_bf16 v[188:191], v[216:219], v[52:55], v[188:191]
    ds_read_b64_tr_b16 v[214:215], v234 offset:50688
    s_cmp_ge_u32 s51, 16
    s_cbranch_scc1 L_rol_136
L_rolb_137:
    s_waitcnt lgkmcnt(8)
    v_mfma_f32_16x16x32_bf16 v[192:195], v[224:227], v[48:51], v[192:195]
    ds_read_b64_tr_b16 v[216:217], v232 offset:40960
    v_mfma_f32_16x16x32_bf16 v[192:195], v[228:231], v[56:59], v[192:195]
    ds_read_b64_tr_b16 v[218:219], v232 offset:43520
    v_mfma_f32_16x16x32_bf16 v[200:203], v[228:231], v[60:63], v[200:203]
    ds_read_b64_tr_b16 v[220:221], v232 offset:46080
    v_mfma_f32_16x16x32_bf16 v[200:203], v[224:227], v[52:55], v[200:203]
    ds_read_b64_tr_b16 v[222:223], v232 offset:48640
    buffer_load_dwordx4 v[104:107], v254, s[44:47], s98 offen offset:1024 sc1
    s_waitcnt lgkmcnt(8)
    v_mfma_f32_16x16x32_bf16 v[196:199], v[160:163], v[48:51], v[196:199]
    ds_read_b64_tr_b16 v[224:225], v233 offset:40960
    v_mfma_f32_16x16x32_bf16 v[196:199], v[164:167], v[56:59], v[196:199]
    ds_read_b64_tr_b16 v[226:227], v233 offset:43520
    v_mfma_f32_16x16x32_bf16 v[204:207], v[164:167], v[60:63], v[204:207]
    ds_read_b64_tr_b16 v[228:229], v233 offset:46080
    v_mfma_f32_16x16x32_bf16 v[204:207], v[160:163], v[52:55], v[204:207]
    ds_read_b64_tr_b16 v[230:231], v233 offset:48640
    buffer_load_dwordx4 v[108:111], v251, s[44:47], s98 offen offset:1024 sc1
    s_waitcnt lgkmcnt(8)
    s_waitcnt vmcnt(11)
    v_mfma_f32_16x16x32_bf16 v[168:171], v[208:211], v[64:67], v[168:171]
    ds_read_b64_tr_b16 v[160:161], v232 offset:41984
    s_waitcnt vmcnt(9)
    v_mfma_f32_16x16x32_bf16 v[168:171], v[212:215], v[72:75], v[168:171]
    ds_read_b64_tr_b16 v[162:163], v232 offset:44544
    s_waitcnt vmcnt(8)
    v_mfma_f32_16x16x32_bf16 v[172:175], v[212:215], v[76:79], v[172:175]
    ds_read_b64_tr_b16 v[164:165], v232 offset:47104
    v_mfma_f32_16x16x32_bf16 v[172:175], v[208:211], v[68:71], v[172:175]
    ds_read_b64_tr_b16 v[166:167], v232 offset:49664
    buffer_load_dwordx4 v[112:115], v254, s[44:47], s99 offen offset:0 sc1
    s_waitcnt lgkmcnt(8)
    v_mfma_f32_16x16x32_bf16 v[176:179], v[216:219], v[64:67], v[176:179]
    ds_read_b64_tr_b16 v[208:209], v233 offset:41984
    v_mfma_f32_16x16x32_bf16 v[176:179], v[220:223], v[72:75], v[176:179]
    ds_read_b64_tr_b16 v[210:211], v233 offset:44544
    v_mfma_f32_16x16x32_bf16 v[184:187], v[220:223], v[76:79], v[184:187]
    ds_read_b64_tr_b16 v[212:213], v233 offset:47104
    v_mfma_f32_16x16x32_bf16 v[184:187], v[216:219], v[68:71], v[184:187]
    ds_read_b64_tr_b16 v[214:215], v233 offset:49664
    buffer_load_dwordx4 v[116:119], v251, s[44:47], s99 offen offset:0 sc1
    s_waitcnt lgkmcnt(8)
    v_mfma_f32_16x16x32_bf16 v[180:183], v[224:227], v[64:67], v[180:183]
    ds_read_b64_tr_b16 v[216:217], v234 offset:53248
    v_mfma_f32_16x16x32_bf16 v[180:183], v[228:231], v[72:75], v[180:183]
    ds_read_b64_tr_b16 v[218:219], v234 offset:55808
    v_mfma_f32_16x16x32_bf16 v[188:191], v[228:231], v[76:79], v[188:191]
    ds_read_b64_tr_b16 v[220:221], v234 offset:58368
    v_mfma_f32_16x16x32_bf16 v[188:191], v[224:227], v[68:71], v[188:191]
    ds_read_b64_tr_b16 v[222:223], v234 offset:60928
    s_waitcnt lgkmcnt(8)
    v_mfma_f32_16x16x32_bf16 v[192:195], v[160:163], v[64:67], v[192:195]
    ds_read_b64_tr_b16 v[224:225], v232 offset:51200
    v_mfma_f32_16x16x32_bf16 v[192:195], v[164:167], v[72:75], v[192:195]
    ds_read_b64_tr_b16 v[226:227], v232 offset:53760
    v_mfma_f32_16x16x32_bf16 v[200:203], v[164:167], v[76:79], v[200:203]
    ds_read_b64_tr_b16 v[228:229], v232 offset:56320
    v_mfma_f32_16x16x32_bf16 v[200:203], v[160:163], v[68:71], v[200:203]
    ds_read_b64_tr_b16 v[230:231], v232 offset:58880
    buffer_load_dwordx4 v[120:123], v254, s[44:47], s99 offen offset:1024 sc1
    s_waitcnt lgkmcnt(8)
    v_mfma_f32_16x16x32_bf16 v[196:199], v[208:211], v[64:67], v[196:199]
    ds_read_b64_tr_b16 v[160:161], v233 offset:51200
    v_mfma_f32_16x16x32_bf16 v[196:199], v[212:215], v[72:75], v[196:199]
    ds_read_b64_tr_b16 v[162:163], v233 offset:53760
    v_mfma_f32_16x16x32_bf16 v[204:207], v[212:215], v[76:79], v[204:207]
    ds_read_b64_tr_b16 v[164:165], v233 offset:56320
    v_mfma_f32_16x16x32_bf16 v[204:207], v[208:211], v[68:71], v[204:207]
    ds_read_b64_tr_b16 v[166:167], v233 offset:58880
    buffer_load_dwordx4 v[124:127], v251, s[44:47], s99 offen offset:1024 sc1
    s_waitcnt lgkmcnt(8)
    s_waitcnt vmcnt(11)
    v_mfma_f32_16x16x32_bf16 v[168:171], v[216:219], v[80:83], v[168:171]
    ds_read_b64_tr_b16 v[208:209], v232 offset:52224
    s_waitcnt vmcnt(9)
    v_mfma_f32_16x16x32_bf16 v[168:171], v[220:223], v[88:91], v[168:171]
    ds_read_b64_tr_b16 v[210:211], v232 offset:54784
    s_waitcnt vmcnt(8)
    v_mfma_f32_16x16x32_bf16 v[172:175], v[220:223], v[92:95], v[172:175]
    ds_read_b64_tr_b16 v[212:213], v232 offset:57344
    v_mfma_f32_16x16x32_bf16 v[172:175], v[216:219], v[84:87], v[172:175]
    ds_read_b64_tr_b16 v[214:215], v232 offset:59904
    buffer_load_dwordx2 v[128:129], v252, s[44:47], s60 offen offset:0 sc1
    buffer_load_dwordx2 v[130:131], v252, s[44:47], s60 offen offset:512 sc1
    s_waitcnt lgkmcnt(8)
    v_mfma_f32_16x16x32_bf16 v[176:179], v[224:227], v[80:83], v[176:179]
    ds_read_b64_tr_b16 v[216:217], v233 offset:52224
    v_mfma_f32_16x16x32_bf16 v[176:179], v[228:231], v[88:91], v[176:179]
    ds_read_b64_tr_b16 v[218:219], v233 offset:54784
    v_mfma_f32_16x16x32_bf16 v[184:187], v[228:231], v[92:95], v[184:187]
    ds_read_b64_tr_b16 v[220:221], v233 offset:57344
    v_mfma_f32_16x16x32_bf16 v[184:187], v[224:227], v[84:87], v[184:187]
    ds_read_b64_tr_b16 v[222:223], v233 offset:59904
    buffer_load_dwordx2 v[132:133], v253, s[44:47], s60 offen offset:0 sc1
    buffer_load_dwordx2 v[134:135], v253, s[44:47], s60 offen offset:512 sc1
    s_waitcnt lgkmcnt(8)
    v_mfma_f32_16x16x32_bf16 v[180:183], v[160:163], v[80:83], v[180:183]
    ds_read_b64_tr_b16 v[224:225], v234 offset:63488
    v_mfma_f32_16x16x32_bf16 v[180:183], v[164:167], v[88:91], v[180:183]
    v_add_u32 v234, 0x0000e000, v234
    ds_read_b64_tr_b16 v[226:227], v234 offset:8704
    v_mfma_f32_16x16x32_bf16 v[188:191], v[164:167], v[92:95], v[188:191]
    ds_read_b64_tr_b16 v[228:229], v234 offset:11264
    v_mfma_f32_16x16x32_bf16 v[188:191], v[160:163], v[84:87], v[188:191]
    ds_read_b64_tr_b16 v[230:231], v234 offset:13824
    s_waitcnt lgkmcnt(8)
    v_mfma_f32_16x16x32_bf16 v[192:195], v[208:211], v[80:83], v[192:195]
    ds_read_b64_tr_b16 v[160:161], v232 offset:61440
    v_mfma_f32_16x16x32_bf16 v[192:195], v[212:215], v[88:91], v[192:195]
    ds_read_b64_tr_b16 v[162:163], v232 offset:64000
    v_mfma_f32_16x16x32_bf16 v[200:203], v[212:215], v[92:95], v[200:203]
    v_add_u32 v232, 0x0000e400, v232
    ds_read_b64_tr_b16 v[164:165], v232 offset:8192
    v_mfma_f32_16x16x32_bf16 v[200:203], v[208:211], v[84:87], v[200:203]
    ds_read_b64_tr_b16 v[166:167], v232 offset:10752
    buffer_load_dwordx2 v[136:137], v252, s[44:47], s60 offen offset:1024 sc1
    buffer_load_dwordx2 v[138:139], v252, s[44:47], s60 offen offset:1536 sc1
    s_waitcnt lgkmcnt(8)
    v_mfma_f32_16x16x32_bf16 v[196:199], v[216:219], v[80:83], v[196:199]
    ds_read_b64_tr_b16 v[208:209], v233 offset:61440
    v_mfma_f32_16x16x32_bf16 v[196:199], v[220:223], v[88:91], v[196:199]
    ds_read_b64_tr_b16 v[210:211], v233 offset:64000
    v_mfma_f32_16x16x32_bf16 v[204:207], v[220:223], v[92:95], v[204:207]
    v_add_u32 v233, 0x0000e400, v233
    ds_read_b64_tr_b16 v[212:213], v233 offset:8192
    v_mfma_f32_16x16x32_bf16 v[204:207], v[216:219], v[84:87], v[204:207]
    ds_read_b64_tr_b16 v[214:215], v233 offset:10752
    buffer_load_dwordx2 v[140:141], v253, s[44:47], s60 offen offset:1024 sc1
    buffer_load_dwordx2 v[142:143], v253, s[44:47], s60 offen offset:1536 sc1
    s_waitcnt lgkmcnt(8)
    s_waitcnt vmcnt(15)
    v_mfma_f32_16x16x32_bf16 v[168:171], v[224:227], v[96:99], v[168:171]
    ds_read_b64_tr_b16 v[216:217], v232 offset:4096
    s_waitcnt vmcnt(13)
    v_mfma_f32_16x16x32_bf16 v[168:171], v[228:231], v[104:107], v[168:171]
    ds_read_b64_tr_b16 v[218:219], v232 offset:6656
    s_waitcnt vmcnt(12)
    v_mfma_f32_16x16x32_bf16 v[172:175], v[228:231], v[108:111], v[172:175]
    ds_read_b64_tr_b16 v[220:221], v232 offset:9216
    v_mfma_f32_16x16x32_bf16 v[172:175], v[224:227], v[100:103], v[172:175]
    ds_read_b64_tr_b16 v[222:223], v232 offset:11776
    s_waitcnt lgkmcnt(8)
    v_mfma_f32_16x16x32_bf16 v[176:179], v[160:163], v[96:99], v[176:179]
    ds_read_b64_tr_b16 v[224:225], v233 offset:4096
    v_mfma_f32_16x16x32_bf16 v[176:179], v[164:167], v[104:107], v[176:179]
    ds_read_b64_tr_b16 v[226:227], v233 offset:6656
    v_mfma_f32_16x16x32_bf16 v[184:187], v[164:167], v[108:111], v[184:187]
    ds_read_b64_tr_b16 v[228:229], v233 offset:9216
    v_mfma_f32_16x16x32_bf16 v[184:187], v[160:163], v[100:103], v[184:187]
    ds_read_b64_tr_b16 v[230:231], v233 offset:11776
    s_waitcnt lgkmcnt(8)
    v_mfma_f32_16x16x32_bf16 v[180:183], v[208:211], v[96:99], v[180:183]
    ds_read_b64_tr_b16 v[160:161], v234 offset:16384
    v_mfma_f32_16x16x32_bf16 v[180:183], v[212:215], v[104:107], v[180:183]
    ds_read_b64_tr_b16 v[162:163], v234 offset:18944
    v_mfma_f32_16x16x32_bf16 v[188:191], v[212:215], v[108:111], v[188:191]
    ds_read_b64_tr_b16 v[164:165], v234 offset:21504
    v_mfma_f32_16x16x32_bf16 v[188:191], v[208:211], v[100:103], v[188:191]
    ds_read_b64_tr_b16 v[166:167], v234 offset:24064
    s_waitcnt lgkmcnt(8)
    v_mfma_f32_16x16x32_bf16 v[192:195], v[216:219], v[96:99], v[192:195]
    ds_read_b64_tr_b16 v[208:209], v232 offset:13312
    v_mfma_f32_16x16x32_bf16 v[192:195], v[220:223], v[104:107], v[192:195]
    ds_read_b64_tr_b16 v[210:211], v232 offset:15872
    v_mfma_f32_16x16x32_bf16 v[200:203], v[220:223], v[108:111], v[200:203]
    ds_read_b64_tr_b16 v[212:213], v232 offset:18432
    v_mfma_f32_16x16x32_bf16 v[200:203], v[216:219], v[100:103], v[200:203]
    ds_read_b64_tr_b16 v[214:215], v232 offset:20992
    s_waitcnt lgkmcnt(8)
    v_mfma_f32_16x16x32_bf16 v[196:199], v[224:227], v[96:99], v[196:199]
    ds_read_b64_tr_b16 v[216:217], v233 offset:13312
    v_mfma_f32_16x16x32_bf16 v[196:199], v[228:231], v[104:107], v[196:199]
    ds_read_b64_tr_b16 v[218:219], v233 offset:15872
    v_mfma_f32_16x16x32_bf16 v[204:207], v[228:231], v[108:111], v[204:207]
    ds_read_b64_tr_b16 v[220:221], v233 offset:18432
    v_mfma_f32_16x16x32_bf16 v[204:207], v[224:227], v[100:103], v[204:207]
    ds_read_b64_tr_b16 v[222:223], v233 offset:20992
    s_waitcnt lgkmcnt(8)
    s_waitcnt vmcnt(11)
    v_mfma_f32_16x16x32_bf16 v[168:171], v[160:163], v[112:115], v[168:171]
    ds_read_b64_tr_b16 v[224:225], v232 offset:14336
    s_waitcnt vmcnt(9)
    v_mfma_f32_16x16x32_bf16 v[168:171], v[164:167], v[120:123], v[168:171]
    ds_read_b64_tr_b16 v[226:227], v232 offset:16896
    s_waitcnt vmcnt(8)
    v_mfma_f32_16x16x32_bf16 v[172:175], v[164:167], v[124:127], v[172:175]
    ds_read_b64_tr_b16 v[228:229], v232 offset:19456
    v_mfma_f32_16x16x32_bf16 v[172:175], v[160:163], v[116:119], v[172:175]
    ds_read_b64_tr_b16 v[230:231], v232 offset:22016
    s_waitcnt lgkmcnt(8)
    v_mfma_f32_16x16x32_bf16 v[176:179], v[208:211], v[112:115], v[176:179]
    ds_read_b64_tr_b16 v[160:161], v233 offset:14336
    v_mfma_f32_16x16x32_bf16 v[176:179], v[212:215], v[120:123], v[176:179]
    ds_read_b64_tr_b16 v[162:163], v233 offset:16896
    v_mfma_f32_16x16x32_bf16 v[184:187], v[212:215], v[124:127], v[184:187]
    ds_read_b64_tr_b16 v[164:165], v233 offset:19456
    v_mfma_f32_16x16x32_bf16 v[184:187], v[208:211], v[116:119], v[184:187]
    ds_read_b64_tr_b16 v[166:167], v233 offset:22016
    s_waitcnt lgkmcnt(8)
    v_mfma_f32_16x16x32_bf16 v[180:183], v[216:219], v[112:115], v[180:183]
    ds_read_b64_tr_b16 v[208:209], v234 offset:26624
    v_mfma_f32_16x16x32_bf16 v[180:183], v[220:223], v[120:123], v[180:183]
    ds_read_b64_tr_b16 v[210:211], v234 offset:29184
    v_mfma_f32_16x16x32_bf16 v[188:191], v[220:223], v[124:127], v[188:191]
    ds_read_b64_tr_b16 v[212:213], v234 offset:31744
    v_mfma_f32_16x16x32_bf16 v[188:191], v[216:219], v[116:119], v[188:191]
    ds_read_b64_tr_b16 v[214:215], v234 offset:34304
    s_waitcnt lgkmcnt(8)
    v_mfma_f32_16x16x32_bf16 v[192:195], v[224:227], v[112:115], v[192:195]
    ds_read_b64_tr_b16 v[216:217], v232 offset:23552
    v_mfma_f32_16x16x32_bf16 v[192:195], v[228:231], v[120:123], v[192:195]
    ds_read_b64_tr_b16 v[218:219], v232 offset:26112
    v_mfma_f32_16x16x32_bf16 v[200:203], v[228:231], v[124:127], v[200:203]
    ds_read_b64_tr_b16 v[220:221], v232 offset:28672
    v_mfma_f32_16x16x32_bf16 v[200:203], v[224:227], v[116:119], v[200:203]
    ds_read_b64_tr_b16 v[222:223], v232 offset:31232
    s_waitcnt lgkmcnt(8)
    v_mfma_f32_16x16x32_bf16 v[196:199], v[160:163], v[112:115], v[196:199]
    ds_read_b64_tr_b16 v[224:225], v233 offset:23552
    v_mfma_f32_16x16x32_bf16 v[196:199], v[164:167], v[120:123], v[196:199]
    ds_read_b64_tr_b16 v[226:227], v233 offset:26112
    v_mfma_f32_16x16x32_bf16 v[204:207], v[164:167], v[124:127], v[204:207]
    ds_read_b64_tr_b16 v[228:229], v233 offset:28672
    v_mfma_f32_16x16x32_bf16 v[204:207], v[160:163], v[116:119], v[204:207]
    ds_read_b64_tr_b16 v[230:231], v233 offset:31232
    s_waitcnt lgkmcnt(8)
    s_waitcnt vmcnt(6)
    v_mfma_f32_16x16x32_bf16 v[168:171], v[208:211], v[128:131], v[168:171]
    ds_read_b64_tr_b16 v[160:161], v232 offset:24576
    s_waitcnt vmcnt(2)
    v_mfma_f32_16x16x32_bf16 v[168:171], v[212:215], v[136:139], v[168:171]
    ds_read_b64_tr_b16 v[162:163], v232 offset:27136
    s_waitcnt vmcnt(0)
    v_mfma_f32_16x16x32_bf16 v[172:175], v[212:215], v[140:143], v[172:175]
    ds_read_b64_tr_b16 v[164:165], v232 offset:29696
    v_mfma_f32_16x16x32_bf16 v[172:175], v[208:211], v[132:135], v[172:175]
    ds_read_b64_tr_b16 v[166:167], v232 offset:32256
    s_waitcnt lgkmcnt(8)
    v_mfma_f32_16x16x32_bf16 v[176:179], v[216:219], v[128:131], v[176:179]
    ds_read_b64_tr_b16 v[208:209], v233 offset:24576
    v_mfma_f32_16x16x32_bf16 v[176:179], v[220:223], v[136:139], v[176:179]
    ds_read_b64_tr_b16 v[210:211], v233 offset:27136
    v_mfma_f32_16x16x32_bf16 v[184:187], v[220:223], v[140:143], v[184:187]
    ds_read_b64_tr_b16 v[212:213], v233 offset:29696
    v_mfma_f32_16x16x32_bf16 v[184:187], v[216:219], v[132:135], v[184:187]
    ds_read_b64_tr_b16 v[214:215], v233 offset:32256
    s_waitcnt lgkmcnt(8)
    v_mfma_f32_16x16x32_bf16 v[180:183], v[224:227], v[128:131], v[180:183]
    v_mfma_f32_16x16x32_bf16 v[180:183], v[228:231], v[136:139], v[180:183]
    v_mfma_f32_16x16x32_bf16 v[188:191], v[228:231], v[140:143], v[188:191]
    v_mfma_f32_16x16x32_bf16 v[188:191], v[224:227], v[132:135], v[188:191]
    s_waitcnt lgkmcnt(4)
    v_mfma_f32_16x16x32_bf16 v[192:195], v[160:163], v[128:131], v[192:195]
    v_mfma_f32_16x16x32_bf16 v[192:195], v[164:167], v[136:139], v[192:195]
    v_mfma_f32_16x16x32_bf16 v[200:203], v[164:167], v[140:143], v[200:203]
    v_mfma_f32_16x16x32_bf16 v[200:203], v[160:163], v[132:135], v[200:203]
    s_waitcnt lgkmcnt(0)
    v_mfma_f32_16x16x32_bf16 v[196:199], v[208:211], v[128:131], v[196:199]
    v_mfma_f32_16x16x32_bf16 v[196:199], v[212:215], v[136:139], v[196:199]
    v_mfma_f32_16x16x32_bf16 v[204:207], v[212:215], v[140:143], v[204:207]
    v_mfma_f32_16x16x32_bf16 v[204:207], v[208:211], v[132:135], v[204:207]
    s_barrier
    ds_read_b64_tr_b16 v[208:209], v232 offset:33792
    ds_read_b64_tr_b16 v[210:211], v232 offset:34816
    ds_read_b64_tr_b16 v[212:213], v232 offset:35840
    ds_read_b64_tr_b16 v[214:215], v232 offset:36864
    ds_read_b64_tr_b16 v[216:217], v233 offset:33792
    ds_read_b64_tr_b16 v[218:219], v233 offset:34816
    ds_read_b64_tr_b16 v[220:221], v233 offset:35840
    ds_read_b64_tr_b16 v[222:223], v233 offset:36864
    ds_read_b64_tr_b16 v[224:225], v232 offset:37888
    ds_read_b64_tr_b16 v[226:227], v232 offset:38912
    ds_read_b64_tr_b16 v[228:229], v232 offset:39936
    ds_read_b64_tr_b16 v[230:231], v232 offset:40960
    s_setprio 1
    v_mul_f32 v246, v168, v168
    v_mul_f32 v247, v169, v169
    v_mul_f32 v248, v170, v170
    v_mul_f32 v249, v171, v171
    v_mul_f32 v250, v172, v172
    v_mul_f32 v251, v173, v173
    v_mul_f32 v252, v174, v174
    v_mul_f32 v253, v175, v175
    v_fma_f32 v246, v246, v239, v238
    v_fma_f32 v247, v247, v239, v238
    v_fma_f32 v248, v248, v239, v238
    v_fma_f32 v249, v249, v239, v238
    v_fma_f32 v250, v250, v243, v242
    v_fma_f32 v251, v251, v243, v242
    v_fma_f32 v252, v252, v243, v242
    v_fma_f32 v253, v253, v243, v242
    v_mul_f32 v246, v246, v168
    v_mul_f32 v247, v247, v169
    v_mul_f32 v248, v248, v170
    v_mul_f32 v249, v249, v171
    v_mul_f32 v250, v250, v172
    v_mul_f32 v251, v251, v173
    v_mul_f32 v252, v252, v174
    v_mul_f32 v253, v253, v175
    v_exp_f32 v246, v246
    v_exp_f32 v247, v247
    v_exp_f32 v248, v248
    s_add_u32 m0, s23, 0x00005000
    s_nop 0
    buffer_load_dwordx4 v235, s[32:35], s10 offen lds
    s_add_u32 m0, s23, 0x000053c0
    s_nop 0
    buffer_load_dwordx4 v235, s[32:35], s10 offen offset:64 lds
    v_exp_f32 v249, v249
    v_exp_f32 v250, v250
    v_exp_f32 v251, v251
    v_exp_f32 v252, v252
    v_exp_f32 v253, v253
    v_fma_f32 v246, v246, v240, v240
    v_fma_f32 v247, v247, v240, v240
    v_fma_f32 v248, v248, v240, v240
    v_fma_f32 v249, v249, v240, v240
    v_fma_f32 v250, v250, v244, v244
    v_fma_f32 v251, v251, v244, v244
    v_fma_f32 v252, v252, v244, v244
    v_fma_f32 v253, v253, v244, v244
    v_rcp_f32 v246, v246
    v_rcp_f32 v247, v247
    v_rcp_f32 v248, v248
    v_rcp_f32 v249, v249
    v_rcp_f32 v250, v250
    v_rcp_f32 v251, v251
    v_rcp_f32 v252, v252
    v_rcp_f32 v253, v253
    v_mul_f32 v246, v246, v168
    v_mul_f32 v247, v247, v169
    v_mul_f32 v248, v248, v170
    v_mul_f32 v249, v249, v171
    s_add_u32 m0, s23, 0x00007800
    s_nop 0
    buffer_load_dwordx4 v235, s[32:35], s11 offen lds
    s_add_u32 m0, s23, 0x00007bc0
    s_nop 0
    buffer_load_dwordx4 v235, s[32:35], s11 offen offset:64 lds
    v_mul_f32 v250, v250, v172
    v_mul_f32 v251, v251, v173
    v_mul_f32 v252, v252, v174
    v_mul_f32 v253, v253, v175
    v_cvt_pk_bf16_f32 v160, v246, v247
    v_cvt_pk_bf16_f32 v161, v248, v249
    v_cvt_pk_bf16_f32 v162, v250, v251
    v_cvt_pk_bf16_f32 v163, v252, v253
    buffer_store_dwordx4 v[160:163], v254, s[44:47], s22 offen offset:0 sc1
    v_mul_f32 v246, v176, v176
    v_mul_f32 v247, v177, v177
    v_mul_f32 v248, v178, v178
    v_mul_f32 v249, v179, v179
    v_mul_f32 v250, v180, v180
    v_mul_f32 v251, v181, v181
    v_mul_f32 v252, v182, v182
    v_mul_f32 v253, v183, v183
    v_fma_f32 v246, v246, v239, v238
    v_fma_f32 v247, v247, v239, v238
    v_fma_f32 v248, v248, v239, v238
    v_fma_f32 v249, v249, v239, v238
    v_fma_f32 v250, v250, v239, v238
    v_fma_f32 v251, v251, v239, v238
    v_fma_f32 v252, v252, v239, v238
    v_fma_f32 v253, v253, v239, v238
    s_mov_b32 exec_hi, 0x00000000
    s_add_u32 m0, s23, 0x00005800
    s_nop 0
    buffer_load_dwordx4 v236, s[32:35], s10 offen lds
    s_add_u32 m0, s23, 0x00008000
    s_nop 0
    buffer_load_dwordx4 v236, s[32:35], s11 offen lds
    s_mov_b64 exec, -1
    v_mul_f32 v246, v246, v176
    v_mul_f32 v247, v247, v177
    v_mul_f32 v248, v248, v178
    v_mul_f32 v249, v249, v179
    v_mul_f32 v250, v250, v180
    v_mul_f32 v251, v251, v181
    v_mul_f32 v252, v252, v182
    v_mul_f32 v253, v253, v183
    v_exp_f32 v246, v246
    v_exp_f32 v247, v247
    v_exp_f32 v248, v248
    v_exp_f32 v249, v249
    v_exp_f32 v250, v250
    v_exp_f32 v251, v251
    v_exp_f32 v252, v252
    v_exp_f32 v253, v253
    v_fma_f32 v246, v246, v240, v240
    v_fma_f32 v247, v247, v240, v240
    v_fma_f32 v248, v248, v240, v240
    v_fma_f32 v249, v249, v240, v240
    v_fma_f32 v250, v250, v240, v240
    v_fma_f32 v251, v251, v240, v240
    v_fma_f32 v252, v252, v240, v240
    v_fma_f32 v253, v253, v240, v240
    v_rcp_f32 v246, v246
    s_add_u32 m0, s23, 0x0000a000
    s_nop 0
    buffer_load_dwordx4 v235, s[32:35], s12 offen lds
    s_add_u32 m0, s23, 0x0000a3c0
    s_nop 0
    buffer_load_dwordx4 v235, s[32:35], s12 offen offset:64 lds
    v_rcp_f32 v247, v247
    v_rcp_f32 v248, v248
    v_rcp_f32 v249, v249
    v_rcp_f32 v250, v250
    v_rcp_f32 v251, v251
    v_rcp_f32 v252, v252
    v_rcp_f32 v253, v253
    v_mul_f32 v246, v246, v176
    v_mul_f32 v247, v247, v177
    v_mul_f32 v248, v248, v178
    v_mul_f32 v249, v249, v179
    v_mul_f32 v250, v250, v180
    v_mul_f32 v251, v251, v181
    v_mul_f32 v252, v252, v182
    v_mul_f32 v253, v253, v183
    v_cvt_pk_bf16_f32 v144, v246, v247
    v_cvt_pk_bf16_f32 v145, v248, v249
    v_cvt_pk_bf16_f32 v146, v250, v251
    v_cvt_pk_bf16_f32 v147, v252, v253
    buffer_store_dwordx4 v[144:147], v254, s[44:47], s20 offen offset:0 sc1
    v_mul_f32 v246, v184, v184
    v_mul_f32 v247, v185, v185
    v_mul_f32 v248, v186, v186
    v_mul_f32 v249, v187, v187
    v_mul_f32 v250, v188, v188
    s_add_u32 m0, s23, 0x00011800
    s_nop 0
    buffer_load_dwordx4 v235, s[32:35], s13 offen lds
    s_add_u32 m0, s23, 0x00011bc0
    s_nop 0
    buffer_load_dwordx4 v235, s[32:35], s13 offen offset:64 lds
    v_mul_f32 v251, v189, v189
    v_mul_f32 v252, v190, v190
    v_mul_f32 v253, v191, v191
    v_fma_f32 v246, v246, v243, v242
    v_fma_f32 v247, v247, v243, v242
    v_fma_f32 v248, v248, v243, v242
    v_fma_f32 v249, v249, v243, v242
    v_fma_f32 v250, v250, v243, v242
    v_fma_f32 v251, v251, v243, v242
    v_fma_f32 v252, v252, v243, v242
    v_fma_f32 v253, v253, v243, v242
    v_mul_f32 v246, v246, v184
    v_mul_f32 v247, v247, v185
    v_mul_f32 v248, v248, v186
    v_mul_f32 v249, v249, v187
    v_mul_f32 v250, v250, v188
    v_mul_f32 v251, v251, v189
    v_mul_f32 v252, v252, v190
    v_mul_f32 v253, v253, v191
    v_exp_f32 v246, v246
    v_exp_f32 v247, v247
    v_exp_f32 v248, v248
    v_exp_f32 v249, v249
    v_exp_f32 v250, v250
    v_exp_f32 v251, v251
    s_mov_b32 exec_hi, 0x00000000
    s_add_u32 m0, s23, 0x0000a800
    s_nop 0
    buffer_load_dwordx4 v236, s[32:35], s12 offen lds
    s_add_u32 m0, s23, 0x00012000
    s_nop 0
    buffer_load_dwordx4 v236, s[32:35], s13 offen lds
    s_mov_b64 exec, -1
    v_exp_f32 v252, v252
    v_exp_f32 v253, v253
    v_fma_f32 v246, v246, v244, v244
    v_fma_f32 v247, v247, v244, v244
    v_fma_f32 v248, v248, v244, v244
    v_fma_f32 v249, v249, v244, v244
    v_fma_f32 v250, v250, v244, v244
    v_fma_f32 v251, v251, v244, v244
    v_fma_f32 v252, v252, v244, v244
    v_fma_f32 v253, v253, v244, v244
    v_rcp_f32 v246, v246
    v_rcp_f32 v247, v247
    v_rcp_f32 v248, v248
    v_rcp_f32 v249, v249
    v_rcp_f32 v250, v250
    v_rcp_f32 v251, v251
    v_rcp_f32 v252, v252
    v_rcp_f32 v253, v253
    v_mul_f32 v246, v246, v184
    v_mul_f32 v247, v247, v185
    v_mul_f32 v248, v248, v186
    v_mul_f32 v249, v249, v187
    v_mul_f32 v250, v250, v188
    v_mul_f32 v251, v251, v189
    v_mul_f32 v252, v252, v190
    s_add_u32 m0, s23, 0x00000000
    s_nop 0
    buffer_load_dwordx4 v235, s[32:35], s8 offen lds
    s_add_u32 m0, s23, 0x000003c0
    s_nop 0
    buffer_load_dwordx4 v235, s[32:35], s8 offen offset:64 lds
    v_mul_f32 v253, v253, v191
    v_cvt_pk_bf16_f32 v148, v246, v247
    v_cvt_pk_bf16_f32 v149, v248, v249
    v_cvt_pk_bf16_f32 v150, v250, v251
    v_cvt_pk_bf16_f32 v151, v252, v253
    buffer_store_dwordx4 v[148:151], v254, s[44:47], s20 offen offset:1024 sc1
    v_mul_f32 v246, v192, v192
    v_mul_f32 v247, v193, v193
    v_mul_f32 v248, v194, v194
    v_mul_f32 v249, v195, v195
    v_mul_f32 v250, v196, v196
    v_mul_f32 v251, v197, v197
    v_mul_f32 v252, v198, v198
    v_mul_f32 v253, v199, v199
    v_fma_f32 v246, v246, v239, v238
    v_fma_f32 v247, v247, v239, v238
    v_fma_f32 v248, v248, v239, v238
    v_fma_f32 v249, v249, v239, v238
    v_fma_f32 v250, v250, v239, v238
    v_fma_f32 v251, v251, v239, v238
    v_fma_f32 v252, v252, v239, v238
    v_fma_f32 v253, v253, v239, v238
    v_mul_f32 v246, v246, v192
    v_mul_f32 v247, v247, v193
    v_mul_f32 v248, v248, v194
    s_add_u32 m0, s23, 0x00002800
    s_nop 0
    buffer_load_dwordx4 v235, s[32:35], s9 offen lds
    s_add_u32 m0, s23, 0x00002bc0
    s_nop 0
    buffer_load_dwordx4 v235, s[32:35], s9 offen offset:64 lds
    v_mul_f32 v249, v249, v195
    v_mul_f32 v250, v250, v196
    v_mul_f32 v251, v251, v197
    v_mul_f32 v252, v252, v198
    v_mul_f32 v253, v253, v199
    v_exp_f32 v246, v246
    v_exp_f32 v247, v247
    v_exp_f32 v248, v248
    v_exp_f32 v249, v249
    v_exp_f32 v250, v250
    v_exp_f32 v251, v251
    v_exp_f32 v252, v252
    v_exp_f32 v253, v253
    v_fma_f32 v246, v246, v240, v240
    v_fma_f32 v247, v247, v240, v240
    v_fma_f32 v248, v248, v240, v240
    v_fma_f32 v249, v249, v240, v240
    v_fma_f32 v250, v250, v240, v240
    v_fma_f32 v251, v251, v240, v240
    v_fma_f32 v252, v252, v240, v240
    v_fma_f32 v253, v253, v240, v240
    v_rcp_f32 v246, v246
    v_rcp_f32 v247, v247
    v_rcp_f32 v248, v248
    v_rcp_f32 v249, v249
    s_mov_b32 exec_hi, 0x00000000
    s_add_u32 m0, s23, 0x00000800
    s_nop 0
    buffer_load_dwordx4 v236, s[32:35], s8 offen lds
    s_add_u32 m0, s23, 0x00003000
    s_nop 0
    buffer_load_dwordx4 v236, s[32:35], s9 offen lds
    s_mov_b64 exec, -1
    v_rcp_f32 v250, v250
    v_rcp_f32 v251, v251
    v_rcp_f32 v252, v252
    v_rcp_f32 v253, v253
    v_mul_f32 v246, v246, v192
    v_mul_f32 v247, v247, v193
    v_mul_f32 v248, v248, v194
    v_mul_f32 v249, v249, v195
    v_mul_f32 v250, v250, v196
    v_mul_f32 v251, v251, v197
    v_mul_f32 v252, v252, v198
    v_mul_f32 v253, v253, v199
    v_cvt_pk_bf16_f32 v152, v246, v247
    v_cvt_pk_bf16_f32 v153, v248, v249
    v_cvt_pk_bf16_f32 v154, v250, v251
    v_cvt_pk_bf16_f32 v155, v252, v253
    buffer_store_dwordx4 v[152:155], v254, s[44:47], s20 offen offset:2048 sc1
    v_mul_f32 v246, v200, v200
    v_mul_f32 v247, v201, v201
    v_mul_f32 v248, v202, v202
    v_mul_f32 v249, v203, v203
    v_mul_f32 v250, v204, v204
    v_mul_f32 v251, v205, v205
    v_mul_f32 v252, v206, v206
    v_mul_f32 v253, v207, v207
    s_mov_b32 s66, 589824
    s_add_u32 m0, s23, 0x0000c800
    s_nop 0
    buffer_load_dwordx4 v235, s[32:35], s66 offen lds
    s_add_u32 m0, s23, 0x0000cbc0
    s_nop 0
    buffer_load_dwordx4 v235, s[32:35], s66 offen offset:64 lds
    v_fma_f32 v246, v246, v243, v242
    v_fma_f32 v247, v247, v243, v242
    v_fma_f32 v248, v248, v243, v242
    v_fma_f32 v249, v249, v243, v242
    v_fma_f32 v250, v250, v243, v242
    v_fma_f32 v251, v251, v243, v242
    v_fma_f32 v252, v252, v243, v242
    v_fma_f32 v253, v253, v243, v242
    v_mul_f32 v246, v246, v200
    v_mul_f32 v247, v247, v201
    v_mul_f32 v248, v248, v202
    v_mul_f32 v249, v249, v203
    v_mul_f32 v250, v250, v204
    v_mul_f32 v251, v251, v205
    v_mul_f32 v252, v252, v206
    v_mul_f32 v253, v253, v207
    v_exp_f32 v246, v246
    v_exp_f32 v247, v247
    v_exp_f32 v248, v248
    v_exp_f32 v249, v249
    v_exp_f32 v250, v250
    v_exp_f32 v251, v251
    v_exp_f32 v252, v252
    v_exp_f32 v253, v253
    v_fma_f32 v246, v246, v244, v244
    s_mov_b32 exec_hi, 0x00000000
    s_mov_b32 s66, 589824
    s_add_u32 m0, s23, 0x0000d000
    s_nop 0
    buffer_load_dwordx4 v236, s[32:35], s66 offen lds
    s_mov_b64 exec, -1
    v_fma_f32 v247, v247, v244, v244
    v_fma_f32 v248, v248, v244, v244
    v_fma_f32 v249, v249, v244, v244
    v_fma_f32 v250, v250, v244, v244
    v_fma_f32 v251, v251, v244, v244
    v_fma_f32 v252, v252, v244, v244
    v_fma_f32 v253, v253, v244, v244
    v_rcp_f32 v246, v246
    v_rcp_f32 v247, v247
    v_rcp_f32 v248, v248
    v_rcp_f32 v249, v249
    v_rcp_f32 v250, v250
    v_rcp_f32 v251, v251
    v_rcp_f32 v252, v252
    v_rcp_f32 v253, v253
    v_mul_f32 v246, v246, v200
    v_mul_f32 v247, v247, v201
    v_mul_f32 v248, v248, v202
    v_mul_f32 v249, v249, v203
    v_mul_f32 v250, v250, v204
    v_mul_f32 v251, v251, v205
    v_mul_f32 v252, v252, v206
    v_mul_f32 v253, v253, v207
    v_cvt_pk_bf16_f32 v156, v246, v247
    v_cvt_pk_bf16_f32 v157, v248, v249
    v_cvt_pk_bf16_f32 v158, v250, v251
    v_cvt_pk_bf16_f32 v159, v252, v253
    buffer_store_dwordx4 v[156:159], v254, s[44:47], s20 offen offset:3072 sc1
    s_setprio 0
    s_waitcnt lgkmcnt(8)
    v_mfma_f32_16x16x32_bf16 v[192:195], v[208:211], v[0:3], 0
    ds_read_b64_tr_b16 v[176:177], v233 offset:37888
    v_mfma_f32_16x16x32_bf16 v[192:195], v[212:215], v[8:11], v[192:195]
    ds_read_b64_tr_b16 v[178:179], v233 offset:38912
    v_mfma_f32_16x16x32_bf16 v[200:203], v[212:215], v[12:15], 0
    ds_read_b64_tr_b16 v[180:181], v233 offset:39936
    v_mfma_f32_16x16x32_bf16 v[200:203], v[208:211], v[4:7], v[200:203]
    ds_read_b64_tr_b16 v[182:183], v233 offset:40960
    s_waitcnt lgkmcnt(8)
    v_mfma_f32_16x16x32_bf16 v[196:199], v[216:219], v[0:3], 0
    ds_read_b64_tr_b16 v[208:209], v232 offset:41984
    v_mfma_f32_16x16x32_bf16 v[196:199], v[220:223], v[8:11], v[196:199]
    ds_read_b64_tr_b16 v[210:211], v232 offset:43008
    v_mfma_f32_16x16x32_bf16 v[204:207], v[220:223], v[12:15], 0
    ds_read_b64_tr_b16 v[212:213], v232 offset:44032
    v_mfma_f32_16x16x32_bf16 v[204:207], v[216:219], v[4:7], v[204:207]
    ds_read_b64_tr_b16 v[214:215], v232 offset:45056
    s_waitcnt lgkmcnt(8)
    v_mfma_f32_16x16x32_bf16 v[192:195], v[224:227], v[16:19], v[192:195]
    ds_read_b64_tr_b16 v[216:217], v233 offset:41984
    v_mfma_f32_16x16x32_bf16 v[192:195], v[228:231], v[24:27], v[192:195]
    ds_read_b64_tr_b16 v[218:219], v233 offset:43008
    v_mfma_f32_16x16x32_bf16 v[200:203], v[228:231], v[28:31], v[200:203]
    ds_read_b64_tr_b16 v[220:221], v233 offset:44032
    v_mfma_f32_16x16x32_bf16 v[200:203], v[224:227], v[20:23], v[200:203]
    ds_read_b64_tr_b16 v[222:223], v233 offset:45056
    s_waitcnt lgkmcnt(8)
    v_mfma_f32_16x16x32_bf16 v[196:199], v[176:179], v[16:19], v[196:199]
    ds_read_b64_tr_b16 v[224:225], v232 offset:46080
    v_mfma_f32_16x16x32_bf16 v[196:199], v[180:183], v[24:27], v[196:199]
    ds_read_b64_tr_b16 v[226:227], v232 offset:47104
    v_mfma_f32_16x16x32_bf16 v[204:207], v[180:183], v[28:31], v[204:207]
    ds_read_b64_tr_b16 v[228:229], v232 offset:48128
    v_mfma_f32_16x16x32_bf16 v[204:207], v[176:179], v[20:23], v[204:207]
    ds_read_b64_tr_b16 v[230:231], v232 offset:49152
    s_waitcnt lgkmcnt(8)
    v_mfma_f32_16x16x32_bf16 v[192:195], v[208:211], v[32:35], v[192:195]
    ds_read_b64_tr_b16 v[176:177], v233 offset:46080
    v_mfma_f32_16x16x32_bf16 v[192:195], v[212:215], v[40:43], v[192:195]
    ds_read_b64_tr_b16 v[178:179], v233 offset:47104
    v_mfma_f32_16x16x32_bf16 v[200:203], v[212:215], v[44:47], v[200:203]
    ds_read_b64_tr_b16 v[180:181], v233 offset:48128
    v_mfma_f32_16x16x32_bf16 v[200:203], v[208:211], v[36:39], v[200:203]
    ds_read_b64_tr_b16 v[182:183], v233 offset:49152
    s_waitcnt lgkmcnt(8)
    v_mfma_f32_16x16x32_bf16 v[196:199], v[216:219], v[32:35], v[196:199]
    ds_read_b64_tr_b16 v[208:209], v232 offset:50176
    v_mfma_f32_16x16x32_bf16 v[196:199], v[220:223], v[40:43], v[196:199]
    ds_read_b64_tr_b16 v[210:211], v232 offset:51200
    v_mfma_f32_16x16x32_bf16 v[204:207], v[220:223], v[44:47], v[204:207]
    ds_read_b64_tr_b16 v[212:213], v232 offset:52224
    v_mfma_f32_16x16x32_bf16 v[204:207], v[216:219], v[36:39], v[204:207]
    ds_read_b64_tr_b16 v[214:215], v232 offset:53248
    s_waitcnt lgkmcnt(8)
    v_mfma_f32_16x16x32_bf16 v[192:195], v[224:227], v[48:51], v[192:195]
    ds_read_b64_tr_b16 v[216:217], v233 offset:50176
    v_mfma_f32_16x16x32_bf16 v[192:195], v[228:231], v[56:59], v[192:195]
    ds_read_b64_tr_b16 v[218:219], v233 offset:51200
    v_mfma_f32_16x16x32_bf16 v[200:203], v[228:231], v[60:63], v[200:203]
    ds_read_b64_tr_b16 v[220:221], v233 offset:52224
    v_mfma_f32_16x16x32_bf16 v[200:203], v[224:227], v[52:55], v[200:203]
    ds_read_b64_tr_b16 v[222:223], v233 offset:53248
    s_waitcnt lgkmcnt(8)
    v_mfma_f32_16x16x32_bf16 v[196:199], v[176:179], v[48:51], v[196:199]
    ds_read_b64_tr_b16 v[224:225], v232 offset:54272
    v_mfma_f32_16x16x32_bf16 v[196:199], v[180:183], v[56:59], v[196:199]
    ds_read_b64_tr_b16 v[226:227], v232 offset:55296
    v_mfma_f32_16x16x32_bf16 v[204:207], v[180:183], v[60:63], v[204:207]
    ds_read_b64_tr_b16 v[228:229], v232 offset:56320
    v_mfma_f32_16x16x32_bf16 v[204:207], v[176:179], v[52:55], v[204:207]
    ds_read_b64_tr_b16 v[230:231], v232 offset:57344
    s_waitcnt lgkmcnt(8)
    v_mfma_f32_16x16x32_bf16 v[192:195], v[208:211], v[64:67], v[192:195]
    ds_read_b64_tr_b16 v[176:177], v233 offset:54272
    v_mfma_f32_16x16x32_bf16 v[192:195], v[212:215], v[72:75], v[192:195]
    ds_read_b64_tr_b16 v[178:179], v233 offset:55296
    v_mfma_f32_16x16x32_bf16 v[200:203], v[212:215], v[76:79], v[200:203]
    ds_read_b64_tr_b16 v[180:181], v233 offset:56320
    v_mfma_f32_16x16x32_bf16 v[200:203], v[208:211], v[68:71], v[200:203]
    ds_read_b64_tr_b16 v[182:183], v233 offset:57344
    s_waitcnt lgkmcnt(8)
    v_mfma_f32_16x16x32_bf16 v[196:199], v[216:219], v[64:67], v[196:199]
    ds_read_b64_tr_b16 v[208:209], v232 offset:58368
    v_mfma_f32_16x16x32_bf16 v[196:199], v[220:223], v[72:75], v[196:199]
    ds_read_b64_tr_b16 v[210:211], v232 offset:59392
    v_mfma_f32_16x16x32_bf16 v[204:207], v[220:223], v[76:79], v[204:207]
    ds_read_b64_tr_b16 v[212:213], v232 offset:60416
    v_mfma_f32_16x16x32_bf16 v[204:207], v[216:219], v[68:71], v[204:207]
    ds_read_b64_tr_b16 v[214:215], v232 offset:61440
    s_waitcnt lgkmcnt(8)
    v_mfma_f32_16x16x32_bf16 v[192:195], v[224:227], v[80:83], v[192:195]
    ds_read_b64_tr_b16 v[216:217], v233 offset:58368
    v_mfma_f32_16x16x32_bf16 v[192:195], v[228:231], v[88:91], v[192:195]
    ds_read_b64_tr_b16 v[218:219], v233 offset:59392
    v_mfma_f32_16x16x32_bf16 v[200:203], v[228:231], v[92:95], v[200:203]
    ds_read_b64_tr_b16 v[220:221], v233 offset:60416
    v_mfma_f32_16x16x32_bf16 v[200:203], v[224:227], v[84:87], v[200:203]
    ds_read_b64_tr_b16 v[222:223], v233 offset:61440
    s_waitcnt lgkmcnt(8)
    v_mfma_f32_16x16x32_bf16 v[196:199], v[176:179], v[80:83], v[196:199]
    ds_read_b64_tr_b16 v[224:225], v232 offset:62464
    v_mfma_f32_16x16x32_bf16 v[196:199], v[180:183], v[88:91], v[196:199]
    ds_read_b64_tr_b16 v[226:227], v232 offset:63488
    v_mfma_f32_16x16x32_bf16 v[204:207], v[180:183], v[92:95], v[204:207]
    ds_read_b64_tr_b16 v[228:229], v232 offset:64512
    v_mfma_f32_16x16x32_bf16 v[204:207], v[176:179], v[84:87], v[204:207]
    v_add_u32 v232, 0x0000e000, v232
    ds_read_b64_tr_b16 v[230:231], v232 offset:8192
    s_waitcnt lgkmcnt(8)
    v_mfma_f32_16x16x32_bf16 v[192:195], v[208:211], v[96:99], v[192:195]
    ds_read_b64_tr_b16 v[176:177], v233 offset:62464
    v_mfma_f32_16x16x32_bf16 v[192:195], v[212:215], v[104:107], v[192:195]
    ds_read_b64_tr_b16 v[178:179], v233 offset:63488
    v_mfma_f32_16x16x32_bf16 v[200:203], v[212:215], v[108:111], v[200:203]
    ds_read_b64_tr_b16 v[180:181], v233 offset:64512
    v_mfma_f32_16x16x32_bf16 v[200:203], v[208:211], v[100:103], v[200:203]
    v_add_u32 v233, 0x0000e000, v233
    ds_read_b64_tr_b16 v[182:183], v233 offset:8192
    s_waitcnt lgkmcnt(8)
    v_mfma_f32_16x16x32_bf16 v[196:199], v[216:219], v[96:99], v[196:199]
    ds_read_b64_tr_b16 v[208:209], v232 offset:9216
    v_mfma_f32_16x16x32_bf16 v[196:199], v[220:223], v[104:107], v[196:199]
    ds_read_b64_tr_b16 v[210:211], v232 offset:10240
    v_mfma_f32_16x16x32_bf16 v[204:207], v[220:223], v[108:111], v[204:207]
    ds_read_b64_tr_b16 v[212:213], v232 offset:11264
    v_mfma_f32_16x16x32_bf16 v[204:207], v[216:219], v[100:103], v[204:207]
    ds_read_b64_tr_b16 v[214:215], v232 offset:12288
    s_waitcnt lgkmcnt(8)
    v_mfma_f32_16x16x32_bf16 v[192:195], v[224:227], v[112:115], v[192:195]
    ds_read_b64_tr_b16 v[216:217], v233 offset:9216
    v_mfma_f32_16x16x32_bf16 v[192:195], v[228:231], v[120:123], v[192:195]
    ds_read_b64_tr_b16 v[218:219], v233 offset:10240
    v_mfma_f32_16x16x32_bf16 v[200:203], v[228:231], v[124:127], v[200:203]
    ds_read_b64_tr_b16 v[220:221], v233 offset:11264
    v_mfma_f32_16x16x32_bf16 v[200:203], v[224:227], v[116:119], v[200:203]
    ds_read_b64_tr_b16 v[222:223], v233 offset:12288
    s_waitcnt lgkmcnt(8)
    v_mfma_f32_16x16x32_bf16 v[196:199], v[176:179], v[112:115], v[196:199]
    v_mfma_f32_16x16x32_bf16 v[196:199], v[180:183], v[120:123], v[196:199]
    v_mfma_f32_16x16x32_bf16 v[204:207], v[180:183], v[124:127], v[204:207]
    v_mfma_f32_16x16x32_bf16 v[204:207], v[176:179], v[116:119], v[204:207]
    s_waitcnt lgkmcnt(4)
    v_mfma_f32_16x16x32_bf16 v[192:195], v[208:211], v[128:131], v[192:195]
    v_mfma_f32_16x16x32_bf16 v[192:195], v[212:215], v[136:139], v[192:195]
    v_mfma_f32_16x16x32_bf16 v[200:203], v[212:215], v[140:143], v[200:203]
    v_mfma_f32_16x16x32_bf16 v[200:203], v[208:211], v[132:135], v[200:203]
    s_waitcnt lgkmcnt(0)
    v_mfma_f32_16x16x32_bf16 v[196:199], v[216:219], v[128:131], v[196:199]
    v_mfma_f32_16x16x32_bf16 v[196:199], v[220:223], v[136:139], v[196:199]
    v_mfma_f32_16x16x32_bf16 v[204:207], v[220:223], v[140:143], v[204:207]
    v_mfma_f32_16x16x32_bf16 v[204:207], v[216:219], v[132:135], v[204:207]
    ds_read_b64_tr_b16 v[208:209], v232 offset:13312
    ds_read_b64_tr_b16 v[210:211], v232 offset:14336
    ds_read_b64_tr_b16 v[212:213], v232 offset:15360
    ds_read_b64_tr_b16 v[214:215], v232 offset:16384
    ds_read_b64_tr_b16 v[216:217], v233 offset:13312
    ds_read_b64_tr_b16 v[218:219], v233 offset:14336
    ds_read_b64_tr_b16 v[220:221], v233 offset:15360
    ds_read_b64_tr_b16 v[222:223], v233 offset:16384
    ds_read_b64_tr_b16 v[224:225], v232 offset:17408
    ds_read_b64_tr_b16 v[226:227], v232 offset:18432
    ds_read_b64_tr_b16 v[228:229], v232 offset:19456
    ds_read_b64_tr_b16 v[230:231], v232 offset:20480
    s_waitcnt vmcnt(0)
    s_buffer_atomic_swap s55, s[44:47], s41 offset:0
    s_buffer_atomic_swap s55, s[44:47], s41 offset:128
    s_buffer_atomic_swap s55, s[44:47], s41 offset:256
    s_buffer_atomic_swap s55, s[44:47], s41 offset:384
    s_barrier
    s_setprio 1
    v_mul_f32 v246, v192, v192
    v_mul_f32 v247, v193, v193
    v_mul_f32 v248, v194, v194
    v_mul_f32 v249, v195, v195
    v_mul_f32 v250, v196, v196
    v_mul_f32 v251, v197, v197
    v_mul_f32 v252, v198, v198
    v_mul_f32 v253, v199, v199
    v_fma_f32 v246, v246, v239, v238
    v_fma_f32 v247, v247, v239, v238
    v_fma_f32 v248, v248, v239, v238
    v_fma_f32 v249, v249, v239, v238
    v_fma_f32 v250, v250, v239, v238
    v_fma_f32 v251, v251, v239, v238
    v_fma_f32 v252, v252, v239, v238
    v_fma_f32 v253, v253, v239, v238
    v_mul_f32 v246, v246, v192
    v_mul_f32 v247, v247, v193
    v_mul_f32 v248, v248, v194
    s_add_u32 m0, s23, 0x00016800
    s_nop 0
    buffer_load_dwordx4 v235, s[32:35], s14 offen lds
    s_add_u32 m0, s23, 0x00016bc0
    s_nop 0
    buffer_load_dwordx4 v235, s[32:35], s14 offen offset:64 lds
    v_mul_f32 v249, v249, v195
    v_mul_f32 v250, v250, v196
    v_mul_f32 v251, v251, v197
    v_mul_f32 v252, v252, v198
    v_mul_f32 v253, v253, v199
    v_exp_f32 v246, v246
    v_exp_f32 v247, v247
    v_exp_f32 v248, v248
    v_exp_f32 v249, v249
    v_exp_f32 v250, v250
    v_exp_f32 v251, v251
    v_exp_f32 v252, v252
    v_exp_f32 v253, v253
    v_fma_f32 v246, v246, v240, v240
    v_fma_f32 v247, v247, v240, v240
    v_fma_f32 v248, v248, v240, v240
    v_fma_f32 v249, v249, v240, v240
    v_fma_f32 v250, v250, v240, v240
    v_fma_f32 v251, v251, v240, v240
    v_fma_f32 v252, v252, v240, v240
    s_add_u32 m0, s23, 0x00019000
    s_nop 0
    buffer_load_dwordx4 v235, s[32:35], s15 offen lds
    s_add_u32 m0, s23, 0x000193c0
    s_nop 0
    buffer_load_dwordx4 v235, s[32:35], s15 offen offset:64 lds
    v_fma_f32 v253, v253, v240, v240
    v_rcp_f32 v246, v246
    v_rcp_f32 v247, v247
    v_rcp_f32 v248, v248
    v_rcp_f32 v249, v249
    v_rcp_f32 v250, v250
    v_rcp_f32 v251, v251
    v_rcp_f32 v252, v252
    v_rcp_f32 v253, v253
    v_mul_f32 v246, v246, v192
    v_mul_f32 v247, v247, v193
    v_mul_f32 v248, v248, v194
    v_mul_f32 v249, v249, v195
    v_mul_f32 v250, v250, v196
    v_mul_f32 v251, v251, v197
    v_mul_f32 v252, v252, v198
    v_mul_f32 v253, v253, v199
    v_cvt_pk_bf16_f32 v160, v246, v247
    v_cvt_pk_bf16_f32 v161, v248, v249
    v_cvt_pk_bf16_f32 v162, v250, v251
    s_mov_b32 exec_hi, 0x00000000
    s_add_u32 m0, s23, 0x00017000
    s_nop 0
    buffer_load_dwordx4 v236, s[32:35], s14 offen lds
    s_add_u32 m0, s23, 0x00019800
    s_nop 0
    buffer_load_dwordx4 v236, s[32:35], s15 offen lds
    s_mov_b64 exec, -1
    v_cvt_pk_bf16_f32 v163, v252, v253
    buffer_store_dwordx4 v[160:163], v254, s[44:47], s21 offen offset:0 sc1
    v_mul_f32 v246, v200, v200
    v_mul_f32 v247, v201, v201
    v_mul_f32 v248, v202, v202
    v_mul_f32 v249, v203, v203
    v_mul_f32 v250, v204, v204
    v_mul_f32 v251, v205, v205
    v_mul_f32 v252, v206, v206
    v_mul_f32 v253, v207, v207
    v_fma_f32 v246, v246, v243, v242
    v_fma_f32 v247, v247, v243, v242
    v_fma_f32 v248, v248, v243, v242
    v_fma_f32 v249, v249, v243, v242
    v_fma_f32 v250, v250, v243, v242
    v_fma_f32 v251, v251, v243, v242
    v_fma_f32 v252, v252, v243, v242
    v_fma_f32 v253, v253, v243, v242
    v_mul_f32 v246, v246, v200
    v_mul_f32 v247, v247, v201
    s_add_u32 m0, s24, 0x0001b780
    s_nop 0
    buffer_load_dwordx4 v235, s[32:35], s8 offen offset:128 lds
    s_add_u32 m0, s24, 0x0001bb40
    s_nop 0
    buffer_load_dwordx4 v235, s[32:35], s8 offen offset:192 lds
    v_mul_f32 v248, v248, v202
    v_mul_f32 v249, v249, v203
    v_mul_f32 v250, v250, v204
    v_mul_f32 v251, v251, v205
    v_mul_f32 v252, v252, v206
    v_mul_f32 v253, v253, v207
    v_exp_f32 v246, v246
    v_exp_f32 v247, v247
    v_exp_f32 v248, v248
    v_exp_f32 v249, v249
    v_exp_f32 v250, v250
    v_exp_f32 v251, v251
    v_exp_f32 v252, v252
    v_exp_f32 v253, v253
    v_fma_f32 v246, v246, v244, v244
    v_fma_f32 v247, v247, v244, v244
    v_fma_f32 v248, v248, v244, v244
    v_fma_f32 v249, v249, v244, v244
    v_fma_f32 v250, v250, v244, v244
    v_fma_f32 v251, v251, v244, v244
    s_add_u32 m0, s24, 0x0001d780
    s_nop 0
    buffer_load_dwordx4 v235, s[32:35], s9 offen offset:128 lds
    s_add_u32 m0, s24, 0x0001db40
    s_nop 0
    buffer_load_dwordx4 v235, s[32:35], s9 offen offset:192 lds
    v_fma_f32 v252, v252, v244, v244
    v_fma_f32 v253, v253, v244, v244
    v_rcp_f32 v246, v246
    v_rcp_f32 v247, v247
    v_rcp_f32 v248, v248
    v_rcp_f32 v249, v249
    v_rcp_f32 v250, v250
    v_rcp_f32 v251, v251
    v_rcp_f32 v252, v252
    v_rcp_f32 v253, v253
    v_mul_f32 v246, v246, v200
    v_mul_f32 v247, v247, v201
    v_mul_f32 v248, v248, v202
    v_mul_f32 v249, v249, v203
    v_mul_f32 v250, v250, v204
    v_mul_f32 v251, v251, v205
    v_mul_f32 v252, v252, v206
    v_mul_f32 v253, v253, v207
    v_cvt_pk_bf16_f32 v164, v246, v247
    v_cvt_pk_bf16_f32 v165, v248, v249
    v_cvt_pk_bf16_f32 v166, v250, v251
    v_cvt_pk_bf16_f32 v167, v252, v253
    buffer_store_dwordx4 v[164:167], v254, s[44:47], s21 offen offset:1024 sc1
    s_setprio 0
    s_waitcnt lgkmcnt(8)
    v_mfma_f32_16x16x32_bf16 v[192:195], v[208:211], v[0:3], 0
    ds_read_b64_tr_b16 v[176:177], v233 offset:17408
    v_mfma_f32_16x16x32_bf16 v[192:195], v[212:215], v[8:11], v[192:195]
    ds_read_b64_tr_b16 v[178:179], v233 offset:18432
    v_mfma_f32_16x16x32_bf16 v[200:203], v[212:215], v[12:15], 0
    ds_read_b64_tr_b16 v[180:181], v233 offset:19456
    v_mfma_f32_16x16x32_bf16 v[200:203], v[208:211], v[4:7], v[200:203]
    ds_read_b64_tr_b16 v[182:183], v233 offset:20480
    s_waitcnt lgkmcnt(8)
    v_mfma_f32_16x16x32_bf16 v[196:199], v[216:219], v[0:3], 0
    ds_read_b64_tr_b16 v[208:209], v232 offset:21504
    v_mfma_f32_16x16x32_bf16 v[196:199], v[220:223], v[8:11], v[196:199]
    ds_read_b64_tr_b16 v[210:211], v232 offset:22528
    v_mfma_f32_16x16x32_bf16 v[204:207], v[220:223], v[12:15], 0
    ds_read_b64_tr_b16 v[212:213], v232 offset:23552
    v_mfma_f32_16x16x32_bf16 v[204:207], v[216:219], v[4:7], v[204:207]
    ds_read_b64_tr_b16 v[214:215], v232 offset:24576
    s_waitcnt lgkmcnt(8)
    v_mfma_f32_16x16x32_bf16 v[192:195], v[224:227], v[16:19], v[192:195]
    ds_read_b64_tr_b16 v[216:217], v233 offset:21504
    v_mfma_f32_16x16x32_bf16 v[192:195], v[228:231], v[24:27], v[192:195]
    ds_read_b64_tr_b16 v[218:219], v233 offset:22528
    v_mfma_f32_16x16x32_bf16 v[200:203], v[228:231], v[28:31], v[200:203]
    ds_read_b64_tr_b16 v[220:221], v233 offset:23552
    v_mfma_f32_16x16x32_bf16 v[200:203], v[224:227], v[20:23], v[200:203]
    ds_read_b64_tr_b16 v[222:223], v233 offset:24576
    s_waitcnt lgkmcnt(8)
    v_mfma_f32_16x16x32_bf16 v[196:199], v[176:179], v[16:19], v[196:199]
    ds_read_b64_tr_b16 v[224:225], v232 offset:25600
    v_mfma_f32_16x16x32_bf16 v[196:199], v[180:183], v[24:27], v[196:199]
    ds_read_b64_tr_b16 v[226:227], v232 offset:26624
    v_mfma_f32_16x16x32_bf16 v[204:207], v[180:183], v[28:31], v[204:207]
    ds_read_b64_tr_b16 v[228:229], v232 offset:27648
    v_mfma_f32_16x16x32_bf16 v[204:207], v[176:179], v[20:23], v[204:207]
    ds_read_b64_tr_b16 v[230:231], v232 offset:28672
    s_waitcnt lgkmcnt(8)
    v_mfma_f32_16x16x32_bf16 v[192:195], v[208:211], v[32:35], v[192:195]
    ds_read_b64_tr_b16 v[176:177], v233 offset:25600
    v_mfma_f32_16x16x32_bf16 v[192:195], v[212:215], v[40:43], v[192:195]
    ds_read_b64_tr_b16 v[178:179], v233 offset:26624
    v_mfma_f32_16x16x32_bf16 v[200:203], v[212:215], v[44:47], v[200:203]
    ds_read_b64_tr_b16 v[180:181], v233 offset:27648
    v_mfma_f32_16x16x32_bf16 v[200:203], v[208:211], v[36:39], v[200:203]
    ds_read_b64_tr_b16 v[182:183], v233 offset:28672
    s_buffer_load_dwordx8 s[92:99], s[44:47], s40 glc
    s_waitcnt lgkmcnt(8)
    v_mfma_f32_16x16x32_bf16 v[196:199], v[216:219], v[32:35], v[196:199]
    ds_read_b64_tr_b16 v[208:209], v232 offset:29696
    v_mfma_f32_16x16x32_bf16 v[196:199], v[220:223], v[40:43], v[196:199]
    ds_read_b64_tr_b16 v[210:211], v232 offset:30720
    v_mfma_f32_16x16x32_bf16 v[204:207], v[220:223], v[44:47], v[204:207]
    ds_read_b64_tr_b16 v[212:213], v232 offset:31744
    v_mfma_f32_16x16x32_bf16 v[204:207], v[216:219], v[36:39], v[204:207]
    ds_read_b64_tr_b16 v[214:215], v232 offset:32768
    s_waitcnt lgkmcnt(8)
    v_mfma_f32_16x16x32_bf16 v[192:195], v[224:227], v[48:51], v[192:195]
    ds_read_b64_tr_b16 v[216:217], v233 offset:29696
    v_mfma_f32_16x16x32_bf16 v[192:195], v[228:231], v[56:59], v[192:195]
    ds_read_b64_tr_b16 v[218:219], v233 offset:30720
    v_mfma_f32_16x16x32_bf16 v[200:203], v[228:231], v[60:63], v[200:203]
    ds_read_b64_tr_b16 v[220:221], v233 offset:31744
    v_mfma_f32_16x16x32_bf16 v[200:203], v[224:227], v[52:55], v[200:203]
    ds_read_b64_tr_b16 v[222:223], v233 offset:32768
    s_waitcnt lgkmcnt(8)
    v_mfma_f32_16x16x32_bf16 v[196:199], v[176:179], v[48:51], v[196:199]
    ds_read_b64_tr_b16 v[224:225], v232 offset:33792
    v_mfma_f32_16x16x32_bf16 v[196:199], v[180:183], v[56:59], v[196:199]
    ds_read_b64_tr_b16 v[226:227], v232 offset:34816
    v_mfma_f32_16x16x32_bf16 v[204:207], v[180:183], v[60:63], v[204:207]
    ds_read_b64_tr_b16 v[228:229], v232 offset:35840
    v_mfma_f32_16x16x32_bf16 v[204:207], v[176:179], v[52:55], v[204:207]
    ds_read_b64_tr_b16 v[230:231], v232 offset:36864
    s_waitcnt lgkmcnt(8)
    v_mfma_f32_16x16x32_bf16 v[192:195], v[208:211], v[64:67], v[192:195]
    ds_read_b64_tr_b16 v[176:177], v233 offset:33792
    v_mfma_f32_16x16x32_bf16 v[192:195], v[212:215], v[72:75], v[192:195]
    ds_read_b64_tr_b16 v[178:179], v233 offset:34816
    v_mfma_f32_16x16x32_bf16 v[200:203], v[212:215], v[76:79], v[200:203]
    ds_read_b64_tr_b16 v[180:181], v233 offset:35840
    v_mfma_f32_16x16x32_bf16 v[200:203], v[208:211], v[68:71], v[200:203]
    ds_read_b64_tr_b16 v[182:183], v233 offset:36864
    s_waitcnt lgkmcnt(8)
    v_mfma_f32_16x16x32_bf16 v[196:199], v[216:219], v[64:67], v[196:199]
    ds_read_b64_tr_b16 v[208:209], v232 offset:37888
    v_mfma_f32_16x16x32_bf16 v[196:199], v[220:223], v[72:75], v[196:199]
    ds_read_b64_tr_b16 v[210:211], v232 offset:38912
    v_mfma_f32_16x16x32_bf16 v[204:207], v[220:223], v[76:79], v[204:207]
    ds_read_b64_tr_b16 v[212:213], v232 offset:39936
    v_mfma_f32_16x16x32_bf16 v[204:207], v[216:219], v[68:71], v[204:207]
    ds_read_b64_tr_b16 v[214:215], v232 offset:40960
    s_waitcnt lgkmcnt(8)
    v_mfma_f32_16x16x32_bf16 v[192:195], v[224:227], v[80:83], v[192:195]
    ds_read_b64_tr_b16 v[216:217], v233 offset:37888
    v_mfma_f32_16x16x32_bf16 v[192:195], v[228:231], v[88:91], v[192:195]
    ds_read_b64_tr_b16 v[218:219], v233 offset:38912
    v_mfma_f32_16x16x32_bf16 v[200:203], v[228:231], v[92:95], v[200:203]
    ds_read_b64_tr_b16 v[220:221], v233 offset:39936
    v_mfma_f32_16x16x32_bf16 v[200:203], v[224:227], v[84:87], v[200:203]
    ds_read_b64_tr_b16 v[222:223], v233 offset:40960
    s_waitcnt lgkmcnt(8)
    v_mfma_f32_16x16x32_bf16 v[196:199], v[176:179], v[80:83], v[196:199]
    ds_read_b64_tr_b16 v[224:225], v232 offset:41984
    v_mfma_f32_16x16x32_bf16 v[196:199], v[180:183], v[88:91], v[196:199]
    ds_read_b64_tr_b16 v[226:227], v232 offset:43008
    v_mfma_f32_16x16x32_bf16 v[204:207], v[180:183], v[92:95], v[204:207]
    ds_read_b64_tr_b16 v[228:229], v232 offset:44032
    v_mfma_f32_16x16x32_bf16 v[204:207], v[176:179], v[84:87], v[204:207]
    ds_read_b64_tr_b16 v[230:231], v232 offset:45056
    s_waitcnt lgkmcnt(8)
    v_mfma_f32_16x16x32_bf16 v[192:195], v[208:211], v[96:99], v[192:195]
    ds_read_b64_tr_b16 v[176:177], v233 offset:41984
    v_mfma_f32_16x16x32_bf16 v[192:195], v[212:215], v[104:107], v[192:195]
    ds_read_b64_tr_b16 v[178:179], v233 offset:43008
    v_mfma_f32_16x16x32_bf16 v[200:203], v[212:215], v[108:111], v[200:203]
    ds_read_b64_tr_b16 v[180:181], v233 offset:44032
    v_mfma_f32_16x16x32_bf16 v[200:203], v[208:211], v[100:103], v[200:203]
    ds_read_b64_tr_b16 v[182:183], v233 offset:45056
    s_waitcnt lgkmcnt(8)
    v_mfma_f32_16x16x32_bf16 v[196:199], v[216:219], v[96:99], v[196:199]
    v_add_u32 v232, 0xffff7400, v232
    ds_read_b64_tr_b16 v[208:209], v232 offset:8192
    v_mfma_f32_16x16x32_bf16 v[196:199], v[220:223], v[104:107], v[196:199]
    ds_read_b64_tr_b16 v[210:211], v232 offset:9216
    v_mfma_f32_16x16x32_bf16 v[204:207], v[220:223], v[108:111], v[204:207]
    ds_read_b64_tr_b16 v[212:213], v232 offset:10240
    v_mfma_f32_16x16x32_bf16 v[204:207], v[216:219], v[100:103], v[204:207]
    ds_read_b64_tr_b16 v[214:215], v232 offset:11264
    s_waitcnt lgkmcnt(8)
    v_mfma_f32_16x16x32_bf16 v[192:195], v[224:227], v[112:115], v[192:195]
    v_add_u32 v233, 0xffff7400, v233
    ds_read_b64_tr_b16 v[216:217], v233 offset:8192
    v_mfma_f32_16x16x32_bf16 v[192:195], v[228:231], v[120:123], v[192:195]
    ds_read_b64_tr_b16 v[218:219], v233 offset:9216
    v_mfma_f32_16x16x32_bf16 v[200:203], v[228:231], v[124:127], v[200:203]
    ds_read_b64_tr_b16 v[220:221], v233 offset:10240
    v_mfma_f32_16x16x32_bf16 v[200:203], v[224:227], v[116:119], v[200:203]
    ds_read_b64_tr_b16 v[222:223], v233 offset:11264
    s_waitcnt lgkmcnt(8)
    v_mfma_f32_16x16x32_bf16 v[196:199], v[176:179], v[112:115], v[196:199]
    v_mfma_f32_16x16x32_bf16 v[196:199], v[180:183], v[120:123], v[196:199]
    v_mfma_f32_16x16x32_bf16 v[204:207], v[180:183], v[124:127], v[204:207]
    v_mfma_f32_16x16x32_bf16 v[204:207], v[176:179], v[116:119], v[204:207]
    s_waitcnt lgkmcnt(4)
    v_mfma_f32_16x16x32_bf16 v[192:195], v[208:211], v[128:131], v[192:195]
    v_mfma_f32_16x16x32_bf16 v[192:195], v[212:215], v[136:139], v[192:195]
    v_mfma_f32_16x16x32_bf16 v[200:203], v[212:215], v[140:143], v[200:203]
    v_mfma_f32_16x16x32_bf16 v[200:203], v[208:211], v[132:135], v[200:203]
    s_waitcnt lgkmcnt(0)
    v_mfma_f32_16x16x32_bf16 v[196:199], v[216:219], v[128:131], v[196:199]
    v_mfma_f32_16x16x32_bf16 v[196:199], v[220:223], v[136:139], v[196:199]
    v_mfma_f32_16x16x32_bf16 v[204:207], v[220:223], v[140:143], v[204:207]
    v_mfma_f32_16x16x32_bf16 v[204:207], v[216:219], v[132:135], v[204:207]
    s_waitcnt vmcnt(1)
    s_barrier
    v_add_u32 v234, 0xffff2000, v234
    ds_read_b64_tr_b16 v[208:209], v234 offset:2048
    ds_read_b64_tr_b16 v[210:211], v234 offset:4608
    ds_read_b64_tr_b16 v[212:213], v234 offset:7168
    ds_read_b64_tr_b16 v[214:215], v234 offset:9728
    v_add_u32 v232, 0xfffec800, v232
    ds_read_b64_tr_b16 v[216:217], v232 offset:0
    ds_read_b64_tr_b16 v[218:219], v232 offset:2560
    ds_read_b64_tr_b16 v[220:221], v232 offset:5120
    ds_read_b64_tr_b16 v[222:223], v232 offset:7680
    s_waitcnt lgkmcnt(0)
    s_xor_b32 s92, s92, s55
    s_xor_b32 s93, s93, s55
    s_xor_b32 s94, s94, s55
    s_xor_b32 s95, s95, s55
    s_xor_b32 s96, s96, s55
    s_or_b32 s92, s92, s96
    s_or_b64 s[92:93], s[92:93], s[94:95]
    s_cbranch_scc1 L_pslow_138
L_pback_139:
    s_setprio 1
    v_mul_f32 v246, v192, v192
    v_mul_f32 v247, v193, v193
    v_mul_f32 v248, v194, v194
    v_mul_f32 v249, v195, v195
    v_mul_f32 v250, v196, v196
    v_mul_f32 v251, v197, v197
    v_mul_f32 v252, v198, v198
    v_mul_f32 v253, v199, v199
    buffer_load_dwordx4 v[0:3], v254, s[44:47], s25 offen offset:0 sc1
    v_fma_f32 v246, v246, v239, v238
    v_fma_f32 v247, v247, v239, v238
    v_fma_f32 v248, v248, v239, v238
    v_fma_f32 v249, v249, v239, v238
    v_fma_f32 v250, v250, v239, v238
    v_fma_f32 v251, v251, v239, v238
    v_fma_f32 v252, v252, v239, v238
    v_fma_f32 v253, v253, v239, v238
    v_mul_f32 v246, v246, v192
    buffer_load_dwordx4 v[4:7], v254, s[44:47], s25 offen offset:1024 sc1
    v_mul_f32 v247, v247, v193
    v_mul_f32 v248, v248, v194
    v_mul_f32 v249, v249, v195
    v_mul_f32 v250, v250, v196
    v_mul_f32 v251, v251, v197
    v_mul_f32 v252, v252, v198
    v_mul_f32 v253, v253, v199
    v_exp_f32 v246, v246
    v_exp_f32 v247, v247
    buffer_load_dwordx4 v[8:11], v254, s[44:47], s25 offen offset:2048 sc1
    v_exp_f32 v248, v248
    v_exp_f32 v249, v249
    v_exp_f32 v250, v250
    v_exp_f32 v251, v251
    v_exp_f32 v252, v252
    v_exp_f32 v253, v253
    v_fma_f32 v246, v246, v240, v240
    v_fma_f32 v247, v247, v240, v240
    v_fma_f32 v248, v248, v240, v240
    buffer_load_dwordx4 v[12:15], v254, s[44:47], s25 offen offset:3072 sc1
    v_fma_f32 v249, v249, v240, v240
    v_fma_f32 v250, v250, v240, v240
    v_fma_f32 v251, v251, v240, v240
    v_fma_f32 v252, v252, v240, v240
    v_fma_f32 v253, v253, v240, v240
    v_rcp_f32 v246, v246
    v_rcp_f32 v247, v247
    v_rcp_f32 v248, v248
    v_rcp_f32 v249, v249
    buffer_load_dwordx4 v[16:19], v254, s[44:47], s26 offen offset:0 sc1
    v_rcp_f32 v250, v250
    v_rcp_f32 v251, v251
    v_rcp_f32 v252, v252
    v_rcp_f32 v253, v253
    v_mul_f32 v246, v246, v192
    v_mul_f32 v247, v247, v193
    v_mul_f32 v248, v248, v194
    v_mul_f32 v249, v249, v195
    v_mul_f32 v250, v250, v196
    buffer_load_dwordx4 v[20:23], v254, s[44:47], s26 offen offset:1024 sc1
    v_mul_f32 v251, v251, v197
    v_mul_f32 v252, v252, v198
    v_mul_f32 v253, v253, v199
    v_cvt_pk_bf16_f32 v168, v246, v247
    v_cvt_pk_bf16_f32 v169, v248, v249
    v_cvt_pk_bf16_f32 v170, v250, v251
    v_cvt_pk_bf16_f32 v171, v252, v253
    buffer_store_dwordx4 v[168:171], v254, s[44:47], s21 offen offset:2048 sc1
    v_mul_f32 v246, v200, v200
    buffer_load_dwordx4 v[24:27], v254, s[44:47], s26 offen offset:2048 sc1
    v_mul_f32 v247, v201, v201
    v_mul_f32 v248, v202, v202
    v_mul_f32 v249, v203, v203
    v_mul_f32 v250, v204, v204
    v_mul_f32 v251, v205, v205
    v_mul_f32 v252, v206, v206
    v_mul_f32 v253, v207, v207
    v_fma_f32 v246, v246, v243, v242
    v_fma_f32 v247, v247, v243, v242
    buffer_load_dwordx4 v[28:31], v254, s[44:47], s26 offen offset:3072 sc1
    v_fma_f32 v248, v248, v243, v242
    v_fma_f32 v249, v249, v243, v242
    v_fma_f32 v250, v250, v243, v242
    v_fma_f32 v251, v251, v243, v242
    v_fma_f32 v252, v252, v243, v242
    v_fma_f32 v253, v253, v243, v242
    v_mul_f32 v246, v246, v200
    v_mul_f32 v247, v247, v201
    v_mul_f32 v248, v248, v202
    buffer_load_dwordx4 v[32:35], v254, s[44:47], s27 offen offset:0 sc1
    v_mul_f32 v249, v249, v203
    v_mul_f32 v250, v250, v204
    v_mul_f32 v251, v251, v205
    v_mul_f32 v252, v252, v206
    v_mul_f32 v253, v253, v207
    v_exp_f32 v246, v246
    v_exp_f32 v247, v247
    v_exp_f32 v248, v248
    v_exp_f32 v249, v249
    buffer_load_dwordx4 v[36:39], v254, s[44:47], s27 offen offset:1024 sc1
    v_exp_f32 v250, v250
    v_exp_f32 v251, v251
    v_exp_f32 v252, v252
    v_exp_f32 v253, v253
    v_fma_f32 v246, v246, v244, v244
    v_fma_f32 v247, v247, v244, v244
    v_fma_f32 v248, v248, v244, v244
    v_fma_f32 v249, v249, v244, v244
    v_fma_f32 v250, v250, v244, v244
    buffer_load_dwordx4 v[40:43], v254, s[44:47], s27 offen offset:2048 sc1
    v_fma_f32 v251, v251, v244, v244
    v_fma_f32 v252, v252, v244, v244
    v_fma_f32 v253, v253, v244, v244
    v_rcp_f32 v246, v246
    v_rcp_f32 v247, v247
    v_rcp_f32 v248, v248
    v_rcp_f32 v249, v249
    v_rcp_f32 v250, v250
    v_rcp_f32 v251, v251
    buffer_load_dwordx4 v[44:47], v254, s[44:47], s27 offen offset:3072 sc1
    v_rcp_f32 v252, v252
    v_rcp_f32 v253, v253
    v_mul_f32 v246, v246, v200
    v_mul_f32 v247, v247, v201
    v_mul_f32 v248, v248, v202
    v_mul_f32 v249, v249, v203
    v_mul_f32 v250, v250, v204
    v_mul_f32 v251, v251, v205
    v_mul_f32 v252, v252, v206
    v_mul_f32 v253, v253, v207
    v_cvt_pk_bf16_f32 v172, v246, v247
    v_cvt_pk_bf16_f32 v173, v248, v249
    v_cvt_pk_bf16_f32 v174, v250, v251
    v_cvt_pk_bf16_f32 v175, v252, v253
    buffer_store_dwordx4 v[172:175], v254, s[44:47], s21 offen offset:3072 sc1
    s_setprio 0
    s_add_u32 s61, s0, 32768
    buffer_load_dwordx4 v[48:51], v254, s[44:47], s61 offen offset:0 sc1
    buffer_load_dwordx4 v[52:55], v254, s[44:47], s61 offen offset:1024 sc1
    buffer_load_dwordx4 v[56:59], v254, s[44:47], s61 offen offset:2048 sc1
    buffer_load_dwordx4 v[60:63], v254, s[44:47], s61 offen offset:3072 sc1
    v_mfma_f32_16x16x32_bf16 v[132:135], v[208:211], v[144:147], 0
    v_add_u32 v233, 0xfffec800, v233
    ds_read_b64_tr_b16 v[224:225], v233 offset:0
    v_mfma_f32_16x16x32_bf16 v[132:135], v[212:215], v[152:155], v[132:135]
    ds_read_b64_tr_b16 v[226:227], v233 offset:2560
    v_mfma_f32_16x16x32_bf16 v[136:139], v[212:215], v[156:159], 0
    ds_read_b64_tr_b16 v[228:229], v233 offset:5120
    v_mfma_f32_16x16x32_bf16 v[136:139], v[208:211], v[148:151], v[136:139]
    ds_read_b64_tr_b16 v[230:231], v233 offset:7680
    s_sub_u32 s61, s1, 249856
    s_mul_i32 s61, s61, 10
    s_add_u32 s61, s61, 8912896
    buffer_load_dwordx4 v[64:67], v254, s[44:47], s61 offen offset:0 sc1
    s_waitcnt vmcnt(5)
    s_buffer_atomic_swap s55, s[44:47], s41 offset:32
    s_buffer_atomic_swap s55, s[44:47], s41 offset:160
    s_buffer_atomic_swap s55, s[44:47], s41 offset:288
    s_buffer_atomic_swap s55, s[44:47], s41 offset:416
    v_mfma_f32_16x16x32_bf16 v[176:179], v[216:219], v[144:147], 0
    ds_read_b64_tr_b16 v[208:209], v232 offset:1024
    v_mfma_f32_16x16x32_bf16 v[176:179], v[220:223], v[152:155], v[176:179]
    ds_read_b64_tr_b16 v[210:211], v232 offset:3584
    v_mfma_f32_16x16x32_bf16 v[184:187], v[220:223], v[156:159], 0
    ds_read_b64_tr_b16 v[212:213], v232 offset:6144
    v_mfma_f32_16x16x32_bf16 v[184:187], v[216:219], v[148:151], v[184:187]
    ds_read_b64_tr_b16 v[214:215], v232 offset:8704
    buffer_load_dwordx4 v[68:71], v254, s[44:47], s61 offen offset:1024 sc1
    s_waitcnt lgkmcnt(4)
    v_mfma_f32_16x16x32_bf16 v[180:183], v[224:227], v[144:147], 0
    ds_read_b64_tr_b16 v[216:217], v233 offset:1024
    v_mfma_f32_16x16x32_bf16 v[180:183], v[228:231], v[152:155], v[180:183]
    ds_read_b64_tr_b16 v[218:219], v233 offset:3584
    v_mfma_f32_16x16x32_bf16 v[188:191], v[228:231], v[156:159], 0
    ds_read_b64_tr_b16 v[220:221], v233 offset:6144
    v_mfma_f32_16x16x32_bf16 v[188:191], v[224:227], v[148:151], v[188:191]
    ds_read_b64_tr_b16 v[222:223], v233 offset:8704
    s_waitcnt lgkmcnt(4)
    v_mfma_f32_16x16x32_bf16 v[192:195], v[208:211], v[144:147], 0
    ds_read_b64_tr_b16 v[224:225], v234 offset:12288
    v_mfma_f32_16x16x32_bf16 v[192:195], v[212:215], v[152:155], v[192:195]
    ds_read_b64_tr_b16 v[226:227], v234 offset:14848
    v_mfma_f32_16x16x32_bf16 v[200:203], v[212:215], v[156:159], 0
    ds_read_b64_tr_b16 v[228:229], v234 offset:17408
    v_mfma_f32_16x16x32_bf16 v[200:203], v[208:211], v[148:151], v[200:203]
    ds_read_b64_tr_b16 v[230:231], v234 offset:19968
    buffer_load_dwordx4 v[72:75], v254, s[44:47], s61 offen offset:2048 sc1
    s_waitcnt lgkmcnt(4)
    v_mfma_f32_16x16x32_bf16 v[196:199], v[216:219], v[144:147], 0
    ds_read_b64_tr_b16 v[208:209], v232 offset:10240
    v_mfma_f32_16x16x32_bf16 v[196:199], v[220:223], v[152:155], v[196:199]
    ds_read_b64_tr_b16 v[210:211], v232 offset:12800
    v_mfma_f32_16x16x32_bf16 v[204:207], v[220:223], v[156:159], 0
    ds_read_b64_tr_b16 v[212:213], v232 offset:15360
    v_mfma_f32_16x16x32_bf16 v[204:207], v[216:219], v[148:151], v[204:207]
    ds_read_b64_tr_b16 v[214:215], v232 offset:17920
    buffer_load_dwordx4 v[76:79], v254, s[44:47], s61 offen offset:3072 sc1
    s_waitcnt lgkmcnt(4)
    v_mfma_f32_16x16x32_bf16 v[132:135], v[224:227], v[160:163], v[132:135]
    ds_read_b64_tr_b16 v[216:217], v233 offset:10240
    v_mfma_f32_16x16x32_bf16 v[132:135], v[228:231], v[168:171], v[132:135]
    ds_read_b64_tr_b16 v[218:219], v233 offset:12800
    v_mfma_f32_16x16x32_bf16 v[136:139], v[228:231], v[172:175], v[136:139]
    ds_read_b64_tr_b16 v[220:221], v233 offset:15360
    v_mfma_f32_16x16x32_bf16 v[136:139], v[224:227], v[164:167], v[136:139]
    ds_read_b64_tr_b16 v[222:223], v233 offset:17920
    s_waitcnt lgkmcnt(4)
    v_mfma_f32_16x16x32_bf16 v[176:179], v[208:211], v[160:163], v[176:179]
    ds_read_b64_tr_b16 v[224:225], v232 offset:11264
    v_mfma_f32_16x16x32_bf16 v[176:179], v[212:215], v[168:171], v[176:179]
    ds_read_b64_tr_b16 v[226:227], v232 offset:13824
    v_mfma_f32_16x16x32_bf16 v[184:187], v[212:215], v[172:175], v[184:187]
    ds_read_b64_tr_b16 v[228:229], v232 offset:16384
    v_mfma_f32_16x16x32_bf16 v[184:187], v[208:211], v[164:167], v[184:187]
    ds_read_b64_tr_b16 v[230:231], v232 offset:18944
    s_add_u32 s61, s61, 4096
    buffer_load_dwordx4 v[80:83], v254, s[44:47], s61 offen offset:0 sc1
    s_waitcnt lgkmcnt(4)
    v_mfma_f32_16x16x32_bf16 v[180:183], v[216:219], v[160:163], v[180:183]
    ds_read_b64_tr_b16 v[208:209], v233 offset:11264
    v_mfma_f32_16x16x32_bf16 v[180:183], v[220:223], v[168:171], v[180:183]
    ds_read_b64_tr_b16 v[210:211], v233 offset:13824
    v_mfma_f32_16x16x32_bf16 v[188:191], v[220:223], v[172:175], v[188:191]
    ds_read_b64_tr_b16 v[212:213], v233 offset:16384
    v_mfma_f32_16x16x32_bf16 v[188:191], v[216:219], v[164:167], v[188:191]
    ds_read_b64_tr_b16 v[214:215], v233 offset:18944
    s_waitcnt lgkmcnt(4)
    v_mfma_f32_16x16x32_bf16 v[192:195], v[224:227], v[160:163], v[192:195]
    ds_read_b64_tr_b16 v[216:217], v234 offset:22528
    v_mfma_f32_16x16x32_bf16 v[192:195], v[228:231], v[168:171], v[192:195]
    ds_read_b64_tr_b16 v[218:219], v234 offset:25088
    v_mfma_f32_16x16x32_bf16 v[200:203], v[228:231], v[172:175], v[200:203]
    ds_read_b64_tr_b16 v[220:221], v234 offset:27648
    v_mfma_f32_16x16x32_bf16 v[200:203], v[224:227], v[164:167], v[200:203]
    ds_read_b64_tr_b16 v[222:223], v234 offset:30208
    s_waitcnt lgkmcnt(4)
    v_mfma_f32_16x16x32_bf16 v[196:199], v[208:211], v[160:163], v[196:199]
    ds_read_b64_tr_b16 v[224:225], v232 offset:20480
    v_mfma_f32_16x16x32_bf16 v[196:199], v[212:215], v[168:171], v[196:199]
    ds_read_b64_tr_b16 v[226:227], v232 offset:23040
    v_mfma_f32_16x16x32_bf16 v[204:207], v[212:215], v[172:175], v[204:207]
    ds_read_b64_tr_b16 v[228:229], v232 offset:25600
    v_mfma_f32_16x16x32_bf16 v[204:207], v[208:211], v[164:167], v[204:207]
    ds_read_b64_tr_b16 v[230:231], v232 offset:28160
    s_buffer_load_dwordx4 s[92:95], s[44:47], s40 offset:32 glc
    s_waitcnt lgkmcnt(4)
    v_mfma_f32_16x16x32_bf16 v[132:135], v[216:219], v[0:3], v[132:135]
    ds_read_b64_tr_b16 v[208:209], v233 offset:20480
    v_mfma_f32_16x16x32_bf16 v[132:135], v[220:223], v[8:11], v[132:135]
    ds_read_b64_tr_b16 v[210:211], v233 offset:23040
    v_mfma_f32_16x16x32_bf16 v[136:139], v[220:223], v[12:15], v[136:139]
    ds_read_b64_tr_b16 v[212:213], v233 offset:25600
    v_mfma_f32_16x16x32_bf16 v[136:139], v[216:219], v[4:7], v[136:139]
    ds_read_b64_tr_b16 v[214:215], v233 offset:28160
    s_waitcnt lgkmcnt(4)
    v_mfma_f32_16x16x32_bf16 v[176:179], v[224:227], v[0:3], v[176:179]
    ds_read_b64_tr_b16 v[216:217], v232 offset:21504
    v_mfma_f32_16x16x32_bf16 v[176:179], v[228:231], v[8:11], v[176:179]
    ds_read_b64_tr_b16 v[218:219], v232 offset:24064
    v_mfma_f32_16x16x32_bf16 v[184:187], v[228:231], v[12:15], v[184:187]
    ds_read_b64_tr_b16 v[220:221], v232 offset:26624
    v_mfma_f32_16x16x32_bf16 v[184:187], v[224:227], v[4:7], v[184:187]
    ds_read_b64_tr_b16 v[222:223], v232 offset:29184
    s_waitcnt lgkmcnt(4)
    v_mfma_f32_16x16x32_bf16 v[180:183], v[208:211], v[0:3], v[180:183]
    ds_read_b64_tr_b16 v[224:225], v233 offset:21504
    v_mfma_f32_16x16x32_bf16 v[180:183], v[212:215], v[8:11], v[180:183]
    ds_read_b64_tr_b16 v[226:227], v233 offset:24064
    v_mfma_f32_16x16x32_bf16 v[188:191], v[212:215], v[12:15], v[188:191]
    ds_read_b64_tr_b16 v[228:229], v233 offset:26624
    v_mfma_f32_16x16x32_bf16 v[188:191], v[208:211], v[4:7], v[188:191]
    ds_read_b64_tr_b16 v[230:231], v233 offset:29184
    s_waitcnt lgkmcnt(4)
    v_mfma_f32_16x16x32_bf16 v[192:195], v[216:219], v[0:3], v[192:195]
    ds_read_b64_tr_b16 v[208:209], v234 offset:32768
    v_mfma_f32_16x16x32_bf16 v[192:195], v[220:223], v[8:11], v[192:195]
    ds_read_b64_tr_b16 v[210:211], v234 offset:35328
    v_mfma_f32_16x16x32_bf16 v[200:203], v[220:223], v[12:15], v[200:203]
    ds_read_b64_tr_b16 v[212:213], v234 offset:37888
    v_mfma_f32_16x16x32_bf16 v[200:203], v[216:219], v[4:7], v[200:203]
    ds_read_b64_tr_b16 v[214:215], v234 offset:40448
    s_waitcnt lgkmcnt(4)
    v_mfma_f32_16x16x32_bf16 v[196:199], v[224:227], v[0:3], v[196:199]
    ds_read_b64_tr_b16 v[216:217], v232 offset:30720
    v_mfma_f32_16x16x32_bf16 v[196:199], v[228:231], v[8:11], v[196:199]
    ds_read_b64_tr_b16 v[218:219], v232 offset:33280
    v_mfma_f32_16x16x32_bf16 v[204:207], v[228:231], v[12:15], v[204:207]
    ds_read_b64_tr_b16 v[220:221], v232 offset:35840
    v_mfma_f32_16x16x32_bf16 v[204:207], v[224:227], v[4:7], v[204:207]
    ds_read_b64_tr_b16 v[222:223], v232 offset:38400
    s_waitcnt lgkmcnt(4)
    v_mfma_f32_16x16x32_bf16 v[132:135], v[208:211], v[16:19], v[132:135]
    ds_read_b64_tr_b16 v[224:225], v233 offset:30720
    v_mfma_f32_16x16x32_bf16 v[132:135], v[212:215], v[24:27], v[132:135]
    ds_read_b64_tr_b16 v[226:227], v233 offset:33280
    v_mfma_f32_16x16x32_bf16 v[136:139], v[212:215], v[28:31], v[136:139]
    ds_read_b64_tr_b16 v[228:229], v233 offset:35840
    v_mfma_f32_16x16x32_bf16 v[136:139], v[208:211], v[20:23], v[136:139]
    ds_read_b64_tr_b16 v[230:231], v233 offset:38400
    s_waitcnt lgkmcnt(4)
    v_mfma_f32_16x16x32_bf16 v[176:179], v[216:219], v[16:19], v[176:179]
    ds_read_b64_tr_b16 v[208:209], v232 offset:31744
    v_mfma_f32_16x16x32_bf16 v[176:179], v[220:223], v[24:27], v[176:179]
    ds_read_b64_tr_b16 v[210:211], v232 offset:34304
    v_mfma_f32_16x16x32_bf16 v[184:187], v[220:223], v[28:31], v[184:187]
    ds_read_b64_tr_b16 v[212:213], v232 offset:36864
    v_mfma_f32_16x16x32_bf16 v[184:187], v[216:219], v[20:23], v[184:187]
    ds_read_b64_tr_b16 v[214:215], v232 offset:39424
    s_waitcnt lgkmcnt(4)
    v_mfma_f32_16x16x32_bf16 v[180:183], v[224:227], v[16:19], v[180:183]
    ds_read_b64_tr_b16 v[216:217], v233 offset:31744
    v_mfma_f32_16x16x32_bf16 v[180:183], v[228:231], v[24:27], v[180:183]
    ds_read_b64_tr_b16 v[218:219], v233 offset:34304
    v_mfma_f32_16x16x32_bf16 v[188:191], v[228:231], v[28:31], v[188:191]
    ds_read_b64_tr_b16 v[220:221], v233 offset:36864
    v_mfma_f32_16x16x32_bf16 v[188:191], v[224:227], v[20:23], v[188:191]
    ds_read_b64_tr_b16 v[222:223], v233 offset:39424
    s_waitcnt lgkmcnt(0)
    s_xor_b32 s92, s92, s55
    s_xor_b32 s93, s93, s55
    s_xor_b32 s94, s94, s55
    s_xor_b32 s95, s95, s55
    s_or_b64 s[92:93], s[92:93], s[94:95]
    s_cbranch_scc1 L_pslow_142
L_pback_143:
    v_mfma_f32_16x16x32_bf16 v[192:195], v[208:211], v[16:19], v[192:195]
    ds_read_b64_tr_b16 v[224:225], v234 offset:43008
    v_mfma_f32_16x16x32_bf16 v[192:195], v[212:215], v[24:27], v[192:195]
    ds_read_b64_tr_b16 v[226:227], v234 offset:45568
    v_mfma_f32_16x16x32_bf16 v[200:203], v[212:215], v[28:31], v[200:203]
    ds_read_b64_tr_b16 v[228:229], v234 offset:48128
    v_mfma_f32_16x16x32_bf16 v[200:203], v[208:211], v[20:23], v[200:203]
    ds_read_b64_tr_b16 v[230:231], v234 offset:50688
    s_add_u32 s25, s25, 4096
    buffer_load_dwordx4 v[84:87], v254, s[44:47], s25 offen offset:0 sc1
    v_mfma_f32_16x16x32_bf16 v[196:199], v[216:219], v[16:19], v[196:199]
    ds_read_b64_tr_b16 v[208:209], v232 offset:40960
    v_mfma_f32_16x16x32_bf16 v[196:199], v[220:223], v[24:27], v[196:199]
    ds_read_b64_tr_b16 v[210:211], v232 offset:43520
    v_mfma_f32_16x16x32_bf16 v[204:207], v[220:223], v[28:31], v[204:207]
    ds_read_b64_tr_b16 v[212:213], v232 offset:46080
    v_mfma_f32_16x16x32_bf16 v[204:207], v[216:219], v[20:23], v[204:207]
    ds_read_b64_tr_b16 v[214:215], v232 offset:48640
    buffer_load_dwordx4 v[88:91], v254, s[44:47], s25 offen offset:1024 sc1
    s_waitcnt lgkmcnt(4)
    v_mfma_f32_16x16x32_bf16 v[132:135], v[224:227], v[32:35], v[132:135]
    ds_read_b64_tr_b16 v[216:217], v233 offset:40960
    v_mfma_f32_16x16x32_bf16 v[132:135], v[228:231], v[40:43], v[132:135]
    ds_read_b64_tr_b16 v[218:219], v233 offset:43520
    v_mfma_f32_16x16x32_bf16 v[136:139], v[228:231], v[44:47], v[136:139]
    ds_read_b64_tr_b16 v[220:221], v233 offset:46080
    v_mfma_f32_16x16x32_bf16 v[136:139], v[224:227], v[36:39], v[136:139]
    ds_read_b64_tr_b16 v[222:223], v233 offset:48640
    buffer_load_dwordx4 v[92:95], v254, s[44:47], s25 offen offset:2048 sc1
    s_waitcnt lgkmcnt(4)
    v_mfma_f32_16x16x32_bf16 v[176:179], v[208:211], v[32:35], v[176:179]
    ds_read_b64_tr_b16 v[224:225], v232 offset:41984
    v_mfma_f32_16x16x32_bf16 v[176:179], v[212:215], v[40:43], v[176:179]
    ds_read_b64_tr_b16 v[226:227], v232 offset:44544
    v_mfma_f32_16x16x32_bf16 v[184:187], v[212:215], v[44:47], v[184:187]
    ds_read_b64_tr_b16 v[228:229], v232 offset:47104
    v_mfma_f32_16x16x32_bf16 v[184:187], v[208:211], v[36:39], v[184:187]
    ds_read_b64_tr_b16 v[230:231], v232 offset:49664
    buffer_load_dwordx4 v[96:99], v254, s[44:47], s25 offen offset:3072 sc1
    s_waitcnt lgkmcnt(4)
    v_mfma_f32_16x16x32_bf16 v[180:183], v[216:219], v[32:35], v[180:183]
    ds_read_b64_tr_b16 v[208:209], v233 offset:41984
    v_mfma_f32_16x16x32_bf16 v[180:183], v[220:223], v[40:43], v[180:183]
    ds_read_b64_tr_b16 v[210:211], v233 offset:44544
    v_mfma_f32_16x16x32_bf16 v[188:191], v[220:223], v[44:47], v[188:191]
    ds_read_b64_tr_b16 v[212:213], v233 offset:47104
    v_mfma_f32_16x16x32_bf16 v[188:191], v[216:219], v[36:39], v[188:191]
    ds_read_b64_tr_b16 v[214:215], v233 offset:49664
    s_add_u32 s26, s26, 4096
    buffer_load_dwordx4 v[100:103], v254, s[44:47], s26 offen offset:0 sc1
    s_waitcnt vmcnt(12)
    v_swap_b32 v50, v52
    v_swap_b32 v51, v53
    s_waitcnt vmcnt(10)
    v_swap_b32 v58, v60
    v_swap_b32 v59, v61
    s_waitcnt lgkmcnt(4)
    v_mfma_f32_16x16x32_bf16 v[192:195], v[224:227], v[32:35], v[192:195]
    ds_read_b64_tr_b16 v[216:217], v234 offset:53248
    v_mfma_f32_16x16x32_bf16 v[192:195], v[228:231], v[40:43], v[192:195]
    ds_read_b64_tr_b16 v[218:219], v234 offset:55808
    v_mfma_f32_16x16x32_bf16 v[200:203], v[228:231], v[44:47], v[200:203]
    ds_read_b64_tr_b16 v[220:221], v234 offset:58368
    v_mfma_f32_16x16x32_bf16 v[200:203], v[224:227], v[36:39], v[200:203]
    ds_read_b64_tr_b16 v[222:223], v234 offset:60928
    buffer_load_dwordx4 v[104:107], v254, s[44:47], s26 offen offset:1024 sc1
    s_waitcnt lgkmcnt(4)
    v_mfma_f32_16x16x32_bf16 v[196:199], v[208:211], v[32:35], v[196:199]
    ds_read_b64_tr_b16 v[224:225], v232 offset:51200
    v_mfma_f32_16x16x32_bf16 v[196:199], v[212:215], v[40:43], v[196:199]
    ds_read_b64_tr_b16 v[226:227], v232 offset:53760
    v_mfma_f32_16x16x32_bf16 v[204:207], v[212:215], v[44:47], v[204:207]
    ds_read_b64_tr_b16 v[228:229], v232 offset:56320
    v_mfma_f32_16x16x32_bf16 v[204:207], v[208:211], v[36:39], v[204:207]
    ds_read_b64_tr_b16 v[230:231], v232 offset:58880
    buffer_load_dwordx4 v[108:111], v254, s[44:47], s26 offen offset:2048 sc1
    s_waitcnt lgkmcnt(4)
    v_mfma_f32_16x16x32_bf16 v[132:135], v[216:219], v[48:51], v[132:135]
    ds_read_b64_tr_b16 v[208:209], v233 offset:51200
    v_mfma_f32_16x16x32_bf16 v[132:135], v[220:223], v[56:59], v[132:135]
    ds_read_b64_tr_b16 v[210:211], v233 offset:53760
    v_mfma_f32_16x16x32_bf16 v[136:139], v[220:223], v[60:63], v[136:139]
    ds_read_b64_tr_b16 v[212:213], v233 offset:56320
    v_mfma_f32_16x16x32_bf16 v[136:139], v[216:219], v[52:55], v[136:139]
    ds_read_b64_tr_b16 v[214:215], v233 offset:58880
    buffer_load_dwordx4 v[112:115], v254, s[44:47], s26 offen offset:3072 sc1
    s_waitcnt lgkmcnt(4)
    v_mfma_f32_16x16x32_bf16 v[176:179], v[224:227], v[48:51], v[176:179]
    ds_read_b64_tr_b16 v[216:217], v232 offset:52224
    v_mfma_f32_16x16x32_bf16 v[176:179], v[228:231], v[56:59], v[176:179]
    ds_read_b64_tr_b16 v[218:219], v232 offset:54784
    v_mfma_f32_16x16x32_bf16 v[184:187], v[228:231], v[60:63], v[184:187]
    ds_read_b64_tr_b16 v[220:221], v232 offset:57344
    v_mfma_f32_16x16x32_bf16 v[184:187], v[224:227], v[52:55], v[184:187]
    ds_read_b64_tr_b16 v[222:223], v232 offset:59904
    s_add_u32 s27, s27, 4096
    buffer_load_dwordx4 v[116:119], v254, s[44:47], s27 offen offset:0 sc1
    s_waitcnt lgkmcnt(4)
    v_mfma_f32_16x16x32_bf16 v[180:183], v[208:211], v[48:51], v[180:183]
    ds_read_b64_tr_b16 v[224:225], v233 offset:52224
    v_mfma_f32_16x16x32_bf16 v[180:183], v[212:215], v[56:59], v[180:183]
    ds_read_b64_tr_b16 v[226:227], v233 offset:54784
    v_mfma_f32_16x16x32_bf16 v[188:191], v[212:215], v[60:63], v[188:191]
    ds_read_b64_tr_b16 v[228:229], v233 offset:57344
    v_mfma_f32_16x16x32_bf16 v[188:191], v[208:211], v[52:55], v[188:191]
    ds_read_b64_tr_b16 v[230:231], v233 offset:59904
    buffer_load_dwordx4 v[120:123], v254, s[44:47], s27 offen offset:1024 sc1
    s_waitcnt lgkmcnt(4)
    v_mfma_f32_16x16x32_bf16 v[192:195], v[216:219], v[48:51], v[192:195]
    ds_read_b64_tr_b16 v[208:209], v234 offset:63488
    v_mfma_f32_16x16x32_bf16 v[192:195], v[220:223], v[56:59], v[192:195]
    v_add_u32 v234, 0x0000e000, v234
    ds_read_b64_tr_b16 v[210:211], v234 offset:8704
    v_mfma_f32_16x16x32_bf16 v[200:203], v[220:223], v[60:63], v[200:203]
    ds_read_b64_tr_b16 v[212:213], v234 offset:11264
    v_mfma_f32_16x16x32_bf16 v[200:203], v[216:219], v[52:55], v[200:203]
    ds_read_b64_tr_b16 v[214:215], v234 offset:13824
    buffer_load_dwordx4 v[124:127], v254, s[44:47], s27 offen offset:2048 sc1
    s_waitcnt lgkmcnt(4)
    v_mfma_f32_16x16x32_bf16 v[196:199], v[224:227], v[48:51], v[196:199]
    ds_read_b64_tr_b16 v[216:217], v232 offset:61440
    v_mfma_f32_16x16x32_bf16 v[196:199], v[228:231], v[56:59], v[196:199]
    ds_read_b64_tr_b16 v[218:219], v232 offset:64000
    v_mfma_f32_16x16x32_bf16 v[204:207], v[228:231], v[60:63], v[204:207]
    v_add_u32 v232, 0x0000e400, v232
    ds_read_b64_tr_b16 v[220:221], v232 offset:8192
    v_mfma_f32_16x16x32_bf16 v[204:207], v[224:227], v[52:55], v[204:207]
    ds_read_b64_tr_b16 v[222:223], v232 offset:10752
    buffer_load_dwordx4 v[128:131], v254, s[44:47], s27 offen offset:3072 sc1
    s_waitcnt lgkmcnt(4)
    s_waitcnt vmcnt(16)
    v_mfma_f32_16x16x32_bf16 v[132:135], v[208:211], v[64:67], v[132:135]
    ds_read_b64_tr_b16 v[224:225], v233 offset:61440
    s_waitcnt vmcnt(14)
    v_mfma_f32_16x16x32_bf16 v[132:135], v[212:215], v[72:75], v[132:135]
    ds_read_b64_tr_b16 v[226:227], v233 offset:64000
    s_waitcnt vmcnt(13)
    v_mfma_f32_16x16x32_bf16 v[136:139], v[212:215], v[76:79], v[136:139]
    v_add_u32 v233, 0x0000e400, v233
    ds_read_b64_tr_b16 v[228:229], v233 offset:8192
    v_mfma_f32_16x16x32_bf16 v[136:139], v[208:211], v[68:71], v[136:139]
    ds_read_b64_tr_b16 v[230:231], v233 offset:10752
    s_waitcnt lgkmcnt(4)
    v_mfma_f32_16x16x32_bf16 v[176:179], v[216:219], v[64:67], v[176:179]
    ds_read_b64_tr_b16 v[208:209], v232 offset:4096
    v_mfma_f32_16x16x32_bf16 v[176:179], v[220:223], v[72:75], v[176:179]
    ds_read_b64_tr_b16 v[210:211], v232 offset:6656
    v_mfma_f32_16x16x32_bf16 v[184:187], v[220:223], v[76:79], v[184:187]
    ds_read_b64_tr_b16 v[212:213], v232 offset:9216
    v_mfma_f32_16x16x32_bf16 v[184:187], v[216:219], v[68:71], v[184:187]
    ds_read_b64_tr_b16 v[214:215], v232 offset:11776
    s_waitcnt lgkmcnt(4)
    v_mfma_f32_16x16x32_bf16 v[180:183], v[224:227], v[64:67], v[180:183]
    ds_read_b64_tr_b16 v[216:217], v233 offset:4096
    v_mfma_f32_16x16x32_bf16 v[180:183], v[228:231], v[72:75], v[180:183]
    ds_read_b64_tr_b16 v[218:219], v233 offset:6656
    v_mfma_f32_16x16x32_bf16 v[188:191], v[228:231], v[76:79], v[188:191]
    ds_read_b64_tr_b16 v[220:221], v233 offset:9216
    v_mfma_f32_16x16x32_bf16 v[188:191], v[224:227], v[68:71], v[188:191]
    ds_read_b64_tr_b16 v[222:223], v233 offset:11776
    s_waitcnt lgkmcnt(4)
    v_mfma_f32_16x16x32_bf16 v[192:195], v[208:211], v[64:67], v[192:195]
    ds_read_b64_tr_b16 v[224:225], v234 offset:26624
    v_mfma_f32_16x16x32_bf16 v[192:195], v[212:215], v[72:75], v[192:195]
    ds_read_b64_tr_b16 v[228:229], v232 offset:23552
    v_mfma_f32_16x16x32_bf16 v[200:203], v[212:215], v[76:79], v[200:203]
    v_mfma_f32_16x16x32_bf16 v[200:203], v[208:211], v[68:71], v[200:203]
    s_waitcnt lgkmcnt(2)
    v_mfma_f32_16x16x32_bf16 v[196:199], v[216:219], v[64:67], v[196:199]
    ds_read_b64_tr_b16 v[208:209], v233 offset:23552
    v_mfma_f32_16x16x32_bf16 v[196:199], v[220:223], v[72:75], v[196:199]
    ds_read_b64_tr_b16 v[212:213], v232 offset:24576
    v_mfma_f32_16x16x32_bf16 v[204:207], v[220:223], v[76:79], v[204:207]
    v_mfma_f32_16x16x32_bf16 v[204:207], v[216:219], v[68:71], v[204:207]
    s_waitcnt vmcnt(12) lgkmcnt(3)
    v_mfma_f32_16x16x16_bf16 v[132:135], v[224:225], v[80:81], v[132:135]
    ds_read_b64_tr_b16 v[216:217], v233 offset:24576
    v_mfma_f32_16x16x16_bf16 v[136:139], v[224:225], v[82:83], v[136:139]
    ds_read_b64_tr_b16 v[220:221], v234 offset:16384
    ds_read_b64_tr_b16 v[222:223], v234 offset:18944
    s_waitcnt lgkmcnt(5)
    v_mfma_f32_16x16x16_bf16 v[176:179], v[228:229], v[80:81], v[176:179]
    ds_read_b64_tr_b16 v[224:225], v234 offset:21504
    v_mfma_f32_16x16x16_bf16 v[184:187], v[228:229], v[82:83], v[184:187]
    ds_read_b64_tr_b16 v[226:227], v234 offset:24064
    s_waitcnt lgkmcnt(6)
    v_mfma_f32_16x16x16_bf16 v[180:183], v[208:209], v[80:81], v[180:183]
    ds_read_b64_tr_b16 v[228:229], v232 offset:13312
    v_mfma_f32_16x16x16_bf16 v[188:191], v[208:209], v[82:83], v[188:191]
    ds_read_b64_tr_b16 v[230:231], v232 offset:15872
    s_waitcnt lgkmcnt(7)
    v_mfma_f32_16x16x16_bf16 v[192:195], v[212:213], v[80:81], v[192:195]
    ds_read_b64_tr_b16 v[208:209], v232 offset:18432
    v_mfma_f32_16x16x16_bf16 v[200:203], v[212:213], v[82:83], v[200:203]
    ds_read_b64_tr_b16 v[210:211], v232 offset:20992
    s_barrier
    s_waitcnt lgkmcnt(8)
    v_mfma_f32_16x16x16_bf16 v[196:199], v[216:217], v[80:81], v[196:199]
    ds_read_b64_tr_b16 v[212:213], v233 offset:13312
    v_mfma_f32_16x16x16_bf16 v[204:207], v[216:217], v[82:83], v[204:207]
    ds_read_b64_tr_b16 v[214:215], v233 offset:15872
    s_waitcnt lgkmcnt(6)
    s_waitcnt vmcnt(11)
    v_mfma_f32_16x16x32_bf16 v[132:135], v[220:223], v[84:87], v[132:135]
    ds_read_b64_tr_b16 v[216:217], v233 offset:18432
    s_waitcnt vmcnt(9)
    v_mfma_f32_16x16x32_bf16 v[132:135], v[224:227], v[92:95], v[132:135]
    ds_read_b64_tr_b16 v[218:219], v233 offset:20992
    s_waitcnt vmcnt(8)
    v_mfma_f32_16x16x32_bf16 v[136:139], v[224:227], v[96:99], v[136:139]
    v_mfma_f32_16x16x32_bf16 v[136:139], v[220:223], v[88:91], v[136:139]
    s_waitcnt lgkmcnt(4)
    v_mfma_f32_16x16x32_bf16 v[176:179], v[228:231], v[84:87], v[176:179]
    ds_read_b64_tr_b16 v[220:221], v232 offset:14336
    v_mfma_f32_16x16x32_bf16 v[176:179], v[208:211], v[92:95], v[176:179]
    ds_read_b64_tr_b16 v[222:223], v232 offset:16896
    v_mfma_f32_16x16x32_bf16 v[184:187], v[208:211], v[96:99], v[184:187]
    ds_read_b64_tr_b16 v[224:225], v232 offset:19456
    v_mfma_f32_16x16x32_bf16 v[184:187], v[228:231], v[88:91], v[184:187]
    ds_read_b64_tr_b16 v[226:227], v232 offset:22016
    s_waitcnt lgkmcnt(4)
    v_mfma_f32_16x16x32_bf16 v[180:183], v[212:215], v[84:87], v[180:183]
    ds_read_b64_tr_b16 v[228:229], v233 offset:14336
    v_mfma_f32_16x16x32_bf16 v[180:183], v[216:219], v[92:95], v[180:183]
    ds_read_b64_tr_b16 v[230:231], v233 offset:16896
    v_mfma_f32_16x16x32_bf16 v[188:191], v[216:219], v[96:99], v[188:191]
    ds_read_b64_tr_b16 v[208:209], v233 offset:19456
    v_mfma_f32_16x16x32_bf16 v[188:191], v[212:215], v[88:91], v[188:191]
    ds_read_b64_tr_b16 v[210:211], v233 offset:22016
    s_waitcnt lgkmcnt(4)
    v_mfma_f32_16x16x32_bf16 v[192:195], v[220:223], v[84:87], v[192:195]
    ds_read_b64_tr_b16 v[212:213], v234 offset:36864
    v_mfma_f32_16x16x32_bf16 v[192:195], v[224:227], v[92:95], v[192:195]
    ds_read_b64_tr_b16 v[214:215], v234 offset:39424
    v_mfma_f32_16x16x32_bf16 v[200:203], v[224:227], v[96:99], v[200:203]
    ds_read_b64_tr_b16 v[216:217], v234 offset:41984
    v_mfma_f32_16x16x32_bf16 v[200:203], v[220:223], v[88:91], v[200:203]
    ds_read_b64_tr_b16 v[218:219], v234 offset:44544
    s_waitcnt lgkmcnt(4)
    v_mfma_f32_16x16x32_bf16 v[196:199], v[228:231], v[84:87], v[196:199]
    ds_read_b64_tr_b16 v[220:221], v232 offset:33792
    v_mfma_f32_16x16x32_bf16 v[196:199], v[208:211], v[92:95], v[196:199]
    ds_read_b64_tr_b16 v[222:223], v232 offset:36352
    v_mfma_f32_16x16x32_bf16 v[204:207], v[208:211], v[96:99], v[204:207]
    ds_read_b64_tr_b16 v[224:225], v232 offset:38912
    v_mfma_f32_16x16x32_bf16 v[204:207], v[228:231], v[88:91], v[204:207]
    ds_read_b64_tr_b16 v[226:227], v232 offset:41472
    s_waitcnt lgkmcnt(4)
    s_waitcnt vmcnt(7)
    v_mfma_f32_16x16x32_bf16 v[132:135], v[212:215], v[100:103], v[132:135]
    ds_read_b64_tr_b16 v[228:229], v233 offset:33792
    s_waitcnt vmcnt(5)
    v_mfma_f32_16x16x32_bf16 v[132:135], v[216:219], v[108:111], v[132:135]
    ds_read_b64_tr_b16 v[230:231], v233 offset:36352
    s_waitcnt vmcnt(4)
    v_mfma_f32_16x16x32_bf16 v[136:139], v[216:219], v[112:115], v[136:139]
    ds_read_b64_tr_b16 v[208:209], v233 offset:38912
    v_mfma_f32_16x16x32_bf16 v[136:139], v[212:215], v[104:107], v[136:139]
    ds_read_b64_tr_b16 v[210:211], v233 offset:41472
    s_waitcnt lgkmcnt(4)
    v_mfma_f32_16x16x32_bf16 v[176:179], v[220:223], v[100:103], v[176:179]
    ds_read_b64_tr_b16 v[212:213], v232 offset:34816
    v_mfma_f32_16x16x32_bf16 v[176:179], v[224:227], v[108:111], v[176:179]
    ds_read_b64_tr_b16 v[214:215], v232 offset:37376
    v_mfma_f32_16x16x32_bf16 v[184:187], v[224:227], v[112:115], v[184:187]
    ds_read_b64_tr_b16 v[216:217], v232 offset:39936
    v_mfma_f32_16x16x32_bf16 v[184:187], v[220:223], v[104:107], v[184:187]
    ds_read_b64_tr_b16 v[218:219], v232 offset:42496
    s_waitcnt lgkmcnt(4)
    v_mfma_f32_16x16x32_bf16 v[180:183], v[228:231], v[100:103], v[180:183]
    ds_read_b64_tr_b16 v[220:221], v233 offset:34816
    v_mfma_f32_16x16x32_bf16 v[180:183], v[208:211], v[108:111], v[180:183]
    ds_read_b64_tr_b16 v[222:223], v233 offset:37376
    v_mfma_f32_16x16x32_bf16 v[188:191], v[208:211], v[112:115], v[188:191]
    ds_read_b64_tr_b16 v[224:225], v233 offset:39936
    v_mfma_f32_16x16x32_bf16 v[188:191], v[228:231], v[104:107], v[188:191]
    ds_read_b64_tr_b16 v[226:227], v233 offset:42496
    s_waitcnt lgkmcnt(4)
    v_mfma_f32_16x16x32_bf16 v[192:195], v[212:215], v[100:103], v[192:195]
    ds_read_b64_tr_b16 v[228:229], v234 offset:47104
    v_mfma_f32_16x16x32_bf16 v[192:195], v[216:219], v[108:111], v[192:195]
    ds_read_b64_tr_b16 v[230:231], v234 offset:49664
    v_mfma_f32_16x16x32_bf16 v[200:203], v[216:219], v[112:115], v[200:203]
    ds_read_b64_tr_b16 v[208:209], v234 offset:52224
    v_mfma_f32_16x16x32_bf16 v[200:203], v[212:215], v[104:107], v[200:203]
    ds_read_b64_tr_b16 v[210:211], v234 offset:54784
    s_waitcnt lgkmcnt(4)
    v_mfma_f32_16x16x32_bf16 v[196:199], v[220:223], v[100:103], v[196:199]
    ds_read_b64_tr_b16 v[212:213], v232 offset:44032
    v_mfma_f32_16x16x32_bf16 v[196:199], v[224:227], v[108:111], v[196:199]
    ds_read_b64_tr_b16 v[214:215], v232 offset:46592
    v_mfma_f32_16x16x32_bf16 v[204:207], v[224:227], v[112:115], v[204:207]
    ds_read_b64_tr_b16 v[216:217], v232 offset:49152
    v_mfma_f32_16x16x32_bf16 v[204:207], v[220:223], v[104:107], v[204:207]
    ds_read_b64_tr_b16 v[218:219], v232 offset:51712
    s_waitcnt lgkmcnt(4)
    s_waitcnt vmcnt(3)
    v_mfma_f32_16x16x32_bf16 v[132:135], v[228:231], v[116:119], v[132:135]
    ds_read_b64_tr_b16 v[220:221], v233 offset:44032
    s_waitcnt vmcnt(1)
    v_mfma_f32_16x16x32_bf16 v[132:135], v[208:211], v[124:127], v[132:135]
    ds_read_b64_tr_b16 v[222:223], v233 offset:46592
    s_waitcnt vmcnt(0)
    v_mfma_f32_16x16x32_bf16 v[136:139], v[208:211], v[128:131], v[136:139]
    ds_read_b64_tr_b16 v[224:225], v233 offset:49152
    v_mfma_f32_16x16x32_bf16 v[136:139], v[228:231], v[120:123], v[136:139]
    ds_read_b64_tr_b16 v[226:227], v233 offset:51712
    s_waitcnt lgkmcnt(4)
    v_mfma_f32_16x16x32_bf16 v[176:179], v[212:215], v[116:119], v[176:179]
    ds_read_b64_tr_b16 v[228:229], v232 offset:45056
    v_mfma_f32_16x16x32_bf16 v[176:179], v[216:219], v[124:127], v[176:179]
    ds_read_b64_tr_b16 v[230:231], v232 offset:47616
    v_mfma_f32_16x16x32_bf16 v[184:187], v[216:219], v[128:131], v[184:187]
    ds_read_b64_tr_b16 v[208:209], v232 offset:50176
    v_mfma_f32_16x16x32_bf16 v[184:187], v[212:215], v[120:123], v[184:187]
    ds_read_b64_tr_b16 v[210:211], v232 offset:52736
    s_waitcnt lgkmcnt(4)
    v_mfma_f32_16x16x32_bf16 v[180:183], v[220:223], v[116:119], v[180:183]
    ds_read_b64_tr_b16 v[212:213], v233 offset:45056
    v_mfma_f32_16x16x32_bf16 v[180:183], v[224:227], v[124:127], v[180:183]
    ds_read_b64_tr_b16 v[214:215], v233 offset:47616
    v_mfma_f32_16x16x32_bf16 v[188:191], v[224:227], v[128:131], v[188:191]
    ds_read_b64_tr_b16 v[216:217], v233 offset:50176
    v_mfma_f32_16x16x32_bf16 v[188:191], v[220:223], v[120:123], v[188:191]
    ds_read_b64_tr_b16 v[218:219], v233 offset:52736
    s_waitcnt lgkmcnt(4)
    v_mfma_f32_16x16x32_bf16 v[192:195], v[228:231], v[116:119], v[192:195]
    v_mfma_f32_16x16x32_bf16 v[192:195], v[208:211], v[124:127], v[192:195]
    v_mfma_f32_16x16x32_bf16 v[200:203], v[208:211], v[128:131], v[200:203]
    v_mfma_f32_16x16x32_bf16 v[200:203], v[228:231], v[120:123], v[200:203]
    s_waitcnt lgkmcnt(0)
    v_mfma_f32_16x16x32_bf16 v[196:199], v[212:215], v[116:119], v[196:199]
    v_mfma_f32_16x16x32_bf16 v[196:199], v[216:219], v[124:127], v[196:199]
    v_mfma_f32_16x16x32_bf16 v[204:207], v[216:219], v[128:131], v[204:207]
    v_mfma_f32_16x16x32_bf16 v[204:207], v[212:215], v[120:123], v[204:207]
    s_barrier
    s_add_u32 m0, s24, 0x00002380
    s_nop 0
    buffer_load_dwordx4 v235, s[32:35], s13 offen offset:128 lds
    s_add_u32 m0, s24, 0x00002740
    s_nop 0
    buffer_load_dwordx4 v235, s[32:35], s13 offen offset:192 lds
    s_add_u32 m0, s24, 0x00004380
    s_nop 0
    buffer_load_dwordx4 v235, s[32:35], s14 offen offset:128 lds
    s_add_u32 m0, s24, 0x00004740
    s_nop 0
    buffer_load_dwordx4 v235, s[32:35], s14 offen offset:192 lds
    s_add_u32 m0, s24, 0x00006380
    s_nop 0
    buffer_load_dwordx4 v235, s[32:35], s15 offen offset:128 lds
    s_add_u32 m0, s24, 0x00006740
    s_nop 0
    buffer_load_dwordx4 v235, s[32:35], s15 offen offset:192 lds
    v_bfe_u32 v245, v255, 4, 2
    v_mul_u32_u24 v235, 18, v245
    v_and_b32 v245, 1, v245
    v_xor_b32 v245, 1, v245
    v_lshl_add_u32 v235, v245, 1, v235
    v_bfe_u32 v245, v255, 2, 2
    v_add_u32 v235, v235, v245
    v_mul_u32_u24 v235, 1152, v235
    v_lshrrev_b32 v245, 3, v255
    v_and_b32 v245, 2, v245
    v_xor_b32 v245, v245, v255
    v_and_b32 v245, 3, v245
    v_lshl_add_u32 v235, v245, 4, v235
    s_mul_i32 s64, s53, 82944
    s_mul_i32 s65, s49, 4608
    s_add_u32 s64, s64, s65
    s_lshl_b32 s65, s54, 8
    s_add_u32 s65, s65, s64
    v_add_u32 v235, s65, v235
    s_add_u32 m0, s24, 0x00000380
    s_nop 0
    buffer_load_dwordx4 v235, s[16:19], s43 offen offset:128 lds
    s_add_u32 m0, s24, 0x00000740
    s_nop 0
    buffer_load_dwordx4 v235, s[16:19], s43 offen offset:192 lds
    ds_read_b64_tr_b16 v[208:209], v232 offset:54272
    ds_read_b64_tr_b16 v[210:211], v232 offset:56320
    ds_read_b64_tr_b16 v[212:213], v232 offset:58368
    ds_read_b64_tr_b16 v[214:215], v232 offset:60416
    ds_read_b64_tr_b16 v[216:217], v233 offset:54272
    ds_read_b64_tr_b16 v[218:219], v233 offset:56320
    ds_read_b64_tr_b16 v[220:221], v233 offset:58368
    ds_read_b64_tr_b16 v[222:223], v233 offset:60416
    s_lshl_b32 s3, s53, 3
    s_add_u32 s3, s3, s53
    s_bfe_u32 s3, s3, 0x30001
    v_cvt_pk_bf16_f32 v132, v132, v133
    v_cvt_pk_bf16_f32 v133, v134, v135
    v_cvt_pk_bf16_f32 v134, v136, v137
    v_cvt_pk_bf16_f32 v135, v138, v139
    v_cvt_pk_bf16_f32 v136, v176, v177
    v_cvt_pk_bf16_f32 v137, v178, v179
    v_cvt_pk_bf16_f32 v138, v180, v181
    v_cvt_pk_bf16_f32 v139, v182, v183
    v_cvt_pk_bf16_f32 v140, v184, v185
    v_cvt_pk_bf16_f32 v141, v186, v187
    v_cvt_pk_bf16_f32 v142, v188, v189
    v_cvt_pk_bf16_f32 v143, v190, v191
    v_cvt_pk_bf16_f32 v246, v192, v193
    v_cvt_pk_bf16_f32 v247, v194, v195
    v_cvt_pk_bf16_f32 v248, v196, v197
    v_cvt_pk_bf16_f32 v249, v198, v199
    v_cvt_pk_bf16_f32 v250, v200, v201
    v_cvt_pk_bf16_f32 v251, v202, v203
    v_cvt_pk_bf16_f32 v252, v204, v205
    v_cvt_pk_bf16_f32 v253, v206, v207
    s_add_u32 s68, s63, 0
    buffer_store_dwordx4 v[136:139], v254, s[44:47], s68 offen sc1
    s_cmp_eq_u32 s48, s3
    s_cbranch_scc1 L_own_146
L_ownb_147:
    s_add_u32 s68, s63, 8192
    buffer_store_dwordx4 v[140:143], v254, s[44:47], s68 offen sc1
    s_cmp_eq_u32 s48, s3
    s_cbranch_scc1 L_own_148
L_ownb_149:
    s_add_u32 s68, s63, 16384
    buffer_store_dwordx4 v[246:249], v254, s[44:47], s68 offen sc1
    s_cmp_eq_u32 s48, s3
    s_cbranch_scc1 L_own_150
L_ownb_151:
    s_add_u32 s68, s63, 24576
    buffer_store_dwordx4 v[250:253], v254, s[44:47], s68 offen sc1
    s_cmp_eq_u32 s48, s3
    s_cbranch_scc1 L_own_152
L_ownb_153:
    s_add_u32 s68, s63, 65536
    buffer_store_dwordx4 v[132:135], v254, s[44:47], s68 offen sc1
    s_cmp_eq_u32 s48, s3
    s_cbranch_scc1 L_own_154
L_ownb_155:
    s_waitcnt vmcnt(5)
    s_barrier
    s_waitcnt vmcnt(0)
    s_waitcnt lgkmcnt(0)
    s_buffer_atomic_swap s55, s[44:47], s42 offset:0
    v_mfma_f32_16x16x32_bf16 v[176:179], v[208:211], v[144:147], 0
    ds_read_b64_tr_b16 v[224:225], v232 offset:62464
    v_mfma_f32_16x16x32_bf16 v[176:179], v[212:215], v[152:155], v[176:179]
    ds_read_b64_tr_b16 v[226:227], v232 offset:64512
    v_mfma_f32_16x16x32_bf16 v[184:187], v[212:215], v[156:159], 0
    v_add_u32 v232, 0x0000e400, v232
    ds_read_b64_tr_b16 v[228:229], v232 offset:8192
    v_mfma_f32_16x16x32_bf16 v[184:187], v[208:211], v[148:151], v[184:187]
    ds_read_b64_tr_b16 v[230:231], v232 offset:10240
    v_mfma_f32_16x16x32_bf16 v[180:183], v[216:219], v[144:147], 0
    ds_read_b64_tr_b16 v[208:209], v233 offset:62464
    v_mfma_f32_16x16x32_bf16 v[180:183], v[220:223], v[152:155], v[180:183]
    ds_read_b64_tr_b16 v[210:211], v233 offset:64512
    v_mfma_f32_16x16x32_bf16 v[188:191], v[220:223], v[156:159], 0
    v_add_u32 v233, 0x0000e400, v233
    ds_read_b64_tr_b16 v[212:213], v233 offset:8192
    v_mfma_f32_16x16x32_bf16 v[188:191], v[216:219], v[148:151], v[188:191]
    ds_read_b64_tr_b16 v[214:215], v233 offset:10240
    s_waitcnt lgkmcnt(4)
    v_mfma_f32_16x16x32_bf16 v[176:179], v[224:227], v[160:163], v[176:179]
    ds_read_b64_tr_b16 v[216:217], v232 offset:12288
    v_mfma_f32_16x16x32_bf16 v[176:179], v[228:231], v[168:171], v[176:179]
    ds_read_b64_tr_b16 v[218:219], v232 offset:14336
    v_mfma_f32_16x16x32_bf16 v[184:187], v[228:231], v[172:175], v[184:187]
    ds_read_b64_tr_b16 v[220:221], v232 offset:16384
    v_mfma_f32_16x16x32_bf16 v[184:187], v[224:227], v[164:167], v[184:187]
    ds_read_b64_tr_b16 v[222:223], v232 offset:18432
    s_waitcnt lgkmcnt(4)
    v_mfma_f32_16x16x32_bf16 v[180:183], v[208:211], v[160:163], v[180:183]
    ds_read_b64_tr_b16 v[224:225], v233 offset:12288
    v_mfma_f32_16x16x32_bf16 v[180:183], v[212:215], v[168:171], v[180:183]
    ds_read_b64_tr_b16 v[226:227], v233 offset:14336
    v_mfma_f32_16x16x32_bf16 v[188:191], v[212:215], v[172:175], v[188:191]
    ds_read_b64_tr_b16 v[228:229], v233 offset:16384
    v_mfma_f32_16x16x32_bf16 v[188:191], v[208:211], v[164:167], v[188:191]
    ds_read_b64_tr_b16 v[230:231], v233 offset:18432
    s_waitcnt lgkmcnt(4)
    v_mfma_f32_16x16x32_bf16 v[176:179], v[216:219], v[0:3], v[176:179]
    ds_read_b64_tr_b16 v[208:209], v232 offset:20480
    v_mfma_f32_16x16x32_bf16 v[176:179], v[220:223], v[8:11], v[176:179]
    ds_read_b64_tr_b16 v[210:211], v232 offset:22528
    v_mfma_f32_16x16x32_bf16 v[184:187], v[220:223], v[12:15], v[184:187]
    ds_read_b64_tr_b16 v[212:213], v232 offset:24576
    v_mfma_f32_16x16x32_bf16 v[184:187], v[216:219], v[4:7], v[184:187]
    ds_read_b64_tr_b16 v[214:215], v232 offset:26624
    s_waitcnt lgkmcnt(4)
    v_mfma_f32_16x16x32_bf16 v[180:183], v[224:227], v[0:3], v[180:183]
    ds_read_b64_tr_b16 v[216:217], v233 offset:20480
    v_mfma_f32_16x16x32_bf16 v[180:183], v[228:231], v[8:11], v[180:183]
    ds_read_b64_tr_b16 v[218:219], v233 offset:22528
    v_mfma_f32_16x16x32_bf16 v[188:191], v[228:231], v[12:15], v[188:191]
    ds_read_b64_tr_b16 v[220:221], v233 offset:24576
    v_mfma_f32_16x16x32_bf16 v[188:191], v[224:227], v[4:7], v[188:191]
    ds_read_b64_tr_b16 v[222:223], v233 offset:26624
    s_waitcnt lgkmcnt(4)
    v_mfma_f32_16x16x32_bf16 v[176:179], v[208:211], v[16:19], v[176:179]
    ds_read_b64_tr_b16 v[224:225], v232 offset:28672
    v_mfma_f32_16x16x32_bf16 v[176:179], v[212:215], v[24:27], v[176:179]
    ds_read_b64_tr_b16 v[226:227], v232 offset:30720
    v_mfma_f32_16x16x32_bf16 v[184:187], v[212:215], v[28:31], v[184:187]
    ds_read_b64_tr_b16 v[228:229], v232 offset:32768
    v_mfma_f32_16x16x32_bf16 v[184:187], v[208:211], v[20:23], v[184:187]
    ds_read_b64_tr_b16 v[230:231], v232 offset:34816
    s_waitcnt lgkmcnt(4)
    v_mfma_f32_16x16x32_bf16 v[180:183], v[216:219], v[16:19], v[180:183]
    ds_read_b64_tr_b16 v[208:209], v233 offset:28672
    v_mfma_f32_16x16x32_bf16 v[180:183], v[220:223], v[24:27], v[180:183]
    ds_read_b64_tr_b16 v[210:211], v233 offset:30720
    v_mfma_f32_16x16x32_bf16 v[188:191], v[220:223], v[28:31], v[188:191]
    ds_read_b64_tr_b16 v[212:213], v233 offset:32768
    v_mfma_f32_16x16x32_bf16 v[188:191], v[216:219], v[20:23], v[188:191]
    ds_read_b64_tr_b16 v[214:215], v233 offset:34816
    s_waitcnt lgkmcnt(4)
    v_mfma_f32_16x16x32_bf16 v[176:179], v[224:227], v[32:35], v[176:179]
    ds_read_b64_tr_b16 v[216:217], v232 offset:36864
    v_mfma_f32_16x16x32_bf16 v[176:179], v[228:231], v[40:43], v[176:179]
    ds_read_b64_tr_b16 v[218:219], v232 offset:38912
    v_mfma_f32_16x16x32_bf16 v[184:187], v[228:231], v[44:47], v[184:187]
    ds_read_b64_tr_b16 v[220:221], v232 offset:40960
    v_mfma_f32_16x16x32_bf16 v[184:187], v[224:227], v[36:39], v[184:187]
    ds_read_b64_tr_b16 v[222:223], v232 offset:43008
    s_waitcnt lgkmcnt(4)
    v_mfma_f32_16x16x32_bf16 v[180:183], v[208:211], v[32:35], v[180:183]
    ds_read_b64_tr_b16 v[224:225], v233 offset:36864
    v_mfma_f32_16x16x32_bf16 v[180:183], v[212:215], v[40:43], v[180:183]
    ds_read_b64_tr_b16 v[226:227], v233 offset:38912
    v_mfma_f32_16x16x32_bf16 v[188:191], v[212:215], v[44:47], v[188:191]
    ds_read_b64_tr_b16 v[228:229], v233 offset:40960
    v_mfma_f32_16x16x32_bf16 v[188:191], v[208:211], v[36:39], v[188:191]
    ds_read_b64_tr_b16 v[230:231], v233 offset:43008
    s_waitcnt lgkmcnt(4)
    v_mfma_f32_16x16x32_bf16 v[176:179], v[216:219], v[48:51], v[176:179]
    v_add_u32 v232, 0xfffe3800, v232
    ds_read_b64_tr_b16 v[208:209], v232 offset:1024
    v_mfma_f32_16x16x32_bf16 v[176:179], v[220:223], v[56:59], v[176:179]
    ds_read_b64_tr_b16 v[210:211], v232 offset:3072
    v_mfma_f32_16x16x32_bf16 v[184:187], v[220:223], v[60:63], v[184:187]
    ds_read_b64_tr_b16 v[212:213], v232 offset:5120
    v_mfma_f32_16x16x32_bf16 v[184:187], v[216:219], v[52:55], v[184:187]
    ds_read_b64_tr_b16 v[214:215], v232 offset:7168
    s_waitcnt lgkmcnt(4)
    v_mfma_f32_16x16x32_bf16 v[180:183], v[224:227], v[48:51], v[180:183]
    v_add_u32 v233, 0xfffe3800, v233
    ds_read_b64_tr_b16 v[216:217], v233 offset:1024
    v_mfma_f32_16x16x32_bf16 v[180:183], v[228:231], v[56:59], v[180:183]
    ds_read_b64_tr_b16 v[218:219], v233 offset:3072
    v_mfma_f32_16x16x32_bf16 v[188:191], v[228:231], v[60:63], v[188:191]
    ds_read_b64_tr_b16 v[220:221], v233 offset:5120
    v_mfma_f32_16x16x32_bf16 v[188:191], v[224:227], v[52:55], v[188:191]
    ds_read_b64_tr_b16 v[222:223], v233 offset:7168
    s_waitcnt lgkmcnt(4)
    v_mfma_f32_16x16x32_bf16 v[176:179], v[208:211], v[64:67], v[176:179]
    v_add_u32 v232, 0x00012800, v232
    ds_read_b64_tr_b16 v[224:225], v232 offset:8704
    v_mfma_f32_16x16x32_bf16 v[176:179], v[212:215], v[72:75], v[176:179]
    v_add_u32 v233, 0x00012800, v233
    ds_read_b64_tr_b16 v[228:229], v233 offset:8704
    v_mfma_f32_16x16x32_bf16 v[184:187], v[212:215], v[76:79], v[184:187]
    v_mfma_f32_16x16x32_bf16 v[184:187], v[208:211], v[68:71], v[184:187]
    s_waitcnt lgkmcnt(2)
    v_mfma_f32_16x16x32_bf16 v[180:183], v[216:219], v[64:67], v[180:183]
    v_add_u32 v232, 0xfffedc00, v232
    ds_read_b64_tr_b16 v[208:209], v232 offset:8192
    v_mfma_f32_16x16x32_bf16 v[180:183], v[220:223], v[72:75], v[180:183]
    ds_read_b64_tr_b16 v[210:211], v232 offset:10240
    v_mfma_f32_16x16x32_bf16 v[188:191], v[220:223], v[76:79], v[188:191]
    ds_read_b64_tr_b16 v[212:213], v232 offset:12288
    v_mfma_f32_16x16x32_bf16 v[188:191], v[216:219], v[68:71], v[188:191]
    ds_read_b64_tr_b16 v[214:215], v232 offset:14336
    s_waitcnt lgkmcnt(5)
    v_mfma_f32_16x16x16_bf16 v[176:179], v[224:225], v[80:81], v[176:179]
    v_add_u32 v233, 0xfffedc00, v233
    ds_read_b64_tr_b16 v[216:217], v233 offset:8192
    v_mfma_f32_16x16x16_bf16 v[184:187], v[224:225], v[82:83], v[184:187]
    ds_read_b64_tr_b16 v[218:219], v233 offset:10240
    ds_read_b64_tr_b16 v[220:221], v233 offset:12288
    ds_read_b64_tr_b16 v[222:223], v233 offset:14336
    s_waitcnt lgkmcnt(8)
    v_mfma_f32_16x16x16_bf16 v[180:183], v[228:229], v[80:81], v[180:183]
    ds_read_b64_tr_b16 v[224:225], v232 offset:16384
    v_mfma_f32_16x16x16_bf16 v[188:191], v[228:229], v[82:83], v[188:191]
    ds_read_b64_tr_b16 v[226:227], v232 offset:18432
    s_waitcnt lgkmcnt(6)
    v_mfma_f32_16x16x32_bf16 v[176:179], v[208:211], v[84:87], v[176:179]
    ds_read_b64_tr_b16 v[228:229], v232 offset:20480
    v_mfma_f32_16x16x32_bf16 v[176:179], v[212:215], v[92:95], v[176:179]
    ds_read_b64_tr_b16 v[230:231], v232 offset:22528
    v_mfma_f32_16x16x32_bf16 v[184:187], v[212:215], v[96:99], v[184:187]
    v_mfma_f32_16x16x32_bf16 v[184:187], v[208:211], v[88:91], v[184:187]
    s_waitcnt lgkmcnt(4)
    v_mfma_f32_16x16x32_bf16 v[180:183], v[216:219], v[84:87], v[180:183]
    ds_read_b64_tr_b16 v[208:209], v233 offset:16384
    v_mfma_f32_16x16x32_bf16 v[180:183], v[220:223], v[92:95], v[180:183]
    ds_read_b64_tr_b16 v[210:211], v233 offset:18432
    v_mfma_f32_16x16x32_bf16 v[188:191], v[220:223], v[96:99], v[188:191]
    ds_read_b64_tr_b16 v[212:213], v233 offset:20480
    v_mfma_f32_16x16x32_bf16 v[188:191], v[216:219], v[88:91], v[188:191]
    ds_read_b64_tr_b16 v[214:215], v233 offset:22528
    s_waitcnt lgkmcnt(4)
    v_mfma_f32_16x16x32_bf16 v[176:179], v[224:227], v[100:103], v[176:179]
    ds_read_b64_tr_b16 v[216:217], v232 offset:24576
    v_mfma_f32_16x16x32_bf16 v[176:179], v[228:231], v[108:111], v[176:179]
    ds_read_b64_tr_b16 v[218:219], v232 offset:26624
    v_mfma_f32_16x16x32_bf16 v[184:187], v[228:231], v[112:115], v[184:187]
    ds_read_b64_tr_b16 v[220:221], v232 offset:28672
    v_mfma_f32_16x16x32_bf16 v[184:187], v[224:227], v[104:107], v[184:187]
    ds_read_b64_tr_b16 v[222:223], v232 offset:30720
    s_waitcnt lgkmcnt(4)
    v_mfma_f32_16x16x32_bf16 v[180:183], v[208:211], v[100:103], v[180:183]
    ds_read_b64_tr_b16 v[224:225], v233 offset:24576
    v_mfma_f32_16x16x32_bf16 v[180:183], v[212:215], v[108:111], v[180:183]
    ds_read_b64_tr_b16 v[226:227], v233 offset:26624
    v_mfma_f32_16x16x32_bf16 v[188:191], v[212:215], v[112:115], v[188:191]
    ds_read_b64_tr_b16 v[228:229], v233 offset:28672
    v_mfma_f32_16x16x32_bf16 v[188:191], v[208:211], v[104:107], v[188:191]
    ds_read_b64_tr_b16 v[230:231], v233 offset:30720
    s_waitcnt lgkmcnt(4)
    v_mfma_f32_16x16x32_bf16 v[176:179], v[216:219], v[116:119], v[176:179]
    v_add_u32 v232, 0x00019800, v232
    ds_read_b64_tr_b16 v[208:209], v232 offset:8192
    v_mfma_f32_16x16x32_bf16 v[176:179], v[220:223], v[124:127], v[176:179]
    ds_read_b64_tr_b16 v[210:211], v232 offset:10240
    v_mfma_f32_16x16x32_bf16 v[184:187], v[220:223], v[128:131], v[184:187]
    ds_read_b64_tr_b16 v[212:213], v232 offset:12288
    v_mfma_f32_16x16x32_bf16 v[184:187], v[216:219], v[120:123], v[184:187]
    ds_read_b64_tr_b16 v[214:215], v232 offset:14336
    s_waitcnt lgkmcnt(4)
    v_mfma_f32_16x16x32_bf16 v[180:183], v[224:227], v[116:119], v[180:183]
    v_add_u32 v233, 0x00019800, v233
    ds_read_b64_tr_b16 v[216:217], v233 offset:8192
    v_mfma_f32_16x16x32_bf16 v[180:183], v[228:231], v[124:127], v[180:183]
    ds_read_b64_tr_b16 v[218:219], v233 offset:10240
    v_mfma_f32_16x16x32_bf16 v[188:191], v[228:231], v[128:131], v[188:191]
    ds_read_b64_tr_b16 v[220:221], v233 offset:12288
    v_mfma_f32_16x16x32_bf16 v[188:191], v[224:227], v[120:123], v[188:191]
    ds_read_b64_tr_b16 v[222:223], v233 offset:14336
    s_waitcnt lgkmcnt(4)
    v_mfma_f32_16x16x32_bf16 v[192:195], v[208:211], v[144:147], 0
    ds_read_b64_tr_b16 v[224:225], v232 offset:16384
    v_mfma_f32_16x16x32_bf16 v[192:195], v[212:215], v[152:155], v[192:195]
    ds_read_b64_tr_b16 v[226:227], v232 offset:18432
    v_mfma_f32_16x16x32_bf16 v[200:203], v[212:215], v[156:159], 0
    ds_read_b64_tr_b16 v[228:229], v232 offset:20480
    v_mfma_f32_16x16x32_bf16 v[200:203], v[208:211], v[148:151], v[200:203]
    ds_read_b64_tr_b16 v[230:231], v232 offset:22528
    s_waitcnt lgkmcnt(4)
    v_mfma_f32_16x16x32_bf16 v[196:199], v[216:219], v[144:147], 0
    ds_read_b64_tr_b16 v[208:209], v233 offset:16384
    v_mfma_f32_16x16x32_bf16 v[196:199], v[220:223], v[152:155], v[196:199]
    ds_read_b64_tr_b16 v[210:211], v233 offset:18432
    v_mfma_f32_16x16x32_bf16 v[204:207], v[220:223], v[156:159], 0
    ds_read_b64_tr_b16 v[212:213], v233 offset:20480
    v_mfma_f32_16x16x32_bf16 v[204:207], v[216:219], v[148:151], v[204:207]
    ds_read_b64_tr_b16 v[214:215], v233 offset:22528
    v_cvt_pk_bf16_f32 v246, v176, v177
    v_cvt_pk_bf16_f32 v247, v178, v179
    v_cvt_pk_bf16_f32 v248, v180, v181
    v_cvt_pk_bf16_f32 v249, v182, v183
    s_add_u32 s68, s63, 32768
    buffer_store_dwordx4 v[246:249], v254, s[44:47], s68 offen sc1
    s_cmp_eq_u32 s48, s3
    s_cbranch_scc1 L_own_156
L_ownb_157:
    s_waitcnt lgkmcnt(4)
    v_mfma_f32_16x16x32_bf16 v[192:195], v[224:227], v[160:163], v[192:195]
    ds_read_b64_tr_b16 v[216:217], v232 offset:24576
    v_mfma_f32_16x16x32_bf16 v[192:195], v[228:231], v[168:171], v[192:195]
    ds_read_b64_tr_b16 v[218:219], v232 offset:26624
    v_mfma_f32_16x16x32_bf16 v[200:203], v[228:231], v[172:175], v[200:203]
    ds_read_b64_tr_b16 v[220:221], v232 offset:28672
    v_mfma_f32_16x16x32_bf16 v[200:203], v[224:227], v[164:167], v[200:203]
    ds_read_b64_tr_b16 v[222:223], v232 offset:30720
    v_cvt_pk_bf16_f32 v250, v184, v185
    v_cvt_pk_bf16_f32 v251, v186, v187
    v_cvt_pk_bf16_f32 v252, v188, v189
    v_cvt_pk_bf16_f32 v253, v190, v191
    s_add_u32 s68, s63, 40960
    buffer_store_dwordx4 v[250:253], v254, s[44:47], s68 offen sc1
    s_cmp_eq_u32 s48, s3
    s_cbranch_scc1 L_own_158
L_ownb_159:
    s_waitcnt lgkmcnt(4)
    v_mfma_f32_16x16x32_bf16 v[196:199], v[208:211], v[160:163], v[196:199]
    ds_read_b64_tr_b16 v[224:225], v233 offset:24576
    v_mfma_f32_16x16x32_bf16 v[196:199], v[212:215], v[168:171], v[196:199]
    ds_read_b64_tr_b16 v[226:227], v233 offset:26624
    v_mfma_f32_16x16x32_bf16 v[204:207], v[212:215], v[172:175], v[204:207]
    ds_read_b64_tr_b16 v[228:229], v233 offset:28672
    v_mfma_f32_16x16x32_bf16 v[204:207], v[208:211], v[164:167], v[204:207]
    ds_read_b64_tr_b16 v[230:231], v233 offset:30720
    s_waitcnt lgkmcnt(4)
    v_mfma_f32_16x16x32_bf16 v[192:195], v[216:219], v[0:3], v[192:195]
    ds_read_b64_tr_b16 v[208:209], v232 offset:32768
    v_mfma_f32_16x16x32_bf16 v[192:195], v[220:223], v[8:11], v[192:195]
    ds_read_b64_tr_b16 v[210:211], v232 offset:34816
    v_mfma_f32_16x16x32_bf16 v[200:203], v[220:223], v[12:15], v[200:203]
    ds_read_b64_tr_b16 v[212:213], v232 offset:36864
    v_mfma_f32_16x16x32_bf16 v[200:203], v[216:219], v[4:7], v[200:203]
    ds_read_b64_tr_b16 v[214:215], v232 offset:38912
    s_waitcnt lgkmcnt(4)
    v_mfma_f32_16x16x32_bf16 v[196:199], v[224:227], v[0:3], v[196:199]
    ds_read_b64_tr_b16 v[216:217], v233 offset:32768
    v_mfma_f32_16x16x32_bf16 v[196:199], v[228:231], v[8:11], v[196:199]
    ds_read_b64_tr_b16 v[218:219], v233 offset:34816
    v_mfma_f32_16x16x32_bf16 v[204:207], v[228:231], v[12:15], v[204:207]
    ds_read_b64_tr_b16 v[220:221], v233 offset:36864
    v_mfma_f32_16x16x32_bf16 v[204:207], v[224:227], v[4:7], v[204:207]
    ds_read_b64_tr_b16 v[222:223], v233 offset:38912
    s_waitcnt lgkmcnt(4)
    v_mfma_f32_16x16x32_bf16 v[192:195], v[208:211], v[16:19], v[192:195]
    ds_read_b64_tr_b16 v[224:225], v232 offset:40960
    v_mfma_f32_16x16x32_bf16 v[192:195], v[212:215], v[24:27], v[192:195]
    ds_read_b64_tr_b16 v[226:227], v232 offset:43008
    v_mfma_f32_16x16x32_bf16 v[200:203], v[212:215], v[28:31], v[200:203]
    ds_read_b64_tr_b16 v[228:229], v232 offset:45056
    v_mfma_f32_16x16x32_bf16 v[200:203], v[208:211], v[20:23], v[200:203]
    ds_read_b64_tr_b16 v[230:231], v232 offset:47104
    s_waitcnt lgkmcnt(4)
    v_mfma_f32_16x16x32_bf16 v[196:199], v[216:219], v[16:19], v[196:199]
    ds_read_b64_tr_b16 v[208:209], v233 offset:40960
    v_mfma_f32_16x16x32_bf16 v[196:199], v[220:223], v[24:27], v[196:199]
    ds_read_b64_tr_b16 v[210:211], v233 offset:43008
    v_mfma_f32_16x16x32_bf16 v[204:207], v[220:223], v[28:31], v[204:207]
    ds_read_b64_tr_b16 v[212:213], v233 offset:45056
    v_mfma_f32_16x16x32_bf16 v[204:207], v[216:219], v[20:23], v[204:207]
    ds_read_b64_tr_b16 v[214:215], v233 offset:47104
    s_waitcnt lgkmcnt(4)
    v_mfma_f32_16x16x32_bf16 v[192:195], v[224:227], v[32:35], v[192:195]
    ds_read_b64_tr_b16 v[216:217], v232 offset:49152
    v_mfma_f32_16x16x32_bf16 v[192:195], v[228:231], v[40:43], v[192:195]
    ds_read_b64_tr_b16 v[218:219], v232 offset:51200
    v_mfma_f32_16x16x32_bf16 v[200:203], v[228:231], v[44:47], v[200:203]
    ds_read_b64_tr_b16 v[220:221], v232 offset:53248
    v_mfma_f32_16x16x32_bf16 v[200:203], v[224:227], v[36:39], v[200:203]
    ds_read_b64_tr_b16 v[222:223], v232 offset:55296
    s_waitcnt lgkmcnt(4)
    v_mfma_f32_16x16x32_bf16 v[196:199], v[208:211], v[32:35], v[196:199]
    ds_read_b64_tr_b16 v[224:225], v233 offset:49152
    v_mfma_f32_16x16x32_bf16 v[196:199], v[212:215], v[40:43], v[196:199]
    ds_read_b64_tr_b16 v[226:227], v233 offset:51200
    v_mfma_f32_16x16x32_bf16 v[204:207], v[212:215], v[44:47], v[204:207]
    ds_read_b64_tr_b16 v[228:229], v233 offset:53248
    v_mfma_f32_16x16x32_bf16 v[204:207], v[208:211], v[36:39], v[204:207]
    ds_read_b64_tr_b16 v[230:231], v233 offset:55296
    s_waitcnt lgkmcnt(4)
    v_mfma_f32_16x16x32_bf16 v[192:195], v[216:219], v[48:51], v[192:195]
    v_add_u32 v232, 0xfffe6400, v232
    ds_read_b64_tr_b16 v[208:209], v232 offset:2048
    v_mfma_f32_16x16x32_bf16 v[192:195], v[220:223], v[56:59], v[192:195]
    ds_read_b64_tr_b16 v[210:211], v232 offset:4096
    v_mfma_f32_16x16x32_bf16 v[200:203], v[220:223], v[60:63], v[200:203]
    ds_read_b64_tr_b16 v[212:213], v232 offset:6144
    v_mfma_f32_16x16x32_bf16 v[200:203], v[216:219], v[52:55], v[200:203]
    ds_read_b64_tr_b16 v[214:215], v232 offset:8192
    s_waitcnt lgkmcnt(4)
    v_mfma_f32_16x16x32_bf16 v[196:199], v[224:227], v[48:51], v[196:199]
    v_add_u32 v233, 0xfffe6400, v233
    ds_read_b64_tr_b16 v[216:217], v233 offset:2048
    v_mfma_f32_16x16x32_bf16 v[196:199], v[228:231], v[56:59], v[196:199]
    ds_read_b64_tr_b16 v[218:219], v233 offset:4096
    v_mfma_f32_16x16x32_bf16 v[204:207], v[228:231], v[60:63], v[204:207]
    ds_read_b64_tr_b16 v[220:221], v233 offset:6144
    v_mfma_f32_16x16x32_bf16 v[204:207], v[224:227], v[52:55], v[204:207]
    ds_read_b64_tr_b16 v[222:223], v233 offset:8192
    s_waitcnt lgkmcnt(4)
    v_mfma_f32_16x16x32_bf16 v[192:195], v[208:211], v[64:67], v[192:195]
    v_add_u32 v232, 0x00012c00, v232
    ds_read_b64_tr_b16 v[224:225], v232 offset:8704
    v_mfma_f32_16x16x32_bf16 v[192:195], v[212:215], v[72:75], v[192:195]
    v_add_u32 v233, 0x00012c00, v233
    ds_read_b64_tr_b16 v[228:229], v233 offset:8704
    v_mfma_f32_16x16x32_bf16 v[200:203], v[212:215], v[76:79], v[200:203]
    v_mfma_f32_16x16x32_bf16 v[200:203], v[208:211], v[68:71], v[200:203]
    s_waitcnt lgkmcnt(2)
    v_mfma_f32_16x16x32_bf16 v[196:199], v[216:219], v[64:67], v[196:199]
    v_add_u32 v232, 0xfffedc00, v232
    ds_read_b64_tr_b16 v[208:209], v232 offset:8192
    v_mfma_f32_16x16x32_bf16 v[196:199], v[220:223], v[72:75], v[196:199]
    ds_read_b64_tr_b16 v[210:211], v232 offset:10240
    v_mfma_f32_16x16x32_bf16 v[204:207], v[220:223], v[76:79], v[204:207]
    ds_read_b64_tr_b16 v[212:213], v232 offset:12288
    v_mfma_f32_16x16x32_bf16 v[204:207], v[216:219], v[68:71], v[204:207]
    ds_read_b64_tr_b16 v[214:215], v232 offset:14336
    s_waitcnt lgkmcnt(5)
    v_mfma_f32_16x16x16_bf16 v[192:195], v[224:225], v[80:81], v[192:195]
    v_add_u32 v233, 0xfffedc00, v233
    ds_read_b64_tr_b16 v[216:217], v233 offset:8192
    v_mfma_f32_16x16x16_bf16 v[200:203], v[224:225], v[82:83], v[200:203]
    ds_read_b64_tr_b16 v[218:219], v233 offset:10240
    ds_read_b64_tr_b16 v[220:221], v233 offset:12288
    ds_read_b64_tr_b16 v[222:223], v233 offset:14336
    s_waitcnt lgkmcnt(8)
    v_mfma_f32_16x16x16_bf16 v[196:199], v[228:229], v[80:81], v[196:199]
    ds_read_b64_tr_b16 v[224:225], v232 offset:16384
    v_mfma_f32_16x16x16_bf16 v[204:207], v[228:229], v[82:83], v[204:207]
    ds_read_b64_tr_b16 v[226:227], v232 offset:18432
    s_waitcnt lgkmcnt(6)
    v_mfma_f32_16x16x32_bf16 v[192:195], v[208:211], v[84:87], v[192:195]
    ds_read_b64_tr_b16 v[228:229], v232 offset:20480
    v_mfma_f32_16x16x32_bf16 v[192:195], v[212:215], v[92:95], v[192:195]
    ds_read_b64_tr_b16 v[230:231], v232 offset:22528
    v_mfma_f32_16x16x32_bf16 v[200:203], v[212:215], v[96:99], v[200:203]
    v_mfma_f32_16x16x32_bf16 v[200:203], v[208:211], v[88:91], v[200:203]
    s_waitcnt lgkmcnt(4)
    v_mfma_f32_16x16x32_bf16 v[196:199], v[216:219], v[84:87], v[196:199]
    ds_read_b64_tr_b16 v[208:209], v233 offset:16384
    v_mfma_f32_16x16x32_bf16 v[196:199], v[220:223], v[92:95], v[196:199]
    ds_read_b64_tr_b16 v[210:211], v233 offset:18432
    v_mfma_f32_16x16x32_bf16 v[204:207], v[220:223], v[96:99], v[204:207]
    ds_read_b64_tr_b16 v[212:213], v233 offset:20480
    v_mfma_f32_16x16x32_bf16 v[204:207], v[216:219], v[88:91], v[204:207]
    ds_read_b64_tr_b16 v[214:215], v233 offset:22528
    s_waitcnt lgkmcnt(4)
    v_mfma_f32_16x16x32_bf16 v[192:195], v[224:227], v[100:103], v[192:195]
    ds_read_b64_tr_b16 v[216:217], v232 offset:24576
    v_mfma_f32_16x16x32_bf16 v[192:195], v[228:231], v[108:111], v[192:195]
    ds_read_b64_tr_b16 v[218:219], v232 offset:26624
    v_mfma_f32_16x16x32_bf16 v[200:203], v[228:231], v[112:115], v[200:203]
    ds_read_b64_tr_b16 v[220:221], v232 offset:28672
    v_mfma_f32_16x16x32_bf16 v[200:203], v[224:227], v[104:107], v[200:203]
    ds_read_b64_tr_b16 v[222:223], v232 offset:30720
    s_waitcnt lgkmcnt(4)
    v_mfma_f32_16x16x32_bf16 v[196:199], v[208:211], v[100:103], v[196:199]
    ds_read_b64_tr_b16 v[224:225], v233 offset:24576
    v_mfma_f32_16x16x32_bf16 v[196:199], v[212:215], v[108:111], v[196:199]
    ds_read_b64_tr_b16 v[226:227], v233 offset:26624
    v_mfma_f32_16x16x32_bf16 v[204:207], v[212:215], v[112:115], v[204:207]
    ds_read_b64_tr_b16 v[228:229], v233 offset:28672
    v_mfma_f32_16x16x32_bf16 v[204:207], v[208:211], v[104:107], v[204:207]
    ds_read_b64_tr_b16 v[230:231], v233 offset:30720
    s_waitcnt lgkmcnt(4)
    v_mfma_f32_16x16x32_bf16 v[192:195], v[216:219], v[116:119], v[192:195]
    v_mfma_f32_16x16x32_bf16 v[192:195], v[220:223], v[124:127], v[192:195]
    v_mfma_f32_16x16x32_bf16 v[200:203], v[220:223], v[128:131], v[200:203]
    v_mfma_f32_16x16x32_bf16 v[200:203], v[216:219], v[120:123], v[200:203]
    s_waitcnt lgkmcnt(0)
    v_mfma_f32_16x16x32_bf16 v[196:199], v[224:227], v[116:119], v[196:199]
    v_mfma_f32_16x16x32_bf16 v[196:199], v[228:231], v[124:127], v[196:199]
    v_mfma_f32_16x16x32_bf16 v[204:207], v[228:231], v[128:131], v[204:207]
    v_mfma_f32_16x16x32_bf16 v[204:207], v[224:227], v[120:123], v[204:207]
    s_waitcnt vmcnt(0)
    s_waitcnt lgkmcnt(0)
    s_buffer_atomic_swap s55, s[44:47], s42 offset:32
    v_cvt_pk_bf16_f32 v246, v192, v193
    v_cvt_pk_bf16_f32 v247, v194, v195
    s_nop 0
    v_cvt_pk_bf16_f32 v248, v196, v197
    v_cvt_pk_bf16_f32 v249, v198, v199
    s_add_u32 s68, s63, 49152
    buffer_store_dwordx4 v[246:249], v254, s[44:47], s68 offen sc1
    s_cmp_eq_u32 s48, s3
    s_cbranch_scc1 L_own_160
L_ownb_161:
    v_cvt_pk_bf16_f32 v250, v200, v201
    v_cvt_pk_bf16_f32 v251, v202, v203
    v_cvt_pk_bf16_f32 v252, v204, v205
    v_cvt_pk_bf16_f32 v253, v206, v207
    s_add_u32 s68, s63, 57344
    buffer_store_dwordx4 v[250:253], v254, s[44:47], s68 offen sc1
    s_cmp_eq_u32 s48, s3
    s_cbranch_scc1 L_own_162
L_ownb_163:
    s_lshl_b32 s59, s52, 2
    s_add_u32 s59, s59, s54
    s_lshl_b32 s59, s59, 3
    s_waitcnt vmcnt(0)
    s_waitcnt lgkmcnt(0)
    s_buffer_atomic_swap s55, s[44:47], s42 offset:64
    s_cmp_lg_u32 s49, 0
    s_cbranch_scc1 L_noodd_164
    s_mov_b32 s56, 8
    s_lshl_b32 s64, s52, 3
    s_add_u32 s64, s64, s3
    s_lshl_b32 s64, s64, 1
    s_mul_i32 s64, s64, 18432
    s_lshl_b32 s66, s54, 9
    s_add_u32 s66, s66, s64
    s_add_u32 s66, s66, 11550720
    v_lshlrev_b32 v41, 3, v255
    buffer_load_dwordx2 v[32:33], v41, s[44:47], s66 offen sc1
    s_add_u32 s66, s66, 18432
    buffer_load_dwordx2 v[34:35], v41, s[44:47], s66 offen sc1
    s_lshl_b32 s65, s54, 5
    s_add_u32 s65, s65, 1024
    s_add_u32 s57, s65, s64
    v_and_b32 v41, 15, v255
    v_mul_u32_u24 v40, 1152, v41
    v_lshrrev_b32 v41, 4, v255
    v_lshl_add_u32 v42, v41, 3, v40
    v_lshrrev_b32 v42, 1, v41
    v_lshl_add_u32 v40, v42, 4, v40
    v_and_b32 v41, 1, v41
    v_mul_u32_u24 v41, 18432, v41
    v_add_u32 v40, v40, v41
    s_add_u32 s64, s59, s3
    s_lshl_b32 s69, s64, 7
    s_add_u32 s69, s69, 512000
    s_mul_i32 s68, s64, 73728
    s_lshl_b32 s65, s56, 13
    s_add_u32 s68, s68, s65
    s_add_u32 s68, s68, 33554432
    s_add_u32 s67, s68, 4096
    s_buffer_load_dwordx8 s[92:99], s[44:47], s69 glc
    s_add_u32 s64, s53, 1
    s_and_b32 s64, s64, 7
    s_lshl_b32 s64, s64, 10
    s_add_u32 s9, s64, s68
    s_add_u32 s64, s53, 2
    s_and_b32 s64, s64, 7
    s_lshl_b32 s64, s64, 10
    s_add_u32 s10, s64, s68
    s_add_u32 s64, s53, 3
    s_and_b32 s64, s64, 7
    s_lshl_b32 s64, s64, 10
    s_add_u32 s11, s64, s68
    s_add_u32 s64, s53, 4
    s_and_b32 s64, s64, 7
    s_lshl_b32 s64, s64, 10
    s_add_u32 s12, s64, s68
    s_add_u32 s64, s53, 5
    s_and_b32 s64, s64, 7
    s_lshl_b32 s64, s64, 10
    s_add_u32 s13, s64, s68
    s_add_u32 s64, s53, 6
    s_and_b32 s64, s64, 7
    s_lshl_b32 s64, s64, 10
    s_add_u32 s14, s64, s68
    s_add_u32 s64, s53, 7
    s_and_b32 s64, s64, 7
    s_lshl_b32 s64, s64, 10
    s_add_u32 s15, s64, s68
    s_cmp_ge_u32 s56, 7
    s_cselect_b32 s65, 0, 0
    s_lshl_b32 s64, s56, 10
    s_add_u32 s64, s64, 40960
    s_add_u32 s64, s64, s65
    v_add_u32 v43, s64, v254
    s_waitcnt lgkmcnt(0)
    s_xor_b32 s92, s92, s55
    s_xor_b32 s93, s93, s55
    s_xor_b32 s94, s94, s55
    s_xor_b32 s95, s95, s55
    s_xor_b32 s96, s96, s55
    s_xor_b32 s97, s97, s55
    s_xor_b32 s98, s98, s55
    s_xor_b32 s99, s99, s55
    s_or_b64 s[92:93], s[92:93], s[98:99]
    s_or_b64 s[92:93], s[92:93], s[96:97]
    s_or_b64 s[92:93], s[92:93], s[94:95]
    s_cbranch_scc1 L_pslow_165
L_pback_166:
    buffer_load_dwordx4 v[4:7], v254, s[44:47], s9 offen sc1
    buffer_load_dwordx4 v[8:11], v254, s[44:47], s10 offen sc1
    buffer_load_dwordx4 v[12:15], v254, s[44:47], s11 offen sc1
    buffer_load_dwordx4 v[16:19], v254, s[44:47], s12 offen sc1
    buffer_load_dwordx4 v[20:23], v254, s[44:47], s13 offen sc1
    buffer_load_dwordx4 v[24:27], v254, s[44:47], s14 offen sc1
    buffer_load_dwordx4 v[28:31], v254, s[44:47], s15 offen sc1
    ds_read_b128 v[0:3], v43
    s_waitcnt vmcnt(8)
    v_lshlrev_b32 v44, 16, v32
    v_and_b32 v45, 0xffff0000, v32
    v_lshlrev_b32 v46, 16, v33
    v_and_b32 v47, 0xffff0000, v33
    s_waitcnt vmcnt(7)
    v_lshlrev_b32 v48, 16, v34
    v_and_b32 v49, 0xffff0000, v34
    v_lshlrev_b32 v50, 16, v35
    v_and_b32 v51, 0xffff0000, v35
    s_waitcnt lgkmcnt(0)
    v_lshlrev_b32 v52, 16, v0
    v_and_b32 v0, 0xffff0000, v0
    v_lshlrev_b32 v53, 16, v1
    v_and_b32 v1, 0xffff0000, v1
    v_lshlrev_b32 v54, 16, v2
    v_and_b32 v2, 0xffff0000, v2
    v_lshlrev_b32 v55, 16, v3
    v_and_b32 v3, 0xffff0000, v3
    v_add_f32 v44, v44, v52
    v_add_f32 v45, v45, v0
    v_add_f32 v46, v46, v53
    v_add_f32 v47, v47, v1
    v_add_f32 v48, v48, v54
    v_add_f32 v49, v49, v2
    v_add_f32 v50, v50, v55
    v_add_f32 v51, v51, v3
    s_waitcnt vmcnt(6)
    v_lshlrev_b32 v52, 16, v4
    v_and_b32 v4, 0xffff0000, v4
    v_lshlrev_b32 v53, 16, v5
    v_and_b32 v5, 0xffff0000, v5
    v_lshlrev_b32 v54, 16, v6
    v_and_b32 v6, 0xffff0000, v6
    v_lshlrev_b32 v55, 16, v7
    v_and_b32 v7, 0xffff0000, v7
    v_add_f32 v44, v44, v52
    v_add_f32 v45, v45, v4
    v_add_f32 v46, v46, v53
    v_add_f32 v47, v47, v5
    v_add_f32 v48, v48, v54
    v_add_f32 v49, v49, v6
    v_add_f32 v50, v50, v55
    v_add_f32 v51, v51, v7
    s_waitcnt vmcnt(5)
    v_lshlrev_b32 v52, 16, v8
    v_and_b32 v8, 0xffff0000, v8
    v_lshlrev_b32 v53, 16, v9
    v_and_b32 v9, 0xffff0000, v9
    v_lshlrev_b32 v54, 16, v10
    v_and_b32 v10, 0xffff0000, v10
    v_lshlrev_b32 v55, 16, v11
    v_and_b32 v11, 0xffff0000, v11
    v_add_f32 v44, v44, v52
    v_add_f32 v45, v45, v8
    v_add_f32 v46, v46, v53
    v_add_f32 v47, v47, v9
    v_add_f32 v48, v48, v54
    v_add_f32 v49, v49, v10
    v_add_f32 v50, v50, v55
    v_add_f32 v51, v51, v11
    s_waitcnt vmcnt(4)
    v_lshlrev_b32 v52, 16, v12
    v_and_b32 v12, 0xffff0000, v12
    v_lshlrev_b32 v53, 16, v13
    v_and_b32 v13, 0xffff0000, v13
    v_lshlrev_b32 v54, 16, v14
    v_and_b32 v14, 0xffff0000, v14
    v_lshlrev_b32 v55, 16, v15
    v_and_b32 v15, 0xffff0000, v15
    v_add_f32 v44, v44, v52
    v_add_f32 v45, v45, v12
    v_add_f32 v46, v46, v53
    v_add_f32 v47, v47, v13
    v_add_f32 v48, v48, v54
    v_add_f32 v49, v49, v14
    v_add_f32 v50, v50, v55
    v_add_f32 v51, v51, v15
    s_waitcnt vmcnt(3)
    v_lshlrev_b32 v52, 16, v16
    v_and_b32 v16, 0xffff0000, v16
    v_lshlrev_b32 v53, 16, v17
    v_and_b32 v17, 0xffff0000, v17
    v_lshlrev_b32 v54, 16, v18
    v_and_b32 v18, 0xffff0000, v18
    v_lshlrev_b32 v55, 16, v19
    v_and_b32 v19, 0xffff0000, v19
    v_add_f32 v44, v44, v52
    v_add_f32 v45, v45, v16
    v_add_f32 v46, v46, v53
    v_add_f32 v47, v47, v17
    v_add_f32 v48, v48, v54
    v_add_f32 v49, v49, v18
    v_add_f32 v50, v50, v55
    v_add_f32 v51, v51, v19
    s_waitcnt vmcnt(2)
    v_lshlrev_b32 v52, 16, v20
    v_and_b32 v20, 0xffff0000, v20
    v_lshlrev_b32 v53, 16, v21
    v_and_b32 v21, 0xffff0000, v21
    v_lshlrev_b32 v54, 16, v22
    v_and_b32 v22, 0xffff0000, v22
    v_lshlrev_b32 v55, 16, v23
    v_and_b32 v23, 0xffff0000, v23
    v_add_f32 v44, v44, v52
    v_add_f32 v45, v45, v20
    v_add_f32 v46, v46, v53
    v_add_f32 v47, v47, v21
    v_add_f32 v48, v48, v54
    v_add_f32 v49, v49, v22
    v_add_f32 v50, v50, v55
    v_add_f32 v51, v51, v23
    s_waitcnt vmcnt(1)
    v_lshlrev_b32 v52, 16, v24
    v_and_b32 v24, 0xffff0000, v24
    v_lshlrev_b32 v53, 16, v25
    v_and_b32 v25, 0xffff0000, v25
    v_lshlrev_b32 v54, 16, v26
    v_and_b32 v26, 0xffff0000, v26
    v_lshlrev_b32 v55, 16, v27
    v_and_b32 v27, 0xffff0000, v27
    v_add_f32 v44, v44, v52
    v_add_f32 v45, v45, v24
    v_add_f32 v46, v46, v53
    v_add_f32 v47, v47, v25
    v_add_f32 v48, v48, v54
    v_add_f32 v49, v49, v26
    v_add_f32 v50, v50, v55
    v_add_f32 v51, v51, v27
    s_waitcnt vmcnt(0)
    v_lshlrev_b32 v52, 16, v28
    v_and_b32 v28, 0xffff0000, v28
    v_lshlrev_b32 v53, 16, v29
    v_and_b32 v29, 0xffff0000, v29
    v_lshlrev_b32 v54, 16, v30
    v_and_b32 v30, 0xffff0000, v30
    v_lshlrev_b32 v55, 16, v31
    v_and_b32 v31, 0xffff0000, v31
    v_add_f32 v44, v44, v52
    v_add_f32 v45, v45, v28
    v_add_f32 v46, v46, v53
    v_add_f32 v47, v47, v29
    v_add_f32 v48, v48, v54
    v_add_f32 v49, v49, v30
    v_add_f32 v50, v50, v55
    v_add_f32 v51, v51, v31
    v_cvt_pk_bf16_f32 v56, v44, v45
    v_cvt_pk_bf16_f32 v57, v46, v47
    v_cvt_pk_bf16_f32 v58, v48, v49
    v_cvt_pk_bf16_f32 v59, v50, v51
    s_nop 0
    v_permlane16_swap_b32 v56, v58
    v_permlane16_swap_b32 v57, v59
    buffer_store_dwordx4 v[56:59], v40, s[36:39], s57 offen sc1
L_noodd_164:
    s_nop 1
    s_endpgm
L_pslow_88:
    s_mov_b32 s62, 0
L_ploop_90:
    s_buffer_load_dwordx4 s[64:67], s[44:47], s100 glc
    s_add_u32 s62, s62, 1
    s_cmp_ge_u32 s62, 40000
    s_cbranch_scc1 L_pgive_91
    s_waitcnt lgkmcnt(0)
    s_xor_b32 s64, s64, s55
    s_xor_b32 s65, s65, s55
    s_xor_b32 s66, s66, s55
    s_xor_b32 s67, s67, s55
    s_or_b64 s[64:65], s[64:65], s[66:67]
    s_cbranch_scc1 L_ploop_90
L_pgive_91:
    s_waitcnt lgkmcnt(0)
    s_branch L_pback_89
L_rol_92:
    s_buffer_atomic_swap s55, s[44:47], s101 offset:0
    s_buffer_atomic_swap s55, s[44:47], s101 offset:128
    s_branch L_rolb_93
L_rol_94:
    s_barrier
    s_branch L_rolb_95
L_pslow_96:
    s_mov_b32 s62, 0
L_ploop_98:
    s_buffer_load_dwordx8 s[92:99], s[44:47], s40 glc
    s_add_u32 s62, s62, 1
    s_cmp_ge_u32 s62, 40000
    s_cbranch_scc1 L_pgive_99
    s_waitcnt lgkmcnt(0)
    s_xor_b32 s92, s92, s55
    s_xor_b32 s93, s93, s55
    s_xor_b32 s94, s94, s55
    s_xor_b32 s95, s95, s55
    s_xor_b32 s96, s96, s55
    s_or_b32 s92, s92, s96
    s_or_b64 s[92:93], s[92:93], s[94:95]
    s_cbranch_scc1 L_ploop_98
L_pgive_99:
    s_waitcnt lgkmcnt(0)
    s_branch L_pback_97
L_pslow_100:
    s_mov_b32 s62, 0
L_ploop_102:
    s_buffer_load_dwordx4 s[92:95], s[44:47], s40 offset:32 glc
    s_add_u32 s62, s62, 1
    s_cmp_ge_u32 s62, 40000
    s_cbranch_scc1 L_pgive_103
    s_waitcnt lgkmcnt(0)
    s_xor_b32 s92, s92, s55
    s_xor_b32 s93, s93, s55
    s_xor_b32 s94, s94, s55
    s_xor_b32 s95, s95, s55
    s_or_b64 s[92:93], s[92:93], s[94:95]
    s_cbranch_scc1 L_ploop_102
L_pgive_103:
    s_waitcnt lgkmcnt(0)
    s_branch L_pback_101
L_pslow_104:
    s_mov_b32 s62, 0
L_ploop_106:
    s_buffer_load_dwordx4 s[92:95], s[44:47], s69 glc
    s_add_u32 s62, s62, 1
    s_cmp_ge_u32 s62, 40000
    s_cbranch_scc1 L_pgive_107
    s_waitcnt lgkmcnt(0)
    s_xor_b32 s92, s92, s55
    s_xor_b32 s93, s93, s55
    s_xor_b32 s94, s94, s55
    s_xor_b32 s95, s95, s55
    s_or_b64 s[92:93], s[92:93], s[94:95]
    s_cbranch_scc1 L_ploop_106
L_pgive_107:
    s_waitcnt lgkmcnt(0)
    s_branch L_pback_105
L_own_108:
    v_add_u32 v245, 40960, v254
    ds_write_b128 v245, v[136:139]
    s_branch L_ownb_109
L_own_110:
    v_add_u32 v245, 41984, v254
    ds_write_b128 v245, v[140:143]
    s_branch L_ownb_111
L_own_112:
    v_add_u32 v245, 43008, v254
    ds_write_b128 v245, v[246:249]
    s_branch L_ownb_113
L_own_114:
    v_add_u32 v245, 44032, v254
    ds_write_b128 v245, v[250:253]
    s_branch L_ownb_115
L_own_116:
    v_add_u32 v245, 49152, v254
    ds_write_b128 v245, v[132:135]
    s_branch L_ownb_117
L_own_118:
    v_add_u32 v245, 45056, v254
    ds_write_b128 v245, v[246:249]
    s_branch L_ownb_119
L_own_120:
    v_add_u32 v245, 46080, v254
    ds_write_b128 v245, v[250:253]
    s_branch L_ownb_121
L_own_122:
    v_add_u32 v245, 47104, v254
    ds_write_b128 v245, v[246:249]
    s_branch L_ownb_123
L_own_124:
    v_add_u32 v245, 48128, v254
    ds_write_b128 v245, v[250:253]
    s_branch L_ownb_125
L_pslow_126:
    s_mov_b32 s62, 0
L_ploop_128:
    s_buffer_load_dwordx8 s[92:99], s[44:47], s69 glc
    s_add_u32 s62, s62, 1
    s_cmp_ge_u32 s62, 40000
    s_cbranch_scc1 L_pgive_129
    s_waitcnt lgkmcnt(0)
    s_xor_b32 s92, s92, s55
    s_xor_b32 s93, s93, s55
    s_xor_b32 s94, s94, s55
    s_xor_b32 s95, s95, s55
    s_xor_b32 s96, s96, s55
    s_xor_b32 s97, s97, s55
    s_xor_b32 s98, s98, s55
    s_xor_b32 s99, s99, s55
    s_or_b64 s[92:93], s[92:93], s[98:99]
    s_or_b64 s[92:93], s[92:93], s[96:97]
    s_or_b64 s[92:93], s[92:93], s[94:95]
    s_cbranch_scc1 L_ploop_128
L_pgive_129:
    s_waitcnt lgkmcnt(0)
    s_branch L_pback_127
L_pslow_130:
    s_mov_b32 s62, 0
L_ploop_132:
    s_buffer_load_dwordx8 s[92:99], s[44:47], s69 glc
    s_add_u32 s62, s62, 1
    s_cmp_ge_u32 s62, 40000
    s_cbranch_scc1 L_pgive_133
    s_waitcnt lgkmcnt(0)
    s_xor_b32 s92, s92, s55
    s_xor_b32 s93, s93, s55
    s_xor_b32 s94, s94, s55
    s_xor_b32 s95, s95, s55
    s_xor_b32 s96, s96, s55
    s_xor_b32 s97, s97, s55
    s_xor_b32 s98, s98, s55
    s_xor_b32 s99, s99, s55
    s_or_b64 s[92:93], s[92:93], s[98:99]
    s_or_b64 s[92:93], s[92:93], s[96:97]
    s_or_b64 s[92:93], s[92:93], s[94:95]
    s_cbranch_scc1 L_ploop_132
L_pgive_133:
    s_waitcnt lgkmcnt(0)
    s_branch L_pback_131
L_rol_134:
    s_barrier
    s_branch L_rolb_135
L_rol_136:
    s_buffer_atomic_swap s55, s[44:47], s101 offset:0
    s_buffer_atomic_swap s55, s[44:47], s101 offset:128
    s_buffer_atomic_swap s55, s[44:47], s101 offset:256
    s_buffer_atomic_swap s55, s[44:47], s101 offset:384
    s_branch L_rolb_137
L_pslow_138:
    s_mov_b32 s62, 0
L_ploop_140:
    s_buffer_load_dwordx8 s[92:99], s[44:47], s40 glc
    s_add_u32 s62, s62, 1
    s_cmp_ge_u32 s62, 40000
    s_cbranch_scc1 L_pgive_141
    s_waitcnt lgkmcnt(0)
    s_xor_b32 s92, s92, s55
    s_xor_b32 s93, s93, s55
    s_xor_b32 s94, s94, s55
    s_xor_b32 s95, s95, s55
    s_xor_b32 s96, s96, s55
    s_or_b32 s92, s92, s96
    s_or_b64 s[92:93], s[92:93], s[94:95]
    s_cbranch_scc1 L_ploop_140
L_pgive_141:
    s_waitcnt lgkmcnt(0)
    s_branch L_pback_139
L_pslow_142:
    s_mov_b32 s62, 0
L_ploop_144:
    s_buffer_load_dwordx4 s[92:95], s[44:47], s40 offset:32 glc
    s_add_u32 s62, s62, 1
    s_cmp_ge_u32 s62, 40000
    s_cbranch_scc1 L_pgive_145
    s_waitcnt lgkmcnt(0)
    s_xor_b32 s92, s92, s55
    s_xor_b32 s93, s93, s55
    s_xor_b32 s94, s94, s55
    s_xor_b32 s95, s95, s55
    s_or_b64 s[92:93], s[92:93], s[94:95]
    s_cbranch_scc1 L_ploop_144
L_pgive_145:
    s_waitcnt lgkmcnt(0)
    s_branch L_pback_143
L_own_146:
    v_add_u32 v245, 40960, v254
    ds_write_b128 v245, v[136:139]
    s_branch L_ownb_147
L_own_148:
    v_add_u32 v245, 41984, v254
    ds_write_b128 v245, v[140:143]
    s_branch L_ownb_149
L_own_150:
    v_add_u32 v245, 43008, v254
    ds_write_b128 v245, v[246:249]
    s_branch L_ownb_151
L_own_152:
    v_add_u32 v245, 44032, v254
    ds_write_b128 v245, v[250:253]
    s_branch L_ownb_153
L_own_154:
    v_add_u32 v245, 49152, v254
    ds_write_b128 v245, v[132:135]
    s_branch L_ownb_155
L_own_156:
    v_add_u32 v245, 45056, v254
    ds_write_b128 v245, v[246:249]
    s_branch L_ownb_157
L_own_158:
    v_add_u32 v245, 46080, v254
    ds_write_b128 v245, v[250:253]
    s_branch L_ownb_159
L_own_160:
    v_add_u32 v245, 47104, v254
    ds_write_b128 v245, v[246:249]
    s_branch L_ownb_161
L_own_162:
    v_add_u32 v245, 48128, v254
    ds_write_b128 v245, v[250:253]
    s_branch L_ownb_163
L_pslow_165:
    s_mov_b32 s62, 0
L_ploop_167:
    s_buffer_load_dwordx8 s[92:99], s[44:47], s69 glc
    s_add_u32 s62, s62, 1
    s_cmp_ge_u32 s62, 40000
    s_cbranch_scc1 L_pgive_168
    s_waitcnt lgkmcnt(0)
    s_xor_b32 s92, s92, s55
    s_xor_b32 s93, s93, s55
    s_xor_b32 s94, s94, s55
    s_xor_b32 s95, s95, s55
    s_xor_b32 s96, s96, s55
    s_xor_b32 s97, s97, s55
    s_xor_b32 s98, s98, s55
    s_xor_b32 s99, s99, s55
    s_or_b64 s[92:93], s[92:93], s[98:99]
    s_or_b64 s[92:93], s[92:93], s[96:97]
    s_or_b64 s[92:93], s[92:93], s[94:95]
    s_cbranch_scc1 L_ploop_167
L_pgive_168:
    s_waitcnt lgkmcnt(0)
    s_branch L_pback_166
L_code_end:
.section .rodata,"a"
.p2align 6
.amdhsa_kernel parallel_sum__linear_kernel_hedgehog__mixer_s_mlp__prompt_kernel
  .amdhsa_next_free_vgpr 256
  .amdhsa_next_free_sgpr 102
  .amdhsa_accum_offset 256
  .amdhsa_group_segment_fixed_size 0
  .amdhsa_kernarg_size 96
  .amdhsa_user_sgpr_count 2
  .amdhsa_user_sgpr_kernarg_segment_ptr 1
  .amdhsa_system_sgpr_workgroup_id_x 1
.end_amdhsa_kernel
```
